```python
import torch

def _softmax(x, axis=-1):
    return torch.softmax(x, dim=axis)
def _gelu(x):
    return torch.nn.functional.gelu(x, approximate="tanh")
def _silu(x):
    return torch.nn.functional.silu(x)
def _sigmoid(x):
    return torch.sigmoid(x)
def _layernorm(x, axis=-1, eps=1e-5):
    m = x.mean(dim=axis, keepdim=True)
    v = x.var(dim=axis, keepdim=True, unbiased=False)
    return (x - m) / torch.sqrt(v + eps)
def _scatter_add(tgt, idx, src, axis=0):
    return tgt.clone().index_add_(axis, idx, src)
def _segment_sum(src, seg, n):
    out = torch.zeros((n,) + src.shape[1:], dtype=src.dtype)
    return out.index_add_(0, seg, src)
def _pad(x, pw):
    flat = tuple(v for pair in reversed(pw) for v in pair)
    return torch.nn.functional.pad(x, flat)

kernel_name = 'standalone__gqa_softmax__near_ridge'

def setup_inputs():

    _w = (lambda a: (lambda t: t.to(torch.bfloat16) if t.is_floating_point() else t)(torch.as_tensor(a)))
    B, Hq, Hkv, Sq, Sk, D = 16, 32, 32, 256, 1024, 128
    return {
        "q": _w((lambda *s: torch.randn(*s, dtype=torch.bfloat16) * 0.8)(B, Hq, Sq, D)),
        "k": _w((lambda *s: torch.randn(*s, dtype=torch.bfloat16) * 0.8)(B, Hkv, Sk, D)),
        "v": _w((lambda *s: torch.randn(*s, dtype=torch.bfloat16) * 0.05)(B, Hkv, Sk, D)),
    }

def reference(q, k, v):
    B, Hq, Sq, D = q.shape
    Hkv = k.shape[1]
    rep = Hq // Hkv
    k = (lambda x, n, axis: torch.repeat_interleave(x, n, dim=axis))(k, rep, axis=1)
    v = (lambda x, n, axis: torch.repeat_interleave(x, n, dim=axis))(v, rep, axis=1)
    scale = D ** -0.5
    scores = torch.einsum("bhqd,bhkd->bhqk", q, k) * scale
    p = _softmax(scores, axis=-1)
    return torch.einsum("bhqk,bhkd->bhqd", p, v)
```

```asm
; @launch grid=(256,1,1) block=(256,1,1) lds=163840
.amdgcn_target "amdgcn-amd-amdhsa--gfx950"
.text
.globl standalone__gqa_softmax__near_ridge_kernel
.p2align 8
.type standalone__gqa_softmax__near_ridge_kernel,@function
standalone__gqa_softmax__near_ridge_kernel:
    s_cmp_ge_u32 s2, 256
    s_cbranch_scc1 L_end
    s_load_dwordx4 s[4:7], s[0:1], 0
    s_load_dwordx4 s[8:11], s[0:1], 16
    v_lshrrev_b32 v1, 6, v0
    v_and_b32 v0, 63, v0
    v_readfirstlane_b32 s34, v1
    v_and_b32 v2, 15, v0
    v_lshrrev_b32 v3, 4, v0
    v_xor_b32 v37, v2, v3
    v_lshlrev_b32 v37, 4, v37
    v_lshl_add_u32 v28, v3, 8, v37
    v_xor_b32 v29, 64, v28
    v_xor_b32 v30, 128, v28
    v_xor_b32 v31, 192, v28
    v_lshlrev_b32 v37, 1, v3
    v_xor_b32 v37, v2, v37
    v_lshlrev_b32 v37, 4, v37
    v_lshl_add_u32 v26, v3, 8, v37
    s_lshl_b32 s48, s34, 11
    s_add_u32 s35, s48, 65536
    s_add_u32 s36, s48, 114688
    s_lshl_b32 s42, s34, 14
    s_and_b32 s49, s34, 1
    s_lshl_b32 s49, s49, 7
    v_add_u32 v26, s48, v26
    v_xor_b32 v27, 128, v26
    v_xor_b32 v24, s49, v28
    v_add_u32 v24, s48, v24
    v_xor_b32 v25, 64, v24
    v_mul_u32_u24 v37, 65280, v3
    s_mul_i32 s49, s34, -1536
    s_add_u32 s49, s49, 1024
    v_add_u32 v37, s49, v37
    v_add_u32 v24, v24, v37
    v_add_u32 v25, v25, v37
    v_add_u32 v25, -768, v25
    v_add_u32 v26, v26, v37
    v_add_u32 v27, v27, v37
    v_add_u32 v27, -768, v27
    v_xor_b32 v37, v2, v3
    v_lshlrev_b32 v37, 4, v37
    v_lshl_add_u32 v37, v2, 8, v37
    v_xor_b32 v38, 0, v37
    v_add_u32 v8, 65536, v38
    v_add_u32 v12, s42, v38
    v_xor_b32 v38, 64, v37
    v_add_u32 v9, 65536, v38
    v_add_u32 v13, s42, v38
    v_xor_b32 v38, 128, v37
    v_add_u32 v10, 65536, v38
    v_add_u32 v14, s42, v38
    v_xor_b32 v38, 192, v37
    v_add_u32 v11, 65536, v38
    v_add_u32 v15, s42, v38
    v_bfe_u32 v4, v0, 2, 2
    v_and_b32 v5, 3, v0
    v_lshl_add_u32 v6, v3, 2, v4
    v_and_b32 v7, 7, v6
    v_lshlrev_b32 v7, 1, v7
    v_lshrrev_b32 v37, 1, v5
    v_xor_b32 v7, v7, v37
    v_lshlrev_b32 v7, 4, v7
    v_lshl_add_u32 v7, v6, 8, v7
    v_and_b32 v37, 1, v5
    v_lshl_add_u32 v7, v37, 3, v7
    v_xor_b32 v37, 0, v7
    v_add_u32 v16, 114688, v37
    v_xor_b32 v37, 32, v7
    v_add_u32 v17, 114688, v37
    v_xor_b32 v37, 64, v7
    v_add_u32 v18, 114688, v37
    v_xor_b32 v37, 96, v7
    v_add_u32 v19, 114688, v37
    v_xor_b32 v37, 128, v7
    v_add_u32 v20, 114688, v37
    v_xor_b32 v37, 160, v7
    v_add_u32 v21, 114688, v37
    v_xor_b32 v37, 192, v7
    v_add_u32 v22, 114688, v37
    v_xor_b32 v37, 224, v7
    v_add_u32 v23, 114688, v37
    v_xor_b32 v1, v2, v3
    v_lshlrev_b32 v1, 4, v1
    v_lshl_add_u32 v1, v3, 8, v1
    v_add_u32 v32, s42, v1
    v_xor_b32 v33, 64, v32
    v_lshlrev_b32 v1, 4, v0
    v_add_u32 v34, s42, v1
    s_mov_b32 s40, 1166016512
    s_mov_b32 s46, 1040356334
    s_mov_b32 s47, 1040356334
    s_mov_b32 s51, 4294901760
    s_getreg_b32 s38, hwreg(HW_REG_XCC_ID)
    s_and_b32 s38, s38, 1
    s_xor_b32 s38, s38, 1
    s_lshl_b32 s38, s38, 4
    s_and_b32 s48, s2, 7
    s_lshl_b32 s48, s48, 6
    s_lshr_b32 s49, s2, 3
    s_lshl_b32 s49, s49, 1
    s_add_u32 s48, s48, s49
    s_waitcnt lgkmcnt(0)
    s_lshl_b32 s49, s48, 16
    s_lshr_b32 s50, s48, 16
    s_add_u32 s16, s4, s49
    s_addc_u32 s17, s5, s50
    s_mov_b32 s18, 131072
    s_mov_b32 s19, 131072
    s_lshl_b32 s49, s48, 18
    s_lshr_b32 s50, s48, 14
    s_add_u32 s20, s6, s49
    s_addc_u32 s21, s7, s50
    s_sub_u32 s20, s20, 1024
    s_subb_u32 s21, s21, 0
    s_mov_b32 s22, 525312
    s_mov_b32 s23, 131072
    s_lshl_b32 s49, s48, 18
    s_lshr_b32 s50, s48, 14
    s_add_u32 s24, s8, s49
    s_addc_u32 s25, s9, s50
    s_sub_u32 s24, s24, 1024
    s_subb_u32 s25, s25, 0
    s_mov_b32 s26, 525312
    s_mov_b32 s27, 131072
    s_lshl_b32 s49, s48, 16
    s_lshr_b32 s50, s48, 16
    s_add_u32 s28, s10, s49
    s_addc_u32 s29, s11, s50
    s_mov_b32 s30, 131072
    s_mov_b32 s31, 131072
    s_add_u32 m0, s35, 0
    s_mov_b32 s37, 0
    buffer_load_dwordx4 v24, s[20:23], s37 offen offset:0 nt lds
    buffer_load_dwordx4 v25, s[20:23], s37 offen offset:1024 nt lds
    s_add_u32 m0, s42, 0
    s_add_u32 s43, s42, 0
    buffer_load_dwordx4 v28, s[16:19], s43 offen offset:0 nt lds
    buffer_load_dwordx4 v29, s[16:19], s43 offen offset:1024 nt lds
    buffer_load_dwordx4 v30, s[16:19], s43 offen offset:2048 nt lds
    buffer_load_dwordx4 v31, s[16:19], s43 offen offset:3072 nt lds
    s_add_u32 m0, s42, 4096
    s_add_u32 s43, s42, 4096
    buffer_load_dwordx4 v28, s[16:19], s43 offen offset:0 nt lds
    buffer_load_dwordx4 v29, s[16:19], s43 offen offset:1024 nt lds
    buffer_load_dwordx4 v30, s[16:19], s43 offen offset:2048 nt lds
    buffer_load_dwordx4 v31, s[16:19], s43 offen offset:3072 nt lds
    s_add_u32 m0, s42, 8192
    s_add_u32 s43, s42, 8192
    buffer_load_dwordx4 v28, s[16:19], s43 offen offset:0 nt lds
    buffer_load_dwordx4 v29, s[16:19], s43 offen offset:1024 nt lds
    s_waitcnt vmcnt(6)
    s_barrier
    ds_read_b128 v[48:51], v12 offset:0
    ds_read_b128 v[52:55], v13 offset:0
    ds_read_b128 v[56:59], v14 offset:0
    ds_read_b128 v[60:63], v15 offset:0
    ds_read_b128 a[128:131], v8 offset:0
    ds_read_b128 a[132:135], v9 offset:0
    ds_read_b128 a[136:139], v10 offset:0
    ds_read_b128 a[140:143], v11 offset:0
    ds_read_b128 a[144:147], v8 offset:4096
    ds_read_b128 a[148:151], v9 offset:4096
    ds_read_b128 a[152:155], v10 offset:4096
    ds_read_b128 a[156:159], v11 offset:4096
    buffer_load_dwordx4 v30, s[16:19], s43 offen offset:2048 nt lds
    buffer_load_dwordx4 v31, s[16:19], s43 offen offset:3072 nt lds
    s_add_u32 m0, s42, 12288
    s_add_u32 s43, s42, 12288
    buffer_load_dwordx4 v28, s[16:19], s43 offen offset:0 nt lds
    buffer_load_dwordx4 v29, s[16:19], s43 offen offset:1024 nt lds
    s_waitcnt lgkmcnt(11)
    v_lshlrev_b32 v40, 16, v48
    v_and_b32 v41, s51, v48
    v_pk_mul_f32 v[40:41], v[40:41], s[46:47]
    v_cvt_pk_bf16_f32 v160, v40, v41
    v_lshlrev_b32 v42, 16, v49
    v_and_b32 v43, s51, v49
    v_pk_mul_f32 v[42:43], v[42:43], s[46:47]
    v_cvt_pk_bf16_f32 v161, v42, v43
    v_lshlrev_b32 v44, 16, v50
    v_and_b32 v45, s51, v50
    v_pk_mul_f32 v[44:45], v[44:45], s[46:47]
    v_cvt_pk_bf16_f32 v162, v44, v45
    v_lshlrev_b32 v46, 16, v51
    v_and_b32 v47, s51, v51
    v_pk_mul_f32 v[46:47], v[46:47], s[46:47]
    v_cvt_pk_bf16_f32 v163, v46, v47
    s_waitcnt lgkmcnt(10)
    v_lshlrev_b32 v40, 16, v52
    v_and_b32 v41, s51, v52
    v_pk_mul_f32 v[40:41], v[40:41], s[46:47]
    v_cvt_pk_bf16_f32 v164, v40, v41
    v_lshlrev_b32 v42, 16, v53
    v_and_b32 v43, s51, v53
    v_pk_mul_f32 v[42:43], v[42:43], s[46:47]
    v_cvt_pk_bf16_f32 v165, v42, v43
    v_lshlrev_b32 v44, 16, v54
    v_and_b32 v45, s51, v54
    v_pk_mul_f32 v[44:45], v[44:45], s[46:47]
    v_cvt_pk_bf16_f32 v166, v44, v45
    v_lshlrev_b32 v46, 16, v55
    v_and_b32 v47, s51, v55
    v_pk_mul_f32 v[46:47], v[46:47], s[46:47]
    v_cvt_pk_bf16_f32 v167, v46, v47
    s_waitcnt lgkmcnt(9)
    v_lshlrev_b32 v40, 16, v56
    v_and_b32 v41, s51, v56
    v_pk_mul_f32 v[40:41], v[40:41], s[46:47]
    v_cvt_pk_bf16_f32 v168, v40, v41
    v_lshlrev_b32 v42, 16, v57
    v_and_b32 v43, s51, v57
    v_pk_mul_f32 v[42:43], v[42:43], s[46:47]
    v_cvt_pk_bf16_f32 v169, v42, v43
    v_lshlrev_b32 v44, 16, v58
    v_and_b32 v45, s51, v58
    v_pk_mul_f32 v[44:45], v[44:45], s[46:47]
    v_cvt_pk_bf16_f32 v170, v44, v45
    v_lshlrev_b32 v46, 16, v59
    v_and_b32 v47, s51, v59
    v_pk_mul_f32 v[46:47], v[46:47], s[46:47]
    v_cvt_pk_bf16_f32 v171, v46, v47
    s_waitcnt lgkmcnt(8)
    v_lshlrev_b32 v40, 16, v60
    v_and_b32 v41, s51, v60
    v_pk_mul_f32 v[40:41], v[40:41], s[46:47]
    v_cvt_pk_bf16_f32 v172, v40, v41
    v_lshlrev_b32 v42, 16, v61
    v_and_b32 v43, s51, v61
    v_pk_mul_f32 v[42:43], v[42:43], s[46:47]
    v_cvt_pk_bf16_f32 v173, v42, v43
    v_lshlrev_b32 v44, 16, v62
    v_and_b32 v45, s51, v62
    v_pk_mul_f32 v[44:45], v[44:45], s[46:47]
    v_cvt_pk_bf16_f32 v174, v44, v45
    v_lshlrev_b32 v46, 16, v63
    v_and_b32 v47, s51, v63
    v_pk_mul_f32 v[46:47], v[46:47], s[46:47]
    v_cvt_pk_bf16_f32 v175, v46, v47
    s_waitcnt vmcnt(6)
    ds_read_b128 v[64:67], v12 offset:4096
    ds_read_b128 v[68:71], v13 offset:4096
    ds_read_b128 v[72:75], v14 offset:4096
    ds_read_b128 v[76:79], v15 offset:4096
    buffer_load_dwordx4 v30, s[16:19], s43 offen offset:2048 nt lds
    buffer_load_dwordx4 v31, s[16:19], s43 offen offset:3072 nt lds
    s_add_u32 m0, s35, 8192
    s_mov_b32 s37, 2048
    buffer_load_dwordx4 v24, s[20:23], s37 offen offset:0 nt lds
    buffer_load_dwordx4 v25, s[20:23], s37 offen offset:1024 nt lds
    s_waitcnt lgkmcnt(4)
    s_waitcnt lgkmcnt(3)
    v_mfma_f32_16x16x32_bf16 v[48:51], a[128:131], v[160:163], 0
    v_lshlrev_b32 v40, 16, v64
    v_and_b32 v41, s51, v64
    v_pk_mul_f32 v[40:41], v[40:41], s[46:47]
    v_cvt_pk_bf16_f32 v176, v40, v41
    v_lshlrev_b32 v42, 16, v65
    v_and_b32 v43, s51, v65
    v_pk_mul_f32 v[42:43], v[42:43], s[46:47]
    v_cvt_pk_bf16_f32 v177, v42, v43
    v_mfma_f32_16x16x32_bf16 v[48:51], a[132:135], v[164:167], v[48:51]
    v_lshlrev_b32 v44, 16, v66
    v_and_b32 v45, s51, v66
    v_pk_mul_f32 v[44:45], v[44:45], s[46:47]
    v_cvt_pk_bf16_f32 v178, v44, v45
    v_lshlrev_b32 v46, 16, v67
    v_and_b32 v47, s51, v67
    v_pk_mul_f32 v[46:47], v[46:47], s[46:47]
    v_cvt_pk_bf16_f32 v179, v46, v47
    s_waitcnt lgkmcnt(2)
    v_mfma_f32_16x16x32_bf16 v[48:51], a[136:139], v[168:171], v[48:51]
    v_lshlrev_b32 v40, 16, v68
    v_and_b32 v41, s51, v68
    v_pk_mul_f32 v[40:41], v[40:41], s[46:47]
    v_cvt_pk_bf16_f32 v180, v40, v41
    v_lshlrev_b32 v42, 16, v69
    v_and_b32 v43, s51, v69
    v_pk_mul_f32 v[42:43], v[42:43], s[46:47]
    v_cvt_pk_bf16_f32 v181, v42, v43
    v_mfma_f32_16x16x32_bf16 v[48:51], a[140:143], v[172:175], v[48:51]
    v_lshlrev_b32 v44, 16, v70
    v_and_b32 v45, s51, v70
    v_pk_mul_f32 v[44:45], v[44:45], s[46:47]
    v_cvt_pk_bf16_f32 v182, v44, v45
    v_lshlrev_b32 v46, 16, v71
    v_and_b32 v47, s51, v71
    v_pk_mul_f32 v[46:47], v[46:47], s[46:47]
    v_cvt_pk_bf16_f32 v183, v46, v47
    s_waitcnt lgkmcnt(1)
    v_mfma_f32_16x16x32_bf16 v[52:55], a[144:147], v[160:163], 0
    v_lshlrev_b32 v40, 16, v72
    v_and_b32 v41, s51, v72
    v_pk_mul_f32 v[40:41], v[40:41], s[46:47]
    v_cvt_pk_bf16_f32 v184, v40, v41
    v_lshlrev_b32 v42, 16, v73
    v_and_b32 v43, s51, v73
    v_pk_mul_f32 v[42:43], v[42:43], s[46:47]
    v_cvt_pk_bf16_f32 v185, v42, v43
    v_mfma_f32_16x16x32_bf16 v[52:55], a[148:151], v[164:167], v[52:55]
    v_lshlrev_b32 v44, 16, v74
    v_and_b32 v45, s51, v74
    v_pk_mul_f32 v[44:45], v[44:45], s[46:47]
    v_cvt_pk_bf16_f32 v186, v44, v45
    v_lshlrev_b32 v46, 16, v75
    v_and_b32 v47, s51, v75
    v_pk_mul_f32 v[46:47], v[46:47], s[46:47]
    v_cvt_pk_bf16_f32 v187, v46, v47
    s_waitcnt lgkmcnt(0)
    v_mfma_f32_16x16x32_bf16 v[52:55], a[152:155], v[168:171], v[52:55]
    v_lshlrev_b32 v40, 16, v76
    v_and_b32 v41, s51, v76
    v_pk_mul_f32 v[40:41], v[40:41], s[46:47]
    v_cvt_pk_bf16_f32 v188, v40, v41
    v_lshlrev_b32 v42, 16, v77
    v_and_b32 v43, s51, v77
    v_pk_mul_f32 v[42:43], v[42:43], s[46:47]
    v_cvt_pk_bf16_f32 v189, v42, v43
    v_mfma_f32_16x16x32_bf16 v[52:55], a[156:159], v[172:175], v[52:55]
    v_lshlrev_b32 v44, 16, v78
    v_and_b32 v45, s51, v78
    v_pk_mul_f32 v[44:45], v[44:45], s[46:47]
    v_cvt_pk_bf16_f32 v190, v44, v45
    v_lshlrev_b32 v46, 16, v79
    v_and_b32 v47, s51, v79
    v_pk_mul_f32 v[46:47], v[46:47], s[46:47]
    v_cvt_pk_bf16_f32 v191, v46, v47
    s_waitcnt vmcnt(6)
    ds_read_b128 v[80:83], v12 offset:8192
    ds_read_b128 v[84:87], v13 offset:8192
    ds_read_b128 v[88:91], v14 offset:8192
    ds_read_b128 v[92:95], v15 offset:8192
    s_add_u32 m0, s36, 0
    s_mov_b32 s41, 0
    buffer_load_dwordx4 v26, s[24:27], s41 offen offset:0 nt lds
    buffer_load_dwordx4 v27, s[24:27], s41 offen offset:1024 nt lds
    s_add_u32 m0, s35, 16384
    s_mov_b32 s37, 4096
    buffer_load_dwordx4 v24, s[20:23], s37 offen offset:0 nt lds
    buffer_load_dwordx4 v25, s[20:23], s37 offen offset:1024 nt lds
    s_waitcnt lgkmcnt(3)
    v_mfma_f32_16x16x32_bf16 v[56:59], a[128:131], v[176:179], 0
    v_lshlrev_b32 v40, 16, v80
    v_and_b32 v41, s51, v80
    v_pk_mul_f32 v[40:41], v[40:41], s[46:47]
    v_cvt_pk_bf16_f32 v192, v40, v41
    v_lshlrev_b32 v42, 16, v81
    v_and_b32 v43, s51, v81
    v_pk_mul_f32 v[42:43], v[42:43], s[46:47]
    v_cvt_pk_bf16_f32 v193, v42, v43
    v_mfma_f32_16x16x32_bf16 v[56:59], a[132:135], v[180:183], v[56:59]
    v_lshlrev_b32 v44, 16, v82
    v_and_b32 v45, s51, v82
    v_pk_mul_f32 v[44:45], v[44:45], s[46:47]
    v_cvt_pk_bf16_f32 v194, v44, v45
    v_lshlrev_b32 v46, 16, v83
    v_and_b32 v47, s51, v83
    v_pk_mul_f32 v[46:47], v[46:47], s[46:47]
    v_cvt_pk_bf16_f32 v195, v46, v47
    s_waitcnt lgkmcnt(2)
    v_mfma_f32_16x16x32_bf16 v[56:59], a[136:139], v[184:187], v[56:59]
    v_lshlrev_b32 v40, 16, v84
    v_and_b32 v41, s51, v84
    v_pk_mul_f32 v[40:41], v[40:41], s[46:47]
    v_cvt_pk_bf16_f32 v196, v40, v41
    v_lshlrev_b32 v42, 16, v85
    v_and_b32 v43, s51, v85
    v_pk_mul_f32 v[42:43], v[42:43], s[46:47]
    v_cvt_pk_bf16_f32 v197, v42, v43
    v_mfma_f32_16x16x32_bf16 v[56:59], a[140:143], v[188:191], v[56:59]
    v_lshlrev_b32 v44, 16, v86
    v_and_b32 v45, s51, v86
    v_pk_mul_f32 v[44:45], v[44:45], s[46:47]
    v_cvt_pk_bf16_f32 v198, v44, v45
    v_lshlrev_b32 v46, 16, v87
    v_and_b32 v47, s51, v87
    v_pk_mul_f32 v[46:47], v[46:47], s[46:47]
    v_cvt_pk_bf16_f32 v199, v46, v47
    s_waitcnt lgkmcnt(1)
    v_mfma_f32_16x16x32_bf16 v[60:63], a[144:147], v[176:179], 0
    v_lshlrev_b32 v40, 16, v88
    v_and_b32 v41, s51, v88
    v_pk_mul_f32 v[40:41], v[40:41], s[46:47]
    v_cvt_pk_bf16_f32 v200, v40, v41
    v_lshlrev_b32 v42, 16, v89
    v_and_b32 v43, s51, v89
    v_pk_mul_f32 v[42:43], v[42:43], s[46:47]
    v_cvt_pk_bf16_f32 v201, v42, v43
    v_mfma_f32_16x16x32_bf16 v[60:63], a[148:151], v[180:183], v[60:63]
    v_lshlrev_b32 v44, 16, v90
    v_and_b32 v45, s51, v90
    v_pk_mul_f32 v[44:45], v[44:45], s[46:47]
    v_cvt_pk_bf16_f32 v202, v44, v45
    v_lshlrev_b32 v46, 16, v91
    v_and_b32 v47, s51, v91
    v_pk_mul_f32 v[46:47], v[46:47], s[46:47]
    v_cvt_pk_bf16_f32 v203, v46, v47
    s_waitcnt lgkmcnt(0)
    v_mfma_f32_16x16x32_bf16 v[60:63], a[152:155], v[184:187], v[60:63]
    v_lshlrev_b32 v40, 16, v92
    v_and_b32 v41, s51, v92
    v_pk_mul_f32 v[40:41], v[40:41], s[46:47]
    v_cvt_pk_bf16_f32 v204, v40, v41
    v_lshlrev_b32 v42, 16, v93
    v_and_b32 v43, s51, v93
    v_pk_mul_f32 v[42:43], v[42:43], s[46:47]
    v_cvt_pk_bf16_f32 v205, v42, v43
    v_mfma_f32_16x16x32_bf16 v[60:63], a[156:159], v[188:191], v[60:63]
    v_lshlrev_b32 v44, 16, v94
    v_and_b32 v45, s51, v94
    v_pk_mul_f32 v[44:45], v[44:45], s[46:47]
    v_cvt_pk_bf16_f32 v206, v44, v45
    v_lshlrev_b32 v46, 16, v95
    v_and_b32 v47, s51, v95
    v_pk_mul_f32 v[46:47], v[46:47], s[46:47]
    v_cvt_pk_bf16_f32 v207, v46, v47
    s_waitcnt vmcnt(6)
    ds_read_b128 v[96:99], v12 offset:12288
    ds_read_b128 v[100:103], v13 offset:12288
    ds_read_b128 v[104:107], v14 offset:12288
    ds_read_b128 v[108:111], v15 offset:12288
    s_add_u32 m0, s36, 8192
    s_mov_b32 s41, 2048
    buffer_load_dwordx4 v26, s[24:27], s41 offen offset:0 nt lds
    buffer_load_dwordx4 v27, s[24:27], s41 offen offset:1024 nt lds
    s_add_u32 m0, s35, 24576
    s_mov_b32 s37, 6144
    buffer_load_dwordx4 v24, s[20:23], s37 offen offset:0 nt lds
    buffer_load_dwordx4 v25, s[20:23], s37 offen offset:1024 nt lds
    s_waitcnt lgkmcnt(3)
    v_mfma_f32_16x16x32_bf16 v[64:67], a[128:131], v[192:195], 0
    v_lshlrev_b32 v40, 16, v96
    v_and_b32 v41, s51, v96
    v_pk_mul_f32 v[40:41], v[40:41], s[46:47]
    v_cvt_pk_bf16_f32 v208, v40, v41
    v_lshlrev_b32 v42, 16, v97
    v_and_b32 v43, s51, v97
    v_pk_mul_f32 v[42:43], v[42:43], s[46:47]
    v_cvt_pk_bf16_f32 v209, v42, v43
    v_mfma_f32_16x16x32_bf16 v[64:67], a[132:135], v[196:199], v[64:67]
    v_lshlrev_b32 v44, 16, v98
    v_and_b32 v45, s51, v98
    v_pk_mul_f32 v[44:45], v[44:45], s[46:47]
    v_cvt_pk_bf16_f32 v210, v44, v45
    v_lshlrev_b32 v46, 16, v99
    v_and_b32 v47, s51, v99
    v_pk_mul_f32 v[46:47], v[46:47], s[46:47]
    v_cvt_pk_bf16_f32 v211, v46, v47
    s_waitcnt lgkmcnt(2)
    v_mfma_f32_16x16x32_bf16 v[64:67], a[136:139], v[200:203], v[64:67]
    v_lshlrev_b32 v40, 16, v100
    v_and_b32 v41, s51, v100
    v_pk_mul_f32 v[40:41], v[40:41], s[46:47]
    v_cvt_pk_bf16_f32 v212, v40, v41
    v_lshlrev_b32 v42, 16, v101
    v_and_b32 v43, s51, v101
    v_pk_mul_f32 v[42:43], v[42:43], s[46:47]
    v_cvt_pk_bf16_f32 v213, v42, v43
    v_mfma_f32_16x16x32_bf16 v[64:67], a[140:143], v[204:207], v[64:67]
    v_lshlrev_b32 v44, 16, v102
    v_and_b32 v45, s51, v102
    v_pk_mul_f32 v[44:45], v[44:45], s[46:47]
    v_cvt_pk_bf16_f32 v214, v44, v45
    v_lshlrev_b32 v46, 16, v103
    v_and_b32 v47, s51, v103
    v_pk_mul_f32 v[46:47], v[46:47], s[46:47]
    v_cvt_pk_bf16_f32 v215, v46, v47
    s_waitcnt lgkmcnt(1)
    v_mfma_f32_16x16x32_bf16 v[68:71], a[144:147], v[192:195], 0
    v_lshlrev_b32 v40, 16, v104
    v_and_b32 v41, s51, v104
    v_pk_mul_f32 v[40:41], v[40:41], s[46:47]
    v_cvt_pk_bf16_f32 v216, v40, v41
    v_lshlrev_b32 v42, 16, v105
    v_and_b32 v43, s51, v105
    v_pk_mul_f32 v[42:43], v[42:43], s[46:47]
    v_cvt_pk_bf16_f32 v217, v42, v43
    v_mfma_f32_16x16x32_bf16 v[68:71], a[148:151], v[196:199], v[68:71]
    v_lshlrev_b32 v44, 16, v106
    v_and_b32 v45, s51, v106
    v_pk_mul_f32 v[44:45], v[44:45], s[46:47]
    v_cvt_pk_bf16_f32 v218, v44, v45
    v_lshlrev_b32 v46, 16, v107
    v_and_b32 v47, s51, v107
    v_pk_mul_f32 v[46:47], v[46:47], s[46:47]
    v_cvt_pk_bf16_f32 v219, v46, v47
    s_waitcnt lgkmcnt(0)
    v_mfma_f32_16x16x32_bf16 v[68:71], a[152:155], v[200:203], v[68:71]
    v_lshlrev_b32 v40, 16, v108
    v_and_b32 v41, s51, v108
    v_pk_mul_f32 v[40:41], v[40:41], s[46:47]
    v_cvt_pk_bf16_f32 v220, v40, v41
    v_lshlrev_b32 v42, 16, v109
    v_and_b32 v43, s51, v109
    v_pk_mul_f32 v[42:43], v[42:43], s[46:47]
    v_cvt_pk_bf16_f32 v221, v42, v43
    v_mfma_f32_16x16x32_bf16 v[68:71], a[156:159], v[204:207], v[68:71]
    v_lshlrev_b32 v44, 16, v110
    v_and_b32 v45, s51, v110
    v_pk_mul_f32 v[44:45], v[44:45], s[46:47]
    v_cvt_pk_bf16_f32 v222, v44, v45
    v_lshlrev_b32 v46, 16, v111
    v_and_b32 v47, s51, v111
    v_pk_mul_f32 v[46:47], v[46:47], s[46:47]
    v_cvt_pk_bf16_f32 v223, v46, v47
    s_nop 1
    s_waitcnt vmcnt(8)
    s_barrier
    v_mfma_f32_16x16x32_bf16 v[72:75], a[128:131], v[208:211], 0
    v_mov_b32 v244, 0
    v_mov_b32 v245, 0
    v_mfma_f32_16x16x32_bf16 v[72:75], a[132:135], v[212:215], v[72:75]
    v_mov_b32 v246, 0
    v_mov_b32 v247, 0
    v_mfma_f32_16x16x32_bf16 v[72:75], a[136:139], v[216:219], v[72:75]
    v_max3_f32 v240, v48, v49, v50
    v_max3_f32 v240, v240, v51, v52
    v_mfma_f32_16x16x32_bf16 v[72:75], a[140:143], v[220:223], v[72:75]
    ds_read_b128 a[128:131], v8 offset:8192
    ds_read_b128 a[132:135], v9 offset:8192
    ds_read_b128 a[136:139], v10 offset:8192
    ds_read_b128 a[140:143], v11 offset:8192
    v_max3_f32 v240, v240, v53, v54
    v_max_f32 v240, v240, v55
    v_mfma_f32_16x16x32_bf16 v[76:79], a[144:147], v[208:211], 0
    v_max3_f32 v241, v56, v57, v58
    v_max3_f32 v241, v241, v59, v60
    v_mfma_f32_16x16x32_bf16 v[76:79], a[148:151], v[212:215], v[76:79]
    v_max3_f32 v241, v241, v61, v62
    v_max_f32 v241, v241, v63
    v_mfma_f32_16x16x32_bf16 v[76:79], a[152:155], v[216:219], v[76:79]
    v_max3_f32 v242, v64, v65, v66
    v_max3_f32 v242, v242, v67, v68
    v_mfma_f32_16x16x32_bf16 v[76:79], a[156:159], v[220:223], v[76:79]
    v_max3_f32 v242, v242, v69, v70
    v_max_f32 v242, v242, v71
    s_nop 5
    v_max3_f32 v243, v72, v73, v74
    v_max3_f32 v243, v243, v75, v76
    v_max3_f32 v243, v243, v77, v78
    v_max_f32 v243, v243, v79
    v_mov_b32 v40, v240
    v_mov_b32 v41, v241
    v_mov_b32 v42, v242
    v_mov_b32 v43, v243
    v_permlane16_swap_b32 v40, v240
    v_permlane16_swap_b32 v41, v241
    v_permlane16_swap_b32 v42, v242
    v_permlane16_swap_b32 v43, v243
    v_max_f32 v240, v240, v40
    v_max_f32 v241, v241, v41
    v_max_f32 v242, v242, v42
    v_max_f32 v243, v243, v43
    v_mov_b32 v40, v240
    v_mov_b32 v41, v241
    v_mov_b32 v42, v242
    v_mov_b32 v43, v243
    v_permlane32_swap_b32 v40, v240
    v_permlane32_swap_b32 v41, v241
    v_permlane32_swap_b32 v42, v242
    v_permlane32_swap_b32 v43, v243
    v_max_f32 v240, v240, v40
    v_max_f32 v241, v241, v41
    v_max_f32 v242, v242, v42
    v_max_f32 v243, v243, v43
    v_sub_f32 v144, 0, v240
    v_sub_f32 v145, 0, v240
    v_sub_f32 v148, 0, v241
    v_sub_f32 v149, 0, v241
    v_sub_f32 v152, 0, v242
    v_sub_f32 v153, 0, v242
    v_sub_f32 v156, 0, v243
    v_sub_f32 v157, 0, v243
    v_pk_mov_b32 v[146:147], v[144:145], v[144:145] op_sel:[0,1]
    v_pk_add_f32 v[48:49], v[48:49], v[144:145]
    v_pk_add_f32 v[50:51], v[50:51], v[144:145]
    v_pk_add_f32 v[52:53], v[52:53], v[144:145]
    v_pk_add_f32 v[54:55], v[54:55], v[144:145]
    v_pk_mov_b32 v[150:151], v[148:149], v[148:149] op_sel:[0,1]
    v_pk_add_f32 v[56:57], v[56:57], v[148:149]
    v_pk_add_f32 v[58:59], v[58:59], v[148:149]
    v_pk_add_f32 v[60:61], v[60:61], v[148:149]
    v_pk_add_f32 v[62:63], v[62:63], v[148:149]
    v_pk_mov_b32 v[154:155], v[152:153], v[152:153] op_sel:[0,1]
    v_pk_add_f32 v[64:65], v[64:65], v[152:153]
    v_pk_add_f32 v[66:67], v[66:67], v[152:153]
    v_pk_add_f32 v[68:69], v[68:69], v[152:153]
    v_pk_add_f32 v[70:71], v[70:71], v[152:153]
    v_pk_mov_b32 v[158:159], v[156:157], v[156:157] op_sel:[0,1]
    v_pk_add_f32 v[72:73], v[72:73], v[156:157]
    v_pk_add_f32 v[74:75], v[74:75], v[156:157]
    v_pk_add_f32 v[76:77], v[76:77], v[156:157]
    v_pk_add_f32 v[78:79], v[78:79], v[156:157]
    s_waitcnt lgkmcnt(0)
    v_mfma_f32_16x16x32_bf16 v[80:83], a[128:131], v[160:163], v[144:147]
    ds_read_b128 a[144:147], v8 offset:12288
    v_exp_f32 v40, v48
    v_exp_f32 v41, v49
    v_mfma_f32_16x16x32_bf16 v[80:83], a[132:135], v[164:167], v[80:83]
    ds_read_b128 a[148:151], v9 offset:12288
    v_exp_f32 v42, v50
    s_add_u32 m0, s36, 16384
    s_mov_b32 s41, 4096
    v_mfma_f32_16x16x32_bf16 v[80:83], a[136:139], v[168:171], v[80:83]
    buffer_load_dwordx4 v26, s[24:27], s41 offen offset:0 nt lds
    v_exp_f32 v43, v51
    v_add_f32 v248, v40, v41
    v_mfma_f32_16x16x32_bf16 v[80:83], a[140:143], v[172:175], v[80:83]
    v_cvt_pk_bf16_f32 v112, v40, v41
    v_exp_f32 v44, v52
    v_exp_f32 v45, v53
    v_mfma_f32_16x16x32_bf16 v[88:91], a[128:131], v[176:179], v[148:151]
    ds_read_b128 a[152:155], v10 offset:12288
    buffer_load_dwordx4 v27, s[24:27], s41 offen offset:1024 nt lds
    v_add_f32 v248, v248, v42
    v_add_f32 v248, v248, v43
    v_cvt_pk_bf16_f32 v113, v42, v43
    v_mfma_f32_16x16x32_bf16 v[88:91], a[132:135], v[180:183], v[88:91]
    ds_read_b128 a[156:159], v11 offset:12288
    v_exp_f32 v46, v54
    v_exp_f32 v47, v55
    v_mfma_f32_16x16x32_bf16 v[88:91], a[136:139], v[184:187], v[88:91]
    v_add_f32 v248, v248, v44
    v_add_f32 v248, v248, v45
    v_cvt_pk_bf16_f32 v114, v44, v45
    v_exp_f32 v40, v56
    v_mfma_f32_16x16x32_bf16 v[88:91], a[140:143], v[188:191], v[88:91]
    v_exp_f32 v41, v57
    v_add_f32 v248, v248, v46
    s_add_u32 m0, s35, 32768
    s_mov_b32 s37, 8192
    v_mfma_f32_16x16x32_bf16 v[96:99], a[128:131], v[192:195], v[152:155]
    buffer_load_dwordx4 v24, s[20:23], s37 offen offset:0 nt lds
    v_add_f32 v248, v248, v47
    v_cvt_pk_bf16_f32 v115, v46, v47
    v_exp_f32 v42, v58
    v_mfma_f32_16x16x32_bf16 v[96:99], a[132:135], v[196:199], v[96:99]
    v_exp_f32 v43, v59
    v_add_f32 v249, v40, v41
    v_cvt_pk_bf16_f32 v116, v40, v41
    v_mfma_f32_16x16x32_bf16 v[96:99], a[136:139], v[200:203], v[96:99]
    buffer_load_dwordx4 v25, s[20:23], s37 offen offset:1024 nt lds
    v_exp_f32 v44, v60
    v_exp_f32 v45, v61
    v_mfma_f32_16x16x32_bf16 v[96:99], a[140:143], v[204:207], v[96:99]
    v_add_f32 v249, v249, v42
    v_add_f32 v249, v249, v43
    v_cvt_pk_bf16_f32 v117, v42, v43
    v_exp_f32 v46, v62
    v_mfma_f32_16x16x32_bf16 v[104:107], a[128:131], v[208:211], v[156:159]
    v_exp_f32 v47, v63
    v_add_f32 v249, v249, v44
    v_add_f32 v249, v249, v45
    v_mfma_f32_16x16x32_bf16 v[104:107], a[132:135], v[212:215], v[104:107]
    v_cvt_pk_bf16_f32 v118, v44, v45
    v_exp_f32 v40, v64
    s_add_u32 m0, s36, 24576
    s_mov_b32 s41, 6144
    v_mfma_f32_16x16x32_bf16 v[104:107], a[136:139], v[216:219], v[104:107]
    buffer_load_dwordx4 v26, s[24:27], s41 offen offset:0 nt lds
    v_exp_f32 v41, v65
    v_add_f32 v249, v249, v46
    v_mfma_f32_16x16x32_bf16 v[104:107], a[140:143], v[220:223], v[104:107]
    v_add_f32 v249, v249, v47
    v_cvt_pk_bf16_f32 v119, v46, v47
    v_exp_f32 v42, v66
    s_waitcnt lgkmcnt(0)
    v_mfma_f32_16x16x32_bf16 v[84:87], a[144:147], v[160:163], v[144:147]
    buffer_load_dwordx4 v27, s[24:27], s41 offen offset:1024 nt lds
    v_exp_f32 v43, v67
    v_add_f32 v250, v40, v41
    v_mfma_f32_16x16x32_bf16 v[84:87], a[148:151], v[164:167], v[84:87]
    v_cvt_pk_bf16_f32 v120, v40, v41
    v_exp_f32 v44, v68
    v_exp_f32 v45, v69
    v_mfma_f32_16x16x32_bf16 v[84:87], a[152:155], v[168:171], v[84:87]
    v_add_f32 v250, v250, v42
    v_add_f32 v250, v250, v43
    v_cvt_pk_bf16_f32 v121, v42, v43
    v_exp_f32 v46, v70
    v_mfma_f32_16x16x32_bf16 v[84:87], a[156:159], v[172:175], v[84:87]
    v_exp_f32 v47, v71
    s_add_u32 m0, s35, 40960
    s_mov_b32 s37, 10240
    v_mfma_f32_16x16x32_bf16 v[92:95], a[144:147], v[176:179], v[148:151]
    buffer_load_dwordx4 v24, s[20:23], s37 offen offset:0 nt lds
    v_add_f32 v250, v250, v44
    v_add_f32 v250, v250, v45
    v_cvt_pk_bf16_f32 v122, v44, v45
    v_mfma_f32_16x16x32_bf16 v[92:95], a[148:151], v[180:183], v[92:95]
    v_exp_f32 v40, v72
    v_exp_f32 v41, v73
    v_add_f32 v250, v250, v46
    v_mfma_f32_16x16x32_bf16 v[92:95], a[152:155], v[184:187], v[92:95]
    buffer_load_dwordx4 v25, s[20:23], s37 offen offset:1024 nt lds
    v_add_f32 v250, v250, v47
    v_cvt_pk_bf16_f32 v123, v46, v47
    v_exp_f32 v42, v74
    v_mfma_f32_16x16x32_bf16 v[92:95], a[156:159], v[188:191], v[92:95]
    v_exp_f32 v43, v75
    s_waitcnt vmcnt(12)
    s_barrier
    v_mfma_f32_16x16x32_bf16 v[100:103], a[144:147], v[192:195], v[152:155]
    ds_read_b128 a[128:131], v8 offset:16384
    ds_read_b128 a[132:135], v9 offset:16384
    v_add_f32 v251, v40, v41
    s_mov_b32 s37, 12288
    s_mov_b32 s41, 8192
    v_mfma_f32_16x16x32_bf16 v[100:103], a[148:151], v[196:199], v[100:103]
    ds_read_b128 a[136:139], v10 offset:16384
    ds_read_b128 a[140:143], v11 offset:16384
    v_cvt_pk_bf16_f32 v124, v40, v41
    v_exp_f32 v44, v76
    v_mfma_f32_16x16x32_bf16 v[100:103], a[152:155], v[200:203], v[100:103]
    ds_read_b64_tr_b16 a[160:161], v16 offset:0
    v_exp_f32 v45, v77
    v_add_f32 v251, v251, v42
    v_mfma_f32_16x16x32_bf16 v[100:103], a[156:159], v[204:207], v[100:103]
    ds_read_b64_tr_b16 a[162:163], v16 offset:4096
    v_add_f32 v251, v251, v43
    v_cvt_pk_bf16_f32 v125, v42, v43
    v_exp_f32 v46, v78
    v_mfma_f32_16x16x32_bf16 v[108:111], a[144:147], v[208:211], v[156:159]
    ds_read_b64_tr_b16 a[164:165], v17 offset:0
    v_exp_f32 v47, v79
    v_add_f32 v251, v251, v44
    v_mfma_f32_16x16x32_bf16 v[108:111], a[148:151], v[212:215], v[108:111]
    ds_read_b64_tr_b16 a[166:167], v17 offset:4096
    v_add_f32 v251, v251, v45
    v_cvt_pk_bf16_f32 v126, v44, v45
    v_add_f32 v251, v251, v46
    v_add_f32 v251, v251, v47
    v_mfma_f32_16x16x32_bf16 v[108:111], a[152:155], v[216:219], v[108:111]
    ds_read_b64_tr_b16 a[168:169], v18 offset:0
    v_cvt_pk_bf16_f32 v127, v46, v47
    v_max3_f32 v35, v248, v249, v250
    v_max_f32 v35, v35, v251
    v_cmp_lt_f32 vcc, s40, v35
    v_mfma_f32_16x16x32_bf16 v[108:111], a[156:159], v[220:223], v[108:111]
    ds_read_b64_tr_b16 a[170:171], v18 offset:4096
    s_cbranch_vccnz L_rare_h0s0
L_ret_h0s0:
    s_waitcnt lgkmcnt(2)
    s_cmp_ge_u32 s38, 2
    s_cbranch_scc1 L_even0
    v_mfma_f32_16x16x32_bf16 v[48:51], a[128:131], v[160:163], v[144:147]
    ds_read_b128 a[144:147], v8 offset:20480
    v_add_f32 v244, v244, v248
    v_add_f32 v245, v245, v249
    v_add_f32 v246, v246, v250
    v_mfma_f32_16x16x32_bf16 v[48:51], a[132:135], v[164:167], v[48:51]
    v_mfma_f32_16x16x32_bf16 v[48:51], a[136:139], v[168:171], v[48:51]
    ds_read_b128 a[148:151], v9 offset:20480
    v_add_f32 v247, v247, v251
    v_exp_f32 v40, v80
    v_mfma_f32_16x16x32_bf16 v[48:51], a[140:143], v[172:175], v[48:51]
    v_mfma_f32_16x16x32_bf16 a[0:3], a[160:163], v[112:115], 0
    ds_read_b64_tr_b16 a[172:173], v19 offset:0
    v_exp_f32 v41, v81
    v_mfma_f32_16x16x32_bf16 a[32:35], a[160:163], v[116:119], 0
    ds_read_b64_tr_b16 a[174:175], v19 offset:4096
    v_exp_f32 v42, v82
    v_mfma_f32_16x16x32_bf16 a[64:67], a[160:163], v[120:123], 0
    v_exp_f32 v43, v83
    v_add_f32 v4, v40, v41
    v_mfma_f32_16x16x32_bf16 a[96:99], a[160:163], v[124:127], 0
    v_mfma_f32_16x16x32_bf16 v[56:59], a[128:131], v[176:179], v[148:151]
    ds_read_b128 a[152:155], v10 offset:20480
    v_cvt_pk_bf16_f32 v128, v40, v41
    v_exp_f32 v44, v84
    v_mfma_f32_16x16x32_bf16 v[56:59], a[132:135], v[180:183], v[56:59]
    v_mfma_f32_16x16x32_bf16 v[56:59], a[136:139], v[184:187], v[56:59]
    ds_read_b128 a[156:159], v11 offset:20480
    v_exp_f32 v45, v85
    v_add_f32 v4, v4, v42
    v_mfma_f32_16x16x32_bf16 v[56:59], a[140:143], v[188:191], v[56:59]
    v_mfma_f32_16x16x32_bf16 a[4:7], a[164:167], v[112:115], 0
    ds_read_b64_tr_b16 a[176:177], v20 offset:0
    v_add_f32 v4, v4, v43
    v_cvt_pk_bf16_f32 v129, v42, v43
    v_exp_f32 v46, v86
    v_mfma_f32_16x16x32_bf16 a[36:39], a[164:167], v[116:119], 0
    ds_read_b64_tr_b16 a[178:179], v20 offset:4096
    v_exp_f32 v47, v87
    v_add_f32 v4, v4, v44
    v_mfma_f32_16x16x32_bf16 a[68:71], a[164:167], v[120:123], 0
    v_mfma_f32_16x16x32_bf16 a[100:103], a[164:167], v[124:127], 0
    v_add_f32 v4, v4, v45
    v_cvt_pk_bf16_f32 v130, v44, v45
    v_exp_f32 v40, v88
    s_waitcnt lgkmcnt(4)
    v_mfma_f32_16x16x32_bf16 v[64:67], a[128:131], v[192:195], v[152:155]
    v_exp_f32 v41, v89
    v_add_f32 v4, v4, v46
    v_add_f32 v4, v4, v47
    v_mfma_f32_16x16x32_bf16 v[64:67], a[132:135], v[196:199], v[64:67]
    v_cvt_pk_bf16_f32 v131, v46, v47
    v_exp_f32 v42, v90
    s_add_u32 m0, s35, 0
    v_mfma_f32_16x16x32_bf16 v[64:67], a[136:139], v[200:203], v[64:67]
    buffer_load_dwordx4 v24, s[20:23], s37 offen offset:0 nt lds
    v_exp_f32 v43, v91
    v_add_f32 v5, v40, v41
    v_mfma_f32_16x16x32_bf16 v[64:67], a[140:143], v[204:207], v[64:67]
    v_mfma_f32_16x16x32_bf16 a[8:11], a[168:171], v[112:115], 0
    ds_read_b64_tr_b16 a[180:181], v21 offset:0
    v_cvt_pk_bf16_f32 v132, v40, v41
    v_exp_f32 v44, v92
    v_mfma_f32_16x16x32_bf16 a[40:43], a[168:171], v[116:119], 0
    ds_read_b64_tr_b16 a[182:183], v21 offset:4096
    v_exp_f32 v45, v93
    v_add_f32 v5, v5, v42
    v_mfma_f32_16x16x32_bf16 a[72:75], a[168:171], v[120:123], 0
    v_mfma_f32_16x16x32_bf16 a[104:107], a[168:171], v[124:127], 0
    v_mfma_f32_16x16x32_bf16 v[72:75], a[128:131], v[208:211], v[156:159]
    v_mfma_f32_16x16x32_bf16 v[72:75], a[132:135], v[212:215], v[72:75]
    v_add_f32 v5, v5, v43
    v_cvt_pk_bf16_f32 v133, v42, v43
    v_exp_f32 v46, v94
    v_mfma_f32_16x16x32_bf16 v[72:75], a[136:139], v[216:219], v[72:75]
    buffer_load_dwordx4 v25, s[20:23], s37 offen offset:1024 nt lds
    v_exp_f32 v47, v95
    s_add_u32 m0, s36, 32768
    v_mfma_f32_16x16x32_bf16 v[72:75], a[140:143], v[220:223], v[72:75]
    v_add_f32 v5, v5, v44
    v_add_f32 v5, v5, v45
    s_add_u32 s37, s37, 2048
    v_mfma_f32_16x16x32_bf16 a[12:15], a[172:175], v[112:115], 0
    ds_read_b64_tr_b16 a[184:185], v22 offset:0
    v_cvt_pk_bf16_f32 v134, v44, v45
    v_exp_f32 v40, v96
    v_mfma_f32_16x16x32_bf16 a[44:47], a[172:175], v[116:119], 0
    ds_read_b64_tr_b16 a[186:187], v22 offset:4096
    v_exp_f32 v41, v97
    v_mfma_f32_16x16x32_bf16 a[76:79], a[172:175], v[120:123], 0
    v_mfma_f32_16x16x32_bf16 a[108:111], a[172:175], v[124:127], 0
    v_add_f32 v5, v5, v46
    v_add_f32 v5, v5, v47
    s_waitcnt lgkmcnt(2)
    v_mfma_f32_16x16x32_bf16 v[52:55], a[144:147], v[160:163], v[144:147]
    v_mfma_f32_16x16x32_bf16 v[52:55], a[148:151], v[164:167], v[52:55]
    v_mfma_f32_16x16x32_bf16 v[52:55], a[152:155], v[168:171], v[52:55]
    buffer_load_dwordx4 v26, s[24:27], s41 offen offset:0 nt lds
    v_cvt_pk_bf16_f32 v135, v46, v47
    v_exp_f32 v42, v98
    v_mfma_f32_16x16x32_bf16 v[52:55], a[156:159], v[172:175], v[52:55]
    v_mfma_f32_16x16x32_bf16 a[16:19], a[176:179], v[112:115], 0
    ds_read_b64_tr_b16 a[188:189], v23 offset:0
    v_exp_f32 v43, v99
    v_add_f32 v6, v40, v41
    v_mfma_f32_16x16x32_bf16 a[48:51], a[176:179], v[116:119], 0
    ds_read_b64_tr_b16 a[190:191], v23 offset:4096
    v_cvt_pk_bf16_f32 v136, v40, v41
    v_exp_f32 v44, v100
    v_mfma_f32_16x16x32_bf16 a[80:83], a[176:179], v[120:123], 0
    v_exp_f32 v45, v101
    v_add_f32 v6, v6, v42
    v_mfma_f32_16x16x32_bf16 a[112:115], a[176:179], v[124:127], 0
    v_mfma_f32_16x16x32_bf16 v[60:63], a[144:147], v[176:179], v[148:151]
    v_mfma_f32_16x16x32_bf16 v[60:63], a[148:151], v[180:183], v[60:63]
    v_mfma_f32_16x16x32_bf16 v[60:63], a[152:155], v[184:187], v[60:63]
    buffer_load_dwordx4 v27, s[24:27], s41 offen offset:1024 nt lds
    v_add_f32 v6, v6, v43
    v_cvt_pk_bf16_f32 v137, v42, v43
    s_add_u32 s41, s41, 2048
    v_mfma_f32_16x16x32_bf16 v[60:63], a[156:159], v[188:191], v[60:63]
    v_mfma_f32_16x16x32_bf16 a[20:23], a[180:183], v[112:115], 0
    v_exp_f32 v46, v102
    v_exp_f32 v47, v103
    v_mfma_f32_16x16x32_bf16 a[52:55], a[180:183], v[116:119], 0
    v_mfma_f32_16x16x32_bf16 a[84:87], a[180:183], v[120:123], 0
    v_mfma_f32_16x16x32_bf16 a[116:119], a[180:183], v[124:127], 0
    v_add_f32 v6, v6, v44
    v_add_f32 v6, v6, v45
    s_waitcnt vmcnt(8) lgkmcnt(0)
    s_barrier
    v_mfma_f32_16x16x32_bf16 v[68:71], a[144:147], v[192:195], v[152:155]
    ds_read_b128 a[128:131], v8 offset:24576
    v_cvt_pk_bf16_f32 v138, v44, v45
    v_exp_f32 v40, v104
    v_mfma_f32_16x16x32_bf16 v[68:71], a[148:151], v[196:199], v[68:71]
    ds_read_b128 a[132:135], v9 offset:24576
    v_exp_f32 v41, v105
    v_mfma_f32_16x16x32_bf16 v[68:71], a[152:155], v[200:203], v[68:71]
    ds_read_b128 a[136:139], v10 offset:24576
    v_add_f32 v6, v6, v46
    v_add_f32 v6, v6, v47
    v_mfma_f32_16x16x32_bf16 v[68:71], a[156:159], v[204:207], v[68:71]
    ds_read_b128 a[140:143], v11 offset:24576
    v_cvt_pk_bf16_f32 v139, v46, v47
    v_exp_f32 v42, v106
    v_mfma_f32_16x16x32_bf16 a[24:27], a[184:187], v[112:115], 0
    ds_read_b64_tr_b16 a[160:161], v16 offset:8192
    v_exp_f32 v43, v107
    v_add_f32 v7, v40, v41
    v_mfma_f32_16x16x32_bf16 a[56:59], a[184:187], v[116:119], 0
    ds_read_b64_tr_b16 a[162:163], v16 offset:12288
    v_cvt_pk_bf16_f32 v140, v40, v41
    v_exp_f32 v44, v108
    v_mfma_f32_16x16x32_bf16 a[88:91], a[184:187], v[120:123], 0
    v_mfma_f32_16x16x32_bf16 a[120:123], a[184:187], v[124:127], 0
    v_mfma_f32_16x16x32_bf16 v[76:79], a[144:147], v[208:211], v[156:159]
    ds_read_b64_tr_b16 a[164:165], v17 offset:8192
    v_exp_f32 v45, v109
    v_add_f32 v7, v7, v42
    v_mfma_f32_16x16x32_bf16 v[76:79], a[148:151], v[212:215], v[76:79]
    ds_read_b64_tr_b16 a[166:167], v17 offset:12288
    v_add_f32 v7, v7, v43
    v_cvt_pk_bf16_f32 v141, v42, v43
    v_exp_f32 v46, v110
    v_mfma_f32_16x16x32_bf16 v[76:79], a[152:155], v[216:219], v[76:79]
    v_exp_f32 v47, v111
    v_add_f32 v7, v7, v44
    v_add_f32 v7, v7, v45
    v_mfma_f32_16x16x32_bf16 v[76:79], a[156:159], v[220:223], v[76:79]
    v_mfma_f32_16x16x32_bf16 a[28:31], a[188:191], v[112:115], 0
    ds_read_b64_tr_b16 a[168:169], v18 offset:8192
    v_cvt_pk_bf16_f32 v142, v44, v45
    v_add_f32 v7, v7, v46
    v_add_f32 v7, v7, v47
    v_mfma_f32_16x16x32_bf16 a[60:63], a[188:191], v[116:119], 0
    ds_read_b64_tr_b16 a[170:171], v18 offset:12288
    v_cvt_pk_bf16_f32 v143, v46, v47
    v_max3_f32 v35, v4, v5, v6
    v_max_f32 v35, v35, v7
    v_cmp_lt_f32 vcc, s40, v35
    v_mfma_f32_16x16x32_bf16 a[92:95], a[188:191], v[120:123], 0
    v_mfma_f32_16x16x32_bf16 a[124:127], a[188:191], v[124:127], 0
    s_cbranch_vccnz L_rare_h0p1
L_ret_h0p1:
    s_waitcnt lgkmcnt(2)
    v_mfma_f32_16x16x32_bf16 v[80:83], a[128:131], v[160:163], v[144:147]
    ds_read_b128 a[144:147], v8 offset:28672
    v_add_f32 v244, v244, v4
    v_add_f32 v245, v245, v5
    v_add_f32 v246, v246, v6
    v_mfma_f32_16x16x32_bf16 v[80:83], a[132:135], v[164:167], v[80:83]
    v_mfma_f32_16x16x32_bf16 v[80:83], a[136:139], v[168:171], v[80:83]
    ds_read_b128 a[148:151], v9 offset:28672
    v_add_f32 v247, v247, v7
    v_exp_f32 v40, v48
    v_mfma_f32_16x16x32_bf16 v[80:83], a[140:143], v[172:175], v[80:83]
    v_mfma_f32_16x16x32_bf16 a[0:3], a[160:163], v[128:131], a[0:3]
    ds_read_b64_tr_b16 a[172:173], v19 offset:8192
    v_exp_f32 v41, v49
    v_mfma_f32_16x16x32_bf16 a[32:35], a[160:163], v[132:135], a[32:35]
    ds_read_b64_tr_b16 a[174:175], v19 offset:12288
    v_exp_f32 v42, v50
    v_mfma_f32_16x16x32_bf16 a[64:67], a[160:163], v[136:139], a[64:67]
    v_exp_f32 v43, v51
    v_add_f32 v248, v40, v41
    v_mfma_f32_16x16x32_bf16 a[96:99], a[160:163], v[140:143], a[96:99]
    v_mfma_f32_16x16x32_bf16 v[88:91], a[128:131], v[176:179], v[148:151]
    ds_read_b128 a[152:155], v10 offset:28672
    v_cvt_pk_bf16_f32 v112, v40, v41
    v_exp_f32 v44, v52
    v_mfma_f32_16x16x32_bf16 v[88:91], a[132:135], v[180:183], v[88:91]
    v_mfma_f32_16x16x32_bf16 v[88:91], a[136:139], v[184:187], v[88:91]
    ds_read_b128 a[156:159], v11 offset:28672
    v_exp_f32 v45, v53
    v_add_f32 v248, v248, v42
    v_mfma_f32_16x16x32_bf16 v[88:91], a[140:143], v[188:191], v[88:91]
    v_mfma_f32_16x16x32_bf16 a[4:7], a[164:167], v[128:131], a[4:7]
    ds_read_b64_tr_b16 a[176:177], v20 offset:8192
    v_add_f32 v248, v248, v43
    v_cvt_pk_bf16_f32 v113, v42, v43
    v_exp_f32 v46, v54
    v_mfma_f32_16x16x32_bf16 a[36:39], a[164:167], v[132:135], a[36:39]
    ds_read_b64_tr_b16 a[178:179], v20 offset:12288
    v_exp_f32 v47, v55
    v_add_f32 v248, v248, v44
    v_mfma_f32_16x16x32_bf16 a[68:71], a[164:167], v[136:139], a[68:71]
    v_mfma_f32_16x16x32_bf16 a[100:103], a[164:167], v[140:143], a[100:103]
    v_add_f32 v248, v248, v45
    v_cvt_pk_bf16_f32 v114, v44, v45
    v_exp_f32 v40, v56
    s_waitcnt lgkmcnt(4)
    v_mfma_f32_16x16x32_bf16 v[96:99], a[128:131], v[192:195], v[152:155]
    v_exp_f32 v41, v57
    v_add_f32 v248, v248, v46
    v_add_f32 v248, v248, v47
    v_mfma_f32_16x16x32_bf16 v[96:99], a[132:135], v[196:199], v[96:99]
    v_cvt_pk_bf16_f32 v115, v46, v47
    v_exp_f32 v42, v58
    s_add_u32 m0, s35, 8192
    v_mfma_f32_16x16x32_bf16 v[96:99], a[136:139], v[200:203], v[96:99]
    buffer_load_dwordx4 v24, s[20:23], s37 offen offset:0 nt lds
    v_exp_f32 v43, v59
    v_add_f32 v249, v40, v41
    v_mfma_f32_16x16x32_bf16 v[96:99], a[140:143], v[204:207], v[96:99]
    v_mfma_f32_16x16x32_bf16 a[8:11], a[168:171], v[128:131], a[8:11]
    ds_read_b64_tr_b16 a[180:181], v21 offset:8192
    v_cvt_pk_bf16_f32 v116, v40, v41
    v_exp_f32 v44, v60
    v_mfma_f32_16x16x32_bf16 a[40:43], a[168:171], v[132:135], a[40:43]
    ds_read_b64_tr_b16 a[182:183], v21 offset:12288
    v_exp_f32 v45, v61
    v_add_f32 v249, v249, v42
    v_mfma_f32_16x16x32_bf16 a[72:75], a[168:171], v[136:139], a[72:75]
    v_mfma_f32_16x16x32_bf16 a[104:107], a[168:171], v[140:143], a[104:107]
    v_mfma_f32_16x16x32_bf16 v[104:107], a[128:131], v[208:211], v[156:159]
    v_mfma_f32_16x16x32_bf16 v[104:107], a[132:135], v[212:215], v[104:107]
    v_add_f32 v249, v249, v43
    v_cvt_pk_bf16_f32 v117, v42, v43
    v_exp_f32 v46, v62
    v_mfma_f32_16x16x32_bf16 v[104:107], a[136:139], v[216:219], v[104:107]
    buffer_load_dwordx4 v25, s[20:23], s37 offen offset:1024 nt lds
    v_exp_f32 v47, v63
    s_add_u32 m0, s36, 40960
    v_mfma_f32_16x16x32_bf16 v[104:107], a[140:143], v[220:223], v[104:107]
    v_add_f32 v249, v249, v44
    v_add_f32 v249, v249, v45
    s_add_u32 s37, s37, 2048
    v_mfma_f32_16x16x32_bf16 a[12:15], a[172:175], v[128:131], a[12:15]
    ds_read_b64_tr_b16 a[184:185], v22 offset:8192
    v_cvt_pk_bf16_f32 v118, v44, v45
    v_exp_f32 v40, v64
    v_mfma_f32_16x16x32_bf16 a[44:47], a[172:175], v[132:135], a[44:47]
    ds_read_b64_tr_b16 a[186:187], v22 offset:12288
    v_exp_f32 v41, v65
    v_mfma_f32_16x16x32_bf16 a[76:79], a[172:175], v[136:139], a[76:79]
    v_mfma_f32_16x16x32_bf16 a[108:111], a[172:175], v[140:143], a[108:111]
    v_add_f32 v249, v249, v46
    v_add_f32 v249, v249, v47
    s_waitcnt lgkmcnt(2)
    v_mfma_f32_16x16x32_bf16 v[84:87], a[144:147], v[160:163], v[144:147]
    v_mfma_f32_16x16x32_bf16 v[84:87], a[148:151], v[164:167], v[84:87]
    v_mfma_f32_16x16x32_bf16 v[84:87], a[152:155], v[168:171], v[84:87]
    buffer_load_dwordx4 v26, s[24:27], s41 offen offset:0 nt lds
    v_cvt_pk_bf16_f32 v119, v46, v47
    v_exp_f32 v42, v66
    v_mfma_f32_16x16x32_bf16 v[84:87], a[156:159], v[172:175], v[84:87]
    v_mfma_f32_16x16x32_bf16 a[16:19], a[176:179], v[128:131], a[16:19]
    ds_read_b64_tr_b16 a[188:189], v23 offset:8192
    v_exp_f32 v43, v67
    v_add_f32 v250, v40, v41
    v_mfma_f32_16x16x32_bf16 a[48:51], a[176:179], v[132:135], a[48:51]
    ds_read_b64_tr_b16 a[190:191], v23 offset:12288
    v_cvt_pk_bf16_f32 v120, v40, v41
    v_exp_f32 v44, v68
    v_mfma_f32_16x16x32_bf16 a[80:83], a[176:179], v[136:139], a[80:83]
    v_exp_f32 v45, v69
    v_add_f32 v250, v250, v42
    v_mfma_f32_16x16x32_bf16 a[112:115], a[176:179], v[140:143], a[112:115]
    v_mfma_f32_16x16x32_bf16 v[92:95], a[144:147], v[176:179], v[148:151]
    v_mfma_f32_16x16x32_bf16 v[92:95], a[148:151], v[180:183], v[92:95]
    v_mfma_f32_16x16x32_bf16 v[92:95], a[152:155], v[184:187], v[92:95]
    buffer_load_dwordx4 v27, s[24:27], s41 offen offset:1024 nt lds
    v_add_f32 v250, v250, v43
    v_cvt_pk_bf16_f32 v121, v42, v43
    s_add_u32 s41, s41, 2048
    v_mfma_f32_16x16x32_bf16 v[92:95], a[156:159], v[188:191], v[92:95]
    v_mfma_f32_16x16x32_bf16 a[20:23], a[180:183], v[128:131], a[20:23]
    v_exp_f32 v46, v70
    v_exp_f32 v47, v71
    v_mfma_f32_16x16x32_bf16 a[52:55], a[180:183], v[132:135], a[52:55]
    v_mfma_f32_16x16x32_bf16 a[84:87], a[180:183], v[136:139], a[84:87]
    v_mfma_f32_16x16x32_bf16 a[116:119], a[180:183], v[140:143], a[116:119]
    v_add_f32 v250, v250, v44
    v_add_f32 v250, v250, v45
    s_waitcnt lgkmcnt(0)
    v_mfma_f32_16x16x32_bf16 v[100:103], a[144:147], v[192:195], v[152:155]
    ds_read_b128 a[128:131], v8 offset:32768
    v_cvt_pk_bf16_f32 v122, v44, v45
    v_exp_f32 v40, v72
    v_mfma_f32_16x16x32_bf16 v[100:103], a[148:151], v[196:199], v[100:103]
    ds_read_b128 a[132:135], v9 offset:32768
    v_exp_f32 v41, v73
    v_mfma_f32_16x16x32_bf16 v[100:103], a[152:155], v[200:203], v[100:103]
    ds_read_b128 a[136:139], v10 offset:32768
    v_add_f32 v250, v250, v46
    v_add_f32 v250, v250, v47
    v_mfma_f32_16x16x32_bf16 v[100:103], a[156:159], v[204:207], v[100:103]
    ds_read_b128 a[140:143], v11 offset:32768
    v_cvt_pk_bf16_f32 v123, v46, v47
    v_exp_f32 v42, v74
    v_mfma_f32_16x16x32_bf16 a[24:27], a[184:187], v[128:131], a[24:27]
    ds_read_b64_tr_b16 a[160:161], v16 offset:16384
    v_exp_f32 v43, v75
    v_add_f32 v251, v40, v41
    v_mfma_f32_16x16x32_bf16 a[56:59], a[184:187], v[132:135], a[56:59]
    ds_read_b64_tr_b16 a[162:163], v16 offset:20480
    v_cvt_pk_bf16_f32 v124, v40, v41
    v_exp_f32 v44, v76
    v_mfma_f32_16x16x32_bf16 a[88:91], a[184:187], v[136:139], a[88:91]
    v_mfma_f32_16x16x32_bf16 a[120:123], a[184:187], v[140:143], a[120:123]
    v_mfma_f32_16x16x32_bf16 v[108:111], a[144:147], v[208:211], v[156:159]
    ds_read_b64_tr_b16 a[164:165], v17 offset:16384
    v_exp_f32 v45, v77
    v_add_f32 v251, v251, v42
    v_mfma_f32_16x16x32_bf16 v[108:111], a[148:151], v[212:215], v[108:111]
    ds_read_b64_tr_b16 a[166:167], v17 offset:20480
    v_add_f32 v251, v251, v43
    v_cvt_pk_bf16_f32 v125, v42, v43
    v_exp_f32 v46, v78
    v_mfma_f32_16x16x32_bf16 v[108:111], a[152:155], v[216:219], v[108:111]
    v_exp_f32 v47, v79
    v_add_f32 v251, v251, v44
    v_add_f32 v251, v251, v45
    v_mfma_f32_16x16x32_bf16 v[108:111], a[156:159], v[220:223], v[108:111]
    v_mfma_f32_16x16x32_bf16 a[28:31], a[188:191], v[128:131], a[28:31]
    ds_read_b64_tr_b16 a[168:169], v18 offset:16384
    v_cvt_pk_bf16_f32 v126, v44, v45
    v_add_f32 v251, v251, v46
    v_add_f32 v251, v251, v47
    v_mfma_f32_16x16x32_bf16 a[60:63], a[188:191], v[132:135], a[60:63]
    ds_read_b64_tr_b16 a[170:171], v18 offset:20480
    v_cvt_pk_bf16_f32 v127, v46, v47
    v_max3_f32 v35, v248, v249, v250
    v_max_f32 v35, v35, v251
    v_cmp_lt_f32 vcc, s40, v35
    v_mfma_f32_16x16x32_bf16 a[92:95], a[188:191], v[136:139], a[92:95]
    v_mfma_f32_16x16x32_bf16 a[124:127], a[188:191], v[140:143], a[124:127]
    s_cbranch_vccnz L_rare_h0p2
L_ret_h0p2:
    s_waitcnt lgkmcnt(2)
    v_mfma_f32_16x16x32_bf16 v[48:51], a[128:131], v[160:163], v[144:147]
    ds_read_b128 a[144:147], v8 offset:36864
    v_add_f32 v244, v244, v248
    v_add_f32 v245, v245, v249
    v_mfma_f32_16x16x32_bf16 v[48:51], a[132:135], v[164:167], v[48:51]
    v_mfma_f32_16x16x32_bf16 v[48:51], a[136:139], v[168:171], v[48:51]
    ds_read_b128 a[148:151], v9 offset:36864
    v_add_f32 v246, v246, v250
    v_add_f32 v247, v247, v251
    v_mfma_f32_16x16x32_bf16 v[48:51], a[140:143], v[172:175], v[48:51]
    v_exp_f32 v40, v80
    v_exp_f32 v41, v81
    v_mfma_f32_16x16x32_bf16 a[0:3], a[160:163], v[112:115], a[0:3]
    ds_read_b64_tr_b16 a[172:173], v19 offset:16384
    v_exp_f32 v42, v82
    v_mfma_f32_16x16x32_bf16 a[32:35], a[160:163], v[116:119], a[32:35]
    ds_read_b64_tr_b16 a[174:175], v19 offset:20480
    v_exp_f32 v43, v83
    v_mfma_f32_16x16x32_bf16 a[64:67], a[160:163], v[120:123], a[64:67]
    v_mfma_f32_16x16x32_bf16 a[96:99], a[160:163], v[124:127], a[96:99]
    v_add_f32 v4, v40, v41
    v_cvt_pk_bf16_f32 v128, v40, v41
    v_exp_f32 v44, v84
    v_mfma_f32_16x16x32_bf16 v[56:59], a[128:131], v[176:179], v[148:151]
    ds_read_b128 a[152:155], v10 offset:36864
    v_exp_f32 v45, v85
    v_mfma_f32_16x16x32_bf16 v[56:59], a[132:135], v[180:183], v[56:59]
    v_mfma_f32_16x16x32_bf16 v[56:59], a[136:139], v[184:187], v[56:59]
    ds_read_b128 a[156:159], v11 offset:36864
    v_add_f32 v4, v4, v42
    v_add_f32 v4, v4, v43
    v_mfma_f32_16x16x32_bf16 v[56:59], a[140:143], v[188:191], v[56:59]
    v_cvt_pk_bf16_f32 v129, v42, v43
    v_exp_f32 v46, v86
    v_mfma_f32_16x16x32_bf16 a[4:7], a[164:167], v[112:115], a[4:7]
    ds_read_b64_tr_b16 a[176:177], v20 offset:16384
    v_exp_f32 v47, v87
    v_mfma_f32_16x16x32_bf16 a[36:39], a[164:167], v[116:119], a[36:39]
    ds_read_b64_tr_b16 a[178:179], v20 offset:20480
    v_add_f32 v4, v4, v44
    v_add_f32 v4, v4, v45
    v_mfma_f32_16x16x32_bf16 a[68:71], a[164:167], v[120:123], a[68:71]
    v_mfma_f32_16x16x32_bf16 a[100:103], a[164:167], v[124:127], a[100:103]
    v_cvt_pk_bf16_f32 v130, v44, v45
    v_exp_f32 v40, v88
    s_waitcnt lgkmcnt(4)
    v_mfma_f32_16x16x32_bf16 v[64:67], a[128:131], v[192:195], v[152:155]
    v_exp_f32 v41, v89
    v_add_f32 v4, v4, v46
    v_mfma_f32_16x16x32_bf16 v[64:67], a[132:135], v[196:199], v[64:67]
    v_add_f32 v4, v4, v47
    v_cvt_pk_bf16_f32 v131, v46, v47
    s_add_u32 m0, s35, 16384
    v_mfma_f32_16x16x32_bf16 v[64:67], a[136:139], v[200:203], v[64:67]
    buffer_load_dwordx4 v24, s[20:23], s37 offen offset:0 nt lds
    v_exp_f32 v42, v90
    v_mfma_f32_16x16x32_bf16 v[64:67], a[140:143], v[204:207], v[64:67]
    v_mfma_f32_16x16x32_bf16 a[8:11], a[168:171], v[112:115], a[8:11]
    ds_read_b64_tr_b16 a[180:181], v21 offset:16384
    v_exp_f32 v43, v91
    v_mfma_f32_16x16x32_bf16 a[40:43], a[168:171], v[116:119], a[40:43]
    ds_read_b64_tr_b16 a[182:183], v21 offset:20480
    v_add_f32 v5, v40, v41
    v_cvt_pk_bf16_f32 v132, v40, v41
    v_mfma_f32_16x16x32_bf16 a[72:75], a[168:171], v[120:123], a[72:75]
    v_exp_f32 v44, v92
    v_exp_f32 v45, v93
    v_mfma_f32_16x16x32_bf16 a[104:107], a[168:171], v[124:127], a[104:107]
    v_mfma_f32_16x16x32_bf16 v[72:75], a[128:131], v[208:211], v[156:159]
    v_add_f32 v5, v5, v42
    v_add_f32 v5, v5, v43
    v_cvt_pk_bf16_f32 v133, v42, v43
    v_mfma_f32_16x16x32_bf16 v[72:75], a[132:135], v[212:215], v[72:75]
    v_mfma_f32_16x16x32_bf16 v[72:75], a[136:139], v[216:219], v[72:75]
    buffer_load_dwordx4 v25, s[20:23], s37 offen offset:1024 nt lds
    v_exp_f32 v46, v94
    s_add_u32 m0, s36, 0
    v_mfma_f32_16x16x32_bf16 v[72:75], a[140:143], v[220:223], v[72:75]
    v_exp_f32 v47, v95
    s_add_u32 s37, s37, 2048
    v_mfma_f32_16x16x32_bf16 a[12:15], a[172:175], v[112:115], a[12:15]
    ds_read_b64_tr_b16 a[184:185], v22 offset:16384
    v_add_f32 v5, v5, v44
    v_add_f32 v5, v5, v45
    v_mfma_f32_16x16x32_bf16 a[44:47], a[172:175], v[116:119], a[44:47]
    ds_read_b64_tr_b16 a[186:187], v22 offset:20480
    v_cvt_pk_bf16_f32 v134, v44, v45
    v_exp_f32 v40, v96
    v_mfma_f32_16x16x32_bf16 a[76:79], a[172:175], v[120:123], a[76:79]
    v_exp_f32 v41, v97
    v_add_f32 v5, v5, v46
    v_mfma_f32_16x16x32_bf16 a[108:111], a[172:175], v[124:127], a[108:111]
    v_add_f32 v5, v5, v47
    v_cvt_pk_bf16_f32 v135, v46, v47
    s_waitcnt lgkmcnt(2)
    v_mfma_f32_16x16x32_bf16 v[52:55], a[144:147], v[160:163], v[144:147]
    v_mfma_f32_16x16x32_bf16 v[52:55], a[148:151], v[164:167], v[52:55]
    v_mfma_f32_16x16x32_bf16 v[52:55], a[152:155], v[168:171], v[52:55]
    buffer_load_dwordx4 v26, s[24:27], s41 offen offset:0 nt lds
    v_exp_f32 v42, v98
    v_mfma_f32_16x16x32_bf16 v[52:55], a[156:159], v[172:175], v[52:55]
    v_exp_f32 v43, v99
    v_add_f32 v6, v40, v41
    v_mfma_f32_16x16x32_bf16 a[16:19], a[176:179], v[112:115], a[16:19]
    ds_read_b64_tr_b16 a[188:189], v23 offset:16384
    v_cvt_pk_bf16_f32 v136, v40, v41
    v_exp_f32 v44, v100
    v_mfma_f32_16x16x32_bf16 a[48:51], a[176:179], v[116:119], a[48:51]
    ds_read_b64_tr_b16 a[190:191], v23 offset:20480
    v_exp_f32 v45, v101
    v_mfma_f32_16x16x32_bf16 a[80:83], a[176:179], v[120:123], a[80:83]
    v_mfma_f32_16x16x32_bf16 a[112:115], a[176:179], v[124:127], a[112:115]
    v_add_f32 v6, v6, v42
    v_add_f32 v6, v6, v43
    v_cvt_pk_bf16_f32 v137, v42, v43
    v_mfma_f32_16x16x32_bf16 v[60:63], a[144:147], v[176:179], v[148:151]
    v_mfma_f32_16x16x32_bf16 v[60:63], a[148:151], v[180:183], v[60:63]
    v_exp_f32 v46, v102
    v_exp_f32 v47, v103
    v_mfma_f32_16x16x32_bf16 v[60:63], a[152:155], v[184:187], v[60:63]
    buffer_load_dwordx4 v27, s[24:27], s41 offen offset:1024 nt lds
    v_add_f32 v6, v6, v44
    s_add_u32 s41, s41, 2048
    v_mfma_f32_16x16x32_bf16 v[60:63], a[156:159], v[188:191], v[60:63]
    v_mfma_f32_16x16x32_bf16 a[20:23], a[180:183], v[112:115], a[20:23]
    v_add_f32 v6, v6, v45
    v_cvt_pk_bf16_f32 v138, v44, v45
    v_exp_f32 v40, v104
    v_mfma_f32_16x16x32_bf16 a[52:55], a[180:183], v[116:119], a[52:55]
    v_mfma_f32_16x16x32_bf16 a[84:87], a[180:183], v[120:123], a[84:87]
    v_exp_f32 v41, v105
    v_add_f32 v6, v6, v46
    v_mfma_f32_16x16x32_bf16 a[116:119], a[180:183], v[124:127], a[116:119]
    v_add_f32 v6, v6, v47
    s_waitcnt vmcnt(8) lgkmcnt(0)
    s_barrier
    v_mfma_f32_16x16x32_bf16 v[68:71], a[144:147], v[192:195], v[152:155]
    ds_read_b128 a[128:131], v8 offset:40960
    v_cvt_pk_bf16_f32 v139, v46, v47
    v_exp_f32 v42, v106
    v_mfma_f32_16x16x32_bf16 v[68:71], a[148:151], v[196:199], v[68:71]
    ds_read_b128 a[132:135], v9 offset:40960
    v_exp_f32 v43, v107
    v_mfma_f32_16x16x32_bf16 v[68:71], a[152:155], v[200:203], v[68:71]
    ds_read_b128 a[136:139], v10 offset:40960
    v_add_f32 v7, v40, v41
    v_cvt_pk_bf16_f32 v140, v40, v41
    v_mfma_f32_16x16x32_bf16 v[68:71], a[156:159], v[204:207], v[68:71]
    ds_read_b128 a[140:143], v11 offset:40960
    v_exp_f32 v44, v108
    v_mfma_f32_16x16x32_bf16 a[24:27], a[184:187], v[112:115], a[24:27]
    ds_read_b64_tr_b16 a[160:161], v16 offset:24576
    v_exp_f32 v45, v109
    v_mfma_f32_16x16x32_bf16 a[56:59], a[184:187], v[116:119], a[56:59]
    ds_read_b64_tr_b16 a[162:163], v16 offset:28672
    v_add_f32 v7, v7, v42
    v_add_f32 v7, v7, v43
    v_mfma_f32_16x16x32_bf16 a[88:91], a[184:187], v[120:123], a[88:91]
    v_mfma_f32_16x16x32_bf16 a[120:123], a[184:187], v[124:127], a[120:123]
    v_cvt_pk_bf16_f32 v141, v42, v43
    v_exp_f32 v46, v110
    v_mfma_f32_16x16x32_bf16 v[76:79], a[144:147], v[208:211], v[156:159]
    ds_read_b64_tr_b16 a[164:165], v17 offset:24576
    v_exp_f32 v47, v111
    v_mfma_f32_16x16x32_bf16 v[76:79], a[148:151], v[212:215], v[76:79]
    ds_read_b64_tr_b16 a[166:167], v17 offset:28672
    v_add_f32 v7, v7, v44
    v_add_f32 v7, v7, v45
    v_mfma_f32_16x16x32_bf16 v[76:79], a[152:155], v[216:219], v[76:79]
    v_mfma_f32_16x16x32_bf16 v[76:79], a[156:159], v[220:223], v[76:79]
    v_cvt_pk_bf16_f32 v142, v44, v45
    v_add_f32 v7, v7, v46
    v_add_f32 v7, v7, v47
    v_mfma_f32_16x16x32_bf16 a[28:31], a[188:191], v[112:115], a[28:31]
    ds_read_b64_tr_b16 a[168:169], v18 offset:24576
    v_cvt_pk_bf16_f32 v143, v46, v47
    v_max3_f32 v35, v4, v5, v6
    v_mfma_f32_16x16x32_bf16 a[60:63], a[188:191], v[116:119], a[60:63]
    ds_read_b64_tr_b16 a[170:171], v18 offset:28672
    v_max_f32 v35, v35, v7
    v_cmp_lt_f32 vcc, s40, v35
    v_mfma_f32_16x16x32_bf16 a[92:95], a[188:191], v[120:123], a[92:95]
    v_mfma_f32_16x16x32_bf16 a[124:127], a[188:191], v[124:127], a[124:127]
    s_cbranch_vccnz L_rare_h0p3
L_ret_h0p3:
    s_waitcnt lgkmcnt(2)
    v_mfma_f32_16x16x32_bf16 v[80:83], a[128:131], v[160:163], v[144:147]
    ds_read_b128 a[144:147], v8 offset:45056
    v_add_f32 v244, v244, v4
    v_add_f32 v245, v245, v5
    v_mfma_f32_16x16x32_bf16 v[80:83], a[132:135], v[164:167], v[80:83]
    v_mfma_f32_16x16x32_bf16 v[80:83], a[136:139], v[168:171], v[80:83]
    ds_read_b128 a[148:151], v9 offset:45056
    v_add_f32 v246, v246, v6
    v_add_f32 v247, v247, v7
    v_mfma_f32_16x16x32_bf16 v[80:83], a[140:143], v[172:175], v[80:83]
    v_exp_f32 v40, v48
    v_exp_f32 v41, v49
    v_mfma_f32_16x16x32_bf16 a[0:3], a[160:163], v[128:131], a[0:3]
    ds_read_b64_tr_b16 a[172:173], v19 offset:24576
    v_exp_f32 v42, v50
    v_mfma_f32_16x16x32_bf16 a[32:35], a[160:163], v[132:135], a[32:35]
    ds_read_b64_tr_b16 a[174:175], v19 offset:28672
    v_exp_f32 v43, v51
    v_mfma_f32_16x16x32_bf16 a[64:67], a[160:163], v[136:139], a[64:67]
    v_mfma_f32_16x16x32_bf16 a[96:99], a[160:163], v[140:143], a[96:99]
    v_add_f32 v248, v40, v41
    v_cvt_pk_bf16_f32 v112, v40, v41
    v_exp_f32 v44, v52
    v_mfma_f32_16x16x32_bf16 v[88:91], a[128:131], v[176:179], v[148:151]
    ds_read_b128 a[152:155], v10 offset:45056
    v_exp_f32 v45, v53
    v_mfma_f32_16x16x32_bf16 v[88:91], a[132:135], v[180:183], v[88:91]
    v_mfma_f32_16x16x32_bf16 v[88:91], a[136:139], v[184:187], v[88:91]
    ds_read_b128 a[156:159], v11 offset:45056
    v_add_f32 v248, v248, v42
    v_add_f32 v248, v248, v43
    v_mfma_f32_16x16x32_bf16 v[88:91], a[140:143], v[188:191], v[88:91]
    v_cvt_pk_bf16_f32 v113, v42, v43
    v_exp_f32 v46, v54
    v_mfma_f32_16x16x32_bf16 a[4:7], a[164:167], v[128:131], a[4:7]
    ds_read_b64_tr_b16 a[176:177], v20 offset:24576
    v_exp_f32 v47, v55
    v_mfma_f32_16x16x32_bf16 a[36:39], a[164:167], v[132:135], a[36:39]
    ds_read_b64_tr_b16 a[178:179], v20 offset:28672
    v_add_f32 v248, v248, v44
    v_add_f32 v248, v248, v45
    v_mfma_f32_16x16x32_bf16 a[68:71], a[164:167], v[136:139], a[68:71]
    v_mfma_f32_16x16x32_bf16 a[100:103], a[164:167], v[140:143], a[100:103]
    v_cvt_pk_bf16_f32 v114, v44, v45
    v_exp_f32 v40, v56
    s_waitcnt lgkmcnt(4)
    v_mfma_f32_16x16x32_bf16 v[96:99], a[128:131], v[192:195], v[152:155]
    v_exp_f32 v41, v57
    v_add_f32 v248, v248, v46
    v_mfma_f32_16x16x32_bf16 v[96:99], a[132:135], v[196:199], v[96:99]
    v_add_f32 v248, v248, v47
    v_cvt_pk_bf16_f32 v115, v46, v47
    s_add_u32 m0, s35, 24576
    v_mfma_f32_16x16x32_bf16 v[96:99], a[136:139], v[200:203], v[96:99]
    buffer_load_dwordx4 v24, s[20:23], s37 offen offset:0 nt lds
    v_exp_f32 v42, v58
    v_mfma_f32_16x16x32_bf16 v[96:99], a[140:143], v[204:207], v[96:99]
    v_mfma_f32_16x16x32_bf16 a[8:11], a[168:171], v[128:131], a[8:11]
    ds_read_b64_tr_b16 a[180:181], v21 offset:24576
    v_exp_f32 v43, v59
    v_mfma_f32_16x16x32_bf16 a[40:43], a[168:171], v[132:135], a[40:43]
    ds_read_b64_tr_b16 a[182:183], v21 offset:28672
    v_add_f32 v249, v40, v41
    v_cvt_pk_bf16_f32 v116, v40, v41
    v_mfma_f32_16x16x32_bf16 a[72:75], a[168:171], v[136:139], a[72:75]
    v_exp_f32 v44, v60
    v_exp_f32 v45, v61
    v_mfma_f32_16x16x32_bf16 a[104:107], a[168:171], v[140:143], a[104:107]
    v_mfma_f32_16x16x32_bf16 v[104:107], a[128:131], v[208:211], v[156:159]
    v_add_f32 v249, v249, v42
    v_add_f32 v249, v249, v43
    v_cvt_pk_bf16_f32 v117, v42, v43
    v_mfma_f32_16x16x32_bf16 v[104:107], a[132:135], v[212:215], v[104:107]
    v_mfma_f32_16x16x32_bf16 v[104:107], a[136:139], v[216:219], v[104:107]
    buffer_load_dwordx4 v25, s[20:23], s37 offen offset:1024 nt lds
    v_exp_f32 v46, v62
    s_add_u32 m0, s36, 8192
    v_mfma_f32_16x16x32_bf16 v[104:107], a[140:143], v[220:223], v[104:107]
    v_exp_f32 v47, v63
    s_add_u32 s37, s37, 2048
    v_mfma_f32_16x16x32_bf16 a[12:15], a[172:175], v[128:131], a[12:15]
    ds_read_b64_tr_b16 a[184:185], v22 offset:24576
    v_add_f32 v249, v249, v44
    v_add_f32 v249, v249, v45
    v_mfma_f32_16x16x32_bf16 a[44:47], a[172:175], v[132:135], a[44:47]
    ds_read_b64_tr_b16 a[186:187], v22 offset:28672
    v_cvt_pk_bf16_f32 v118, v44, v45
    v_exp_f32 v40, v64
    v_mfma_f32_16x16x32_bf16 a[76:79], a[172:175], v[136:139], a[76:79]
    v_exp_f32 v41, v65
    v_add_f32 v249, v249, v46
    v_mfma_f32_16x16x32_bf16 a[108:111], a[172:175], v[140:143], a[108:111]
    v_add_f32 v249, v249, v47
    v_cvt_pk_bf16_f32 v119, v46, v47
    s_waitcnt lgkmcnt(2)
    v_mfma_f32_16x16x32_bf16 v[84:87], a[144:147], v[160:163], v[144:147]
    v_mfma_f32_16x16x32_bf16 v[84:87], a[148:151], v[164:167], v[84:87]
    v_mfma_f32_16x16x32_bf16 v[84:87], a[152:155], v[168:171], v[84:87]
    buffer_load_dwordx4 v26, s[24:27], s41 offen offset:0 nt lds
    v_exp_f32 v42, v66
    v_mfma_f32_16x16x32_bf16 v[84:87], a[156:159], v[172:175], v[84:87]
    v_exp_f32 v43, v67
    v_add_f32 v250, v40, v41
    v_mfma_f32_16x16x32_bf16 a[16:19], a[176:179], v[128:131], a[16:19]
    ds_read_b64_tr_b16 a[188:189], v23 offset:24576
    v_cvt_pk_bf16_f32 v120, v40, v41
    v_exp_f32 v44, v68
    v_mfma_f32_16x16x32_bf16 a[48:51], a[176:179], v[132:135], a[48:51]
    ds_read_b64_tr_b16 a[190:191], v23 offset:28672
    v_exp_f32 v45, v69
    v_mfma_f32_16x16x32_bf16 a[80:83], a[176:179], v[136:139], a[80:83]
    v_mfma_f32_16x16x32_bf16 a[112:115], a[176:179], v[140:143], a[112:115]
    v_add_f32 v250, v250, v42
    v_add_f32 v250, v250, v43
    v_cvt_pk_bf16_f32 v121, v42, v43
    v_mfma_f32_16x16x32_bf16 v[92:95], a[144:147], v[176:179], v[148:151]
    v_mfma_f32_16x16x32_bf16 v[92:95], a[148:151], v[180:183], v[92:95]
    v_exp_f32 v46, v70
    v_exp_f32 v47, v71
    v_mfma_f32_16x16x32_bf16 v[92:95], a[152:155], v[184:187], v[92:95]
    buffer_load_dwordx4 v27, s[24:27], s41 offen offset:1024 nt lds
    v_add_f32 v250, v250, v44
    s_add_u32 s41, s41, 2048
    v_mfma_f32_16x16x32_bf16 v[92:95], a[156:159], v[188:191], v[92:95]
    v_mfma_f32_16x16x32_bf16 a[20:23], a[180:183], v[128:131], a[20:23]
    v_add_f32 v250, v250, v45
    v_cvt_pk_bf16_f32 v122, v44, v45
    v_exp_f32 v40, v72
    v_mfma_f32_16x16x32_bf16 a[52:55], a[180:183], v[132:135], a[52:55]
    v_mfma_f32_16x16x32_bf16 a[84:87], a[180:183], v[136:139], a[84:87]
    v_exp_f32 v41, v73
    v_add_f32 v250, v250, v46
    v_mfma_f32_16x16x32_bf16 a[116:119], a[180:183], v[140:143], a[116:119]
    v_add_f32 v250, v250, v47
    v_cvt_pk_bf16_f32 v123, v46, v47
    s_waitcnt lgkmcnt(0)
    v_mfma_f32_16x16x32_bf16 v[100:103], a[144:147], v[192:195], v[152:155]
    ds_read_b128 a[128:131], v8 offset:0
    v_exp_f32 v42, v74
    v_mfma_f32_16x16x32_bf16 v[100:103], a[148:151], v[196:199], v[100:103]
    ds_read_b128 a[132:135], v9 offset:0
    v_exp_f32 v43, v75
    v_mfma_f32_16x16x32_bf16 v[100:103], a[152:155], v[200:203], v[100:103]
    ds_read_b128 a[136:139], v10 offset:0
    v_add_f32 v251, v40, v41
    v_cvt_pk_bf16_f32 v124, v40, v41
    v_mfma_f32_16x16x32_bf16 v[100:103], a[156:159], v[204:207], v[100:103]
    ds_read_b128 a[140:143], v11 offset:0
    v_exp_f32 v44, v76
    v_mfma_f32_16x16x32_bf16 a[24:27], a[184:187], v[128:131], a[24:27]
    ds_read_b64_tr_b16 a[160:161], v16 offset:32768
    v_exp_f32 v45, v77
    v_mfma_f32_16x16x32_bf16 a[56:59], a[184:187], v[132:135], a[56:59]
    ds_read_b64_tr_b16 a[162:163], v16 offset:36864
    v_add_f32 v251, v251, v42
    v_add_f32 v251, v251, v43
    v_mfma_f32_16x16x32_bf16 a[88:91], a[184:187], v[136:139], a[88:91]
    v_mfma_f32_16x16x32_bf16 a[120:123], a[184:187], v[140:143], a[120:123]
    v_cvt_pk_bf16_f32 v125, v42, v43
    v_exp_f32 v46, v78
    v_mfma_f32_16x16x32_bf16 v[108:111], a[144:147], v[208:211], v[156:159]
    ds_read_b64_tr_b16 a[164:165], v17 offset:32768
    v_exp_f32 v47, v79
    v_mfma_f32_16x16x32_bf16 v[108:111], a[148:151], v[212:215], v[108:111]
    ds_read_b64_tr_b16 a[166:167], v17 offset:36864
    v_add_f32 v251, v251, v44
    v_add_f32 v251, v251, v45
    v_mfma_f32_16x16x32_bf16 v[108:111], a[152:155], v[216:219], v[108:111]
    v_mfma_f32_16x16x32_bf16 v[108:111], a[156:159], v[220:223], v[108:111]
    v_cvt_pk_bf16_f32 v126, v44, v45
    v_add_f32 v251, v251, v46
    v_add_f32 v251, v251, v47
    v_mfma_f32_16x16x32_bf16 a[28:31], a[188:191], v[128:131], a[28:31]
    ds_read_b64_tr_b16 a[168:169], v18 offset:32768
    v_cvt_pk_bf16_f32 v127, v46, v47
    v_max3_f32 v35, v248, v249, v250
    v_mfma_f32_16x16x32_bf16 a[60:63], a[188:191], v[132:135], a[60:63]
    ds_read_b64_tr_b16 a[170:171], v18 offset:36864
    v_max_f32 v35, v35, v251
    v_cmp_lt_f32 vcc, s40, v35
    v_mfma_f32_16x16x32_bf16 a[92:95], a[188:191], v[136:139], a[92:95]
    v_mfma_f32_16x16x32_bf16 a[124:127], a[188:191], v[140:143], a[124:127]
    s_cbranch_vccnz L_rare_h0p4
L_ret_h0p4:
    s_waitcnt lgkmcnt(2)
    v_mfma_f32_16x16x32_bf16 v[48:51], a[128:131], v[160:163], v[144:147]
    ds_read_b128 a[144:147], v8 offset:4096
    v_add_f32 v244, v244, v248
    v_mfma_f32_16x16x32_bf16 v[48:51], a[132:135], v[164:167], v[48:51]
    v_add_f32 v245, v245, v249
    v_add_f32 v246, v246, v250
    v_add_f32 v247, v247, v251
    v_mfma_f32_16x16x32_bf16 v[48:51], a[136:139], v[168:171], v[48:51]
    ds_read_b128 a[148:151], v9 offset:4096
    v_exp_f32 v40, v80
    v_mfma_f32_16x16x32_bf16 v[48:51], a[140:143], v[172:175], v[48:51]
    v_mfma_f32_16x16x32_bf16 a[0:3], a[160:163], v[112:115], a[0:3]
    ds_read_b64_tr_b16 a[172:173], v19 offset:32768
    v_exp_f32 v41, v81
    v_mfma_f32_16x16x32_bf16 a[32:35], a[160:163], v[116:119], a[32:35]
    ds_read_b64_tr_b16 a[174:175], v19 offset:36864
    v_exp_f32 v42, v82
    v_mfma_f32_16x16x32_bf16 a[64:67], a[160:163], v[120:123], a[64:67]
    v_exp_f32 v43, v83
    v_add_f32 v4, v40, v41
    v_mfma_f32_16x16x32_bf16 a[96:99], a[160:163], v[124:127], a[96:99]
    v_cvt_pk_bf16_f32 v128, v40, v41
    v_exp_f32 v44, v84
    v_mfma_f32_16x16x32_bf16 v[56:59], a[128:131], v[176:179], v[148:151]
    ds_read_b128 a[152:155], v10 offset:4096
    v_exp_f32 v45, v85
    v_mfma_f32_16x16x32_bf16 v[56:59], a[132:135], v[180:183], v[56:59]
    v_add_f32 v4, v4, v42
    v_add_f32 v4, v4, v43
    v_cvt_pk_bf16_f32 v129, v42, v43
    v_mfma_f32_16x16x32_bf16 v[56:59], a[136:139], v[184:187], v[56:59]
    ds_read_b128 a[156:159], v11 offset:4096
    v_exp_f32 v46, v86
    v_mfma_f32_16x16x32_bf16 v[56:59], a[140:143], v[188:191], v[56:59]
    v_mfma_f32_16x16x32_bf16 a[4:7], a[164:167], v[112:115], a[4:7]
    ds_read_b64_tr_b16 a[176:177], v20 offset:32768
    v_exp_f32 v47, v87
    v_mfma_f32_16x16x32_bf16 a[36:39], a[164:167], v[116:119], a[36:39]
    ds_read_b64_tr_b16 a[178:179], v20 offset:36864
    v_add_f32 v4, v4, v44
    v_add_f32 v4, v4, v45
    v_mfma_f32_16x16x32_bf16 a[68:71], a[164:167], v[120:123], a[68:71]
    v_cvt_pk_bf16_f32 v130, v44, v45
    v_exp_f32 v40, v88
    v_mfma_f32_16x16x32_bf16 a[100:103], a[164:167], v[124:127], a[100:103]
    v_exp_f32 v41, v89
    s_waitcnt lgkmcnt(4)
    v_mfma_f32_16x16x32_bf16 v[64:67], a[128:131], v[192:195], v[152:155]
    v_add_f32 v4, v4, v46
    v_add_f32 v4, v4, v47
    v_cvt_pk_bf16_f32 v131, v46, v47
    v_mfma_f32_16x16x32_bf16 v[64:67], a[132:135], v[196:199], v[64:67]
    v_exp_f32 v42, v90
    s_add_u32 m0, s35, 32768
    v_mfma_f32_16x16x32_bf16 v[64:67], a[136:139], v[200:203], v[64:67]
    buffer_load_dwordx4 v24, s[20:23], s37 offen offset:0 nt lds
    v_exp_f32 v43, v91
    v_mfma_f32_16x16x32_bf16 v[64:67], a[140:143], v[204:207], v[64:67]
    v_add_f32 v5, v40, v41
    v_cvt_pk_bf16_f32 v132, v40, v41
    v_mfma_f32_16x16x32_bf16 a[8:11], a[168:171], v[112:115], a[8:11]
    ds_read_b64_tr_b16 a[180:181], v21 offset:32768
    v_exp_f32 v44, v92
    v_mfma_f32_16x16x32_bf16 a[40:43], a[168:171], v[116:119], a[40:43]
    ds_read_b64_tr_b16 a[182:183], v21 offset:36864
    v_exp_f32 v45, v93
    v_mfma_f32_16x16x32_bf16 a[72:75], a[168:171], v[120:123], a[72:75]
    v_mfma_f32_16x16x32_bf16 a[104:107], a[168:171], v[124:127], a[104:107]
    v_add_f32 v5, v5, v42
    v_add_f32 v5, v5, v43
    v_mfma_f32_16x16x32_bf16 v[72:75], a[128:131], v[208:211], v[156:159]
    v_cvt_pk_bf16_f32 v133, v42, v43
    v_exp_f32 v46, v94
    v_mfma_f32_16x16x32_bf16 v[72:75], a[132:135], v[212:215], v[72:75]
    v_exp_f32 v47, v95
    v_mfma_f32_16x16x32_bf16 v[72:75], a[136:139], v[216:219], v[72:75]
    buffer_load_dwordx4 v25, s[20:23], s37 offen offset:1024 nt lds
    v_add_f32 v5, v5, v44
    s_add_u32 m0, s36, 16384
    v_mfma_f32_16x16x32_bf16 v[72:75], a[140:143], v[220:223], v[72:75]
    v_add_f32 v5, v5, v45
    v_cvt_pk_bf16_f32 v134, v44, v45
    s_add_u32 s37, s37, 2048
    v_mfma_f32_16x16x32_bf16 a[12:15], a[172:175], v[112:115], a[12:15]
    ds_read_b64_tr_b16 a[184:185], v22 offset:32768
    v_exp_f32 v40, v96
    v_mfma_f32_16x16x32_bf16 a[44:47], a[172:175], v[116:119], a[44:47]
    ds_read_b64_tr_b16 a[186:187], v22 offset:36864
    v_exp_f32 v41, v97
    v_mfma_f32_16x16x32_bf16 a[76:79], a[172:175], v[120:123], a[76:79]
    v_mfma_f32_16x16x32_bf16 a[108:111], a[172:175], v[124:127], a[108:111]
    v_add_f32 v5, v5, v46
    v_add_f32 v5, v5, v47
    s_waitcnt lgkmcnt(2)
    v_mfma_f32_16x16x32_bf16 v[52:55], a[144:147], v[160:163], v[144:147]
    v_cvt_pk_bf16_f32 v135, v46, v47
    v_exp_f32 v42, v98
    v_mfma_f32_16x16x32_bf16 v[52:55], a[148:151], v[164:167], v[52:55]
    v_exp_f32 v43, v99
    v_mfma_f32_16x16x32_bf16 v[52:55], a[152:155], v[168:171], v[52:55]
    buffer_load_dwordx4 v26, s[24:27], s41 offen offset:0 nt lds
    v_add_f32 v6, v40, v41
    v_cvt_pk_bf16_f32 v136, v40, v41
    v_mfma_f32_16x16x32_bf16 v[52:55], a[156:159], v[172:175], v[52:55]
    v_mfma_f32_16x16x32_bf16 a[16:19], a[176:179], v[112:115], a[16:19]
    ds_read_b64_tr_b16 a[188:189], v23 offset:32768
    v_exp_f32 v44, v100
    v_mfma_f32_16x16x32_bf16 a[48:51], a[176:179], v[116:119], a[48:51]
    ds_read_b64_tr_b16 a[190:191], v23 offset:36864
    v_exp_f32 v45, v101
    v_mfma_f32_16x16x32_bf16 a[80:83], a[176:179], v[120:123], a[80:83]
    v_add_f32 v6, v6, v42
    v_add_f32 v6, v6, v43
    v_mfma_f32_16x16x32_bf16 a[112:115], a[176:179], v[124:127], a[112:115]
    v_cvt_pk_bf16_f32 v137, v42, v43
    v_exp_f32 v46, v102
    v_mfma_f32_16x16x32_bf16 v[60:63], a[144:147], v[176:179], v[148:151]
    v_exp_f32 v47, v103
    v_mfma_f32_16x16x32_bf16 v[60:63], a[148:151], v[180:183], v[60:63]
    v_mfma_f32_16x16x32_bf16 v[60:63], a[152:155], v[184:187], v[60:63]
    buffer_load_dwordx4 v27, s[24:27], s41 offen offset:1024 nt lds
    s_add_u32 s41, s41, 2048
    v_mfma_f32_16x16x32_bf16 v[60:63], a[156:159], v[188:191], v[60:63]
    v_add_f32 v6, v6, v44
    v_add_f32 v6, v6, v45
    v_mfma_f32_16x16x32_bf16 a[20:23], a[180:183], v[112:115], a[20:23]
    v_cvt_pk_bf16_f32 v138, v44, v45
    v_exp_f32 v40, v104
    v_mfma_f32_16x16x32_bf16 a[52:55], a[180:183], v[116:119], a[52:55]
    v_exp_f32 v41, v105
    v_mfma_f32_16x16x32_bf16 a[84:87], a[180:183], v[120:123], a[84:87]
    v_mfma_f32_16x16x32_bf16 a[116:119], a[180:183], v[124:127], a[116:119]
    s_waitcnt vmcnt(8) lgkmcnt(0)
    s_barrier
    v_mfma_f32_16x16x32_bf16 v[68:71], a[144:147], v[192:195], v[152:155]
    ds_read_b128 a[128:131], v8 offset:8192
    v_add_f32 v6, v6, v46
    v_mfma_f32_16x16x32_bf16 v[68:71], a[148:151], v[196:199], v[68:71]
    ds_read_b128 a[132:135], v9 offset:8192
    v_add_f32 v6, v6, v47
    v_cvt_pk_bf16_f32 v139, v46, v47
    v_mfma_f32_16x16x32_bf16 v[68:71], a[152:155], v[200:203], v[68:71]
    ds_read_b128 a[136:139], v10 offset:8192
    v_exp_f32 v42, v106
    v_mfma_f32_16x16x32_bf16 v[68:71], a[156:159], v[204:207], v[68:71]
    ds_read_b128 a[140:143], v11 offset:8192
    v_exp_f32 v43, v107
    v_mfma_f32_16x16x32_bf16 a[24:27], a[184:187], v[112:115], a[24:27]
    ds_read_b64_tr_b16 a[160:161], v16 offset:40960
    v_add_f32 v7, v40, v41
    v_cvt_pk_bf16_f32 v140, v40, v41
    v_mfma_f32_16x16x32_bf16 a[56:59], a[184:187], v[116:119], a[56:59]
    ds_read_b64_tr_b16 a[162:163], v16 offset:45056
    v_exp_f32 v44, v108
    v_mfma_f32_16x16x32_bf16 a[88:91], a[184:187], v[120:123], a[88:91]
    v_exp_f32 v45, v109
    v_mfma_f32_16x16x32_bf16 a[120:123], a[184:187], v[124:127], a[120:123]
    v_add_f32 v7, v7, v42
    v_add_f32 v7, v7, v43
    v_cvt_pk_bf16_f32 v141, v42, v43
    v_mfma_f32_16x16x32_bf16 v[76:79], a[144:147], v[208:211], v[156:159]
    ds_read_b64_tr_b16 a[164:165], v17 offset:40960
    v_exp_f32 v46, v110
    v_mfma_f32_16x16x32_bf16 v[76:79], a[148:151], v[212:215], v[76:79]
    ds_read_b64_tr_b16 a[166:167], v17 offset:45056
    v_exp_f32 v47, v111
    v_mfma_f32_16x16x32_bf16 v[76:79], a[152:155], v[216:219], v[76:79]
    v_add_f32 v7, v7, v44
    v_add_f32 v7, v7, v45
    v_mfma_f32_16x16x32_bf16 v[76:79], a[156:159], v[220:223], v[76:79]
    v_mfma_f32_16x16x32_bf16 a[28:31], a[188:191], v[112:115], a[28:31]
    ds_read_b64_tr_b16 a[168:169], v18 offset:40960
    v_cvt_pk_bf16_f32 v142, v44, v45
    v_add_f32 v7, v7, v46
    v_mfma_f32_16x16x32_bf16 a[60:63], a[188:191], v[116:119], a[60:63]
    ds_read_b64_tr_b16 a[170:171], v18 offset:45056
    v_add_f32 v7, v7, v47
    v_cvt_pk_bf16_f32 v143, v46, v47
    v_mfma_f32_16x16x32_bf16 a[92:95], a[188:191], v[120:123], a[92:95]
    v_max3_f32 v35, v4, v5, v6
    v_max_f32 v35, v35, v7
    v_cmp_lt_f32 vcc, s40, v35
    v_mfma_f32_16x16x32_bf16 a[124:127], a[188:191], v[124:127], a[124:127]
    s_cbranch_vccnz L_rare_h0p5
L_ret_h0p5:
    s_waitcnt lgkmcnt(2)
    v_mfma_f32_16x16x32_bf16 v[80:83], a[128:131], v[160:163], v[144:147]
    ds_read_b128 a[144:147], v8 offset:12288
    v_add_f32 v244, v244, v4
    v_mfma_f32_16x16x32_bf16 v[80:83], a[132:135], v[164:167], v[80:83]
    v_add_f32 v245, v245, v5
    v_add_f32 v246, v246, v6
    v_add_f32 v247, v247, v7
    v_mfma_f32_16x16x32_bf16 v[80:83], a[136:139], v[168:171], v[80:83]
    ds_read_b128 a[148:151], v9 offset:12288
    v_exp_f32 v40, v48
    v_mfma_f32_16x16x32_bf16 v[80:83], a[140:143], v[172:175], v[80:83]
    v_mfma_f32_16x16x32_bf16 a[0:3], a[160:163], v[128:131], a[0:3]
    ds_read_b64_tr_b16 a[172:173], v19 offset:40960
    v_exp_f32 v41, v49
    v_mfma_f32_16x16x32_bf16 a[32:35], a[160:163], v[132:135], a[32:35]
    ds_read_b64_tr_b16 a[174:175], v19 offset:45056
    v_exp_f32 v42, v50
    v_mfma_f32_16x16x32_bf16 a[64:67], a[160:163], v[136:139], a[64:67]
    v_exp_f32 v43, v51
    v_add_f32 v248, v40, v41
    v_mfma_f32_16x16x32_bf16 a[96:99], a[160:163], v[140:143], a[96:99]
    v_cvt_pk_bf16_f32 v112, v40, v41
    v_exp_f32 v44, v52
    v_mfma_f32_16x16x32_bf16 v[88:91], a[128:131], v[176:179], v[148:151]
    ds_read_b128 a[152:155], v10 offset:12288
    v_exp_f32 v45, v53
    v_mfma_f32_16x16x32_bf16 v[88:91], a[132:135], v[180:183], v[88:91]
    v_add_f32 v248, v248, v42
    v_add_f32 v248, v248, v43
    v_cvt_pk_bf16_f32 v113, v42, v43
    v_mfma_f32_16x16x32_bf16 v[88:91], a[136:139], v[184:187], v[88:91]
    ds_read_b128 a[156:159], v11 offset:12288
    v_exp_f32 v46, v54
    v_mfma_f32_16x16x32_bf16 v[88:91], a[140:143], v[188:191], v[88:91]
    v_mfma_f32_16x16x32_bf16 a[4:7], a[164:167], v[128:131], a[4:7]
    ds_read_b64_tr_b16 a[176:177], v20 offset:40960
    v_exp_f32 v47, v55
    v_mfma_f32_16x16x32_bf16 a[36:39], a[164:167], v[132:135], a[36:39]
    ds_read_b64_tr_b16 a[178:179], v20 offset:45056
    v_add_f32 v248, v248, v44
    v_add_f32 v248, v248, v45
    v_mfma_f32_16x16x32_bf16 a[68:71], a[164:167], v[136:139], a[68:71]
    v_cvt_pk_bf16_f32 v114, v44, v45
    v_exp_f32 v40, v56
    v_mfma_f32_16x16x32_bf16 a[100:103], a[164:167], v[140:143], a[100:103]
    v_exp_f32 v41, v57
    s_waitcnt lgkmcnt(4)
    v_mfma_f32_16x16x32_bf16 v[96:99], a[128:131], v[192:195], v[152:155]
    v_add_f32 v248, v248, v46
    v_add_f32 v248, v248, v47
    v_cvt_pk_bf16_f32 v115, v46, v47
    v_mfma_f32_16x16x32_bf16 v[96:99], a[132:135], v[196:199], v[96:99]
    v_exp_f32 v42, v58
    s_add_u32 m0, s35, 40960
    v_mfma_f32_16x16x32_bf16 v[96:99], a[136:139], v[200:203], v[96:99]
    buffer_load_dwordx4 v24, s[20:23], s37 offen offset:0 nt lds
    v_exp_f32 v43, v59
    v_mfma_f32_16x16x32_bf16 v[96:99], a[140:143], v[204:207], v[96:99]
    v_add_f32 v249, v40, v41
    v_cvt_pk_bf16_f32 v116, v40, v41
    v_mfma_f32_16x16x32_bf16 a[8:11], a[168:171], v[128:131], a[8:11]
    ds_read_b64_tr_b16 a[180:181], v21 offset:40960
    v_exp_f32 v44, v60
    v_mfma_f32_16x16x32_bf16 a[40:43], a[168:171], v[132:135], a[40:43]
    ds_read_b64_tr_b16 a[182:183], v21 offset:45056
    v_exp_f32 v45, v61
    v_mfma_f32_16x16x32_bf16 a[72:75], a[168:171], v[136:139], a[72:75]
    v_mfma_f32_16x16x32_bf16 a[104:107], a[168:171], v[140:143], a[104:107]
    v_add_f32 v249, v249, v42
    v_add_f32 v249, v249, v43
    v_mfma_f32_16x16x32_bf16 v[104:107], a[128:131], v[208:211], v[156:159]
    v_cvt_pk_bf16_f32 v117, v42, v43
    v_exp_f32 v46, v62
    v_mfma_f32_16x16x32_bf16 v[104:107], a[132:135], v[212:215], v[104:107]
    v_exp_f32 v47, v63
    v_mfma_f32_16x16x32_bf16 v[104:107], a[136:139], v[216:219], v[104:107]
    buffer_load_dwordx4 v25, s[20:23], s37 offen offset:1024 nt lds
    s_add_u32 m0, s36, 24576
    v_mfma_f32_16x16x32_bf16 v[104:107], a[140:143], v[220:223], v[104:107]
    v_add_f32 v249, v249, v44
    s_add_u32 s37, s37, 2048
    v_mfma_f32_16x16x32_bf16 a[12:15], a[172:175], v[128:131], a[12:15]
    ds_read_b64_tr_b16 a[184:185], v22 offset:40960
    v_add_f32 v249, v249, v45
    v_cvt_pk_bf16_f32 v118, v44, v45
    v_mfma_f32_16x16x32_bf16 a[44:47], a[172:175], v[132:135], a[44:47]
    ds_read_b64_tr_b16 a[186:187], v22 offset:45056
    v_exp_f32 v40, v64
    v_mfma_f32_16x16x32_bf16 a[76:79], a[172:175], v[136:139], a[76:79]
    v_mfma_f32_16x16x32_bf16 a[108:111], a[172:175], v[140:143], a[108:111]
    v_exp_f32 v41, v65
    s_waitcnt lgkmcnt(2)
    v_mfma_f32_16x16x32_bf16 v[84:87], a[144:147], v[160:163], v[144:147]
    v_add_f32 v249, v249, v46
    v_add_f32 v249, v249, v47
    v_mfma_f32_16x16x32_bf16 v[84:87], a[148:151], v[164:167], v[84:87]
    v_cvt_pk_bf16_f32 v119, v46, v47
    v_exp_f32 v42, v66
    v_mfma_f32_16x16x32_bf16 v[84:87], a[152:155], v[168:171], v[84:87]
    buffer_load_dwordx4 v26, s[24:27], s41 offen offset:0 nt lds
    v_exp_f32 v43, v67
    v_mfma_f32_16x16x32_bf16 v[84:87], a[156:159], v[172:175], v[84:87]
    v_mfma_f32_16x16x32_bf16 a[16:19], a[176:179], v[128:131], a[16:19]
    ds_read_b64_tr_b16 a[188:189], v23 offset:40960
    v_add_f32 v250, v40, v41
    v_cvt_pk_bf16_f32 v120, v40, v41
    v_mfma_f32_16x16x32_bf16 a[48:51], a[176:179], v[132:135], a[48:51]
    ds_read_b64_tr_b16 a[190:191], v23 offset:45056
    v_exp_f32 v44, v68
    v_mfma_f32_16x16x32_bf16 a[80:83], a[176:179], v[136:139], a[80:83]
    v_exp_f32 v45, v69
    v_mfma_f32_16x16x32_bf16 a[112:115], a[176:179], v[140:143], a[112:115]
    v_add_f32 v250, v250, v42
    v_add_f32 v250, v250, v43
    v_mfma_f32_16x16x32_bf16 v[92:95], a[144:147], v[176:179], v[148:151]
    v_cvt_pk_bf16_f32 v121, v42, v43
    v_exp_f32 v46, v70
    v_mfma_f32_16x16x32_bf16 v[92:95], a[148:151], v[180:183], v[92:95]
    v_mfma_f32_16x16x32_bf16 v[92:95], a[152:155], v[184:187], v[92:95]
    buffer_load_dwordx4 v27, s[24:27], s41 offen offset:1024 nt lds
    s_add_u32 s41, s41, 2048
    v_mfma_f32_16x16x32_bf16 v[92:95], a[156:159], v[188:191], v[92:95]
    v_exp_f32 v47, v71
    v_mfma_f32_16x16x32_bf16 a[20:23], a[180:183], v[128:131], a[20:23]
    v_add_f32 v250, v250, v44
    v_add_f32 v250, v250, v45
    v_mfma_f32_16x16x32_bf16 a[52:55], a[180:183], v[132:135], a[52:55]
    v_cvt_pk_bf16_f32 v122, v44, v45
    v_exp_f32 v40, v72
    v_mfma_f32_16x16x32_bf16 a[84:87], a[180:183], v[136:139], a[84:87]
    v_mfma_f32_16x16x32_bf16 a[116:119], a[180:183], v[140:143], a[116:119]
    v_exp_f32 v41, v73
    s_waitcnt lgkmcnt(0)
    v_mfma_f32_16x16x32_bf16 v[100:103], a[144:147], v[192:195], v[152:155]
    ds_read_b128 a[128:131], v8 offset:16384
    v_add_f32 v250, v250, v46
    v_mfma_f32_16x16x32_bf16 v[100:103], a[148:151], v[196:199], v[100:103]
    ds_read_b128 a[132:135], v9 offset:16384
    v_add_f32 v250, v250, v47
    v_cvt_pk_bf16_f32 v123, v46, v47
    v_mfma_f32_16x16x32_bf16 v[100:103], a[152:155], v[200:203], v[100:103]
    ds_read_b128 a[136:139], v10 offset:16384
    v_exp_f32 v42, v74
    v_mfma_f32_16x16x32_bf16 v[100:103], a[156:159], v[204:207], v[100:103]
    ds_read_b128 a[140:143], v11 offset:16384
    v_exp_f32 v43, v75
    v_mfma_f32_16x16x32_bf16 a[24:27], a[184:187], v[128:131], a[24:27]
    ds_read_b64_tr_b16 a[160:161], v16 offset:0
    v_add_f32 v251, v40, v41
    v_cvt_pk_bf16_f32 v124, v40, v41
    v_mfma_f32_16x16x32_bf16 a[56:59], a[184:187], v[132:135], a[56:59]
    ds_read_b64_tr_b16 a[162:163], v16 offset:4096
    v_exp_f32 v44, v76
    v_mfma_f32_16x16x32_bf16 a[88:91], a[184:187], v[136:139], a[88:91]
    v_exp_f32 v45, v77
    v_mfma_f32_16x16x32_bf16 a[120:123], a[184:187], v[140:143], a[120:123]
    v_add_f32 v251, v251, v42
    v_add_f32 v251, v251, v43
    v_cvt_pk_bf16_f32 v125, v42, v43
    v_mfma_f32_16x16x32_bf16 v[108:111], a[144:147], v[208:211], v[156:159]
    ds_read_b64_tr_b16 a[164:165], v17 offset:0
    v_exp_f32 v46, v78
    v_mfma_f32_16x16x32_bf16 v[108:111], a[148:151], v[212:215], v[108:111]
    ds_read_b64_tr_b16 a[166:167], v17 offset:4096
    v_exp_f32 v47, v79
    v_mfma_f32_16x16x32_bf16 v[108:111], a[152:155], v[216:219], v[108:111]
    v_add_f32 v251, v251, v44
    v_add_f32 v251, v251, v45
    v_mfma_f32_16x16x32_bf16 v[108:111], a[156:159], v[220:223], v[108:111]
    v_mfma_f32_16x16x32_bf16 a[28:31], a[188:191], v[128:131], a[28:31]
    ds_read_b64_tr_b16 a[168:169], v18 offset:0
    v_cvt_pk_bf16_f32 v126, v44, v45
    v_add_f32 v251, v251, v46
    v_mfma_f32_16x16x32_bf16 a[60:63], a[188:191], v[132:135], a[60:63]
    ds_read_b64_tr_b16 a[170:171], v18 offset:4096
    v_add_f32 v251, v251, v47
    v_cvt_pk_bf16_f32 v127, v46, v47
    v_mfma_f32_16x16x32_bf16 a[92:95], a[188:191], v[136:139], a[92:95]
    v_max3_f32 v35, v248, v249, v250
    v_max_f32 v35, v35, v251
    v_cmp_lt_f32 vcc, s40, v35
    v_mfma_f32_16x16x32_bf16 a[124:127], a[188:191], v[140:143], a[124:127]
    s_cbranch_vccnz L_rare_h0p6
L_ret_h0p6:
    s_waitcnt lgkmcnt(2)
    s_mov_b32 s39, 4
    s_add_u32 s43, s42, 65536
    s_mov_b32 s44, s42
L_loop0:
    v_mfma_f32_16x16x32_bf16 v[48:51], a[128:131], v[160:163], v[144:147]
    ds_read_b128 a[144:147], v8 offset:20480
    v_add_f32 v244, v244, v248
    v_mfma_f32_16x16x32_bf16 v[48:51], a[132:135], v[164:167], v[48:51]
    v_add_f32 v245, v245, v249
    v_add_f32 v246, v246, v250
    v_mfma_f32_16x16x32_bf16 v[48:51], a[136:139], v[168:171], v[48:51]
    ds_read_b128 a[148:151], v9 offset:20480
    v_add_f32 v247, v247, v251
    v_mfma_f32_16x16x32_bf16 v[48:51], a[140:143], v[172:175], v[48:51]
    v_exp_f32 v40, v80
    v_mfma_f32_16x16x32_bf16 a[0:3], a[160:163], v[112:115], a[0:3]
    ds_read_b64_tr_b16 a[172:173], v19 offset:0
    v_exp_f32 v41, v81
    v_mfma_f32_16x16x32_bf16 a[32:35], a[160:163], v[116:119], a[32:35]
    ds_read_b64_tr_b16 a[174:175], v19 offset:4096
    v_exp_f32 v42, v82
    v_mfma_f32_16x16x32_bf16 a[64:67], a[160:163], v[120:123], a[64:67]
    v_exp_f32 v43, v83
    v_mfma_f32_16x16x32_bf16 a[96:99], a[160:163], v[124:127], a[96:99]
    v_add_f32 v4, v40, v41
    v_cvt_pk_bf16_f32 v128, v40, v41
    v_mfma_f32_16x16x32_bf16 v[56:59], a[128:131], v[176:179], v[148:151]
    ds_read_b128 a[152:155], v10 offset:20480
    v_exp_f32 v44, v84
    v_mfma_f32_16x16x32_bf16 v[56:59], a[132:135], v[180:183], v[56:59]
    v_exp_f32 v45, v85
    v_mfma_f32_16x16x32_bf16 v[56:59], a[136:139], v[184:187], v[56:59]
    ds_read_b128 a[156:159], v11 offset:20480
    v_add_f32 v4, v4, v42
    v_mfma_f32_16x16x32_bf16 v[56:59], a[140:143], v[188:191], v[56:59]
    v_add_f32 v4, v4, v43
    v_cvt_pk_bf16_f32 v129, v42, v43
    v_mfma_f32_16x16x32_bf16 a[4:7], a[164:167], v[112:115], a[4:7]
    ds_read_b64_tr_b16 a[176:177], v20 offset:0
    v_exp_f32 v46, v86
    v_mfma_f32_16x16x32_bf16 a[36:39], a[164:167], v[116:119], a[36:39]
    ds_read_b64_tr_b16 a[178:179], v20 offset:4096
    v_exp_f32 v47, v87
    v_mfma_f32_16x16x32_bf16 a[68:71], a[164:167], v[120:123], a[68:71]
    v_add_f32 v4, v4, v44
    v_add_f32 v4, v4, v45
    v_mfma_f32_16x16x32_bf16 a[100:103], a[164:167], v[124:127], a[100:103]
    v_cvt_pk_bf16_f32 v130, v44, v45
    s_waitcnt lgkmcnt(4)
    v_mfma_f32_16x16x32_bf16 v[64:67], a[128:131], v[192:195], v[152:155]
    v_exp_f32 v40, v88
    v_mfma_f32_16x16x32_bf16 v[64:67], a[132:135], v[196:199], v[64:67]
    v_exp_f32 v41, v89
    s_add_u32 m0, s35, 0
    v_mfma_f32_16x16x32_bf16 v[64:67], a[136:139], v[200:203], v[64:67]
    buffer_load_dwordx4 v24, s[20:23], s37 offen offset:0 nt lds
    v_add_f32 v4, v4, v46
    v_mfma_f32_16x16x32_bf16 v[64:67], a[140:143], v[204:207], v[64:67]
    v_add_f32 v4, v4, v47
    v_cvt_pk_bf16_f32 v131, v46, v47
    v_mfma_f32_16x16x32_bf16 a[8:11], a[168:171], v[112:115], a[8:11]
    ds_read_b64_tr_b16 a[180:181], v21 offset:0
    v_exp_f32 v42, v90
    v_mfma_f32_16x16x32_bf16 a[40:43], a[168:171], v[116:119], a[40:43]
    ds_read_b64_tr_b16 a[182:183], v21 offset:4096
    v_exp_f32 v43, v91
    v_mfma_f32_16x16x32_bf16 a[72:75], a[168:171], v[120:123], a[72:75]
    v_add_f32 v5, v40, v41
    v_cvt_pk_bf16_f32 v132, v40, v41
    v_mfma_f32_16x16x32_bf16 a[104:107], a[168:171], v[124:127], a[104:107]
    v_exp_f32 v44, v92
    v_mfma_f32_16x16x32_bf16 v[72:75], a[128:131], v[208:211], v[156:159]
    v_exp_f32 v45, v93
    v_mfma_f32_16x16x32_bf16 v[72:75], a[132:135], v[212:215], v[72:75]
    v_add_f32 v5, v5, v42
    v_add_f32 v5, v5, v43
    v_mfma_f32_16x16x32_bf16 v[72:75], a[136:139], v[216:219], v[72:75]
    buffer_load_dwordx4 v25, s[20:23], s37 offen offset:1024 nt lds
    s_add_u32 m0, s36, 32768
    v_mfma_f32_16x16x32_bf16 v[72:75], a[140:143], v[220:223], v[72:75]
    v_cvt_pk_bf16_f32 v133, v42, v43
    s_add_u32 s37, s37, 2048
    v_mfma_f32_16x16x32_bf16 a[12:15], a[172:175], v[112:115], a[12:15]
    ds_read_b64_tr_b16 a[184:185], v22 offset:0
    v_exp_f32 v46, v94
    v_mfma_f32_16x16x32_bf16 a[44:47], a[172:175], v[116:119], a[44:47]
    ds_read_b64_tr_b16 a[186:187], v22 offset:4096
    v_exp_f32 v47, v95
    v_mfma_f32_16x16x32_bf16 a[76:79], a[172:175], v[120:123], a[76:79]
    v_add_f32 v5, v5, v44
    v_add_f32 v5, v5, v45
    v_mfma_f32_16x16x32_bf16 a[108:111], a[172:175], v[124:127], a[108:111]
    v_cvt_pk_bf16_f32 v134, v44, v45
    s_waitcnt lgkmcnt(2)
    v_mfma_f32_16x16x32_bf16 v[52:55], a[144:147], v[160:163], v[144:147]
    v_exp_f32 v40, v96
    v_mfma_f32_16x16x32_bf16 v[52:55], a[148:151], v[164:167], v[52:55]
    v_exp_f32 v41, v97
    v_mfma_f32_16x16x32_bf16 v[52:55], a[152:155], v[168:171], v[52:55]
    buffer_load_dwordx4 v26, s[24:27], s41 offen offset:0 nt lds
    v_add_f32 v5, v5, v46
    v_mfma_f32_16x16x32_bf16 v[52:55], a[156:159], v[172:175], v[52:55]
    v_add_f32 v5, v5, v47
    v_cvt_pk_bf16_f32 v135, v46, v47
    v_mfma_f32_16x16x32_bf16 a[16:19], a[176:179], v[112:115], a[16:19]
    ds_read_b64_tr_b16 a[188:189], v23 offset:0
    v_exp_f32 v42, v98
    v_mfma_f32_16x16x32_bf16 a[48:51], a[176:179], v[116:119], a[48:51]
    ds_read_b64_tr_b16 a[190:191], v23 offset:4096
    v_exp_f32 v43, v99
    v_mfma_f32_16x16x32_bf16 a[80:83], a[176:179], v[120:123], a[80:83]
    v_add_f32 v6, v40, v41
    v_cvt_pk_bf16_f32 v136, v40, v41
    v_mfma_f32_16x16x32_bf16 a[112:115], a[176:179], v[124:127], a[112:115]
    v_exp_f32 v44, v100
    v_mfma_f32_16x16x32_bf16 v[60:63], a[144:147], v[176:179], v[148:151]
    v_exp_f32 v45, v101
    v_mfma_f32_16x16x32_bf16 v[60:63], a[148:151], v[180:183], v[60:63]
    v_add_f32 v6, v6, v42
    v_add_f32 v6, v6, v43
    v_mfma_f32_16x16x32_bf16 v[60:63], a[152:155], v[184:187], v[60:63]
    buffer_load_dwordx4 v27, s[24:27], s41 offen offset:1024 nt lds
    s_add_u32 s41, s41, 2048
    v_mfma_f32_16x16x32_bf16 v[60:63], a[156:159], v[188:191], v[60:63]
    v_cvt_pk_bf16_f32 v137, v42, v43
    v_exp_f32 v46, v102
    v_mfma_f32_16x16x32_bf16 a[20:23], a[180:183], v[112:115], a[20:23]
    v_exp_f32 v47, v103
    v_mfma_f32_16x16x32_bf16 a[52:55], a[180:183], v[116:119], a[52:55]
    v_add_f32 v6, v6, v44
    v_add_f32 v6, v6, v45
    v_mfma_f32_16x16x32_bf16 a[84:87], a[180:183], v[120:123], a[84:87]
    v_cvt_pk_bf16_f32 v138, v44, v45
    v_exp_f32 v40, v104
    v_mfma_f32_16x16x32_bf16 a[116:119], a[180:183], v[124:127], a[116:119]
    s_waitcnt vmcnt(8) lgkmcnt(0)
    s_barrier
    v_mfma_f32_16x16x32_bf16 v[68:71], a[144:147], v[192:195], v[152:155]
    ds_read_b128 a[128:131], v8 offset:24576
    v_exp_f32 v41, v105
    v_mfma_f32_16x16x32_bf16 v[68:71], a[148:151], v[196:199], v[68:71]
    ds_read_b128 a[132:135], v9 offset:24576
    v_add_f32 v6, v6, v46
    v_mfma_f32_16x16x32_bf16 v[68:71], a[152:155], v[200:203], v[68:71]
    ds_read_b128 a[136:139], v10 offset:24576
    v_add_f32 v6, v6, v47
    v_cvt_pk_bf16_f32 v139, v46, v47
    v_mfma_f32_16x16x32_bf16 v[68:71], a[156:159], v[204:207], v[68:71]
    ds_read_b128 a[140:143], v11 offset:24576
    v_exp_f32 v42, v106
    v_mfma_f32_16x16x32_bf16 a[24:27], a[184:187], v[112:115], a[24:27]
    ds_read_b64_tr_b16 a[160:161], v16 offset:8192
    v_exp_f32 v43, v107
    v_mfma_f32_16x16x32_bf16 a[56:59], a[184:187], v[116:119], a[56:59]
    ds_read_b64_tr_b16 a[162:163], v16 offset:12288
    v_add_f32 v7, v40, v41
    v_mfma_f32_16x16x32_bf16 a[88:91], a[184:187], v[120:123], a[88:91]
    v_cvt_pk_bf16_f32 v140, v40, v41
    v_exp_f32 v44, v108
    v_mfma_f32_16x16x32_bf16 a[120:123], a[184:187], v[124:127], a[120:123]
    v_exp_f32 v45, v109
    v_add_f32 v7, v7, v42
    v_mfma_f32_16x16x32_bf16 v[76:79], a[144:147], v[208:211], v[156:159]
    ds_read_b64_tr_b16 a[164:165], v17 offset:8192
    v_add_f32 v7, v7, v43
    v_cvt_pk_bf16_f32 v141, v42, v43
    v_mfma_f32_16x16x32_bf16 v[76:79], a[148:151], v[212:215], v[76:79]
    ds_read_b64_tr_b16 a[166:167], v17 offset:12288
    v_exp_f32 v46, v110
    v_mfma_f32_16x16x32_bf16 v[76:79], a[152:155], v[216:219], v[76:79]
    v_exp_f32 v47, v111
    v_mfma_f32_16x16x32_bf16 v[76:79], a[156:159], v[220:223], v[76:79]
    v_add_f32 v7, v7, v44
    v_add_f32 v7, v7, v45
    v_mfma_f32_16x16x32_bf16 a[28:31], a[188:191], v[112:115], a[28:31]
    ds_read_b64_tr_b16 a[168:169], v18 offset:8192
    v_cvt_pk_bf16_f32 v142, v44, v45
    v_add_f32 v7, v7, v46
    v_mfma_f32_16x16x32_bf16 a[60:63], a[188:191], v[116:119], a[60:63]
    ds_read_b64_tr_b16 a[170:171], v18 offset:12288
    v_add_f32 v7, v7, v47
    v_cvt_pk_bf16_f32 v143, v46, v47
    v_mfma_f32_16x16x32_bf16 a[92:95], a[188:191], v[120:123], a[92:95]
    v_max3_f32 v35, v4, v5, v6
    v_max_f32 v35, v35, v7
    v_cmp_lt_f32 vcc, s40, v35
    v_mfma_f32_16x16x32_bf16 a[124:127], a[188:191], v[124:127], a[124:127]
    s_cbranch_vccnz L_rare_h0u0
L_ret_h0u0:
    s_waitcnt lgkmcnt(2)
    v_mfma_f32_16x16x32_bf16 v[80:83], a[128:131], v[160:163], v[144:147]
    ds_read_b128 a[144:147], v8 offset:28672
    v_add_f32 v244, v244, v4
    v_mfma_f32_16x16x32_bf16 v[80:83], a[132:135], v[164:167], v[80:83]
    v_add_f32 v245, v245, v5
    v_add_f32 v246, v246, v6
    v_add_f32 v247, v247, v7
    v_mfma_f32_16x16x32_bf16 v[80:83], a[136:139], v[168:171], v[80:83]
    ds_read_b128 a[148:151], v9 offset:28672
    v_exp_f32 v40, v48
    v_mfma_f32_16x16x32_bf16 v[80:83], a[140:143], v[172:175], v[80:83]
    v_exp_f32 v41, v49
    v_mfma_f32_16x16x32_bf16 a[0:3], a[160:163], v[128:131], a[0:3]
    ds_read_b64_tr_b16 a[172:173], v19 offset:8192
    v_exp_f32 v42, v50
    v_mfma_f32_16x16x32_bf16 a[32:35], a[160:163], v[132:135], a[32:35]
    ds_read_b64_tr_b16 a[174:175], v19 offset:12288
    s_mov_b32 m0, s44
    v_mfma_f32_16x16x32_bf16 a[64:67], a[160:163], v[136:139], a[64:67]
    buffer_load_dwordx4 v28, s[16:19], s43 offen offset:0 nt lds
    v_exp_f32 v43, v51
    v_mfma_f32_16x16x32_bf16 a[96:99], a[160:163], v[140:143], a[96:99]
    v_add_f32 v248, v40, v41
    v_cvt_pk_bf16_f32 v112, v40, v41
    v_mfma_f32_16x16x32_bf16 v[88:91], a[128:131], v[176:179], v[148:151]
    ds_read_b128 a[152:155], v10 offset:28672
    v_exp_f32 v44, v52
    v_mfma_f32_16x16x32_bf16 v[88:91], a[132:135], v[180:183], v[88:91]
    v_exp_f32 v45, v53
    v_mfma_f32_16x16x32_bf16 v[88:91], a[136:139], v[184:187], v[88:91]
    ds_read_b128 a[156:159], v11 offset:28672
    v_add_f32 v248, v248, v42
    v_add_f32 v248, v248, v43
    v_mfma_f32_16x16x32_bf16 v[88:91], a[140:143], v[188:191], v[88:91]
    v_cvt_pk_bf16_f32 v113, v42, v43
    v_exp_f32 v46, v54
    v_mfma_f32_16x16x32_bf16 a[4:7], a[164:167], v[128:131], a[4:7]
    ds_read_b64_tr_b16 a[176:177], v20 offset:8192
    v_exp_f32 v47, v55
    v_mfma_f32_16x16x32_bf16 a[36:39], a[164:167], v[132:135], a[36:39]
    ds_read_b64_tr_b16 a[178:179], v20 offset:12288
    v_add_f32 v248, v248, v44
    v_mfma_f32_16x16x32_bf16 a[68:71], a[164:167], v[136:139], a[68:71]
    buffer_load_dwordx4 v29, s[16:19], s43 offen offset:1024 nt lds
    v_add_f32 v248, v248, v45
    v_mfma_f32_16x16x32_bf16 a[100:103], a[164:167], v[140:143], a[100:103]
    v_cvt_pk_bf16_f32 v114, v44, v45
    s_waitcnt lgkmcnt(4)
    v_mfma_f32_16x16x32_bf16 v[96:99], a[128:131], v[192:195], v[152:155]
    v_exp_f32 v40, v56
    v_mfma_f32_16x16x32_bf16 v[96:99], a[132:135], v[196:199], v[96:99]
    v_exp_f32 v41, v57
    s_add_u32 m0, s35, 8192
    v_mfma_f32_16x16x32_bf16 v[96:99], a[136:139], v[200:203], v[96:99]
    buffer_load_dwordx4 v24, s[20:23], s37 offen offset:0 nt lds
    v_add_f32 v248, v248, v46
    v_mfma_f32_16x16x32_bf16 v[96:99], a[140:143], v[204:207], v[96:99]
    v_add_f32 v248, v248, v47
    v_cvt_pk_bf16_f32 v115, v46, v47
    v_mfma_f32_16x16x32_bf16 a[8:11], a[168:171], v[128:131], a[8:11]
    ds_read_b64_tr_b16 a[180:181], v21 offset:8192
    v_exp_f32 v42, v58
    v_mfma_f32_16x16x32_bf16 a[40:43], a[168:171], v[132:135], a[40:43]
    ds_read_b64_tr_b16 a[182:183], v21 offset:12288
    v_exp_f32 v43, v59
    v_mfma_f32_16x16x32_bf16 a[72:75], a[168:171], v[136:139], a[72:75]
    v_add_f32 v249, v40, v41
    v_cvt_pk_bf16_f32 v116, v40, v41
    v_mfma_f32_16x16x32_bf16 a[104:107], a[168:171], v[140:143], a[104:107]
    v_exp_f32 v44, v60
    v_mfma_f32_16x16x32_bf16 v[104:107], a[128:131], v[208:211], v[156:159]
    v_exp_f32 v45, v61
    v_add_f32 v249, v249, v42
    v_mfma_f32_16x16x32_bf16 v[104:107], a[132:135], v[212:215], v[104:107]
    v_add_f32 v249, v249, v43
    v_cvt_pk_bf16_f32 v117, v42, v43
    v_mfma_f32_16x16x32_bf16 v[104:107], a[136:139], v[216:219], v[104:107]
    buffer_load_dwordx4 v25, s[20:23], s37 offen offset:1024 nt lds
    s_add_u32 m0, s36, 40960
    v_mfma_f32_16x16x32_bf16 v[104:107], a[140:143], v[220:223], v[104:107]
    v_exp_f32 v46, v62
    s_add_u32 s37, s37, 2048
    v_mfma_f32_16x16x32_bf16 a[12:15], a[172:175], v[128:131], a[12:15]
    ds_read_b64_tr_b16 a[184:185], v22 offset:8192
    s_cmp_eq_u32 s37, 65536
    s_cmov_b32 s37, 262144
    v_mfma_f32_16x16x32_bf16 a[44:47], a[172:175], v[132:135], a[44:47]
    ds_read_b64_tr_b16 a[186:187], v22 offset:12288
    v_exp_f32 v47, v63
    v_mfma_f32_16x16x32_bf16 a[76:79], a[172:175], v[136:139], a[76:79]
    v_add_f32 v249, v249, v44
    v_add_f32 v249, v249, v45
    v_mfma_f32_16x16x32_bf16 a[108:111], a[172:175], v[140:143], a[108:111]
    v_cvt_pk_bf16_f32 v118, v44, v45
    s_waitcnt lgkmcnt(2)
    v_mfma_f32_16x16x32_bf16 v[84:87], a[144:147], v[160:163], v[144:147]
    v_exp_f32 v40, v64
    v_mfma_f32_16x16x32_bf16 v[84:87], a[148:151], v[164:167], v[84:87]
    v_exp_f32 v41, v65
    v_mfma_f32_16x16x32_bf16 v[84:87], a[152:155], v[168:171], v[84:87]
    buffer_load_dwordx4 v26, s[24:27], s41 offen offset:0 nt lds
    v_add_f32 v249, v249, v46
    v_mfma_f32_16x16x32_bf16 v[84:87], a[156:159], v[172:175], v[84:87]
    v_add_f32 v249, v249, v47
    v_cvt_pk_bf16_f32 v119, v46, v47
    v_mfma_f32_16x16x32_bf16 a[16:19], a[176:179], v[128:131], a[16:19]
    ds_read_b64_tr_b16 a[188:189], v23 offset:8192
    v_exp_f32 v42, v66
    v_mfma_f32_16x16x32_bf16 a[48:51], a[176:179], v[132:135], a[48:51]
    ds_read_b64_tr_b16 a[190:191], v23 offset:12288
    v_exp_f32 v43, v67
    v_mfma_f32_16x16x32_bf16 a[80:83], a[176:179], v[136:139], a[80:83]
    v_add_f32 v250, v40, v41
    v_cvt_pk_bf16_f32 v120, v40, v41
    v_mfma_f32_16x16x32_bf16 a[112:115], a[176:179], v[140:143], a[112:115]
    v_exp_f32 v44, v68
    v_mfma_f32_16x16x32_bf16 v[92:95], a[144:147], v[176:179], v[148:151]
    v_exp_f32 v45, v69
    v_mfma_f32_16x16x32_bf16 v[92:95], a[148:151], v[180:183], v[92:95]
    v_add_f32 v250, v250, v42
    v_add_f32 v250, v250, v43
    v_mfma_f32_16x16x32_bf16 v[92:95], a[152:155], v[184:187], v[92:95]
    buffer_load_dwordx4 v27, s[24:27], s41 offen offset:1024 nt lds
    s_add_u32 s41, s41, 2048
    v_mfma_f32_16x16x32_bf16 v[92:95], a[156:159], v[188:191], v[92:95]
    v_cvt_pk_bf16_f32 v121, v42, v43
    v_exp_f32 v46, v70
    v_mfma_f32_16x16x32_bf16 a[20:23], a[180:183], v[128:131], a[20:23]
    v_exp_f32 v47, v71
    v_mfma_f32_16x16x32_bf16 a[52:55], a[180:183], v[132:135], a[52:55]
    v_add_f32 v250, v250, v44
    v_add_f32 v250, v250, v45
    v_mfma_f32_16x16x32_bf16 a[84:87], a[180:183], v[136:139], a[84:87]
    v_cvt_pk_bf16_f32 v122, v44, v45
    v_exp_f32 v40, v72
    v_mfma_f32_16x16x32_bf16 a[116:119], a[180:183], v[140:143], a[116:119]
    v_exp_f32 v41, v73
    s_waitcnt lgkmcnt(0)
    v_mfma_f32_16x16x32_bf16 v[100:103], a[144:147], v[192:195], v[152:155]
    ds_read_b128 a[128:131], v8 offset:32768
    v_add_f32 v250, v250, v46
    v_mfma_f32_16x16x32_bf16 v[100:103], a[148:151], v[196:199], v[100:103]
    ds_read_b128 a[132:135], v9 offset:32768
    v_add_f32 v250, v250, v47
    v_mfma_f32_16x16x32_bf16 v[100:103], a[152:155], v[200:203], v[100:103]
    ds_read_b128 a[136:139], v10 offset:32768
    v_cvt_pk_bf16_f32 v123, v46, v47
    v_mfma_f32_16x16x32_bf16 v[100:103], a[156:159], v[204:207], v[100:103]
    ds_read_b128 a[140:143], v11 offset:32768
    v_exp_f32 v42, v74
    v_mfma_f32_16x16x32_bf16 a[24:27], a[184:187], v[128:131], a[24:27]
    ds_read_b64_tr_b16 a[160:161], v16 offset:16384
    v_exp_f32 v43, v75
    v_mfma_f32_16x16x32_bf16 a[56:59], a[184:187], v[132:135], a[56:59]
    ds_read_b64_tr_b16 a[162:163], v16 offset:20480
    v_add_f32 v251, v40, v41
    v_mfma_f32_16x16x32_bf16 a[88:91], a[184:187], v[136:139], a[88:91]
    v_cvt_pk_bf16_f32 v124, v40, v41
    v_exp_f32 v44, v76
    v_mfma_f32_16x16x32_bf16 a[120:123], a[184:187], v[140:143], a[120:123]
    v_exp_f32 v45, v77
    v_add_f32 v251, v251, v42
    v_mfma_f32_16x16x32_bf16 v[108:111], a[144:147], v[208:211], v[156:159]
    ds_read_b64_tr_b16 a[164:165], v17 offset:16384
    v_add_f32 v251, v251, v43
    v_cvt_pk_bf16_f32 v125, v42, v43
    v_mfma_f32_16x16x32_bf16 v[108:111], a[148:151], v[212:215], v[108:111]
    ds_read_b64_tr_b16 a[166:167], v17 offset:20480
    v_exp_f32 v46, v78
    v_mfma_f32_16x16x32_bf16 v[108:111], a[152:155], v[216:219], v[108:111]
    v_exp_f32 v47, v79
    v_mfma_f32_16x16x32_bf16 v[108:111], a[156:159], v[220:223], v[108:111]
    v_add_f32 v251, v251, v44
    v_add_f32 v251, v251, v45
    v_mfma_f32_16x16x32_bf16 a[28:31], a[188:191], v[128:131], a[28:31]
    ds_read_b64_tr_b16 a[168:169], v18 offset:16384
    v_cvt_pk_bf16_f32 v126, v44, v45
    v_add_f32 v251, v251, v46
    v_mfma_f32_16x16x32_bf16 a[60:63], a[188:191], v[132:135], a[60:63]
    ds_read_b64_tr_b16 a[170:171], v18 offset:20480
    v_add_f32 v251, v251, v47
    v_cvt_pk_bf16_f32 v127, v46, v47
    v_mfma_f32_16x16x32_bf16 a[92:95], a[188:191], v[136:139], a[92:95]
    v_max3_f32 v35, v248, v249, v250
    v_max_f32 v35, v35, v251
    v_cmp_lt_f32 vcc, s40, v35
    v_mfma_f32_16x16x32_bf16 a[124:127], a[188:191], v[140:143], a[124:127]
    s_cbranch_vccnz L_rare_h0u1
L_ret_h0u1:
    s_waitcnt lgkmcnt(2)
    v_mfma_f32_16x16x32_bf16 v[48:51], a[128:131], v[160:163], v[144:147]
    ds_read_b128 a[144:147], v8 offset:36864
    v_add_f32 v244, v244, v248
    v_mfma_f32_16x16x32_bf16 v[48:51], a[132:135], v[164:167], v[48:51]
    v_add_f32 v245, v245, v249
    v_add_f32 v246, v246, v250
    v_mfma_f32_16x16x32_bf16 v[48:51], a[136:139], v[168:171], v[48:51]
    ds_read_b128 a[148:151], v9 offset:36864
    v_add_f32 v247, v247, v251
    v_mfma_f32_16x16x32_bf16 v[48:51], a[140:143], v[172:175], v[48:51]
    v_exp_f32 v40, v80
    v_mfma_f32_16x16x32_bf16 a[0:3], a[160:163], v[112:115], a[0:3]
    ds_read_b64_tr_b16 a[172:173], v19 offset:16384
    v_exp_f32 v41, v81
    v_mfma_f32_16x16x32_bf16 a[32:35], a[160:163], v[116:119], a[32:35]
    ds_read_b64_tr_b16 a[174:175], v19 offset:20480
    v_exp_f32 v42, v82
    v_mfma_f32_16x16x32_bf16 a[64:67], a[160:163], v[120:123], a[64:67]
    v_exp_f32 v43, v83
    v_mfma_f32_16x16x32_bf16 a[96:99], a[160:163], v[124:127], a[96:99]
    v_add_f32 v4, v40, v41
    v_cvt_pk_bf16_f32 v128, v40, v41
    v_mfma_f32_16x16x32_bf16 v[56:59], a[128:131], v[176:179], v[148:151]
    ds_read_b128 a[152:155], v10 offset:36864
    v_exp_f32 v44, v84
    v_mfma_f32_16x16x32_bf16 v[56:59], a[132:135], v[180:183], v[56:59]
    v_exp_f32 v45, v85
    v_mfma_f32_16x16x32_bf16 v[56:59], a[136:139], v[184:187], v[56:59]
    ds_read_b128 a[156:159], v11 offset:36864
    v_add_f32 v4, v4, v42
    v_mfma_f32_16x16x32_bf16 v[56:59], a[140:143], v[188:191], v[56:59]
    v_add_f32 v4, v4, v43
    v_cvt_pk_bf16_f32 v129, v42, v43
    v_mfma_f32_16x16x32_bf16 a[4:7], a[164:167], v[112:115], a[4:7]
    ds_read_b64_tr_b16 a[176:177], v20 offset:16384
    v_exp_f32 v46, v86
    v_mfma_f32_16x16x32_bf16 a[36:39], a[164:167], v[116:119], a[36:39]
    ds_read_b64_tr_b16 a[178:179], v20 offset:20480
    v_exp_f32 v47, v87
    v_mfma_f32_16x16x32_bf16 a[68:71], a[164:167], v[120:123], a[68:71]
    v_add_f32 v4, v4, v44
    v_add_f32 v4, v4, v45
    v_mfma_f32_16x16x32_bf16 a[100:103], a[164:167], v[124:127], a[100:103]
    v_cvt_pk_bf16_f32 v130, v44, v45
    s_waitcnt lgkmcnt(4)
    v_mfma_f32_16x16x32_bf16 v[64:67], a[128:131], v[192:195], v[152:155]
    v_exp_f32 v40, v88
    v_mfma_f32_16x16x32_bf16 v[64:67], a[132:135], v[196:199], v[64:67]
    v_exp_f32 v41, v89
    s_add_u32 m0, s35, 16384
    v_mfma_f32_16x16x32_bf16 v[64:67], a[136:139], v[200:203], v[64:67]
    buffer_load_dwordx4 v24, s[20:23], s37 offen offset:0 nt lds
    v_add_f32 v4, v4, v46
    v_mfma_f32_16x16x32_bf16 v[64:67], a[140:143], v[204:207], v[64:67]
    v_add_f32 v4, v4, v47
    v_cvt_pk_bf16_f32 v131, v46, v47
    v_mfma_f32_16x16x32_bf16 a[8:11], a[168:171], v[112:115], a[8:11]
    ds_read_b64_tr_b16 a[180:181], v21 offset:16384
    v_exp_f32 v42, v90
    v_mfma_f32_16x16x32_bf16 a[40:43], a[168:171], v[116:119], a[40:43]
    ds_read_b64_tr_b16 a[182:183], v21 offset:20480
    v_exp_f32 v43, v91
    v_mfma_f32_16x16x32_bf16 a[72:75], a[168:171], v[120:123], a[72:75]
    v_add_f32 v5, v40, v41
    v_cvt_pk_bf16_f32 v132, v40, v41
    v_mfma_f32_16x16x32_bf16 a[104:107], a[168:171], v[124:127], a[104:107]
    v_exp_f32 v44, v92
    v_mfma_f32_16x16x32_bf16 v[72:75], a[128:131], v[208:211], v[156:159]
    v_exp_f32 v45, v93
    v_mfma_f32_16x16x32_bf16 v[72:75], a[132:135], v[212:215], v[72:75]
    v_add_f32 v5, v5, v42
    v_add_f32 v5, v5, v43
    v_mfma_f32_16x16x32_bf16 v[72:75], a[136:139], v[216:219], v[72:75]
    buffer_load_dwordx4 v25, s[20:23], s37 offen offset:1024 nt lds
    s_add_u32 m0, s36, 0
    v_mfma_f32_16x16x32_bf16 v[72:75], a[140:143], v[220:223], v[72:75]
    v_cvt_pk_bf16_f32 v133, v42, v43
    s_add_u32 s37, s37, 2048
    v_mfma_f32_16x16x32_bf16 a[12:15], a[172:175], v[112:115], a[12:15]
    ds_read_b64_tr_b16 a[184:185], v22 offset:16384
    v_exp_f32 v46, v94
    v_mfma_f32_16x16x32_bf16 a[44:47], a[172:175], v[116:119], a[44:47]
    ds_read_b64_tr_b16 a[186:187], v22 offset:20480
    v_exp_f32 v47, v95
    v_mfma_f32_16x16x32_bf16 a[76:79], a[172:175], v[120:123], a[76:79]
    v_add_f32 v5, v5, v44
    v_add_f32 v5, v5, v45
    v_mfma_f32_16x16x32_bf16 a[108:111], a[172:175], v[124:127], a[108:111]
    v_cvt_pk_bf16_f32 v134, v44, v45
    s_waitcnt lgkmcnt(2)
    v_mfma_f32_16x16x32_bf16 v[52:55], a[144:147], v[160:163], v[144:147]
    v_exp_f32 v40, v96
    v_mfma_f32_16x16x32_bf16 v[52:55], a[148:151], v[164:167], v[52:55]
    v_exp_f32 v41, v97
    v_mfma_f32_16x16x32_bf16 v[52:55], a[152:155], v[168:171], v[52:55]
    buffer_load_dwordx4 v26, s[24:27], s41 offen offset:0 nt lds
    v_add_f32 v5, v5, v46
    v_mfma_f32_16x16x32_bf16 v[52:55], a[156:159], v[172:175], v[52:55]
    v_add_f32 v5, v5, v47
    v_cvt_pk_bf16_f32 v135, v46, v47
    v_mfma_f32_16x16x32_bf16 a[16:19], a[176:179], v[112:115], a[16:19]
    ds_read_b64_tr_b16 a[188:189], v23 offset:16384
    v_exp_f32 v42, v98
    v_mfma_f32_16x16x32_bf16 a[48:51], a[176:179], v[116:119], a[48:51]
    ds_read_b64_tr_b16 a[190:191], v23 offset:20480
    v_exp_f32 v43, v99
    v_mfma_f32_16x16x32_bf16 a[80:83], a[176:179], v[120:123], a[80:83]
    v_add_f32 v6, v40, v41
    v_cvt_pk_bf16_f32 v136, v40, v41
    v_mfma_f32_16x16x32_bf16 a[112:115], a[176:179], v[124:127], a[112:115]
    v_exp_f32 v44, v100
    v_mfma_f32_16x16x32_bf16 v[60:63], a[144:147], v[176:179], v[148:151]
    v_exp_f32 v45, v101
    v_mfma_f32_16x16x32_bf16 v[60:63], a[148:151], v[180:183], v[60:63]
    v_add_f32 v6, v6, v42
    v_add_f32 v6, v6, v43
    v_mfma_f32_16x16x32_bf16 v[60:63], a[152:155], v[184:187], v[60:63]
    buffer_load_dwordx4 v27, s[24:27], s41 offen offset:1024 nt lds
    s_add_u32 s41, s41, 2048
    v_mfma_f32_16x16x32_bf16 v[60:63], a[156:159], v[188:191], v[60:63]
    v_cvt_pk_bf16_f32 v137, v42, v43
    v_exp_f32 v46, v102
    v_mfma_f32_16x16x32_bf16 a[20:23], a[180:183], v[112:115], a[20:23]
    v_exp_f32 v47, v103
    v_mfma_f32_16x16x32_bf16 a[52:55], a[180:183], v[116:119], a[52:55]
    v_add_f32 v6, v6, v44
    v_add_f32 v6, v6, v45
    v_mfma_f32_16x16x32_bf16 a[84:87], a[180:183], v[120:123], a[84:87]
    v_cvt_pk_bf16_f32 v138, v44, v45
    v_exp_f32 v40, v104
    v_mfma_f32_16x16x32_bf16 a[116:119], a[180:183], v[124:127], a[116:119]
    s_waitcnt vmcnt(10) lgkmcnt(0)
    s_barrier
    v_mfma_f32_16x16x32_bf16 v[68:71], a[144:147], v[192:195], v[152:155]
    ds_read_b128 a[128:131], v8 offset:40960
    v_exp_f32 v41, v105
    v_mfma_f32_16x16x32_bf16 v[68:71], a[148:151], v[196:199], v[68:71]
    ds_read_b128 a[132:135], v9 offset:40960
    v_add_f32 v6, v6, v46
    v_mfma_f32_16x16x32_bf16 v[68:71], a[152:155], v[200:203], v[68:71]
    ds_read_b128 a[136:139], v10 offset:40960
    v_add_f32 v6, v6, v47
    v_cvt_pk_bf16_f32 v139, v46, v47
    v_mfma_f32_16x16x32_bf16 v[68:71], a[156:159], v[204:207], v[68:71]
    ds_read_b128 a[140:143], v11 offset:40960
    v_exp_f32 v42, v106
    v_mfma_f32_16x16x32_bf16 a[24:27], a[184:187], v[112:115], a[24:27]
    ds_read_b64_tr_b16 a[160:161], v16 offset:24576
    v_exp_f32 v43, v107
    v_mfma_f32_16x16x32_bf16 a[56:59], a[184:187], v[116:119], a[56:59]
    ds_read_b64_tr_b16 a[162:163], v16 offset:28672
    v_add_f32 v7, v40, v41
    v_mfma_f32_16x16x32_bf16 a[88:91], a[184:187], v[120:123], a[88:91]
    v_cvt_pk_bf16_f32 v140, v40, v41
    v_exp_f32 v44, v108
    v_mfma_f32_16x16x32_bf16 a[120:123], a[184:187], v[124:127], a[120:123]
    v_exp_f32 v45, v109
    v_add_f32 v7, v7, v42
    v_mfma_f32_16x16x32_bf16 v[76:79], a[144:147], v[208:211], v[156:159]
    ds_read_b64_tr_b16 a[164:165], v17 offset:24576
    v_add_f32 v7, v7, v43
    v_cvt_pk_bf16_f32 v141, v42, v43
    v_mfma_f32_16x16x32_bf16 v[76:79], a[148:151], v[212:215], v[76:79]
    ds_read_b64_tr_b16 a[166:167], v17 offset:28672
    v_exp_f32 v46, v110
    v_mfma_f32_16x16x32_bf16 v[76:79], a[152:155], v[216:219], v[76:79]
    v_exp_f32 v47, v111
    v_mfma_f32_16x16x32_bf16 v[76:79], a[156:159], v[220:223], v[76:79]
    v_add_f32 v7, v7, v44
    v_add_f32 v7, v7, v45
    v_mfma_f32_16x16x32_bf16 a[28:31], a[188:191], v[112:115], a[28:31]
    ds_read_b64_tr_b16 a[168:169], v18 offset:24576
    v_cvt_pk_bf16_f32 v142, v44, v45
    v_add_f32 v7, v7, v46
    v_mfma_f32_16x16x32_bf16 a[60:63], a[188:191], v[116:119], a[60:63]
    ds_read_b64_tr_b16 a[170:171], v18 offset:28672
    v_add_f32 v7, v7, v47
    v_cvt_pk_bf16_f32 v143, v46, v47
    v_mfma_f32_16x16x32_bf16 a[92:95], a[188:191], v[120:123], a[92:95]
    v_max3_f32 v35, v4, v5, v6
    v_max_f32 v35, v35, v7
    v_cmp_lt_f32 vcc, s40, v35
    v_mfma_f32_16x16x32_bf16 a[124:127], a[188:191], v[124:127], a[124:127]
    s_cbranch_vccnz L_rare_h0u2
L_ret_h0u2:
    s_waitcnt lgkmcnt(2)
    v_mfma_f32_16x16x32_bf16 v[80:83], a[128:131], v[160:163], v[144:147]
    ds_read_b128 a[144:147], v8 offset:45056
    v_add_f32 v244, v244, v4
    v_mfma_f32_16x16x32_bf16 v[80:83], a[132:135], v[164:167], v[80:83]
    v_add_f32 v245, v245, v5
    v_add_f32 v246, v246, v6
    v_add_f32 v247, v247, v7
    v_mfma_f32_16x16x32_bf16 v[80:83], a[136:139], v[168:171], v[80:83]
    ds_read_b128 a[148:151], v9 offset:45056
    v_exp_f32 v40, v48
    v_mfma_f32_16x16x32_bf16 v[80:83], a[140:143], v[172:175], v[80:83]
    v_exp_f32 v41, v49
    v_mfma_f32_16x16x32_bf16 a[0:3], a[160:163], v[128:131], a[0:3]
    ds_read_b64_tr_b16 a[172:173], v19 offset:24576
    v_exp_f32 v42, v50
    v_mfma_f32_16x16x32_bf16 a[32:35], a[160:163], v[132:135], a[32:35]
    ds_read_b64_tr_b16 a[174:175], v19 offset:28672
    s_mov_b32 m0, s44
    v_mfma_f32_16x16x32_bf16 a[64:67], a[160:163], v[136:139], a[64:67]
    buffer_load_dwordx4 v30, s[16:19], s43 offen offset:2048 nt lds
    v_exp_f32 v43, v51
    v_mfma_f32_16x16x32_bf16 a[96:99], a[160:163], v[140:143], a[96:99]
    v_add_f32 v248, v40, v41
    v_cvt_pk_bf16_f32 v112, v40, v41
    v_mfma_f32_16x16x32_bf16 v[88:91], a[128:131], v[176:179], v[148:151]
    ds_read_b128 a[152:155], v10 offset:45056
    v_exp_f32 v44, v52
    v_mfma_f32_16x16x32_bf16 v[88:91], a[132:135], v[180:183], v[88:91]
    v_exp_f32 v45, v53
    v_mfma_f32_16x16x32_bf16 v[88:91], a[136:139], v[184:187], v[88:91]
    ds_read_b128 a[156:159], v11 offset:45056
    v_add_f32 v248, v248, v42
    v_add_f32 v248, v248, v43
    v_mfma_f32_16x16x32_bf16 v[88:91], a[140:143], v[188:191], v[88:91]
    v_cvt_pk_bf16_f32 v113, v42, v43
    v_exp_f32 v46, v54
    v_mfma_f32_16x16x32_bf16 a[4:7], a[164:167], v[128:131], a[4:7]
    ds_read_b64_tr_b16 a[176:177], v20 offset:24576
    v_exp_f32 v47, v55
    v_mfma_f32_16x16x32_bf16 a[36:39], a[164:167], v[132:135], a[36:39]
    ds_read_b64_tr_b16 a[178:179], v20 offset:28672
    v_add_f32 v248, v248, v44
    v_mfma_f32_16x16x32_bf16 a[68:71], a[164:167], v[136:139], a[68:71]
    buffer_load_dwordx4 v31, s[16:19], s43 offen offset:3072 nt lds
    s_add_u32 s44, s44, 4096
    v_mfma_f32_16x16x32_bf16 a[100:103], a[164:167], v[140:143], a[100:103]
    s_add_u32 s43, s43, 4096
    s_waitcnt lgkmcnt(4)
    v_mfma_f32_16x16x32_bf16 v[96:99], a[128:131], v[192:195], v[152:155]
    v_add_f32 v248, v248, v45
    v_cvt_pk_bf16_f32 v114, v44, v45
    v_mfma_f32_16x16x32_bf16 v[96:99], a[132:135], v[196:199], v[96:99]
    v_exp_f32 v40, v56
    s_add_u32 m0, s35, 24576
    v_mfma_f32_16x16x32_bf16 v[96:99], a[136:139], v[200:203], v[96:99]
    buffer_load_dwordx4 v24, s[20:23], s37 offen offset:0 nt lds
    v_exp_f32 v41, v57
    v_mfma_f32_16x16x32_bf16 v[96:99], a[140:143], v[204:207], v[96:99]
    v_add_f32 v248, v248, v46
    v_add_f32 v248, v248, v47
    v_mfma_f32_16x16x32_bf16 a[8:11], a[168:171], v[128:131], a[8:11]
    ds_read_b64_tr_b16 a[180:181], v21 offset:24576
    v_cvt_pk_bf16_f32 v115, v46, v47
    v_mfma_f32_16x16x32_bf16 a[40:43], a[168:171], v[132:135], a[40:43]
    ds_read_b64_tr_b16 a[182:183], v21 offset:28672
    v_exp_f32 v42, v58
    v_mfma_f32_16x16x32_bf16 a[72:75], a[168:171], v[136:139], a[72:75]
    v_exp_f32 v43, v59
    v_add_f32 v249, v40, v41
    v_mfma_f32_16x16x32_bf16 a[104:107], a[168:171], v[140:143], a[104:107]
    v_cvt_pk_bf16_f32 v116, v40, v41
    v_exp_f32 v44, v60
    v_mfma_f32_16x16x32_bf16 v[104:107], a[128:131], v[208:211], v[156:159]
    v_exp_f32 v45, v61
    v_mfma_f32_16x16x32_bf16 v[104:107], a[132:135], v[212:215], v[104:107]
    v_add_f32 v249, v249, v42
    v_add_f32 v249, v249, v43
    v_mfma_f32_16x16x32_bf16 v[104:107], a[136:139], v[216:219], v[104:107]
    buffer_load_dwordx4 v25, s[20:23], s37 offen offset:1024 nt lds
    s_add_u32 m0, s36, 8192
    v_mfma_f32_16x16x32_bf16 v[104:107], a[140:143], v[220:223], v[104:107]
    v_cvt_pk_bf16_f32 v117, v42, v43
    s_add_u32 s37, s37, 2048
    v_mfma_f32_16x16x32_bf16 a[12:15], a[172:175], v[128:131], a[12:15]
    ds_read_b64_tr_b16 a[184:185], v22 offset:24576
    v_exp_f32 v46, v62
    v_mfma_f32_16x16x32_bf16 a[44:47], a[172:175], v[132:135], a[44:47]
    ds_read_b64_tr_b16 a[186:187], v22 offset:28672
    v_exp_f32 v47, v63
    v_mfma_f32_16x16x32_bf16 a[76:79], a[172:175], v[136:139], a[76:79]
    v_add_f32 v249, v249, v44
    v_add_f32 v249, v249, v45
    v_mfma_f32_16x16x32_bf16 a[108:111], a[172:175], v[140:143], a[108:111]
    v_cvt_pk_bf16_f32 v118, v44, v45
    s_waitcnt lgkmcnt(2)
    v_mfma_f32_16x16x32_bf16 v[84:87], a[144:147], v[160:163], v[144:147]
    v_exp_f32 v40, v64
    v_mfma_f32_16x16x32_bf16 v[84:87], a[148:151], v[164:167], v[84:87]
    v_exp_f32 v41, v65
    v_mfma_f32_16x16x32_bf16 v[84:87], a[152:155], v[168:171], v[84:87]
    buffer_load_dwordx4 v26, s[24:27], s41 offen offset:0 nt lds
    v_add_f32 v249, v249, v46
    v_mfma_f32_16x16x32_bf16 v[84:87], a[156:159], v[172:175], v[84:87]
    v_add_f32 v249, v249, v47
    v_cvt_pk_bf16_f32 v119, v46, v47
    v_mfma_f32_16x16x32_bf16 a[16:19], a[176:179], v[128:131], a[16:19]
    ds_read_b64_tr_b16 a[188:189], v23 offset:24576
    v_exp_f32 v42, v66
    v_mfma_f32_16x16x32_bf16 a[48:51], a[176:179], v[132:135], a[48:51]
    ds_read_b64_tr_b16 a[190:191], v23 offset:28672
    v_exp_f32 v43, v67
    v_mfma_f32_16x16x32_bf16 a[80:83], a[176:179], v[136:139], a[80:83]
    v_add_f32 v250, v40, v41
    v_cvt_pk_bf16_f32 v120, v40, v41
    v_mfma_f32_16x16x32_bf16 a[112:115], a[176:179], v[140:143], a[112:115]
    v_exp_f32 v44, v68
    v_mfma_f32_16x16x32_bf16 v[92:95], a[144:147], v[176:179], v[148:151]
    v_exp_f32 v45, v69
    v_mfma_f32_16x16x32_bf16 v[92:95], a[148:151], v[180:183], v[92:95]
    v_add_f32 v250, v250, v42
    v_add_f32 v250, v250, v43
    v_mfma_f32_16x16x32_bf16 v[92:95], a[152:155], v[184:187], v[92:95]
    buffer_load_dwordx4 v27, s[24:27], s41 offen offset:1024 nt lds
    s_add_u32 s41, s41, 2048
    v_mfma_f32_16x16x32_bf16 v[92:95], a[156:159], v[188:191], v[92:95]
    s_cmp_eq_u32 s41, 65536
    s_cmov_b32 s41, 262144
    v_mfma_f32_16x16x32_bf16 a[20:23], a[180:183], v[128:131], a[20:23]
    v_cvt_pk_bf16_f32 v121, v42, v43
    v_exp_f32 v46, v70
    v_mfma_f32_16x16x32_bf16 a[52:55], a[180:183], v[132:135], a[52:55]
    v_exp_f32 v47, v71
    v_mfma_f32_16x16x32_bf16 a[84:87], a[180:183], v[136:139], a[84:87]
    v_add_f32 v250, v250, v44
    v_add_f32 v250, v250, v45
    v_cvt_pk_bf16_f32 v122, v44, v45
    v_mfma_f32_16x16x32_bf16 a[116:119], a[180:183], v[140:143], a[116:119]
    v_exp_f32 v40, v72
    s_waitcnt lgkmcnt(0)
    v_mfma_f32_16x16x32_bf16 v[100:103], a[144:147], v[192:195], v[152:155]
    ds_read_b128 a[128:131], v8 offset:0
    v_exp_f32 v41, v73
    v_mfma_f32_16x16x32_bf16 v[100:103], a[148:151], v[196:199], v[100:103]
    ds_read_b128 a[132:135], v9 offset:0
    v_add_f32 v250, v250, v46
    v_mfma_f32_16x16x32_bf16 v[100:103], a[152:155], v[200:203], v[100:103]
    ds_read_b128 a[136:139], v10 offset:0
    v_add_f32 v250, v250, v47
    v_cvt_pk_bf16_f32 v123, v46, v47
    v_mfma_f32_16x16x32_bf16 v[100:103], a[156:159], v[204:207], v[100:103]
    ds_read_b128 a[140:143], v11 offset:0
    v_exp_f32 v42, v74
    v_mfma_f32_16x16x32_bf16 a[24:27], a[184:187], v[128:131], a[24:27]
    ds_read_b64_tr_b16 a[160:161], v16 offset:32768
    v_exp_f32 v43, v75
    v_mfma_f32_16x16x32_bf16 a[56:59], a[184:187], v[132:135], a[56:59]
    ds_read_b64_tr_b16 a[162:163], v16 offset:36864
    v_add_f32 v251, v40, v41
    v_mfma_f32_16x16x32_bf16 a[88:91], a[184:187], v[136:139], a[88:91]
    v_cvt_pk_bf16_f32 v124, v40, v41
    v_exp_f32 v44, v76
    v_mfma_f32_16x16x32_bf16 a[120:123], a[184:187], v[140:143], a[120:123]
    v_exp_f32 v45, v77
    v_add_f32 v251, v251, v42
    v_mfma_f32_16x16x32_bf16 v[108:111], a[144:147], v[208:211], v[156:159]
    ds_read_b64_tr_b16 a[164:165], v17 offset:32768
    v_add_f32 v251, v251, v43
    v_cvt_pk_bf16_f32 v125, v42, v43
    v_mfma_f32_16x16x32_bf16 v[108:111], a[148:151], v[212:215], v[108:111]
    ds_read_b64_tr_b16 a[166:167], v17 offset:36864
    v_exp_f32 v46, v78
    v_mfma_f32_16x16x32_bf16 v[108:111], a[152:155], v[216:219], v[108:111]
    v_exp_f32 v47, v79
    v_mfma_f32_16x16x32_bf16 v[108:111], a[156:159], v[220:223], v[108:111]
    v_add_f32 v251, v251, v44
    v_add_f32 v251, v251, v45
    v_mfma_f32_16x16x32_bf16 a[28:31], a[188:191], v[128:131], a[28:31]
    ds_read_b64_tr_b16 a[168:169], v18 offset:32768
    v_cvt_pk_bf16_f32 v126, v44, v45
    v_add_f32 v251, v251, v46
    v_mfma_f32_16x16x32_bf16 a[60:63], a[188:191], v[132:135], a[60:63]
    ds_read_b64_tr_b16 a[170:171], v18 offset:36864
    v_add_f32 v251, v251, v47
    v_cvt_pk_bf16_f32 v127, v46, v47
    v_mfma_f32_16x16x32_bf16 a[92:95], a[188:191], v[136:139], a[92:95]
    v_max3_f32 v35, v248, v249, v250
    v_max_f32 v35, v35, v251
    v_cmp_lt_f32 vcc, s40, v35
    v_mfma_f32_16x16x32_bf16 a[124:127], a[188:191], v[140:143], a[124:127]
    s_cbranch_vccnz L_rare_h0u3
L_ret_h0u3:
    s_waitcnt lgkmcnt(2)
    v_mfma_f32_16x16x32_bf16 v[48:51], a[128:131], v[160:163], v[144:147]
    ds_read_b128 a[144:147], v8 offset:4096
    v_add_f32 v244, v244, v248
    v_mfma_f32_16x16x32_bf16 v[48:51], a[132:135], v[164:167], v[48:51]
    v_add_f32 v245, v245, v249
    v_add_f32 v246, v246, v250
    v_mfma_f32_16x16x32_bf16 v[48:51], a[136:139], v[168:171], v[48:51]
    ds_read_b128 a[148:151], v9 offset:4096
    v_add_f32 v247, v247, v251
    v_mfma_f32_16x16x32_bf16 v[48:51], a[140:143], v[172:175], v[48:51]
    v_exp_f32 v40, v80
    v_mfma_f32_16x16x32_bf16 a[0:3], a[160:163], v[112:115], a[0:3]
    ds_read_b64_tr_b16 a[172:173], v19 offset:32768
    v_exp_f32 v41, v81
    v_mfma_f32_16x16x32_bf16 a[32:35], a[160:163], v[116:119], a[32:35]
    ds_read_b64_tr_b16 a[174:175], v19 offset:36864
    v_exp_f32 v42, v82
    v_mfma_f32_16x16x32_bf16 a[64:67], a[160:163], v[120:123], a[64:67]
    v_exp_f32 v43, v83
    v_mfma_f32_16x16x32_bf16 a[96:99], a[160:163], v[124:127], a[96:99]
    v_add_f32 v4, v40, v41
    v_cvt_pk_bf16_f32 v128, v40, v41
    v_mfma_f32_16x16x32_bf16 v[56:59], a[128:131], v[176:179], v[148:151]
    ds_read_b128 a[152:155], v10 offset:4096
    v_exp_f32 v44, v84
    v_mfma_f32_16x16x32_bf16 v[56:59], a[132:135], v[180:183], v[56:59]
    v_exp_f32 v45, v85
    v_mfma_f32_16x16x32_bf16 v[56:59], a[136:139], v[184:187], v[56:59]
    ds_read_b128 a[156:159], v11 offset:4096
    v_add_f32 v4, v4, v42
    v_mfma_f32_16x16x32_bf16 v[56:59], a[140:143], v[188:191], v[56:59]
    v_add_f32 v4, v4, v43
    v_cvt_pk_bf16_f32 v129, v42, v43
    v_mfma_f32_16x16x32_bf16 a[4:7], a[164:167], v[112:115], a[4:7]
    ds_read_b64_tr_b16 a[176:177], v20 offset:32768
    v_exp_f32 v46, v86
    v_mfma_f32_16x16x32_bf16 a[36:39], a[164:167], v[116:119], a[36:39]
    ds_read_b64_tr_b16 a[178:179], v20 offset:36864
    v_exp_f32 v47, v87
    v_mfma_f32_16x16x32_bf16 a[68:71], a[164:167], v[120:123], a[68:71]
    v_add_f32 v4, v4, v44
    v_add_f32 v4, v4, v45
    v_mfma_f32_16x16x32_bf16 a[100:103], a[164:167], v[124:127], a[100:103]
    v_cvt_pk_bf16_f32 v130, v44, v45
    s_waitcnt lgkmcnt(4)
    v_mfma_f32_16x16x32_bf16 v[64:67], a[128:131], v[192:195], v[152:155]
    v_exp_f32 v40, v88
    v_mfma_f32_16x16x32_bf16 v[64:67], a[132:135], v[196:199], v[64:67]
    v_exp_f32 v41, v89
    s_add_u32 m0, s35, 32768
    v_mfma_f32_16x16x32_bf16 v[64:67], a[136:139], v[200:203], v[64:67]
    buffer_load_dwordx4 v24, s[20:23], s37 offen offset:0 nt lds
    v_add_f32 v4, v4, v46
    v_mfma_f32_16x16x32_bf16 v[64:67], a[140:143], v[204:207], v[64:67]
    v_add_f32 v4, v4, v47
    v_cvt_pk_bf16_f32 v131, v46, v47
    v_mfma_f32_16x16x32_bf16 a[8:11], a[168:171], v[112:115], a[8:11]
    ds_read_b64_tr_b16 a[180:181], v21 offset:32768
    v_exp_f32 v42, v90
    v_mfma_f32_16x16x32_bf16 a[40:43], a[168:171], v[116:119], a[40:43]
    ds_read_b64_tr_b16 a[182:183], v21 offset:36864
    v_exp_f32 v43, v91
    v_mfma_f32_16x16x32_bf16 a[72:75], a[168:171], v[120:123], a[72:75]
    v_add_f32 v5, v40, v41
    v_cvt_pk_bf16_f32 v132, v40, v41
    v_mfma_f32_16x16x32_bf16 a[104:107], a[168:171], v[124:127], a[104:107]
    v_exp_f32 v44, v92
    v_mfma_f32_16x16x32_bf16 v[72:75], a[128:131], v[208:211], v[156:159]
    v_exp_f32 v45, v93
    v_mfma_f32_16x16x32_bf16 v[72:75], a[132:135], v[212:215], v[72:75]
    v_add_f32 v5, v5, v42
    v_add_f32 v5, v5, v43
    v_mfma_f32_16x16x32_bf16 v[72:75], a[136:139], v[216:219], v[72:75]
    buffer_load_dwordx4 v25, s[20:23], s37 offen offset:1024 nt lds
    s_add_u32 m0, s36, 16384
    v_mfma_f32_16x16x32_bf16 v[72:75], a[140:143], v[220:223], v[72:75]
    v_cvt_pk_bf16_f32 v133, v42, v43
    s_add_u32 s37, s37, 2048
    v_mfma_f32_16x16x32_bf16 a[12:15], a[172:175], v[112:115], a[12:15]
    ds_read_b64_tr_b16 a[184:185], v22 offset:32768
    v_exp_f32 v46, v94
    v_mfma_f32_16x16x32_bf16 a[44:47], a[172:175], v[116:119], a[44:47]
    ds_read_b64_tr_b16 a[186:187], v22 offset:36864
    v_exp_f32 v47, v95
    v_mfma_f32_16x16x32_bf16 a[76:79], a[172:175], v[120:123], a[76:79]
    v_add_f32 v5, v5, v44
    v_add_f32 v5, v5, v45
    v_mfma_f32_16x16x32_bf16 a[108:111], a[172:175], v[124:127], a[108:111]
    v_cvt_pk_bf16_f32 v134, v44, v45
    s_waitcnt lgkmcnt(2)
    v_mfma_f32_16x16x32_bf16 v[52:55], a[144:147], v[160:163], v[144:147]
    v_exp_f32 v40, v96
    v_mfma_f32_16x16x32_bf16 v[52:55], a[148:151], v[164:167], v[52:55]
    v_exp_f32 v41, v97
    v_mfma_f32_16x16x32_bf16 v[52:55], a[152:155], v[168:171], v[52:55]
    buffer_load_dwordx4 v26, s[24:27], s41 offen offset:0 nt lds
    v_add_f32 v5, v5, v46
    v_mfma_f32_16x16x32_bf16 v[52:55], a[156:159], v[172:175], v[52:55]
    v_add_f32 v5, v5, v47
    v_cvt_pk_bf16_f32 v135, v46, v47
    v_mfma_f32_16x16x32_bf16 a[16:19], a[176:179], v[112:115], a[16:19]
    ds_read_b64_tr_b16 a[188:189], v23 offset:32768
    v_exp_f32 v42, v98
    v_mfma_f32_16x16x32_bf16 a[48:51], a[176:179], v[116:119], a[48:51]
    ds_read_b64_tr_b16 a[190:191], v23 offset:36864
    v_exp_f32 v43, v99
    v_mfma_f32_16x16x32_bf16 a[80:83], a[176:179], v[120:123], a[80:83]
    v_add_f32 v6, v40, v41
    v_cvt_pk_bf16_f32 v136, v40, v41
    v_mfma_f32_16x16x32_bf16 a[112:115], a[176:179], v[124:127], a[112:115]
    v_exp_f32 v44, v100
    v_mfma_f32_16x16x32_bf16 v[60:63], a[144:147], v[176:179], v[148:151]
    v_exp_f32 v45, v101
    v_mfma_f32_16x16x32_bf16 v[60:63], a[148:151], v[180:183], v[60:63]
    v_add_f32 v6, v6, v42
    v_add_f32 v6, v6, v43
    v_mfma_f32_16x16x32_bf16 v[60:63], a[152:155], v[184:187], v[60:63]
    buffer_load_dwordx4 v27, s[24:27], s41 offen offset:1024 nt lds
    s_add_u32 s41, s41, 2048
    v_mfma_f32_16x16x32_bf16 v[60:63], a[156:159], v[188:191], v[60:63]
    v_cvt_pk_bf16_f32 v137, v42, v43
    v_exp_f32 v46, v102
    v_mfma_f32_16x16x32_bf16 a[20:23], a[180:183], v[112:115], a[20:23]
    v_exp_f32 v47, v103
    v_mfma_f32_16x16x32_bf16 a[52:55], a[180:183], v[116:119], a[52:55]
    v_add_f32 v6, v6, v44
    v_add_f32 v6, v6, v45
    v_mfma_f32_16x16x32_bf16 a[84:87], a[180:183], v[120:123], a[84:87]
    v_cvt_pk_bf16_f32 v138, v44, v45
    v_exp_f32 v40, v104
    v_mfma_f32_16x16x32_bf16 a[116:119], a[180:183], v[124:127], a[116:119]
    s_waitcnt vmcnt(10) lgkmcnt(0)
    s_barrier
    v_mfma_f32_16x16x32_bf16 v[68:71], a[144:147], v[192:195], v[152:155]
    ds_read_b128 a[128:131], v8 offset:8192
    v_exp_f32 v41, v105
    v_mfma_f32_16x16x32_bf16 v[68:71], a[148:151], v[196:199], v[68:71]
    ds_read_b128 a[132:135], v9 offset:8192
    v_add_f32 v6, v6, v46
    v_mfma_f32_16x16x32_bf16 v[68:71], a[152:155], v[200:203], v[68:71]
    ds_read_b128 a[136:139], v10 offset:8192
    v_add_f32 v6, v6, v47
    v_cvt_pk_bf16_f32 v139, v46, v47
    v_mfma_f32_16x16x32_bf16 v[68:71], a[156:159], v[204:207], v[68:71]
    ds_read_b128 a[140:143], v11 offset:8192
    v_exp_f32 v42, v106
    v_mfma_f32_16x16x32_bf16 a[24:27], a[184:187], v[112:115], a[24:27]
    ds_read_b64_tr_b16 a[160:161], v16 offset:40960
    v_exp_f32 v43, v107
    v_mfma_f32_16x16x32_bf16 a[56:59], a[184:187], v[116:119], a[56:59]
    ds_read_b64_tr_b16 a[162:163], v16 offset:45056
    v_add_f32 v7, v40, v41
    v_mfma_f32_16x16x32_bf16 a[88:91], a[184:187], v[120:123], a[88:91]
    v_cvt_pk_bf16_f32 v140, v40, v41
    v_exp_f32 v44, v108
    v_mfma_f32_16x16x32_bf16 a[120:123], a[184:187], v[124:127], a[120:123]
    v_exp_f32 v45, v109
    v_add_f32 v7, v7, v42
    v_mfma_f32_16x16x32_bf16 v[76:79], a[144:147], v[208:211], v[156:159]
    ds_read_b64_tr_b16 a[164:165], v17 offset:40960
    v_add_f32 v7, v7, v43
    v_cvt_pk_bf16_f32 v141, v42, v43
    v_mfma_f32_16x16x32_bf16 v[76:79], a[148:151], v[212:215], v[76:79]
    ds_read_b64_tr_b16 a[166:167], v17 offset:45056
    v_exp_f32 v46, v110
    v_mfma_f32_16x16x32_bf16 v[76:79], a[152:155], v[216:219], v[76:79]
    v_exp_f32 v47, v111
    v_mfma_f32_16x16x32_bf16 v[76:79], a[156:159], v[220:223], v[76:79]
    v_add_f32 v7, v7, v44
    v_add_f32 v7, v7, v45
    v_mfma_f32_16x16x32_bf16 a[28:31], a[188:191], v[112:115], a[28:31]
    ds_read_b64_tr_b16 a[168:169], v18 offset:40960
    v_cvt_pk_bf16_f32 v142, v44, v45
    v_add_f32 v7, v7, v46
    v_mfma_f32_16x16x32_bf16 a[60:63], a[188:191], v[116:119], a[60:63]
    ds_read_b64_tr_b16 a[170:171], v18 offset:45056
    v_add_f32 v7, v7, v47
    v_cvt_pk_bf16_f32 v143, v46, v47
    v_mfma_f32_16x16x32_bf16 a[92:95], a[188:191], v[120:123], a[92:95]
    v_max3_f32 v35, v4, v5, v6
    v_max_f32 v35, v35, v7
    v_cmp_lt_f32 vcc, s40, v35
    v_mfma_f32_16x16x32_bf16 a[124:127], a[188:191], v[124:127], a[124:127]
    s_cbranch_vccnz L_rare_h0u4
L_ret_h0u4:
    s_waitcnt lgkmcnt(2)
    v_mfma_f32_16x16x32_bf16 v[80:83], a[128:131], v[160:163], v[144:147]
    ds_read_b128 a[144:147], v8 offset:12288
    v_add_f32 v244, v244, v4
    v_mfma_f32_16x16x32_bf16 v[80:83], a[132:135], v[164:167], v[80:83]
    v_add_f32 v245, v245, v5
    v_add_f32 v246, v246, v6
    v_mfma_f32_16x16x32_bf16 v[80:83], a[136:139], v[168:171], v[80:83]
    ds_read_b128 a[148:151], v9 offset:12288
    v_add_f32 v247, v247, v7
    v_mfma_f32_16x16x32_bf16 v[80:83], a[140:143], v[172:175], v[80:83]
    v_exp_f32 v40, v48
    v_mfma_f32_16x16x32_bf16 a[0:3], a[160:163], v[128:131], a[0:3]
    ds_read_b64_tr_b16 a[172:173], v19 offset:40960
    v_exp_f32 v41, v49
    v_mfma_f32_16x16x32_bf16 a[32:35], a[160:163], v[132:135], a[32:35]
    ds_read_b64_tr_b16 a[174:175], v19 offset:45056
    v_exp_f32 v42, v50
    v_mfma_f32_16x16x32_bf16 a[64:67], a[160:163], v[136:139], a[64:67]
    v_exp_f32 v43, v51
    v_mfma_f32_16x16x32_bf16 a[96:99], a[160:163], v[140:143], a[96:99]
    v_add_f32 v248, v40, v41
    v_cvt_pk_bf16_f32 v112, v40, v41
    v_mfma_f32_16x16x32_bf16 v[88:91], a[128:131], v[176:179], v[148:151]
    ds_read_b128 a[152:155], v10 offset:12288
    v_exp_f32 v44, v52
    v_mfma_f32_16x16x32_bf16 v[88:91], a[132:135], v[180:183], v[88:91]
    v_exp_f32 v45, v53
    v_mfma_f32_16x16x32_bf16 v[88:91], a[136:139], v[184:187], v[88:91]
    ds_read_b128 a[156:159], v11 offset:12288
    v_add_f32 v248, v248, v42
    v_mfma_f32_16x16x32_bf16 v[88:91], a[140:143], v[188:191], v[88:91]
    v_add_f32 v248, v248, v43
    v_cvt_pk_bf16_f32 v113, v42, v43
    v_mfma_f32_16x16x32_bf16 a[4:7], a[164:167], v[128:131], a[4:7]
    ds_read_b64_tr_b16 a[176:177], v20 offset:40960
    v_exp_f32 v46, v54
    v_mfma_f32_16x16x32_bf16 a[36:39], a[164:167], v[132:135], a[36:39]
    ds_read_b64_tr_b16 a[178:179], v20 offset:45056
    v_exp_f32 v47, v55
    v_mfma_f32_16x16x32_bf16 a[68:71], a[164:167], v[136:139], a[68:71]
    v_add_f32 v248, v248, v44
    v_add_f32 v248, v248, v45
    v_mfma_f32_16x16x32_bf16 a[100:103], a[164:167], v[140:143], a[100:103]
    v_cvt_pk_bf16_f32 v114, v44, v45
    s_waitcnt lgkmcnt(4)
    v_mfma_f32_16x16x32_bf16 v[96:99], a[128:131], v[192:195], v[152:155]
    v_exp_f32 v40, v56
    v_mfma_f32_16x16x32_bf16 v[96:99], a[132:135], v[196:199], v[96:99]
    v_exp_f32 v41, v57
    s_add_u32 m0, s35, 40960
    v_mfma_f32_16x16x32_bf16 v[96:99], a[136:139], v[200:203], v[96:99]
    buffer_load_dwordx4 v24, s[20:23], s37 offen offset:0 nt lds
    v_add_f32 v248, v248, v46
    v_mfma_f32_16x16x32_bf16 v[96:99], a[140:143], v[204:207], v[96:99]
    v_add_f32 v248, v248, v47
    v_cvt_pk_bf16_f32 v115, v46, v47
    v_mfma_f32_16x16x32_bf16 a[8:11], a[168:171], v[128:131], a[8:11]
    ds_read_b64_tr_b16 a[180:181], v21 offset:40960
    v_exp_f32 v42, v58
    v_mfma_f32_16x16x32_bf16 a[40:43], a[168:171], v[132:135], a[40:43]
    ds_read_b64_tr_b16 a[182:183], v21 offset:45056
    v_exp_f32 v43, v59
    v_mfma_f32_16x16x32_bf16 a[72:75], a[168:171], v[136:139], a[72:75]
    v_add_f32 v249, v40, v41
    v_cvt_pk_bf16_f32 v116, v40, v41
    v_mfma_f32_16x16x32_bf16 a[104:107], a[168:171], v[140:143], a[104:107]
    v_exp_f32 v44, v60
    v_mfma_f32_16x16x32_bf16 v[104:107], a[128:131], v[208:211], v[156:159]
    v_exp_f32 v45, v61
    v_mfma_f32_16x16x32_bf16 v[104:107], a[132:135], v[212:215], v[104:107]
    v_add_f32 v249, v249, v42
    v_add_f32 v249, v249, v43
    v_mfma_f32_16x16x32_bf16 v[104:107], a[136:139], v[216:219], v[104:107]
    buffer_load_dwordx4 v25, s[20:23], s37 offen offset:1024 nt lds
    s_add_u32 m0, s36, 24576
    v_mfma_f32_16x16x32_bf16 v[104:107], a[140:143], v[220:223], v[104:107]
    v_cvt_pk_bf16_f32 v117, v42, v43
    s_add_u32 s37, s37, 2048
    v_mfma_f32_16x16x32_bf16 a[12:15], a[172:175], v[128:131], a[12:15]
    ds_read_b64_tr_b16 a[184:185], v22 offset:40960
    v_exp_f32 v46, v62
    v_mfma_f32_16x16x32_bf16 a[44:47], a[172:175], v[132:135], a[44:47]
    ds_read_b64_tr_b16 a[186:187], v22 offset:45056
    v_exp_f32 v47, v63
    v_mfma_f32_16x16x32_bf16 a[76:79], a[172:175], v[136:139], a[76:79]
    v_add_f32 v249, v249, v44
    v_add_f32 v249, v249, v45
    v_mfma_f32_16x16x32_bf16 a[108:111], a[172:175], v[140:143], a[108:111]
    v_cvt_pk_bf16_f32 v118, v44, v45
    s_waitcnt lgkmcnt(2)
    v_mfma_f32_16x16x32_bf16 v[84:87], a[144:147], v[160:163], v[144:147]
    v_exp_f32 v40, v64
    v_mfma_f32_16x16x32_bf16 v[84:87], a[148:151], v[164:167], v[84:87]
    v_exp_f32 v41, v65
    v_mfma_f32_16x16x32_bf16 v[84:87], a[152:155], v[168:171], v[84:87]
    buffer_load_dwordx4 v26, s[24:27], s41 offen offset:0 nt lds
    v_add_f32 v249, v249, v46
    v_mfma_f32_16x16x32_bf16 v[84:87], a[156:159], v[172:175], v[84:87]
    v_add_f32 v249, v249, v47
    v_cvt_pk_bf16_f32 v119, v46, v47
    v_mfma_f32_16x16x32_bf16 a[16:19], a[176:179], v[128:131], a[16:19]
    ds_read_b64_tr_b16 a[188:189], v23 offset:40960
    v_exp_f32 v42, v66
    v_mfma_f32_16x16x32_bf16 a[48:51], a[176:179], v[132:135], a[48:51]
    ds_read_b64_tr_b16 a[190:191], v23 offset:45056
    v_exp_f32 v43, v67
    v_mfma_f32_16x16x32_bf16 a[80:83], a[176:179], v[136:139], a[80:83]
    v_add_f32 v250, v40, v41
    v_cvt_pk_bf16_f32 v120, v40, v41
    v_mfma_f32_16x16x32_bf16 a[112:115], a[176:179], v[140:143], a[112:115]
    v_exp_f32 v44, v68
    v_mfma_f32_16x16x32_bf16 v[92:95], a[144:147], v[176:179], v[148:151]
    v_exp_f32 v45, v69
    v_mfma_f32_16x16x32_bf16 v[92:95], a[148:151], v[180:183], v[92:95]
    v_add_f32 v250, v250, v42
    v_add_f32 v250, v250, v43
    v_mfma_f32_16x16x32_bf16 v[92:95], a[152:155], v[184:187], v[92:95]
    buffer_load_dwordx4 v27, s[24:27], s41 offen offset:1024 nt lds
    s_add_u32 s41, s41, 2048
    v_mfma_f32_16x16x32_bf16 v[92:95], a[156:159], v[188:191], v[92:95]
    v_cvt_pk_bf16_f32 v121, v42, v43
    v_exp_f32 v46, v70
    v_mfma_f32_16x16x32_bf16 a[20:23], a[180:183], v[128:131], a[20:23]
    v_exp_f32 v47, v71
    v_mfma_f32_16x16x32_bf16 a[52:55], a[180:183], v[132:135], a[52:55]
    v_add_f32 v250, v250, v44
    v_add_f32 v250, v250, v45
    v_mfma_f32_16x16x32_bf16 a[84:87], a[180:183], v[136:139], a[84:87]
    v_cvt_pk_bf16_f32 v122, v44, v45
    v_exp_f32 v40, v72
    v_mfma_f32_16x16x32_bf16 a[116:119], a[180:183], v[140:143], a[116:119]
    v_exp_f32 v41, v73
    s_waitcnt lgkmcnt(0)
    v_mfma_f32_16x16x32_bf16 v[100:103], a[144:147], v[192:195], v[152:155]
    ds_read_b128 a[128:131], v8 offset:16384
    v_add_f32 v250, v250, v46
    v_mfma_f32_16x16x32_bf16 v[100:103], a[148:151], v[196:199], v[100:103]
    ds_read_b128 a[132:135], v9 offset:16384
    v_add_f32 v250, v250, v47
    v_mfma_f32_16x16x32_bf16 v[100:103], a[152:155], v[200:203], v[100:103]
    ds_read_b128 a[136:139], v10 offset:16384
    v_cvt_pk_bf16_f32 v123, v46, v47
    v_mfma_f32_16x16x32_bf16 v[100:103], a[156:159], v[204:207], v[100:103]
    ds_read_b128 a[140:143], v11 offset:16384
    v_exp_f32 v42, v74
    v_mfma_f32_16x16x32_bf16 a[24:27], a[184:187], v[128:131], a[24:27]
    ds_read_b64_tr_b16 a[160:161], v16 offset:0
    v_exp_f32 v43, v75
    v_mfma_f32_16x16x32_bf16 a[56:59], a[184:187], v[132:135], a[56:59]
    ds_read_b64_tr_b16 a[162:163], v16 offset:4096
    v_add_f32 v251, v40, v41
    v_mfma_f32_16x16x32_bf16 a[88:91], a[184:187], v[136:139], a[88:91]
    v_cvt_pk_bf16_f32 v124, v40, v41
    v_exp_f32 v44, v76
    v_mfma_f32_16x16x32_bf16 a[120:123], a[184:187], v[140:143], a[120:123]
    v_exp_f32 v45, v77
    v_add_f32 v251, v251, v42
    v_mfma_f32_16x16x32_bf16 v[108:111], a[144:147], v[208:211], v[156:159]
    ds_read_b64_tr_b16 a[164:165], v17 offset:0
    v_add_f32 v251, v251, v43
    v_cvt_pk_bf16_f32 v125, v42, v43
    v_mfma_f32_16x16x32_bf16 v[108:111], a[148:151], v[212:215], v[108:111]
    ds_read_b64_tr_b16 a[166:167], v17 offset:4096
    v_exp_f32 v46, v78
    v_mfma_f32_16x16x32_bf16 v[108:111], a[152:155], v[216:219], v[108:111]
    v_exp_f32 v47, v79
    s_sub_u32 s39, s39, 1
    v_mfma_f32_16x16x32_bf16 v[108:111], a[156:159], v[220:223], v[108:111]
    v_add_f32 v251, v251, v44
    v_add_f32 v251, v251, v45
    v_cvt_pk_bf16_f32 v126, v44, v45
    v_mfma_f32_16x16x32_bf16 a[28:31], a[188:191], v[128:131], a[28:31]
    ds_read_b64_tr_b16 a[168:169], v18 offset:0
    v_add_f32 v251, v251, v46
    s_cmp_lg_u32 s39, 0
    v_mfma_f32_16x16x32_bf16 a[60:63], a[188:191], v[132:135], a[60:63]
    ds_read_b64_tr_b16 a[170:171], v18 offset:4096
    v_add_f32 v251, v251, v47
    v_cvt_pk_bf16_f32 v127, v46, v47
    v_mfma_f32_16x16x32_bf16 a[92:95], a[188:191], v[136:139], a[92:95]
    v_max3_f32 v35, v248, v249, v250
    v_max_f32 v35, v35, v251
    v_cmp_lt_f32 vcc, s40, v35
    v_mfma_f32_16x16x32_bf16 a[124:127], a[188:191], v[140:143], a[124:127]
    s_cbranch_vccnz L_rare_h0u5
L_ret_h0u5:
    s_waitcnt lgkmcnt(2)
    s_cbranch_scc1 L_loop0
    s_branch L_loopx0
L_even0:
    v_mfma_f32_16x16x32_bf16 v[48:51], a[128:131], v[160:163], v[144:147]
    ds_read_b128 a[144:147], v8 offset:20480
    v_mfma_f32_16x16x32_bf16 v[48:51], a[132:135], v[164:167], v[48:51]
    v_mfma_f32_16x16x32_bf16 v[48:51], a[136:139], v[168:171], v[48:51]
    ds_read_b128 a[148:151], v9 offset:20480
    v_mfma_f32_16x16x32_bf16 v[48:51], a[140:143], v[172:175], v[48:51]
    v_mfma_f32_16x16x32_bf16 a[0:3], a[160:163], v[112:115], 0
    ds_read_b64_tr_b16 a[172:173], v19 offset:0
    v_mfma_f32_16x16x32_bf16 a[32:35], a[160:163], v[116:119], 0
    ds_read_b64_tr_b16 a[174:175], v19 offset:4096
    v_mfma_f32_16x16x32_bf16 a[64:67], a[160:163], v[120:123], 0
    v_mfma_f32_16x16x32_bf16 a[96:99], a[160:163], v[124:127], 0
    v_mfma_f32_16x16x32_bf16 v[56:59], a[128:131], v[176:179], v[148:151]
    ds_read_b128 a[152:155], v10 offset:20480
    v_mfma_f32_16x16x32_bf16 v[56:59], a[132:135], v[180:183], v[56:59]
    v_mfma_f32_16x16x32_bf16 v[56:59], a[136:139], v[184:187], v[56:59]
    ds_read_b128 a[156:159], v11 offset:20480
    v_mfma_f32_16x16x32_bf16 v[56:59], a[140:143], v[188:191], v[56:59]
    v_mfma_f32_16x16x32_bf16 a[4:7], a[164:167], v[112:115], 0
    ds_read_b64_tr_b16 a[176:177], v20 offset:0
    v_mfma_f32_16x16x32_bf16 a[36:39], a[164:167], v[116:119], 0
    ds_read_b64_tr_b16 a[178:179], v20 offset:4096
    v_mfma_f32_16x16x32_bf16 a[68:71], a[164:167], v[120:123], 0
    v_add_f32 v244, v244, v248
    v_add_f32 v245, v245, v249
    v_add_f32 v246, v246, v250
    v_add_f32 v247, v247, v251
    v_exp_f32 v40, v80
    v_exp_f32 v41, v81
    v_exp_f32 v42, v82
    v_exp_f32 v43, v83
    v_add_f32 v4, v40, v41
    v_cvt_pk_bf16_f32 v128, v40, v41
    v_exp_f32 v44, v84
    v_exp_f32 v45, v85
    v_add_f32 v4, v4, v42
    v_add_f32 v4, v4, v43
    v_cvt_pk_bf16_f32 v129, v42, v43
    v_exp_f32 v46, v86
    v_exp_f32 v47, v87
    v_add_f32 v4, v4, v44
    v_add_f32 v4, v4, v45
    v_cvt_pk_bf16_f32 v130, v44, v45
    v_mfma_f32_16x16x32_bf16 a[100:103], a[164:167], v[124:127], 0
    s_waitcnt lgkmcnt(4)
    v_mfma_f32_16x16x32_bf16 v[64:67], a[128:131], v[192:195], v[152:155]
    v_mfma_f32_16x16x32_bf16 v[64:67], a[132:135], v[196:199], v[64:67]
    s_add_u32 m0, s35, 0
    v_mfma_f32_16x16x32_bf16 v[64:67], a[136:139], v[200:203], v[64:67]
    buffer_load_dwordx4 v24, s[20:23], s37 offen offset:0 nt lds
    v_mfma_f32_16x16x32_bf16 v[64:67], a[140:143], v[204:207], v[64:67]
    v_mfma_f32_16x16x32_bf16 a[8:11], a[168:171], v[112:115], 0
    ds_read_b64_tr_b16 a[180:181], v21 offset:0
    v_mfma_f32_16x16x32_bf16 a[40:43], a[168:171], v[116:119], 0
    ds_read_b64_tr_b16 a[182:183], v21 offset:4096
    v_mfma_f32_16x16x32_bf16 a[72:75], a[168:171], v[120:123], 0
    v_mfma_f32_16x16x32_bf16 a[104:107], a[168:171], v[124:127], 0
    v_mfma_f32_16x16x32_bf16 v[72:75], a[128:131], v[208:211], v[156:159]
    v_mfma_f32_16x16x32_bf16 v[72:75], a[132:135], v[212:215], v[72:75]
    v_mfma_f32_16x16x32_bf16 v[72:75], a[136:139], v[216:219], v[72:75]
    buffer_load_dwordx4 v25, s[20:23], s37 offen offset:1024 nt lds
    s_add_u32 m0, s36, 32768
    v_mfma_f32_16x16x32_bf16 v[72:75], a[140:143], v[220:223], v[72:75]
    s_add_u32 s37, s37, 2048
    v_mfma_f32_16x16x32_bf16 a[12:15], a[172:175], v[112:115], 0
    ds_read_b64_tr_b16 a[184:185], v22 offset:0
    v_mfma_f32_16x16x32_bf16 a[44:47], a[172:175], v[116:119], 0
    ds_read_b64_tr_b16 a[186:187], v22 offset:4096
    v_exp_f32 v40, v88
    v_exp_f32 v41, v89
    v_add_f32 v4, v4, v46
    v_add_f32 v4, v4, v47
    v_cvt_pk_bf16_f32 v131, v46, v47
    v_exp_f32 v42, v90
    v_exp_f32 v43, v91
    v_add_f32 v5, v40, v41
    v_cvt_pk_bf16_f32 v132, v40, v41
    v_exp_f32 v44, v92
    v_exp_f32 v45, v93
    v_add_f32 v5, v5, v42
    v_add_f32 v5, v5, v43
    v_cvt_pk_bf16_f32 v133, v42, v43
    v_exp_f32 v46, v94
    v_exp_f32 v47, v95
    v_add_f32 v5, v5, v44
    v_add_f32 v5, v5, v45
    v_cvt_pk_bf16_f32 v134, v44, v45
    v_exp_f32 v40, v96
    v_mfma_f32_16x16x32_bf16 a[76:79], a[172:175], v[120:123], 0
    v_mfma_f32_16x16x32_bf16 a[108:111], a[172:175], v[124:127], 0
    s_waitcnt lgkmcnt(2)
    v_mfma_f32_16x16x32_bf16 v[52:55], a[144:147], v[160:163], v[144:147]
    v_mfma_f32_16x16x32_bf16 v[52:55], a[148:151], v[164:167], v[52:55]
    v_mfma_f32_16x16x32_bf16 v[52:55], a[152:155], v[168:171], v[52:55]
    buffer_load_dwordx4 v26, s[24:27], s41 offen offset:0 nt lds
    v_mfma_f32_16x16x32_bf16 v[52:55], a[156:159], v[172:175], v[52:55]
    v_mfma_f32_16x16x32_bf16 a[16:19], a[176:179], v[112:115], 0
    ds_read_b64_tr_b16 a[188:189], v23 offset:0
    v_mfma_f32_16x16x32_bf16 a[48:51], a[176:179], v[116:119], 0
    ds_read_b64_tr_b16 a[190:191], v23 offset:4096
    v_mfma_f32_16x16x32_bf16 a[80:83], a[176:179], v[120:123], 0
    v_mfma_f32_16x16x32_bf16 a[112:115], a[176:179], v[124:127], 0
    v_mfma_f32_16x16x32_bf16 v[60:63], a[144:147], v[176:179], v[148:151]
    v_mfma_f32_16x16x32_bf16 v[60:63], a[148:151], v[180:183], v[60:63]
    v_mfma_f32_16x16x32_bf16 v[60:63], a[152:155], v[184:187], v[60:63]
    buffer_load_dwordx4 v27, s[24:27], s41 offen offset:1024 nt lds
    s_add_u32 s41, s41, 2048
    v_mfma_f32_16x16x32_bf16 v[60:63], a[156:159], v[188:191], v[60:63]
    v_mfma_f32_16x16x32_bf16 a[20:23], a[180:183], v[112:115], 0
    v_mfma_f32_16x16x32_bf16 a[52:55], a[180:183], v[116:119], 0
    v_exp_f32 v41, v97
    v_add_f32 v5, v5, v46
    v_add_f32 v5, v5, v47
    v_cvt_pk_bf16_f32 v135, v46, v47
    v_exp_f32 v42, v98
    v_exp_f32 v43, v99
    v_add_f32 v6, v40, v41
    v_cvt_pk_bf16_f32 v136, v40, v41
    v_exp_f32 v44, v100
    v_exp_f32 v45, v101
    v_add_f32 v6, v6, v42
    v_add_f32 v6, v6, v43
    v_cvt_pk_bf16_f32 v137, v42, v43
    v_exp_f32 v46, v102
    v_exp_f32 v47, v103
    v_add_f32 v6, v6, v44
    v_add_f32 v6, v6, v45
    v_cvt_pk_bf16_f32 v138, v44, v45
    v_exp_f32 v40, v104
    v_exp_f32 v41, v105
    v_add_f32 v6, v6, v46
    v_mfma_f32_16x16x32_bf16 a[84:87], a[180:183], v[120:123], 0
    v_mfma_f32_16x16x32_bf16 a[116:119], a[180:183], v[124:127], 0
    s_waitcnt vmcnt(8) lgkmcnt(0)
    s_barrier
    v_mfma_f32_16x16x32_bf16 v[68:71], a[144:147], v[192:195], v[152:155]
    ds_read_b128 a[128:131], v8 offset:24576
    v_mfma_f32_16x16x32_bf16 v[68:71], a[148:151], v[196:199], v[68:71]
    ds_read_b128 a[132:135], v9 offset:24576
    v_mfma_f32_16x16x32_bf16 v[68:71], a[152:155], v[200:203], v[68:71]
    ds_read_b128 a[136:139], v10 offset:24576
    v_mfma_f32_16x16x32_bf16 v[68:71], a[156:159], v[204:207], v[68:71]
    ds_read_b128 a[140:143], v11 offset:24576
    v_mfma_f32_16x16x32_bf16 a[24:27], a[184:187], v[112:115], 0
    ds_read_b64_tr_b16 a[160:161], v16 offset:8192
    v_mfma_f32_16x16x32_bf16 a[56:59], a[184:187], v[116:119], 0
    ds_read_b64_tr_b16 a[162:163], v16 offset:12288
    v_mfma_f32_16x16x32_bf16 a[88:91], a[184:187], v[120:123], 0
    v_mfma_f32_16x16x32_bf16 a[120:123], a[184:187], v[124:127], 0
    v_mfma_f32_16x16x32_bf16 v[76:79], a[144:147], v[208:211], v[156:159]
    ds_read_b64_tr_b16 a[164:165], v17 offset:8192
    v_mfma_f32_16x16x32_bf16 v[76:79], a[148:151], v[212:215], v[76:79]
    ds_read_b64_tr_b16 a[166:167], v17 offset:12288
    v_mfma_f32_16x16x32_bf16 v[76:79], a[152:155], v[216:219], v[76:79]
    v_mfma_f32_16x16x32_bf16 v[76:79], a[156:159], v[220:223], v[76:79]
    v_mfma_f32_16x16x32_bf16 a[28:31], a[188:191], v[112:115], 0
    ds_read_b64_tr_b16 a[168:169], v18 offset:8192
    v_mfma_f32_16x16x32_bf16 a[60:63], a[188:191], v[116:119], 0
    ds_read_b64_tr_b16 a[170:171], v18 offset:12288
    v_add_f32 v6, v6, v47
    v_cvt_pk_bf16_f32 v139, v46, v47
    v_exp_f32 v42, v106
    v_exp_f32 v43, v107
    v_add_f32 v7, v40, v41
    v_cvt_pk_bf16_f32 v140, v40, v41
    v_exp_f32 v44, v108
    v_exp_f32 v45, v109
    v_add_f32 v7, v7, v42
    v_add_f32 v7, v7, v43
    v_cvt_pk_bf16_f32 v141, v42, v43
    v_exp_f32 v46, v110
    v_exp_f32 v47, v111
    v_add_f32 v7, v7, v44
    v_add_f32 v7, v7, v45
    v_cvt_pk_bf16_f32 v142, v44, v45
    v_add_f32 v7, v7, v46
    v_add_f32 v7, v7, v47
    v_cvt_pk_bf16_f32 v143, v46, v47
    v_max3_f32 v35, v4, v5, v6
    v_max_f32 v35, v35, v7
    v_cmp_lt_f32 vcc, s40, v35
    v_mfma_f32_16x16x32_bf16 a[92:95], a[188:191], v[120:123], 0
    v_mfma_f32_16x16x32_bf16 a[124:127], a[188:191], v[124:127], 0
    s_cbranch_vccnz L_rare_h0q1
L_ret_h0q1:
    s_waitcnt lgkmcnt(2)
    v_mfma_f32_16x16x32_bf16 v[80:83], a[128:131], v[160:163], v[144:147]
    ds_read_b128 a[144:147], v8 offset:28672
    v_mfma_f32_16x16x32_bf16 v[80:83], a[132:135], v[164:167], v[80:83]
    v_mfma_f32_16x16x32_bf16 v[80:83], a[136:139], v[168:171], v[80:83]
    ds_read_b128 a[148:151], v9 offset:28672
    v_mfma_f32_16x16x32_bf16 v[80:83], a[140:143], v[172:175], v[80:83]
    v_mfma_f32_16x16x32_bf16 a[0:3], a[160:163], v[128:131], a[0:3]
    ds_read_b64_tr_b16 a[172:173], v19 offset:8192
    v_mfma_f32_16x16x32_bf16 a[32:35], a[160:163], v[132:135], a[32:35]
    ds_read_b64_tr_b16 a[174:175], v19 offset:12288
    v_mfma_f32_16x16x32_bf16 a[64:67], a[160:163], v[136:139], a[64:67]
    v_mfma_f32_16x16x32_bf16 a[96:99], a[160:163], v[140:143], a[96:99]
    v_mfma_f32_16x16x32_bf16 v[88:91], a[128:131], v[176:179], v[148:151]
    ds_read_b128 a[152:155], v10 offset:28672
    v_mfma_f32_16x16x32_bf16 v[88:91], a[132:135], v[180:183], v[88:91]
    v_mfma_f32_16x16x32_bf16 v[88:91], a[136:139], v[184:187], v[88:91]
    ds_read_b128 a[156:159], v11 offset:28672
    v_mfma_f32_16x16x32_bf16 v[88:91], a[140:143], v[188:191], v[88:91]
    v_mfma_f32_16x16x32_bf16 a[4:7], a[164:167], v[128:131], a[4:7]
    ds_read_b64_tr_b16 a[176:177], v20 offset:8192
    v_mfma_f32_16x16x32_bf16 a[36:39], a[164:167], v[132:135], a[36:39]
    ds_read_b64_tr_b16 a[178:179], v20 offset:12288
    v_mfma_f32_16x16x32_bf16 a[68:71], a[164:167], v[136:139], a[68:71]
    v_add_f32 v244, v244, v4
    v_add_f32 v245, v245, v5
    v_add_f32 v246, v246, v6
    v_add_f32 v247, v247, v7
    v_exp_f32 v40, v48
    v_exp_f32 v41, v49
    v_exp_f32 v42, v50
    v_exp_f32 v43, v51
    v_add_f32 v248, v40, v41
    v_cvt_pk_bf16_f32 v112, v40, v41
    v_exp_f32 v44, v52
    v_exp_f32 v45, v53
    v_add_f32 v248, v248, v42
    v_add_f32 v248, v248, v43
    v_cvt_pk_bf16_f32 v113, v42, v43
    v_exp_f32 v46, v54
    v_exp_f32 v47, v55
    v_add_f32 v248, v248, v44
    v_add_f32 v248, v248, v45
    v_cvt_pk_bf16_f32 v114, v44, v45
    v_mfma_f32_16x16x32_bf16 a[100:103], a[164:167], v[140:143], a[100:103]
    s_waitcnt lgkmcnt(4)
    v_mfma_f32_16x16x32_bf16 v[96:99], a[128:131], v[192:195], v[152:155]
    v_mfma_f32_16x16x32_bf16 v[96:99], a[132:135], v[196:199], v[96:99]
    s_add_u32 m0, s35, 8192
    v_mfma_f32_16x16x32_bf16 v[96:99], a[136:139], v[200:203], v[96:99]
    buffer_load_dwordx4 v24, s[20:23], s37 offen offset:0 nt lds
    v_mfma_f32_16x16x32_bf16 v[96:99], a[140:143], v[204:207], v[96:99]
    v_mfma_f32_16x16x32_bf16 a[8:11], a[168:171], v[128:131], a[8:11]
    ds_read_b64_tr_b16 a[180:181], v21 offset:8192
    v_mfma_f32_16x16x32_bf16 a[40:43], a[168:171], v[132:135], a[40:43]
    ds_read_b64_tr_b16 a[182:183], v21 offset:12288
    v_mfma_f32_16x16x32_bf16 a[72:75], a[168:171], v[136:139], a[72:75]
    v_mfma_f32_16x16x32_bf16 a[104:107], a[168:171], v[140:143], a[104:107]
    v_mfma_f32_16x16x32_bf16 v[104:107], a[128:131], v[208:211], v[156:159]
    v_mfma_f32_16x16x32_bf16 v[104:107], a[132:135], v[212:215], v[104:107]
    v_mfma_f32_16x16x32_bf16 v[104:107], a[136:139], v[216:219], v[104:107]
    buffer_load_dwordx4 v25, s[20:23], s37 offen offset:1024 nt lds
    s_add_u32 m0, s36, 40960
    v_mfma_f32_16x16x32_bf16 v[104:107], a[140:143], v[220:223], v[104:107]
    s_add_u32 s37, s37, 2048
    v_mfma_f32_16x16x32_bf16 a[12:15], a[172:175], v[128:131], a[12:15]
    ds_read_b64_tr_b16 a[184:185], v22 offset:8192
    v_mfma_f32_16x16x32_bf16 a[44:47], a[172:175], v[132:135], a[44:47]
    ds_read_b64_tr_b16 a[186:187], v22 offset:12288
    v_exp_f32 v40, v56
    v_exp_f32 v41, v57
    v_add_f32 v248, v248, v46
    v_add_f32 v248, v248, v47
    v_cvt_pk_bf16_f32 v115, v46, v47
    v_exp_f32 v42, v58
    v_exp_f32 v43, v59
    v_add_f32 v249, v40, v41
    v_cvt_pk_bf16_f32 v116, v40, v41
    v_exp_f32 v44, v60
    v_exp_f32 v45, v61
    v_add_f32 v249, v249, v42
    v_add_f32 v249, v249, v43
    v_cvt_pk_bf16_f32 v117, v42, v43
    v_exp_f32 v46, v62
    v_exp_f32 v47, v63
    v_add_f32 v249, v249, v44
    v_add_f32 v249, v249, v45
    v_cvt_pk_bf16_f32 v118, v44, v45
    v_exp_f32 v40, v64
    v_mfma_f32_16x16x32_bf16 a[76:79], a[172:175], v[136:139], a[76:79]
    v_mfma_f32_16x16x32_bf16 a[108:111], a[172:175], v[140:143], a[108:111]
    s_waitcnt lgkmcnt(2)
    v_mfma_f32_16x16x32_bf16 v[84:87], a[144:147], v[160:163], v[144:147]
    v_mfma_f32_16x16x32_bf16 v[84:87], a[148:151], v[164:167], v[84:87]
    v_mfma_f32_16x16x32_bf16 v[84:87], a[152:155], v[168:171], v[84:87]
    buffer_load_dwordx4 v26, s[24:27], s41 offen offset:0 nt lds
    v_mfma_f32_16x16x32_bf16 v[84:87], a[156:159], v[172:175], v[84:87]
    v_mfma_f32_16x16x32_bf16 a[16:19], a[176:179], v[128:131], a[16:19]
    ds_read_b64_tr_b16 a[188:189], v23 offset:8192
    v_mfma_f32_16x16x32_bf16 a[48:51], a[176:179], v[132:135], a[48:51]
    ds_read_b64_tr_b16 a[190:191], v23 offset:12288
    v_mfma_f32_16x16x32_bf16 a[80:83], a[176:179], v[136:139], a[80:83]
    v_mfma_f32_16x16x32_bf16 a[112:115], a[176:179], v[140:143], a[112:115]
    v_mfma_f32_16x16x32_bf16 v[92:95], a[144:147], v[176:179], v[148:151]
    v_mfma_f32_16x16x32_bf16 v[92:95], a[148:151], v[180:183], v[92:95]
    v_mfma_f32_16x16x32_bf16 v[92:95], a[152:155], v[184:187], v[92:95]
    buffer_load_dwordx4 v27, s[24:27], s41 offen offset:1024 nt lds
    s_add_u32 s41, s41, 2048
    v_mfma_f32_16x16x32_bf16 v[92:95], a[156:159], v[188:191], v[92:95]
    v_mfma_f32_16x16x32_bf16 a[20:23], a[180:183], v[128:131], a[20:23]
    v_mfma_f32_16x16x32_bf16 a[52:55], a[180:183], v[132:135], a[52:55]
    v_exp_f32 v41, v65
    v_add_f32 v249, v249, v46
    v_add_f32 v249, v249, v47
    v_cvt_pk_bf16_f32 v119, v46, v47
    v_exp_f32 v42, v66
    v_exp_f32 v43, v67
    v_add_f32 v250, v40, v41
    v_cvt_pk_bf16_f32 v120, v40, v41
    v_exp_f32 v44, v68
    v_exp_f32 v45, v69
    v_add_f32 v250, v250, v42
    v_add_f32 v250, v250, v43
    v_cvt_pk_bf16_f32 v121, v42, v43
    v_exp_f32 v46, v70
    v_exp_f32 v47, v71
    v_add_f32 v250, v250, v44
    v_add_f32 v250, v250, v45
    v_cvt_pk_bf16_f32 v122, v44, v45
    v_exp_f32 v40, v72
    v_exp_f32 v41, v73
    v_add_f32 v250, v250, v46
    v_mfma_f32_16x16x32_bf16 a[84:87], a[180:183], v[136:139], a[84:87]
    v_mfma_f32_16x16x32_bf16 a[116:119], a[180:183], v[140:143], a[116:119]
    s_waitcnt lgkmcnt(0)
    v_mfma_f32_16x16x32_bf16 v[100:103], a[144:147], v[192:195], v[152:155]
    ds_read_b128 a[128:131], v8 offset:32768
    v_mfma_f32_16x16x32_bf16 v[100:103], a[148:151], v[196:199], v[100:103]
    ds_read_b128 a[132:135], v9 offset:32768
    v_mfma_f32_16x16x32_bf16 v[100:103], a[152:155], v[200:203], v[100:103]
    ds_read_b128 a[136:139], v10 offset:32768
    v_mfma_f32_16x16x32_bf16 v[100:103], a[156:159], v[204:207], v[100:103]
    ds_read_b128 a[140:143], v11 offset:32768
    v_mfma_f32_16x16x32_bf16 a[24:27], a[184:187], v[128:131], a[24:27]
    ds_read_b64_tr_b16 a[160:161], v16 offset:16384
    v_mfma_f32_16x16x32_bf16 a[56:59], a[184:187], v[132:135], a[56:59]
    ds_read_b64_tr_b16 a[162:163], v16 offset:20480
    v_mfma_f32_16x16x32_bf16 a[88:91], a[184:187], v[136:139], a[88:91]
    v_mfma_f32_16x16x32_bf16 a[120:123], a[184:187], v[140:143], a[120:123]
    v_mfma_f32_16x16x32_bf16 v[108:111], a[144:147], v[208:211], v[156:159]
    ds_read_b64_tr_b16 a[164:165], v17 offset:16384
    v_mfma_f32_16x16x32_bf16 v[108:111], a[148:151], v[212:215], v[108:111]
    ds_read_b64_tr_b16 a[166:167], v17 offset:20480
    v_mfma_f32_16x16x32_bf16 v[108:111], a[152:155], v[216:219], v[108:111]
    v_mfma_f32_16x16x32_bf16 v[108:111], a[156:159], v[220:223], v[108:111]
    v_mfma_f32_16x16x32_bf16 a[28:31], a[188:191], v[128:131], a[28:31]
    ds_read_b64_tr_b16 a[168:169], v18 offset:16384
    v_mfma_f32_16x16x32_bf16 a[60:63], a[188:191], v[132:135], a[60:63]
    ds_read_b64_tr_b16 a[170:171], v18 offset:20480
    v_add_f32 v250, v250, v47
    v_cvt_pk_bf16_f32 v123, v46, v47
    v_exp_f32 v42, v74
    v_exp_f32 v43, v75
    v_add_f32 v251, v40, v41
    v_cvt_pk_bf16_f32 v124, v40, v41
    v_exp_f32 v44, v76
    v_exp_f32 v45, v77
    v_add_f32 v251, v251, v42
    v_add_f32 v251, v251, v43
    v_cvt_pk_bf16_f32 v125, v42, v43
    v_exp_f32 v46, v78
    v_exp_f32 v47, v79
    v_add_f32 v251, v251, v44
    v_add_f32 v251, v251, v45
    v_cvt_pk_bf16_f32 v126, v44, v45
    v_add_f32 v251, v251, v46
    v_add_f32 v251, v251, v47
    v_cvt_pk_bf16_f32 v127, v46, v47
    v_max3_f32 v35, v248, v249, v250
    v_max_f32 v35, v35, v251
    v_cmp_lt_f32 vcc, s40, v35
    v_mfma_f32_16x16x32_bf16 a[92:95], a[188:191], v[136:139], a[92:95]
    v_mfma_f32_16x16x32_bf16 a[124:127], a[188:191], v[140:143], a[124:127]
    s_cbranch_vccnz L_rare_h0q2
L_ret_h0q2:
    s_waitcnt lgkmcnt(2)
    v_mfma_f32_16x16x32_bf16 v[48:51], a[128:131], v[160:163], v[144:147]
    ds_read_b128 a[144:147], v8 offset:36864
    v_mfma_f32_16x16x32_bf16 v[48:51], a[132:135], v[164:167], v[48:51]
    v_mfma_f32_16x16x32_bf16 v[48:51], a[136:139], v[168:171], v[48:51]
    ds_read_b128 a[148:151], v9 offset:36864
    v_mfma_f32_16x16x32_bf16 v[48:51], a[140:143], v[172:175], v[48:51]
    v_mfma_f32_16x16x32_bf16 a[0:3], a[160:163], v[112:115], a[0:3]
    ds_read_b64_tr_b16 a[172:173], v19 offset:16384
    v_mfma_f32_16x16x32_bf16 a[32:35], a[160:163], v[116:119], a[32:35]
    ds_read_b64_tr_b16 a[174:175], v19 offset:20480
    v_mfma_f32_16x16x32_bf16 a[64:67], a[160:163], v[120:123], a[64:67]
    v_mfma_f32_16x16x32_bf16 a[96:99], a[160:163], v[124:127], a[96:99]
    v_mfma_f32_16x16x32_bf16 v[56:59], a[128:131], v[176:179], v[148:151]
    ds_read_b128 a[152:155], v10 offset:36864
    v_mfma_f32_16x16x32_bf16 v[56:59], a[132:135], v[180:183], v[56:59]
    v_mfma_f32_16x16x32_bf16 v[56:59], a[136:139], v[184:187], v[56:59]
    ds_read_b128 a[156:159], v11 offset:36864
    v_mfma_f32_16x16x32_bf16 v[56:59], a[140:143], v[188:191], v[56:59]
    v_mfma_f32_16x16x32_bf16 a[4:7], a[164:167], v[112:115], a[4:7]
    ds_read_b64_tr_b16 a[176:177], v20 offset:16384
    v_mfma_f32_16x16x32_bf16 a[36:39], a[164:167], v[116:119], a[36:39]
    ds_read_b64_tr_b16 a[178:179], v20 offset:20480
    v_mfma_f32_16x16x32_bf16 a[68:71], a[164:167], v[120:123], a[68:71]
    v_add_f32 v244, v244, v248
    v_add_f32 v245, v245, v249
    v_add_f32 v246, v246, v250
    v_add_f32 v247, v247, v251
    v_exp_f32 v40, v80
    v_exp_f32 v41, v81
    v_exp_f32 v42, v82
    v_exp_f32 v43, v83
    v_add_f32 v4, v40, v41
    v_cvt_pk_bf16_f32 v128, v40, v41
    v_exp_f32 v44, v84
    v_exp_f32 v45, v85
    v_add_f32 v4, v4, v42
    v_add_f32 v4, v4, v43
    v_cvt_pk_bf16_f32 v129, v42, v43
    v_exp_f32 v46, v86
    v_exp_f32 v47, v87
    v_add_f32 v4, v4, v44
    v_add_f32 v4, v4, v45
    v_cvt_pk_bf16_f32 v130, v44, v45
    v_mfma_f32_16x16x32_bf16 a[100:103], a[164:167], v[124:127], a[100:103]
    s_waitcnt lgkmcnt(4)
    v_mfma_f32_16x16x32_bf16 v[64:67], a[128:131], v[192:195], v[152:155]
    v_mfma_f32_16x16x32_bf16 v[64:67], a[132:135], v[196:199], v[64:67]
    s_add_u32 m0, s35, 16384
    v_mfma_f32_16x16x32_bf16 v[64:67], a[136:139], v[200:203], v[64:67]
    buffer_load_dwordx4 v24, s[20:23], s37 offen offset:0 nt lds
    v_mfma_f32_16x16x32_bf16 v[64:67], a[140:143], v[204:207], v[64:67]
    v_mfma_f32_16x16x32_bf16 a[8:11], a[168:171], v[112:115], a[8:11]
    ds_read_b64_tr_b16 a[180:181], v21 offset:16384
    v_mfma_f32_16x16x32_bf16 a[40:43], a[168:171], v[116:119], a[40:43]
    ds_read_b64_tr_b16 a[182:183], v21 offset:20480
    v_mfma_f32_16x16x32_bf16 a[72:75], a[168:171], v[120:123], a[72:75]
    v_mfma_f32_16x16x32_bf16 a[104:107], a[168:171], v[124:127], a[104:107]
    v_mfma_f32_16x16x32_bf16 v[72:75], a[128:131], v[208:211], v[156:159]
    v_mfma_f32_16x16x32_bf16 v[72:75], a[132:135], v[212:215], v[72:75]
    v_mfma_f32_16x16x32_bf16 v[72:75], a[136:139], v[216:219], v[72:75]
    buffer_load_dwordx4 v25, s[20:23], s37 offen offset:1024 nt lds
    s_add_u32 m0, s36, 0
    v_mfma_f32_16x16x32_bf16 v[72:75], a[140:143], v[220:223], v[72:75]
    s_add_u32 s37, s37, 2048
    v_mfma_f32_16x16x32_bf16 a[12:15], a[172:175], v[112:115], a[12:15]
    ds_read_b64_tr_b16 a[184:185], v22 offset:16384
    v_mfma_f32_16x16x32_bf16 a[44:47], a[172:175], v[116:119], a[44:47]
    ds_read_b64_tr_b16 a[186:187], v22 offset:20480
    v_exp_f32 v40, v88
    v_exp_f32 v41, v89
    v_add_f32 v4, v4, v46
    v_add_f32 v4, v4, v47
    v_cvt_pk_bf16_f32 v131, v46, v47
    v_exp_f32 v42, v90
    v_exp_f32 v43, v91
    v_add_f32 v5, v40, v41
    v_cvt_pk_bf16_f32 v132, v40, v41
    v_exp_f32 v44, v92
    v_exp_f32 v45, v93
    v_add_f32 v5, v5, v42
    v_add_f32 v5, v5, v43
    v_cvt_pk_bf16_f32 v133, v42, v43
    v_exp_f32 v46, v94
    v_exp_f32 v47, v95
    v_add_f32 v5, v5, v44
    v_add_f32 v5, v5, v45
    v_cvt_pk_bf16_f32 v134, v44, v45
    v_exp_f32 v40, v96
    v_mfma_f32_16x16x32_bf16 a[76:79], a[172:175], v[120:123], a[76:79]
    v_mfma_f32_16x16x32_bf16 a[108:111], a[172:175], v[124:127], a[108:111]
    s_waitcnt lgkmcnt(2)
    v_mfma_f32_16x16x32_bf16 v[52:55], a[144:147], v[160:163], v[144:147]
    v_mfma_f32_16x16x32_bf16 v[52:55], a[148:151], v[164:167], v[52:55]
    v_mfma_f32_16x16x32_bf16 v[52:55], a[152:155], v[168:171], v[52:55]
    buffer_load_dwordx4 v26, s[24:27], s41 offen offset:0 nt lds
    v_mfma_f32_16x16x32_bf16 v[52:55], a[156:159], v[172:175], v[52:55]
    v_mfma_f32_16x16x32_bf16 a[16:19], a[176:179], v[112:115], a[16:19]
    ds_read_b64_tr_b16 a[188:189], v23 offset:16384
    v_mfma_f32_16x16x32_bf16 a[48:51], a[176:179], v[116:119], a[48:51]
    ds_read_b64_tr_b16 a[190:191], v23 offset:20480
    v_mfma_f32_16x16x32_bf16 a[80:83], a[176:179], v[120:123], a[80:83]
    v_mfma_f32_16x16x32_bf16 a[112:115], a[176:179], v[124:127], a[112:115]
    v_mfma_f32_16x16x32_bf16 v[60:63], a[144:147], v[176:179], v[148:151]
    v_mfma_f32_16x16x32_bf16 v[60:63], a[148:151], v[180:183], v[60:63]
    v_mfma_f32_16x16x32_bf16 v[60:63], a[152:155], v[184:187], v[60:63]
    buffer_load_dwordx4 v27, s[24:27], s41 offen offset:1024 nt lds
    s_add_u32 s41, s41, 2048
    v_mfma_f32_16x16x32_bf16 v[60:63], a[156:159], v[188:191], v[60:63]
    v_mfma_f32_16x16x32_bf16 a[20:23], a[180:183], v[112:115], a[20:23]
    v_mfma_f32_16x16x32_bf16 a[52:55], a[180:183], v[116:119], a[52:55]
    v_exp_f32 v41, v97
    v_add_f32 v5, v5, v46
    v_add_f32 v5, v5, v47
    v_cvt_pk_bf16_f32 v135, v46, v47
    v_exp_f32 v42, v98
    v_exp_f32 v43, v99
    v_add_f32 v6, v40, v41
    v_cvt_pk_bf16_f32 v136, v40, v41
    v_exp_f32 v44, v100
    v_exp_f32 v45, v101
    v_add_f32 v6, v6, v42
    v_add_f32 v6, v6, v43
    v_cvt_pk_bf16_f32 v137, v42, v43
    v_exp_f32 v46, v102
    v_exp_f32 v47, v103
    v_add_f32 v6, v6, v44
    v_add_f32 v6, v6, v45
    v_cvt_pk_bf16_f32 v138, v44, v45
    v_exp_f32 v40, v104
    v_exp_f32 v41, v105
    v_add_f32 v6, v6, v46
    v_mfma_f32_16x16x32_bf16 a[84:87], a[180:183], v[120:123], a[84:87]
    v_mfma_f32_16x16x32_bf16 a[116:119], a[180:183], v[124:127], a[116:119]
    s_waitcnt vmcnt(8) lgkmcnt(0)
    s_barrier
    v_mfma_f32_16x16x32_bf16 v[68:71], a[144:147], v[192:195], v[152:155]
    ds_read_b128 a[128:131], v8 offset:40960
    v_mfma_f32_16x16x32_bf16 v[68:71], a[148:151], v[196:199], v[68:71]
    ds_read_b128 a[132:135], v9 offset:40960
    v_mfma_f32_16x16x32_bf16 v[68:71], a[152:155], v[200:203], v[68:71]
    ds_read_b128 a[136:139], v10 offset:40960
    v_mfma_f32_16x16x32_bf16 v[68:71], a[156:159], v[204:207], v[68:71]
    ds_read_b128 a[140:143], v11 offset:40960
    v_mfma_f32_16x16x32_bf16 a[24:27], a[184:187], v[112:115], a[24:27]
    ds_read_b64_tr_b16 a[160:161], v16 offset:24576
    v_mfma_f32_16x16x32_bf16 a[56:59], a[184:187], v[116:119], a[56:59]
    ds_read_b64_tr_b16 a[162:163], v16 offset:28672
    v_mfma_f32_16x16x32_bf16 a[88:91], a[184:187], v[120:123], a[88:91]
    v_mfma_f32_16x16x32_bf16 a[120:123], a[184:187], v[124:127], a[120:123]
    v_mfma_f32_16x16x32_bf16 v[76:79], a[144:147], v[208:211], v[156:159]
    ds_read_b64_tr_b16 a[164:165], v17 offset:24576
    v_mfma_f32_16x16x32_bf16 v[76:79], a[148:151], v[212:215], v[76:79]
    ds_read_b64_tr_b16 a[166:167], v17 offset:28672
    v_mfma_f32_16x16x32_bf16 v[76:79], a[152:155], v[216:219], v[76:79]
    v_mfma_f32_16x16x32_bf16 v[76:79], a[156:159], v[220:223], v[76:79]
    v_mfma_f32_16x16x32_bf16 a[28:31], a[188:191], v[112:115], a[28:31]
    ds_read_b64_tr_b16 a[168:169], v18 offset:24576
    v_mfma_f32_16x16x32_bf16 a[60:63], a[188:191], v[116:119], a[60:63]
    ds_read_b64_tr_b16 a[170:171], v18 offset:28672
    v_add_f32 v6, v6, v47
    v_cvt_pk_bf16_f32 v139, v46, v47
    v_exp_f32 v42, v106
    v_exp_f32 v43, v107
    v_add_f32 v7, v40, v41
    v_cvt_pk_bf16_f32 v140, v40, v41
    v_exp_f32 v44, v108
    v_exp_f32 v45, v109
    v_add_f32 v7, v7, v42
    v_add_f32 v7, v7, v43
    v_cvt_pk_bf16_f32 v141, v42, v43
    v_exp_f32 v46, v110
    v_exp_f32 v47, v111
    v_add_f32 v7, v7, v44
    v_add_f32 v7, v7, v45
    v_cvt_pk_bf16_f32 v142, v44, v45
    v_add_f32 v7, v7, v46
    v_add_f32 v7, v7, v47
    v_cvt_pk_bf16_f32 v143, v46, v47
    v_max3_f32 v35, v4, v5, v6
    v_max_f32 v35, v35, v7
    v_cmp_lt_f32 vcc, s40, v35
    v_mfma_f32_16x16x32_bf16 a[92:95], a[188:191], v[120:123], a[92:95]
    v_mfma_f32_16x16x32_bf16 a[124:127], a[188:191], v[124:127], a[124:127]
    s_cbranch_vccnz L_rare_h0q3
L_ret_h0q3:
    s_waitcnt lgkmcnt(2)
    v_mfma_f32_16x16x32_bf16 v[80:83], a[128:131], v[160:163], v[144:147]
    ds_read_b128 a[144:147], v8 offset:45056
    v_mfma_f32_16x16x32_bf16 v[80:83], a[132:135], v[164:167], v[80:83]
    v_mfma_f32_16x16x32_bf16 v[80:83], a[136:139], v[168:171], v[80:83]
    ds_read_b128 a[148:151], v9 offset:45056
    v_mfma_f32_16x16x32_bf16 v[80:83], a[140:143], v[172:175], v[80:83]
    v_mfma_f32_16x16x32_bf16 a[0:3], a[160:163], v[128:131], a[0:3]
    ds_read_b64_tr_b16 a[172:173], v19 offset:24576
    v_mfma_f32_16x16x32_bf16 a[32:35], a[160:163], v[132:135], a[32:35]
    ds_read_b64_tr_b16 a[174:175], v19 offset:28672
    v_mfma_f32_16x16x32_bf16 a[64:67], a[160:163], v[136:139], a[64:67]
    v_mfma_f32_16x16x32_bf16 a[96:99], a[160:163], v[140:143], a[96:99]
    v_mfma_f32_16x16x32_bf16 v[88:91], a[128:131], v[176:179], v[148:151]
    ds_read_b128 a[152:155], v10 offset:45056
    v_mfma_f32_16x16x32_bf16 v[88:91], a[132:135], v[180:183], v[88:91]
    v_mfma_f32_16x16x32_bf16 v[88:91], a[136:139], v[184:187], v[88:91]
    ds_read_b128 a[156:159], v11 offset:45056
    v_mfma_f32_16x16x32_bf16 v[88:91], a[140:143], v[188:191], v[88:91]
    v_mfma_f32_16x16x32_bf16 a[4:7], a[164:167], v[128:131], a[4:7]
    ds_read_b64_tr_b16 a[176:177], v20 offset:24576
    v_mfma_f32_16x16x32_bf16 a[36:39], a[164:167], v[132:135], a[36:39]
    ds_read_b64_tr_b16 a[178:179], v20 offset:28672
    v_mfma_f32_16x16x32_bf16 a[68:71], a[164:167], v[136:139], a[68:71]
    v_add_f32 v244, v244, v4
    v_add_f32 v245, v245, v5
    v_add_f32 v246, v246, v6
    v_add_f32 v247, v247, v7
    v_exp_f32 v40, v48
    v_exp_f32 v41, v49
    v_exp_f32 v42, v50
    v_exp_f32 v43, v51
    v_add_f32 v248, v40, v41
    v_cvt_pk_bf16_f32 v112, v40, v41
    v_exp_f32 v44, v52
    v_exp_f32 v45, v53
    v_add_f32 v248, v248, v42
    v_add_f32 v248, v248, v43
    v_cvt_pk_bf16_f32 v113, v42, v43
    v_exp_f32 v46, v54
    v_exp_f32 v47, v55
    v_add_f32 v248, v248, v44
    v_add_f32 v248, v248, v45
    v_cvt_pk_bf16_f32 v114, v44, v45
    v_mfma_f32_16x16x32_bf16 a[100:103], a[164:167], v[140:143], a[100:103]
    s_waitcnt lgkmcnt(4)
    v_mfma_f32_16x16x32_bf16 v[96:99], a[128:131], v[192:195], v[152:155]
    v_mfma_f32_16x16x32_bf16 v[96:99], a[132:135], v[196:199], v[96:99]
    s_add_u32 m0, s35, 24576
    v_mfma_f32_16x16x32_bf16 v[96:99], a[136:139], v[200:203], v[96:99]
    buffer_load_dwordx4 v24, s[20:23], s37 offen offset:0 nt lds
    v_mfma_f32_16x16x32_bf16 v[96:99], a[140:143], v[204:207], v[96:99]
    v_mfma_f32_16x16x32_bf16 a[8:11], a[168:171], v[128:131], a[8:11]
    ds_read_b64_tr_b16 a[180:181], v21 offset:24576
    v_mfma_f32_16x16x32_bf16 a[40:43], a[168:171], v[132:135], a[40:43]
    ds_read_b64_tr_b16 a[182:183], v21 offset:28672
    v_mfma_f32_16x16x32_bf16 a[72:75], a[168:171], v[136:139], a[72:75]
    v_mfma_f32_16x16x32_bf16 a[104:107], a[168:171], v[140:143], a[104:107]
    v_mfma_f32_16x16x32_bf16 v[104:107], a[128:131], v[208:211], v[156:159]
    v_mfma_f32_16x16x32_bf16 v[104:107], a[132:135], v[212:215], v[104:107]
    v_mfma_f32_16x16x32_bf16 v[104:107], a[136:139], v[216:219], v[104:107]
    buffer_load_dwordx4 v25, s[20:23], s37 offen offset:1024 nt lds
    s_add_u32 m0, s36, 8192
    v_mfma_f32_16x16x32_bf16 v[104:107], a[140:143], v[220:223], v[104:107]
    s_add_u32 s37, s37, 2048
    v_mfma_f32_16x16x32_bf16 a[12:15], a[172:175], v[128:131], a[12:15]
    ds_read_b64_tr_b16 a[184:185], v22 offset:24576
    v_mfma_f32_16x16x32_bf16 a[44:47], a[172:175], v[132:135], a[44:47]
    ds_read_b64_tr_b16 a[186:187], v22 offset:28672
    v_exp_f32 v40, v56
    v_exp_f32 v41, v57
    v_add_f32 v248, v248, v46
    v_add_f32 v248, v248, v47
    v_cvt_pk_bf16_f32 v115, v46, v47
    v_exp_f32 v42, v58
    v_exp_f32 v43, v59
    v_add_f32 v249, v40, v41
    v_cvt_pk_bf16_f32 v116, v40, v41
    v_exp_f32 v44, v60
    v_exp_f32 v45, v61
    v_add_f32 v249, v249, v42
    v_add_f32 v249, v249, v43
    v_cvt_pk_bf16_f32 v117, v42, v43
    v_exp_f32 v46, v62
    v_exp_f32 v47, v63
    v_add_f32 v249, v249, v44
    v_add_f32 v249, v249, v45
    v_cvt_pk_bf16_f32 v118, v44, v45
    v_exp_f32 v40, v64
    v_mfma_f32_16x16x32_bf16 a[76:79], a[172:175], v[136:139], a[76:79]
    v_mfma_f32_16x16x32_bf16 a[108:111], a[172:175], v[140:143], a[108:111]
    s_waitcnt lgkmcnt(2)
    v_mfma_f32_16x16x32_bf16 v[84:87], a[144:147], v[160:163], v[144:147]
    v_mfma_f32_16x16x32_bf16 v[84:87], a[148:151], v[164:167], v[84:87]
    v_mfma_f32_16x16x32_bf16 v[84:87], a[152:155], v[168:171], v[84:87]
    buffer_load_dwordx4 v26, s[24:27], s41 offen offset:0 nt lds
    v_mfma_f32_16x16x32_bf16 v[84:87], a[156:159], v[172:175], v[84:87]
    v_mfma_f32_16x16x32_bf16 a[16:19], a[176:179], v[128:131], a[16:19]
    ds_read_b64_tr_b16 a[188:189], v23 offset:24576
    v_mfma_f32_16x16x32_bf16 a[48:51], a[176:179], v[132:135], a[48:51]
    ds_read_b64_tr_b16 a[190:191], v23 offset:28672
    v_mfma_f32_16x16x32_bf16 a[80:83], a[176:179], v[136:139], a[80:83]
    v_mfma_f32_16x16x32_bf16 a[112:115], a[176:179], v[140:143], a[112:115]
    v_mfma_f32_16x16x32_bf16 v[92:95], a[144:147], v[176:179], v[148:151]
    v_mfma_f32_16x16x32_bf16 v[92:95], a[148:151], v[180:183], v[92:95]
    v_mfma_f32_16x16x32_bf16 v[92:95], a[152:155], v[184:187], v[92:95]
    buffer_load_dwordx4 v27, s[24:27], s41 offen offset:1024 nt lds
    s_add_u32 s41, s41, 2048
    v_mfma_f32_16x16x32_bf16 v[92:95], a[156:159], v[188:191], v[92:95]
    v_mfma_f32_16x16x32_bf16 a[20:23], a[180:183], v[128:131], a[20:23]
    v_mfma_f32_16x16x32_bf16 a[52:55], a[180:183], v[132:135], a[52:55]
    v_exp_f32 v41, v65
    v_add_f32 v249, v249, v46
    v_add_f32 v249, v249, v47
    v_cvt_pk_bf16_f32 v119, v46, v47
    v_exp_f32 v42, v66
    v_exp_f32 v43, v67
    v_add_f32 v250, v40, v41
    v_cvt_pk_bf16_f32 v120, v40, v41
    v_exp_f32 v44, v68
    v_exp_f32 v45, v69
    v_add_f32 v250, v250, v42
    v_add_f32 v250, v250, v43
    v_cvt_pk_bf16_f32 v121, v42, v43
    v_exp_f32 v46, v70
    v_exp_f32 v47, v71
    v_add_f32 v250, v250, v44
    v_add_f32 v250, v250, v45
    v_cvt_pk_bf16_f32 v122, v44, v45
    v_exp_f32 v40, v72
    v_exp_f32 v41, v73
    v_add_f32 v250, v250, v46
    v_mfma_f32_16x16x32_bf16 a[84:87], a[180:183], v[136:139], a[84:87]
    v_mfma_f32_16x16x32_bf16 a[116:119], a[180:183], v[140:143], a[116:119]
    s_waitcnt lgkmcnt(0)
    v_mfma_f32_16x16x32_bf16 v[100:103], a[144:147], v[192:195], v[152:155]
    ds_read_b128 a[128:131], v8 offset:0
    v_mfma_f32_16x16x32_bf16 v[100:103], a[148:151], v[196:199], v[100:103]
    ds_read_b128 a[132:135], v9 offset:0
    v_mfma_f32_16x16x32_bf16 v[100:103], a[152:155], v[200:203], v[100:103]
    ds_read_b128 a[136:139], v10 offset:0
    v_mfma_f32_16x16x32_bf16 v[100:103], a[156:159], v[204:207], v[100:103]
    ds_read_b128 a[140:143], v11 offset:0
    v_mfma_f32_16x16x32_bf16 a[24:27], a[184:187], v[128:131], a[24:27]
    ds_read_b64_tr_b16 a[160:161], v16 offset:32768
    v_mfma_f32_16x16x32_bf16 a[56:59], a[184:187], v[132:135], a[56:59]
    ds_read_b64_tr_b16 a[162:163], v16 offset:36864
    v_mfma_f32_16x16x32_bf16 a[88:91], a[184:187], v[136:139], a[88:91]
    v_mfma_f32_16x16x32_bf16 a[120:123], a[184:187], v[140:143], a[120:123]
    v_mfma_f32_16x16x32_bf16 v[108:111], a[144:147], v[208:211], v[156:159]
    ds_read_b64_tr_b16 a[164:165], v17 offset:32768
    v_mfma_f32_16x16x32_bf16 v[108:111], a[148:151], v[212:215], v[108:111]
    ds_read_b64_tr_b16 a[166:167], v17 offset:36864
    v_mfma_f32_16x16x32_bf16 v[108:111], a[152:155], v[216:219], v[108:111]
    v_mfma_f32_16x16x32_bf16 v[108:111], a[156:159], v[220:223], v[108:111]
    v_mfma_f32_16x16x32_bf16 a[28:31], a[188:191], v[128:131], a[28:31]
    ds_read_b64_tr_b16 a[168:169], v18 offset:32768
    v_mfma_f32_16x16x32_bf16 a[60:63], a[188:191], v[132:135], a[60:63]
    ds_read_b64_tr_b16 a[170:171], v18 offset:36864
    v_add_f32 v250, v250, v47
    v_cvt_pk_bf16_f32 v123, v46, v47
    v_exp_f32 v42, v74
    v_exp_f32 v43, v75
    v_add_f32 v251, v40, v41
    v_cvt_pk_bf16_f32 v124, v40, v41
    v_exp_f32 v44, v76
    v_exp_f32 v45, v77
    v_add_f32 v251, v251, v42
    v_add_f32 v251, v251, v43
    v_cvt_pk_bf16_f32 v125, v42, v43
    v_exp_f32 v46, v78
    v_exp_f32 v47, v79
    v_add_f32 v251, v251, v44
    v_add_f32 v251, v251, v45
    v_cvt_pk_bf16_f32 v126, v44, v45
    v_add_f32 v251, v251, v46
    v_add_f32 v251, v251, v47
    v_cvt_pk_bf16_f32 v127, v46, v47
    v_max3_f32 v35, v248, v249, v250
    v_max_f32 v35, v35, v251
    v_cmp_lt_f32 vcc, s40, v35
    v_mfma_f32_16x16x32_bf16 a[92:95], a[188:191], v[136:139], a[92:95]
    v_mfma_f32_16x16x32_bf16 a[124:127], a[188:191], v[140:143], a[124:127]
    s_cbranch_vccnz L_rare_h0q4
L_ret_h0q4:
    s_waitcnt lgkmcnt(2)
    v_mfma_f32_16x16x32_bf16 v[48:51], a[128:131], v[160:163], v[144:147]
    ds_read_b128 a[144:147], v8 offset:4096
    v_mfma_f32_16x16x32_bf16 v[48:51], a[132:135], v[164:167], v[48:51]
    v_mfma_f32_16x16x32_bf16 v[48:51], a[136:139], v[168:171], v[48:51]
    ds_read_b128 a[148:151], v9 offset:4096
    v_mfma_f32_16x16x32_bf16 v[48:51], a[140:143], v[172:175], v[48:51]
    v_mfma_f32_16x16x32_bf16 a[0:3], a[160:163], v[112:115], a[0:3]
    ds_read_b64_tr_b16 a[172:173], v19 offset:32768
    v_mfma_f32_16x16x32_bf16 a[32:35], a[160:163], v[116:119], a[32:35]
    ds_read_b64_tr_b16 a[174:175], v19 offset:36864
    v_mfma_f32_16x16x32_bf16 a[64:67], a[160:163], v[120:123], a[64:67]
    v_mfma_f32_16x16x32_bf16 a[96:99], a[160:163], v[124:127], a[96:99]
    v_mfma_f32_16x16x32_bf16 v[56:59], a[128:131], v[176:179], v[148:151]
    ds_read_b128 a[152:155], v10 offset:4096
    v_mfma_f32_16x16x32_bf16 v[56:59], a[132:135], v[180:183], v[56:59]
    v_mfma_f32_16x16x32_bf16 v[56:59], a[136:139], v[184:187], v[56:59]
    ds_read_b128 a[156:159], v11 offset:4096
    v_mfma_f32_16x16x32_bf16 v[56:59], a[140:143], v[188:191], v[56:59]
    v_mfma_f32_16x16x32_bf16 a[4:7], a[164:167], v[112:115], a[4:7]
    ds_read_b64_tr_b16 a[176:177], v20 offset:32768
    v_mfma_f32_16x16x32_bf16 a[36:39], a[164:167], v[116:119], a[36:39]
    ds_read_b64_tr_b16 a[178:179], v20 offset:36864
    v_mfma_f32_16x16x32_bf16 a[68:71], a[164:167], v[120:123], a[68:71]
    v_add_f32 v244, v244, v248
    v_add_f32 v245, v245, v249
    v_add_f32 v246, v246, v250
    v_add_f32 v247, v247, v251
    v_exp_f32 v40, v80
    v_exp_f32 v41, v81
    v_exp_f32 v42, v82
    v_exp_f32 v43, v83
    v_add_f32 v4, v40, v41
    v_cvt_pk_bf16_f32 v128, v40, v41
    v_exp_f32 v44, v84
    v_exp_f32 v45, v85
    v_add_f32 v4, v4, v42
    v_add_f32 v4, v4, v43
    v_cvt_pk_bf16_f32 v129, v42, v43
    v_exp_f32 v46, v86
    v_exp_f32 v47, v87
    v_add_f32 v4, v4, v44
    v_add_f32 v4, v4, v45
    v_cvt_pk_bf16_f32 v130, v44, v45
    v_mfma_f32_16x16x32_bf16 a[100:103], a[164:167], v[124:127], a[100:103]
    s_waitcnt lgkmcnt(4)
    v_mfma_f32_16x16x32_bf16 v[64:67], a[128:131], v[192:195], v[152:155]
    v_mfma_f32_16x16x32_bf16 v[64:67], a[132:135], v[196:199], v[64:67]
    s_add_u32 m0, s35, 32768
    v_mfma_f32_16x16x32_bf16 v[64:67], a[136:139], v[200:203], v[64:67]
    buffer_load_dwordx4 v24, s[20:23], s37 offen offset:0 nt lds
    v_mfma_f32_16x16x32_bf16 v[64:67], a[140:143], v[204:207], v[64:67]
    v_mfma_f32_16x16x32_bf16 a[8:11], a[168:171], v[112:115], a[8:11]
    ds_read_b64_tr_b16 a[180:181], v21 offset:32768
    v_mfma_f32_16x16x32_bf16 a[40:43], a[168:171], v[116:119], a[40:43]
    ds_read_b64_tr_b16 a[182:183], v21 offset:36864
    v_mfma_f32_16x16x32_bf16 a[72:75], a[168:171], v[120:123], a[72:75]
    v_mfma_f32_16x16x32_bf16 a[104:107], a[168:171], v[124:127], a[104:107]
    v_mfma_f32_16x16x32_bf16 v[72:75], a[128:131], v[208:211], v[156:159]
    v_mfma_f32_16x16x32_bf16 v[72:75], a[132:135], v[212:215], v[72:75]
    v_mfma_f32_16x16x32_bf16 v[72:75], a[136:139], v[216:219], v[72:75]
    buffer_load_dwordx4 v25, s[20:23], s37 offen offset:1024 nt lds
    s_add_u32 m0, s36, 16384
    v_mfma_f32_16x16x32_bf16 v[72:75], a[140:143], v[220:223], v[72:75]
    s_add_u32 s37, s37, 2048
    v_mfma_f32_16x16x32_bf16 a[12:15], a[172:175], v[112:115], a[12:15]
    ds_read_b64_tr_b16 a[184:185], v22 offset:32768
    v_mfma_f32_16x16x32_bf16 a[44:47], a[172:175], v[116:119], a[44:47]
    ds_read_b64_tr_b16 a[186:187], v22 offset:36864
    v_exp_f32 v40, v88
    v_exp_f32 v41, v89
    v_add_f32 v4, v4, v46
    v_add_f32 v4, v4, v47
    v_cvt_pk_bf16_f32 v131, v46, v47
    v_exp_f32 v42, v90
    v_exp_f32 v43, v91
    v_add_f32 v5, v40, v41
    v_cvt_pk_bf16_f32 v132, v40, v41
    v_exp_f32 v44, v92
    v_exp_f32 v45, v93
    v_add_f32 v5, v5, v42
    v_add_f32 v5, v5, v43
    v_cvt_pk_bf16_f32 v133, v42, v43
    v_exp_f32 v46, v94
    v_exp_f32 v47, v95
    v_add_f32 v5, v5, v44
    v_add_f32 v5, v5, v45
    v_cvt_pk_bf16_f32 v134, v44, v45
    v_exp_f32 v40, v96
    v_mfma_f32_16x16x32_bf16 a[76:79], a[172:175], v[120:123], a[76:79]
    v_mfma_f32_16x16x32_bf16 a[108:111], a[172:175], v[124:127], a[108:111]
    s_waitcnt lgkmcnt(2)
    v_mfma_f32_16x16x32_bf16 v[52:55], a[144:147], v[160:163], v[144:147]
    v_mfma_f32_16x16x32_bf16 v[52:55], a[148:151], v[164:167], v[52:55]
    v_mfma_f32_16x16x32_bf16 v[52:55], a[152:155], v[168:171], v[52:55]
    buffer_load_dwordx4 v26, s[24:27], s41 offen offset:0 nt lds
    v_mfma_f32_16x16x32_bf16 v[52:55], a[156:159], v[172:175], v[52:55]
    v_mfma_f32_16x16x32_bf16 a[16:19], a[176:179], v[112:115], a[16:19]
    ds_read_b64_tr_b16 a[188:189], v23 offset:32768
    v_mfma_f32_16x16x32_bf16 a[48:51], a[176:179], v[116:119], a[48:51]
    ds_read_b64_tr_b16 a[190:191], v23 offset:36864
    v_mfma_f32_16x16x32_bf16 a[80:83], a[176:179], v[120:123], a[80:83]
    v_mfma_f32_16x16x32_bf16 a[112:115], a[176:179], v[124:127], a[112:115]
    v_mfma_f32_16x16x32_bf16 v[60:63], a[144:147], v[176:179], v[148:151]
    v_mfma_f32_16x16x32_bf16 v[60:63], a[148:151], v[180:183], v[60:63]
    v_mfma_f32_16x16x32_bf16 v[60:63], a[152:155], v[184:187], v[60:63]
    buffer_load_dwordx4 v27, s[24:27], s41 offen offset:1024 nt lds
    s_add_u32 s41, s41, 2048
    v_mfma_f32_16x16x32_bf16 v[60:63], a[156:159], v[188:191], v[60:63]
    v_mfma_f32_16x16x32_bf16 a[20:23], a[180:183], v[112:115], a[20:23]
    v_mfma_f32_16x16x32_bf16 a[52:55], a[180:183], v[116:119], a[52:55]
    v_exp_f32 v41, v97
    v_add_f32 v5, v5, v46
    v_add_f32 v5, v5, v47
    v_cvt_pk_bf16_f32 v135, v46, v47
    v_exp_f32 v42, v98
    v_exp_f32 v43, v99
    v_add_f32 v6, v40, v41
    v_cvt_pk_bf16_f32 v136, v40, v41
    v_exp_f32 v44, v100
    v_exp_f32 v45, v101
    v_add_f32 v6, v6, v42
    v_add_f32 v6, v6, v43
    v_cvt_pk_bf16_f32 v137, v42, v43
    v_exp_f32 v46, v102
    v_exp_f32 v47, v103
    v_add_f32 v6, v6, v44
    v_add_f32 v6, v6, v45
    v_cvt_pk_bf16_f32 v138, v44, v45
    v_exp_f32 v40, v104
    v_exp_f32 v41, v105
    v_add_f32 v6, v6, v46
    v_mfma_f32_16x16x32_bf16 a[84:87], a[180:183], v[120:123], a[84:87]
    v_mfma_f32_16x16x32_bf16 a[116:119], a[180:183], v[124:127], a[116:119]
    s_waitcnt vmcnt(8) lgkmcnt(0)
    s_barrier
    v_mfma_f32_16x16x32_bf16 v[68:71], a[144:147], v[192:195], v[152:155]
    ds_read_b128 a[128:131], v8 offset:8192
    v_mfma_f32_16x16x32_bf16 v[68:71], a[148:151], v[196:199], v[68:71]
    ds_read_b128 a[132:135], v9 offset:8192
    v_mfma_f32_16x16x32_bf16 v[68:71], a[152:155], v[200:203], v[68:71]
    ds_read_b128 a[136:139], v10 offset:8192
    v_mfma_f32_16x16x32_bf16 v[68:71], a[156:159], v[204:207], v[68:71]
    ds_read_b128 a[140:143], v11 offset:8192
    v_mfma_f32_16x16x32_bf16 a[24:27], a[184:187], v[112:115], a[24:27]
    ds_read_b64_tr_b16 a[160:161], v16 offset:40960
    v_mfma_f32_16x16x32_bf16 a[56:59], a[184:187], v[116:119], a[56:59]
    ds_read_b64_tr_b16 a[162:163], v16 offset:45056
    v_mfma_f32_16x16x32_bf16 a[88:91], a[184:187], v[120:123], a[88:91]
    v_mfma_f32_16x16x32_bf16 a[120:123], a[184:187], v[124:127], a[120:123]
    v_mfma_f32_16x16x32_bf16 v[76:79], a[144:147], v[208:211], v[156:159]
    ds_read_b64_tr_b16 a[164:165], v17 offset:40960
    v_mfma_f32_16x16x32_bf16 v[76:79], a[148:151], v[212:215], v[76:79]
    ds_read_b64_tr_b16 a[166:167], v17 offset:45056
    v_mfma_f32_16x16x32_bf16 v[76:79], a[152:155], v[216:219], v[76:79]
    v_mfma_f32_16x16x32_bf16 v[76:79], a[156:159], v[220:223], v[76:79]
    v_mfma_f32_16x16x32_bf16 a[28:31], a[188:191], v[112:115], a[28:31]
    ds_read_b64_tr_b16 a[168:169], v18 offset:40960
    v_mfma_f32_16x16x32_bf16 a[60:63], a[188:191], v[116:119], a[60:63]
    ds_read_b64_tr_b16 a[170:171], v18 offset:45056
    v_add_f32 v6, v6, v47
    v_cvt_pk_bf16_f32 v139, v46, v47
    v_exp_f32 v42, v106
    v_exp_f32 v43, v107
    v_add_f32 v7, v40, v41
    v_cvt_pk_bf16_f32 v140, v40, v41
    v_exp_f32 v44, v108
    v_exp_f32 v45, v109
    v_add_f32 v7, v7, v42
    v_add_f32 v7, v7, v43
    v_cvt_pk_bf16_f32 v141, v42, v43
    v_exp_f32 v46, v110
    v_exp_f32 v47, v111
    v_add_f32 v7, v7, v44
    v_add_f32 v7, v7, v45
    v_cvt_pk_bf16_f32 v142, v44, v45
    v_add_f32 v7, v7, v46
    v_add_f32 v7, v7, v47
    v_cvt_pk_bf16_f32 v143, v46, v47
    v_max3_f32 v35, v4, v5, v6
    v_max_f32 v35, v35, v7
    v_cmp_lt_f32 vcc, s40, v35
    v_mfma_f32_16x16x32_bf16 a[92:95], a[188:191], v[120:123], a[92:95]
    v_mfma_f32_16x16x32_bf16 a[124:127], a[188:191], v[124:127], a[124:127]
    s_cbranch_vccnz L_rare_h0q5
L_ret_h0q5:
    s_waitcnt lgkmcnt(2)
    v_mfma_f32_16x16x32_bf16 v[80:83], a[128:131], v[160:163], v[144:147]
    ds_read_b128 a[144:147], v8 offset:12288
    v_mfma_f32_16x16x32_bf16 v[80:83], a[132:135], v[164:167], v[80:83]
    v_mfma_f32_16x16x32_bf16 v[80:83], a[136:139], v[168:171], v[80:83]
    ds_read_b128 a[148:151], v9 offset:12288
    v_mfma_f32_16x16x32_bf16 v[80:83], a[140:143], v[172:175], v[80:83]
    v_mfma_f32_16x16x32_bf16 a[0:3], a[160:163], v[128:131], a[0:3]
    ds_read_b64_tr_b16 a[172:173], v19 offset:40960
    v_mfma_f32_16x16x32_bf16 a[32:35], a[160:163], v[132:135], a[32:35]
    ds_read_b64_tr_b16 a[174:175], v19 offset:45056
    v_mfma_f32_16x16x32_bf16 a[64:67], a[160:163], v[136:139], a[64:67]
    v_mfma_f32_16x16x32_bf16 a[96:99], a[160:163], v[140:143], a[96:99]
    v_mfma_f32_16x16x32_bf16 v[88:91], a[128:131], v[176:179], v[148:151]
    ds_read_b128 a[152:155], v10 offset:12288
    v_mfma_f32_16x16x32_bf16 v[88:91], a[132:135], v[180:183], v[88:91]
    v_mfma_f32_16x16x32_bf16 v[88:91], a[136:139], v[184:187], v[88:91]
    ds_read_b128 a[156:159], v11 offset:12288
    v_mfma_f32_16x16x32_bf16 v[88:91], a[140:143], v[188:191], v[88:91]
    v_mfma_f32_16x16x32_bf16 a[4:7], a[164:167], v[128:131], a[4:7]
    ds_read_b64_tr_b16 a[176:177], v20 offset:40960
    v_mfma_f32_16x16x32_bf16 a[36:39], a[164:167], v[132:135], a[36:39]
    ds_read_b64_tr_b16 a[178:179], v20 offset:45056
    v_mfma_f32_16x16x32_bf16 a[68:71], a[164:167], v[136:139], a[68:71]
    v_add_f32 v244, v244, v4
    v_add_f32 v245, v245, v5
    v_add_f32 v246, v246, v6
    v_add_f32 v247, v247, v7
    v_exp_f32 v40, v48
    v_exp_f32 v41, v49
    v_exp_f32 v42, v50
    v_exp_f32 v43, v51
    v_add_f32 v248, v40, v41
    v_cvt_pk_bf16_f32 v112, v40, v41
    v_exp_f32 v44, v52
    v_exp_f32 v45, v53
    v_add_f32 v248, v248, v42
    v_add_f32 v248, v248, v43
    v_cvt_pk_bf16_f32 v113, v42, v43
    v_exp_f32 v46, v54
    v_exp_f32 v47, v55
    v_add_f32 v248, v248, v44
    v_add_f32 v248, v248, v45
    v_cvt_pk_bf16_f32 v114, v44, v45
    v_mfma_f32_16x16x32_bf16 a[100:103], a[164:167], v[140:143], a[100:103]
    s_waitcnt lgkmcnt(4)
    v_mfma_f32_16x16x32_bf16 v[96:99], a[128:131], v[192:195], v[152:155]
    v_mfma_f32_16x16x32_bf16 v[96:99], a[132:135], v[196:199], v[96:99]
    s_add_u32 m0, s35, 40960
    v_mfma_f32_16x16x32_bf16 v[96:99], a[136:139], v[200:203], v[96:99]
    buffer_load_dwordx4 v24, s[20:23], s37 offen offset:0 nt lds
    v_mfma_f32_16x16x32_bf16 v[96:99], a[140:143], v[204:207], v[96:99]
    v_mfma_f32_16x16x32_bf16 a[8:11], a[168:171], v[128:131], a[8:11]
    ds_read_b64_tr_b16 a[180:181], v21 offset:40960
    v_mfma_f32_16x16x32_bf16 a[40:43], a[168:171], v[132:135], a[40:43]
    ds_read_b64_tr_b16 a[182:183], v21 offset:45056
    v_mfma_f32_16x16x32_bf16 a[72:75], a[168:171], v[136:139], a[72:75]
    v_mfma_f32_16x16x32_bf16 a[104:107], a[168:171], v[140:143], a[104:107]
    v_mfma_f32_16x16x32_bf16 v[104:107], a[128:131], v[208:211], v[156:159]
    v_mfma_f32_16x16x32_bf16 v[104:107], a[132:135], v[212:215], v[104:107]
    v_mfma_f32_16x16x32_bf16 v[104:107], a[136:139], v[216:219], v[104:107]
    buffer_load_dwordx4 v25, s[20:23], s37 offen offset:1024 nt lds
    s_add_u32 m0, s36, 24576
    v_mfma_f32_16x16x32_bf16 v[104:107], a[140:143], v[220:223], v[104:107]
    s_add_u32 s37, s37, 2048
    v_mfma_f32_16x16x32_bf16 a[12:15], a[172:175], v[128:131], a[12:15]
    ds_read_b64_tr_b16 a[184:185], v22 offset:40960
    v_mfma_f32_16x16x32_bf16 a[44:47], a[172:175], v[132:135], a[44:47]
    ds_read_b64_tr_b16 a[186:187], v22 offset:45056
    v_exp_f32 v40, v56
    v_exp_f32 v41, v57
    v_add_f32 v248, v248, v46
    v_add_f32 v248, v248, v47
    v_cvt_pk_bf16_f32 v115, v46, v47
    v_exp_f32 v42, v58
    v_exp_f32 v43, v59
    v_add_f32 v249, v40, v41
    v_cvt_pk_bf16_f32 v116, v40, v41
    v_exp_f32 v44, v60
    v_exp_f32 v45, v61
    v_add_f32 v249, v249, v42
    v_add_f32 v249, v249, v43
    v_cvt_pk_bf16_f32 v117, v42, v43
    v_exp_f32 v46, v62
    v_exp_f32 v47, v63
    v_add_f32 v249, v249, v44
    v_add_f32 v249, v249, v45
    v_cvt_pk_bf16_f32 v118, v44, v45
    v_exp_f32 v40, v64
    v_mfma_f32_16x16x32_bf16 a[76:79], a[172:175], v[136:139], a[76:79]
    v_mfma_f32_16x16x32_bf16 a[108:111], a[172:175], v[140:143], a[108:111]
    s_waitcnt lgkmcnt(2)
    v_mfma_f32_16x16x32_bf16 v[84:87], a[144:147], v[160:163], v[144:147]
    v_mfma_f32_16x16x32_bf16 v[84:87], a[148:151], v[164:167], v[84:87]
    v_mfma_f32_16x16x32_bf16 v[84:87], a[152:155], v[168:171], v[84:87]
    buffer_load_dwordx4 v26, s[24:27], s41 offen offset:0 nt lds
    v_mfma_f32_16x16x32_bf16 v[84:87], a[156:159], v[172:175], v[84:87]
    v_mfma_f32_16x16x32_bf16 a[16:19], a[176:179], v[128:131], a[16:19]
    ds_read_b64_tr_b16 a[188:189], v23 offset:40960
    v_mfma_f32_16x16x32_bf16 a[48:51], a[176:179], v[132:135], a[48:51]
    ds_read_b64_tr_b16 a[190:191], v23 offset:45056
    v_mfma_f32_16x16x32_bf16 a[80:83], a[176:179], v[136:139], a[80:83]
    v_mfma_f32_16x16x32_bf16 a[112:115], a[176:179], v[140:143], a[112:115]
    v_mfma_f32_16x16x32_bf16 v[92:95], a[144:147], v[176:179], v[148:151]
    v_mfma_f32_16x16x32_bf16 v[92:95], a[148:151], v[180:183], v[92:95]
    v_mfma_f32_16x16x32_bf16 v[92:95], a[152:155], v[184:187], v[92:95]
    buffer_load_dwordx4 v27, s[24:27], s41 offen offset:1024 nt lds
    s_add_u32 s41, s41, 2048
    v_mfma_f32_16x16x32_bf16 v[92:95], a[156:159], v[188:191], v[92:95]
    v_mfma_f32_16x16x32_bf16 a[20:23], a[180:183], v[128:131], a[20:23]
    v_mfma_f32_16x16x32_bf16 a[52:55], a[180:183], v[132:135], a[52:55]
    v_exp_f32 v41, v65
    v_add_f32 v249, v249, v46
    v_add_f32 v249, v249, v47
    v_cvt_pk_bf16_f32 v119, v46, v47
    v_exp_f32 v42, v66
    v_exp_f32 v43, v67
    v_add_f32 v250, v40, v41
    v_cvt_pk_bf16_f32 v120, v40, v41
    v_exp_f32 v44, v68
    v_exp_f32 v45, v69
    v_add_f32 v250, v250, v42
    v_add_f32 v250, v250, v43
    v_cvt_pk_bf16_f32 v121, v42, v43
    v_exp_f32 v46, v70
    v_exp_f32 v47, v71
    v_add_f32 v250, v250, v44
    v_add_f32 v250, v250, v45
    v_cvt_pk_bf16_f32 v122, v44, v45
    v_exp_f32 v40, v72
    v_exp_f32 v41, v73
    v_add_f32 v250, v250, v46
    v_mfma_f32_16x16x32_bf16 a[84:87], a[180:183], v[136:139], a[84:87]
    v_mfma_f32_16x16x32_bf16 a[116:119], a[180:183], v[140:143], a[116:119]
    s_waitcnt lgkmcnt(0)
    v_mfma_f32_16x16x32_bf16 v[100:103], a[144:147], v[192:195], v[152:155]
    ds_read_b128 a[128:131], v8 offset:16384
    v_mfma_f32_16x16x32_bf16 v[100:103], a[148:151], v[196:199], v[100:103]
    ds_read_b128 a[132:135], v9 offset:16384
    v_mfma_f32_16x16x32_bf16 v[100:103], a[152:155], v[200:203], v[100:103]
    ds_read_b128 a[136:139], v10 offset:16384
    v_mfma_f32_16x16x32_bf16 v[100:103], a[156:159], v[204:207], v[100:103]
    ds_read_b128 a[140:143], v11 offset:16384
    v_mfma_f32_16x16x32_bf16 a[24:27], a[184:187], v[128:131], a[24:27]
    ds_read_b64_tr_b16 a[160:161], v16 offset:0
    v_mfma_f32_16x16x32_bf16 a[56:59], a[184:187], v[132:135], a[56:59]
    ds_read_b64_tr_b16 a[162:163], v16 offset:4096
    v_mfma_f32_16x16x32_bf16 a[88:91], a[184:187], v[136:139], a[88:91]
    v_mfma_f32_16x16x32_bf16 a[120:123], a[184:187], v[140:143], a[120:123]
    v_mfma_f32_16x16x32_bf16 v[108:111], a[144:147], v[208:211], v[156:159]
    ds_read_b64_tr_b16 a[164:165], v17 offset:0
    v_mfma_f32_16x16x32_bf16 v[108:111], a[148:151], v[212:215], v[108:111]
    ds_read_b64_tr_b16 a[166:167], v17 offset:4096
    v_mfma_f32_16x16x32_bf16 v[108:111], a[152:155], v[216:219], v[108:111]
    v_mfma_f32_16x16x32_bf16 v[108:111], a[156:159], v[220:223], v[108:111]
    v_mfma_f32_16x16x32_bf16 a[28:31], a[188:191], v[128:131], a[28:31]
    ds_read_b64_tr_b16 a[168:169], v18 offset:0
    v_mfma_f32_16x16x32_bf16 a[60:63], a[188:191], v[132:135], a[60:63]
    ds_read_b64_tr_b16 a[170:171], v18 offset:4096
    v_add_f32 v250, v250, v47
    v_cvt_pk_bf16_f32 v123, v46, v47
    v_exp_f32 v42, v74
    v_exp_f32 v43, v75
    v_add_f32 v251, v40, v41
    v_cvt_pk_bf16_f32 v124, v40, v41
    v_exp_f32 v44, v76
    v_exp_f32 v45, v77
    v_add_f32 v251, v251, v42
    v_add_f32 v251, v251, v43
    v_cvt_pk_bf16_f32 v125, v42, v43
    v_exp_f32 v46, v78
    v_exp_f32 v47, v79
    v_add_f32 v251, v251, v44
    v_add_f32 v251, v251, v45
    v_cvt_pk_bf16_f32 v126, v44, v45
    v_add_f32 v251, v251, v46
    v_add_f32 v251, v251, v47
    v_cvt_pk_bf16_f32 v127, v46, v47
    v_max3_f32 v35, v248, v249, v250
    v_max_f32 v35, v35, v251
    v_cmp_lt_f32 vcc, s40, v35
    v_mfma_f32_16x16x32_bf16 a[92:95], a[188:191], v[136:139], a[92:95]
    v_mfma_f32_16x16x32_bf16 a[124:127], a[188:191], v[140:143], a[124:127]
    s_cbranch_vccnz L_rare_h0q6
L_ret_h0q6:
    s_waitcnt lgkmcnt(2)
    s_mov_b32 s39, 4
    s_add_u32 s43, s42, 65536
    s_mov_b32 s44, s42
L_loops0:
    v_mfma_f32_16x16x32_bf16 v[48:51], a[128:131], v[160:163], v[144:147]
    ds_read_b128 a[144:147], v8 offset:20480
    v_add_f32 v244, v244, v248
    v_add_f32 v245, v245, v249
    v_mfma_f32_16x16x32_bf16 v[48:51], a[132:135], v[164:167], v[48:51]
    v_mfma_f32_16x16x32_bf16 v[48:51], a[136:139], v[168:171], v[48:51]
    ds_read_b128 a[148:151], v9 offset:20480
    v_add_f32 v246, v246, v250
    v_add_f32 v247, v247, v251
    v_mfma_f32_16x16x32_bf16 v[48:51], a[140:143], v[172:175], v[48:51]
    v_exp_f32 v40, v80
    v_exp_f32 v41, v81
    v_mfma_f32_16x16x32_bf16 a[0:3], a[160:163], v[112:115], a[0:3]
    ds_read_b64_tr_b16 a[172:173], v19 offset:0
    v_exp_f32 v42, v82
    v_mfma_f32_16x16x32_bf16 a[32:35], a[160:163], v[116:119], a[32:35]
    ds_read_b64_tr_b16 a[174:175], v19 offset:4096
    v_exp_f32 v43, v83
    v_mfma_f32_16x16x32_bf16 a[64:67], a[160:163], v[120:123], a[64:67]
    v_mfma_f32_16x16x32_bf16 a[96:99], a[160:163], v[124:127], a[96:99]
    v_mfma_f32_16x16x32_bf16 v[56:59], a[128:131], v[176:179], v[148:151]
    ds_read_b128 a[152:155], v10 offset:20480
    v_add_f32 v4, v40, v41
    v_cvt_pk_bf16_f32 v128, v40, v41
    v_mfma_f32_16x16x32_bf16 v[56:59], a[132:135], v[180:183], v[56:59]
    v_exp_f32 v44, v84
    v_exp_f32 v45, v85
    v_mfma_f32_16x16x32_bf16 v[56:59], a[136:139], v[184:187], v[56:59]
    ds_read_b128 a[156:159], v11 offset:20480
    v_add_f32 v4, v4, v42
    v_add_f32 v4, v4, v43
    v_mfma_f32_16x16x32_bf16 v[56:59], a[140:143], v[188:191], v[56:59]
    v_mfma_f32_16x16x32_bf16 a[4:7], a[164:167], v[112:115], a[4:7]
    ds_read_b64_tr_b16 a[176:177], v20 offset:0
    v_cvt_pk_bf16_f32 v129, v42, v43
    v_exp_f32 v46, v86
    v_mfma_f32_16x16x32_bf16 a[36:39], a[164:167], v[116:119], a[36:39]
    ds_read_b64_tr_b16 a[178:179], v20 offset:4096
    v_exp_f32 v47, v87
    v_mfma_f32_16x16x32_bf16 a[68:71], a[164:167], v[120:123], a[68:71]
    v_mfma_f32_16x16x32_bf16 a[100:103], a[164:167], v[124:127], a[100:103]
    v_add_f32 v4, v4, v44
    v_add_f32 v4, v4, v45
    s_waitcnt lgkmcnt(4)
    v_mfma_f32_16x16x32_bf16 v[64:67], a[128:131], v[192:195], v[152:155]
    v_cvt_pk_bf16_f32 v130, v44, v45
    v_exp_f32 v40, v88
    v_mfma_f32_16x16x32_bf16 v[64:67], a[132:135], v[196:199], v[64:67]
    v_exp_f32 v41, v89
    s_add_u32 m0, s35, 0
    v_mfma_f32_16x16x32_bf16 v[64:67], a[136:139], v[200:203], v[64:67]
    buffer_load_dwordx4 v24, s[20:23], s37 offen offset:0 nt lds
    v_add_f32 v4, v4, v46
    v_add_f32 v4, v4, v47
    v_mfma_f32_16x16x32_bf16 v[64:67], a[140:143], v[204:207], v[64:67]
    v_mfma_f32_16x16x32_bf16 a[8:11], a[168:171], v[112:115], a[8:11]
    ds_read_b64_tr_b16 a[180:181], v21 offset:0
    v_cvt_pk_bf16_f32 v131, v46, v47
    v_exp_f32 v42, v90
    v_mfma_f32_16x16x32_bf16 a[40:43], a[168:171], v[116:119], a[40:43]
    ds_read_b64_tr_b16 a[182:183], v21 offset:4096
    v_exp_f32 v43, v91
    v_mfma_f32_16x16x32_bf16 a[72:75], a[168:171], v[120:123], a[72:75]
    v_mfma_f32_16x16x32_bf16 a[104:107], a[168:171], v[124:127], a[104:107]
    v_add_f32 v5, v40, v41
    v_cvt_pk_bf16_f32 v132, v40, v41
    v_exp_f32 v44, v92
    v_mfma_f32_16x16x32_bf16 v[72:75], a[128:131], v[208:211], v[156:159]
    v_mfma_f32_16x16x32_bf16 v[72:75], a[132:135], v[212:215], v[72:75]
    v_mfma_f32_16x16x32_bf16 v[72:75], a[136:139], v[216:219], v[72:75]
    buffer_load_dwordx4 v25, s[20:23], s37 offen offset:1024 nt lds
    v_exp_f32 v45, v93
    s_add_u32 m0, s36, 32768
    v_mfma_f32_16x16x32_bf16 v[72:75], a[140:143], v[220:223], v[72:75]
    v_add_f32 v5, v5, v42
    v_add_f32 v5, v5, v43
    s_add_u32 s37, s37, 2048
    v_mfma_f32_16x16x32_bf16 a[12:15], a[172:175], v[112:115], a[12:15]
    ds_read_b64_tr_b16 a[184:185], v22 offset:0
    v_cvt_pk_bf16_f32 v133, v42, v43
    v_exp_f32 v46, v94
    v_mfma_f32_16x16x32_bf16 a[44:47], a[172:175], v[116:119], a[44:47]
    ds_read_b64_tr_b16 a[186:187], v22 offset:4096
    v_exp_f32 v47, v95
    v_mfma_f32_16x16x32_bf16 a[76:79], a[172:175], v[120:123], a[76:79]
    v_add_f32 v5, v5, v44
    v_add_f32 v5, v5, v45
    v_cvt_pk_bf16_f32 v134, v44, v45
    v_mfma_f32_16x16x32_bf16 a[108:111], a[172:175], v[124:127], a[108:111]
    v_exp_f32 v40, v96
    s_waitcnt lgkmcnt(2)
    v_mfma_f32_16x16x32_bf16 v[52:55], a[144:147], v[160:163], v[144:147]
    v_mfma_f32_16x16x32_bf16 v[52:55], a[148:151], v[164:167], v[52:55]
    v_mfma_f32_16x16x32_bf16 v[52:55], a[152:155], v[168:171], v[52:55]
    buffer_load_dwordx4 v26, s[24:27], s41 offen offset:0 nt lds
    v_exp_f32 v41, v97
    v_add_f32 v5, v5, v46
    v_mfma_f32_16x16x32_bf16 v[52:55], a[156:159], v[172:175], v[52:55]
    v_add_f32 v5, v5, v47
    v_cvt_pk_bf16_f32 v135, v46, v47
    v_exp_f32 v42, v98
    v_mfma_f32_16x16x32_bf16 a[16:19], a[176:179], v[112:115], a[16:19]
    ds_read_b64_tr_b16 a[188:189], v23 offset:0
    v_exp_f32 v43, v99
    v_add_f32 v6, v40, v41
    v_mfma_f32_16x16x32_bf16 a[48:51], a[176:179], v[116:119], a[48:51]
    ds_read_b64_tr_b16 a[190:191], v23 offset:4096
    v_cvt_pk_bf16_f32 v136, v40, v41
    v_exp_f32 v44, v100
    v_mfma_f32_16x16x32_bf16 a[80:83], a[176:179], v[120:123], a[80:83]
    v_mfma_f32_16x16x32_bf16 a[112:115], a[176:179], v[124:127], a[112:115]
    v_mfma_f32_16x16x32_bf16 v[60:63], a[144:147], v[176:179], v[148:151]
    v_exp_f32 v45, v101
    v_add_f32 v6, v6, v42
    v_mfma_f32_16x16x32_bf16 v[60:63], a[148:151], v[180:183], v[60:63]
    v_mfma_f32_16x16x32_bf16 v[60:63], a[152:155], v[184:187], v[60:63]
    buffer_load_dwordx4 v27, s[24:27], s41 offen offset:1024 nt lds
    v_add_f32 v6, v6, v43
    v_cvt_pk_bf16_f32 v137, v42, v43
    s_add_u32 s41, s41, 2048
    v_mfma_f32_16x16x32_bf16 v[60:63], a[156:159], v[188:191], v[60:63]
    v_mfma_f32_16x16x32_bf16 a[20:23], a[180:183], v[112:115], a[20:23]
    v_exp_f32 v46, v102
    v_exp_f32 v47, v103
    v_mfma_f32_16x16x32_bf16 a[52:55], a[180:183], v[116:119], a[52:55]
    v_mfma_f32_16x16x32_bf16 a[84:87], a[180:183], v[120:123], a[84:87]
    v_mfma_f32_16x16x32_bf16 a[116:119], a[180:183], v[124:127], a[116:119]
    v_add_f32 v6, v6, v44
    v_add_f32 v6, v6, v45
    s_waitcnt vmcnt(8) lgkmcnt(0)
    s_barrier
    v_mfma_f32_16x16x32_bf16 v[68:71], a[144:147], v[192:195], v[152:155]
    ds_read_b128 a[128:131], v8 offset:24576
    v_cvt_pk_bf16_f32 v138, v44, v45
    v_exp_f32 v40, v104
    v_mfma_f32_16x16x32_bf16 v[68:71], a[148:151], v[196:199], v[68:71]
    ds_read_b128 a[132:135], v9 offset:24576
    v_exp_f32 v41, v105
    v_mfma_f32_16x16x32_bf16 v[68:71], a[152:155], v[200:203], v[68:71]
    ds_read_b128 a[136:139], v10 offset:24576
    v_add_f32 v6, v6, v46
    v_add_f32 v6, v6, v47
    v_mfma_f32_16x16x32_bf16 v[68:71], a[156:159], v[204:207], v[68:71]
    ds_read_b128 a[140:143], v11 offset:24576
    v_cvt_pk_bf16_f32 v139, v46, v47
    v_exp_f32 v42, v106
    v_mfma_f32_16x16x32_bf16 a[24:27], a[184:187], v[112:115], a[24:27]
    ds_read_b64_tr_b16 a[160:161], v16 offset:8192
    v_exp_f32 v43, v107
    v_add_f32 v7, v40, v41
    v_mfma_f32_16x16x32_bf16 a[56:59], a[184:187], v[116:119], a[56:59]
    ds_read_b64_tr_b16 a[162:163], v16 offset:12288
    v_cvt_pk_bf16_f32 v140, v40, v41
    v_exp_f32 v44, v108
    v_mfma_f32_16x16x32_bf16 a[88:91], a[184:187], v[120:123], a[88:91]
    v_exp_f32 v45, v109
    v_add_f32 v7, v7, v42
    v_add_f32 v7, v7, v43
    v_mfma_f32_16x16x32_bf16 a[120:123], a[184:187], v[124:127], a[120:123]
    v_mfma_f32_16x16x32_bf16 v[76:79], a[144:147], v[208:211], v[156:159]
    ds_read_b64_tr_b16 a[164:165], v17 offset:8192
    v_cvt_pk_bf16_f32 v141, v42, v43
    v_exp_f32 v46, v110
    v_mfma_f32_16x16x32_bf16 v[76:79], a[148:151], v[212:215], v[76:79]
    ds_read_b64_tr_b16 a[166:167], v17 offset:12288
    v_exp_f32 v47, v111
    v_mfma_f32_16x16x32_bf16 v[76:79], a[152:155], v[216:219], v[76:79]
    v_mfma_f32_16x16x32_bf16 v[76:79], a[156:159], v[220:223], v[76:79]
    v_add_f32 v7, v7, v44
    v_add_f32 v7, v7, v45
    v_cvt_pk_bf16_f32 v142, v44, v45
    v_mfma_f32_16x16x32_bf16 a[28:31], a[188:191], v[112:115], a[28:31]
    ds_read_b64_tr_b16 a[168:169], v18 offset:8192
    v_add_f32 v7, v7, v46
    v_add_f32 v7, v7, v47
    v_cvt_pk_bf16_f32 v143, v46, v47
    v_mfma_f32_16x16x32_bf16 a[60:63], a[188:191], v[116:119], a[60:63]
    ds_read_b64_tr_b16 a[170:171], v18 offset:12288
    v_max3_f32 v35, v4, v5, v6
    v_max_f32 v35, v35, v7
    v_cmp_lt_f32 vcc, s40, v35
    v_mfma_f32_16x16x32_bf16 a[92:95], a[188:191], v[120:123], a[92:95]
    v_mfma_f32_16x16x32_bf16 a[124:127], a[188:191], v[124:127], a[124:127]
    s_cbranch_vccnz L_rare_h0v0
L_ret_h0v0:
    s_waitcnt lgkmcnt(2)
    v_mfma_f32_16x16x32_bf16 v[80:83], a[128:131], v[160:163], v[144:147]
    ds_read_b128 a[144:147], v8 offset:28672
    v_add_f32 v244, v244, v4
    v_add_f32 v245, v245, v5
    v_add_f32 v246, v246, v6
    v_mfma_f32_16x16x32_bf16 v[80:83], a[132:135], v[164:167], v[80:83]
    v_mfma_f32_16x16x32_bf16 v[80:83], a[136:139], v[168:171], v[80:83]
    ds_read_b128 a[148:151], v9 offset:28672
    v_add_f32 v247, v247, v7
    v_exp_f32 v40, v48
    v_mfma_f32_16x16x32_bf16 v[80:83], a[140:143], v[172:175], v[80:83]
    v_exp_f32 v41, v49
    v_exp_f32 v42, v50
    v_mfma_f32_16x16x32_bf16 a[0:3], a[160:163], v[128:131], a[0:3]
    ds_read_b64_tr_b16 a[172:173], v19 offset:8192
    v_exp_f32 v43, v51
    v_mfma_f32_16x16x32_bf16 a[32:35], a[160:163], v[132:135], a[32:35]
    ds_read_b64_tr_b16 a[174:175], v19 offset:12288
    v_add_f32 v248, v40, v41
    s_mov_b32 m0, s44
    v_mfma_f32_16x16x32_bf16 a[64:67], a[160:163], v[136:139], a[64:67]
    buffer_load_dwordx4 v28, s[16:19], s43 offen offset:0 nt lds
    v_cvt_pk_bf16_f32 v112, v40, v41
    v_exp_f32 v44, v52
    v_mfma_f32_16x16x32_bf16 a[96:99], a[160:163], v[140:143], a[96:99]
    v_mfma_f32_16x16x32_bf16 v[88:91], a[128:131], v[176:179], v[148:151]
    ds_read_b128 a[152:155], v10 offset:28672
    v_exp_f32 v45, v53
    v_mfma_f32_16x16x32_bf16 v[88:91], a[132:135], v[180:183], v[88:91]
    v_mfma_f32_16x16x32_bf16 v[88:91], a[136:139], v[184:187], v[88:91]
    ds_read_b128 a[156:159], v11 offset:28672
    v_add_f32 v248, v248, v42
    v_add_f32 v248, v248, v43
    v_mfma_f32_16x16x32_bf16 v[88:91], a[140:143], v[188:191], v[88:91]
    v_mfma_f32_16x16x32_bf16 a[4:7], a[164:167], v[128:131], a[4:7]
    ds_read_b64_tr_b16 a[176:177], v20 offset:8192
    v_cvt_pk_bf16_f32 v113, v42, v43
    v_exp_f32 v46, v54
    v_mfma_f32_16x16x32_bf16 a[36:39], a[164:167], v[132:135], a[36:39]
    ds_read_b64_tr_b16 a[178:179], v20 offset:12288
    v_exp_f32 v47, v55
    v_mfma_f32_16x16x32_bf16 a[68:71], a[164:167], v[136:139], a[68:71]
    buffer_load_dwordx4 v29, s[16:19], s43 offen offset:1024 nt lds
    v_add_f32 v248, v248, v44
    v_add_f32 v248, v248, v45
    v_mfma_f32_16x16x32_bf16 a[100:103], a[164:167], v[140:143], a[100:103]
    v_cvt_pk_bf16_f32 v114, v44, v45
    v_exp_f32 v40, v56
    s_waitcnt lgkmcnt(4)
    v_mfma_f32_16x16x32_bf16 v[96:99], a[128:131], v[192:195], v[152:155]
    v_exp_f32 v41, v57
    v_add_f32 v248, v248, v46
    v_add_f32 v248, v248, v47
    v_mfma_f32_16x16x32_bf16 v[96:99], a[132:135], v[196:199], v[96:99]
    v_cvt_pk_bf16_f32 v115, v46, v47
    v_exp_f32 v42, v58
    s_add_u32 m0, s35, 8192
    v_mfma_f32_16x16x32_bf16 v[96:99], a[136:139], v[200:203], v[96:99]
    buffer_load_dwordx4 v24, s[20:23], s37 offen offset:0 nt lds
    v_exp_f32 v43, v59
    v_add_f32 v249, v40, v41
    v_mfma_f32_16x16x32_bf16 v[96:99], a[140:143], v[204:207], v[96:99]
    v_mfma_f32_16x16x32_bf16 a[8:11], a[168:171], v[128:131], a[8:11]
    ds_read_b64_tr_b16 a[180:181], v21 offset:8192
    v_cvt_pk_bf16_f32 v116, v40, v41
    v_exp_f32 v44, v60
    v_mfma_f32_16x16x32_bf16 a[40:43], a[168:171], v[132:135], a[40:43]
    ds_read_b64_tr_b16 a[182:183], v21 offset:12288
    v_exp_f32 v45, v61
    v_mfma_f32_16x16x32_bf16 a[72:75], a[168:171], v[136:139], a[72:75]
    v_mfma_f32_16x16x32_bf16 a[104:107], a[168:171], v[140:143], a[104:107]
    v_add_f32 v249, v249, v42
    v_add_f32 v249, v249, v43
    v_cvt_pk_bf16_f32 v117, v42, v43
    v_mfma_f32_16x16x32_bf16 v[104:107], a[128:131], v[208:211], v[156:159]
    v_mfma_f32_16x16x32_bf16 v[104:107], a[132:135], v[212:215], v[104:107]
    v_mfma_f32_16x16x32_bf16 v[104:107], a[136:139], v[216:219], v[104:107]
    buffer_load_dwordx4 v25, s[20:23], s37 offen offset:1024 nt lds
    v_exp_f32 v46, v62
    s_add_u32 m0, s36, 40960
    v_mfma_f32_16x16x32_bf16 v[104:107], a[140:143], v[220:223], v[104:107]
    v_exp_f32 v47, v63
    v_add_f32 v249, v249, v44
    s_add_u32 s37, s37, 2048
    v_mfma_f32_16x16x32_bf16 a[12:15], a[172:175], v[128:131], a[12:15]
    ds_read_b64_tr_b16 a[184:185], v22 offset:8192
    v_add_f32 v249, v249, v45
    s_cmp_eq_u32 s37, 65536
    s_cmov_b32 s37, 262144
    v_mfma_f32_16x16x32_bf16 a[44:47], a[172:175], v[132:135], a[44:47]
    ds_read_b64_tr_b16 a[186:187], v22 offset:12288
    v_cvt_pk_bf16_f32 v118, v44, v45
    v_exp_f32 v40, v64
    v_mfma_f32_16x16x32_bf16 a[76:79], a[172:175], v[136:139], a[76:79]
    v_mfma_f32_16x16x32_bf16 a[108:111], a[172:175], v[140:143], a[108:111]
    v_exp_f32 v41, v65
    v_add_f32 v249, v249, v46
    s_waitcnt lgkmcnt(2)
    v_mfma_f32_16x16x32_bf16 v[84:87], a[144:147], v[160:163], v[144:147]
    v_add_f32 v249, v249, v47
    v_cvt_pk_bf16_f32 v119, v46, v47
    v_exp_f32 v42, v66
    v_mfma_f32_16x16x32_bf16 v[84:87], a[148:151], v[164:167], v[84:87]
    v_mfma_f32_16x16x32_bf16 v[84:87], a[152:155], v[168:171], v[84:87]
    buffer_load_dwordx4 v26, s[24:27], s41 offen offset:0 nt lds
    v_exp_f32 v43, v67
    v_add_f32 v250, v40, v41
    v_mfma_f32_16x16x32_bf16 v[84:87], a[156:159], v[172:175], v[84:87]
    v_mfma_f32_16x16x32_bf16 a[16:19], a[176:179], v[128:131], a[16:19]
    ds_read_b64_tr_b16 a[188:189], v23 offset:8192
    v_cvt_pk_bf16_f32 v120, v40, v41
    v_exp_f32 v44, v68
    v_mfma_f32_16x16x32_bf16 a[48:51], a[176:179], v[132:135], a[48:51]
    ds_read_b64_tr_b16 a[190:191], v23 offset:12288
    v_exp_f32 v45, v69
    v_mfma_f32_16x16x32_bf16 a[80:83], a[176:179], v[136:139], a[80:83]
    v_add_f32 v250, v250, v42
    v_add_f32 v250, v250, v43
    v_cvt_pk_bf16_f32 v121, v42, v43
    v_mfma_f32_16x16x32_bf16 a[112:115], a[176:179], v[140:143], a[112:115]
    v_mfma_f32_16x16x32_bf16 v[92:95], a[144:147], v[176:179], v[148:151]
    v_mfma_f32_16x16x32_bf16 v[92:95], a[148:151], v[180:183], v[92:95]
    v_mfma_f32_16x16x32_bf16 v[92:95], a[152:155], v[184:187], v[92:95]
    buffer_load_dwordx4 v27, s[24:27], s41 offen offset:1024 nt lds
    v_exp_f32 v46, v70
    s_add_u32 s41, s41, 2048
    v_mfma_f32_16x16x32_bf16 v[92:95], a[156:159], v[188:191], v[92:95]
    v_exp_f32 v47, v71
    v_add_f32 v250, v250, v44
    v_mfma_f32_16x16x32_bf16 a[20:23], a[180:183], v[128:131], a[20:23]
    v_mfma_f32_16x16x32_bf16 a[52:55], a[180:183], v[132:135], a[52:55]
    v_mfma_f32_16x16x32_bf16 a[84:87], a[180:183], v[136:139], a[84:87]
    v_add_f32 v250, v250, v45
    v_cvt_pk_bf16_f32 v122, v44, v45
    v_exp_f32 v40, v72
    v_mfma_f32_16x16x32_bf16 a[116:119], a[180:183], v[140:143], a[116:119]
    v_exp_f32 v41, v73
    s_waitcnt lgkmcnt(0)
    v_mfma_f32_16x16x32_bf16 v[100:103], a[144:147], v[192:195], v[152:155]
    ds_read_b128 a[128:131], v8 offset:32768
    v_add_f32 v250, v250, v46
    v_add_f32 v250, v250, v47
    v_mfma_f32_16x16x32_bf16 v[100:103], a[148:151], v[196:199], v[100:103]
    ds_read_b128 a[132:135], v9 offset:32768
    v_cvt_pk_bf16_f32 v123, v46, v47
    v_exp_f32 v42, v74
    v_mfma_f32_16x16x32_bf16 v[100:103], a[152:155], v[200:203], v[100:103]
    ds_read_b128 a[136:139], v10 offset:32768
    v_exp_f32 v43, v75
    v_add_f32 v251, v40, v41
    v_mfma_f32_16x16x32_bf16 v[100:103], a[156:159], v[204:207], v[100:103]
    ds_read_b128 a[140:143], v11 offset:32768
    v_cvt_pk_bf16_f32 v124, v40, v41
    v_exp_f32 v44, v76
    v_mfma_f32_16x16x32_bf16 a[24:27], a[184:187], v[128:131], a[24:27]
    ds_read_b64_tr_b16 a[160:161], v16 offset:16384
    v_exp_f32 v45, v77
    v_mfma_f32_16x16x32_bf16 a[56:59], a[184:187], v[132:135], a[56:59]
    ds_read_b64_tr_b16 a[162:163], v16 offset:20480
    v_add_f32 v251, v251, v42
    v_add_f32 v251, v251, v43
    v_mfma_f32_16x16x32_bf16 a[88:91], a[184:187], v[136:139], a[88:91]
    v_mfma_f32_16x16x32_bf16 a[120:123], a[184:187], v[140:143], a[120:123]
    v_mfma_f32_16x16x32_bf16 v[108:111], a[144:147], v[208:211], v[156:159]
    ds_read_b64_tr_b16 a[164:165], v17 offset:16384
    v_cvt_pk_bf16_f32 v125, v42, v43
    v_exp_f32 v46, v78
    v_mfma_f32_16x16x32_bf16 v[108:111], a[148:151], v[212:215], v[108:111]
    ds_read_b64_tr_b16 a[166:167], v17 offset:20480
    v_exp_f32 v47, v79
    v_mfma_f32_16x16x32_bf16 v[108:111], a[152:155], v[216:219], v[108:111]
    v_mfma_f32_16x16x32_bf16 v[108:111], a[156:159], v[220:223], v[108:111]
    v_add_f32 v251, v251, v44
    v_add_f32 v251, v251, v45
    v_cvt_pk_bf16_f32 v126, v44, v45
    v_mfma_f32_16x16x32_bf16 a[28:31], a[188:191], v[128:131], a[28:31]
    ds_read_b64_tr_b16 a[168:169], v18 offset:16384
    v_add_f32 v251, v251, v46
    v_add_f32 v251, v251, v47
    v_cvt_pk_bf16_f32 v127, v46, v47
    v_mfma_f32_16x16x32_bf16 a[60:63], a[188:191], v[132:135], a[60:63]
    ds_read_b64_tr_b16 a[170:171], v18 offset:20480
    v_max3_f32 v35, v248, v249, v250
    v_max_f32 v35, v35, v251
    v_cmp_lt_f32 vcc, s40, v35
    v_mfma_f32_16x16x32_bf16 a[92:95], a[188:191], v[136:139], a[92:95]
    v_mfma_f32_16x16x32_bf16 a[124:127], a[188:191], v[140:143], a[124:127]
    s_cbranch_vccnz L_rare_h0v1
L_ret_h0v1:
    s_waitcnt lgkmcnt(2)
    v_mfma_f32_16x16x32_bf16 v[48:51], a[128:131], v[160:163], v[144:147]
    ds_read_b128 a[144:147], v8 offset:36864
    v_add_f32 v244, v244, v248
    v_add_f32 v245, v245, v249
    v_mfma_f32_16x16x32_bf16 v[48:51], a[132:135], v[164:167], v[48:51]
    v_mfma_f32_16x16x32_bf16 v[48:51], a[136:139], v[168:171], v[48:51]
    ds_read_b128 a[148:151], v9 offset:36864
    v_add_f32 v246, v246, v250
    v_add_f32 v247, v247, v251
    v_mfma_f32_16x16x32_bf16 v[48:51], a[140:143], v[172:175], v[48:51]
    v_exp_f32 v40, v80
    v_exp_f32 v41, v81
    v_mfma_f32_16x16x32_bf16 a[0:3], a[160:163], v[112:115], a[0:3]
    ds_read_b64_tr_b16 a[172:173], v19 offset:16384
    v_exp_f32 v42, v82
    v_mfma_f32_16x16x32_bf16 a[32:35], a[160:163], v[116:119], a[32:35]
    ds_read_b64_tr_b16 a[174:175], v19 offset:20480
    v_exp_f32 v43, v83
    v_mfma_f32_16x16x32_bf16 a[64:67], a[160:163], v[120:123], a[64:67]
    v_mfma_f32_16x16x32_bf16 a[96:99], a[160:163], v[124:127], a[96:99]
    v_mfma_f32_16x16x32_bf16 v[56:59], a[128:131], v[176:179], v[148:151]
    ds_read_b128 a[152:155], v10 offset:36864
    v_add_f32 v4, v40, v41
    v_cvt_pk_bf16_f32 v128, v40, v41
    v_mfma_f32_16x16x32_bf16 v[56:59], a[132:135], v[180:183], v[56:59]
    v_exp_f32 v44, v84
    v_exp_f32 v45, v85
    v_mfma_f32_16x16x32_bf16 v[56:59], a[136:139], v[184:187], v[56:59]
    ds_read_b128 a[156:159], v11 offset:36864
    v_add_f32 v4, v4, v42
    v_add_f32 v4, v4, v43
    v_mfma_f32_16x16x32_bf16 v[56:59], a[140:143], v[188:191], v[56:59]
    v_mfma_f32_16x16x32_bf16 a[4:7], a[164:167], v[112:115], a[4:7]
    ds_read_b64_tr_b16 a[176:177], v20 offset:16384
    v_cvt_pk_bf16_f32 v129, v42, v43
    v_exp_f32 v46, v86
    v_mfma_f32_16x16x32_bf16 a[36:39], a[164:167], v[116:119], a[36:39]
    ds_read_b64_tr_b16 a[178:179], v20 offset:20480
    v_exp_f32 v47, v87
    v_mfma_f32_16x16x32_bf16 a[68:71], a[164:167], v[120:123], a[68:71]
    v_mfma_f32_16x16x32_bf16 a[100:103], a[164:167], v[124:127], a[100:103]
    v_add_f32 v4, v4, v44
    v_add_f32 v4, v4, v45
    s_waitcnt lgkmcnt(4)
    v_mfma_f32_16x16x32_bf16 v[64:67], a[128:131], v[192:195], v[152:155]
    v_cvt_pk_bf16_f32 v130, v44, v45
    v_exp_f32 v40, v88
    v_mfma_f32_16x16x32_bf16 v[64:67], a[132:135], v[196:199], v[64:67]
    v_exp_f32 v41, v89
    s_add_u32 m0, s35, 16384
    v_mfma_f32_16x16x32_bf16 v[64:67], a[136:139], v[200:203], v[64:67]
    buffer_load_dwordx4 v24, s[20:23], s37 offen offset:0 nt lds
    v_add_f32 v4, v4, v46
    v_add_f32 v4, v4, v47
    v_mfma_f32_16x16x32_bf16 v[64:67], a[140:143], v[204:207], v[64:67]
    v_mfma_f32_16x16x32_bf16 a[8:11], a[168:171], v[112:115], a[8:11]
    ds_read_b64_tr_b16 a[180:181], v21 offset:16384
    v_cvt_pk_bf16_f32 v131, v46, v47
    v_exp_f32 v42, v90
    v_mfma_f32_16x16x32_bf16 a[40:43], a[168:171], v[116:119], a[40:43]
    ds_read_b64_tr_b16 a[182:183], v21 offset:20480
    v_exp_f32 v43, v91
    v_mfma_f32_16x16x32_bf16 a[72:75], a[168:171], v[120:123], a[72:75]
    v_mfma_f32_16x16x32_bf16 a[104:107], a[168:171], v[124:127], a[104:107]
    v_add_f32 v5, v40, v41
    v_cvt_pk_bf16_f32 v132, v40, v41
    v_exp_f32 v44, v92
    v_mfma_f32_16x16x32_bf16 v[72:75], a[128:131], v[208:211], v[156:159]
    v_mfma_f32_16x16x32_bf16 v[72:75], a[132:135], v[212:215], v[72:75]
    v_mfma_f32_16x16x32_bf16 v[72:75], a[136:139], v[216:219], v[72:75]
    buffer_load_dwordx4 v25, s[20:23], s37 offen offset:1024 nt lds
    v_exp_f32 v45, v93
    s_add_u32 m0, s36, 0
    v_mfma_f32_16x16x32_bf16 v[72:75], a[140:143], v[220:223], v[72:75]
    v_add_f32 v5, v5, v42
    v_add_f32 v5, v5, v43
    s_add_u32 s37, s37, 2048
    v_mfma_f32_16x16x32_bf16 a[12:15], a[172:175], v[112:115], a[12:15]
    ds_read_b64_tr_b16 a[184:185], v22 offset:16384
    v_cvt_pk_bf16_f32 v133, v42, v43
    v_exp_f32 v46, v94
    v_mfma_f32_16x16x32_bf16 a[44:47], a[172:175], v[116:119], a[44:47]
    ds_read_b64_tr_b16 a[186:187], v22 offset:20480
    v_exp_f32 v47, v95
    v_mfma_f32_16x16x32_bf16 a[76:79], a[172:175], v[120:123], a[76:79]
    v_add_f32 v5, v5, v44
    v_add_f32 v5, v5, v45
    v_cvt_pk_bf16_f32 v134, v44, v45
    v_mfma_f32_16x16x32_bf16 a[108:111], a[172:175], v[124:127], a[108:111]
    v_exp_f32 v40, v96
    s_waitcnt lgkmcnt(2)
    v_mfma_f32_16x16x32_bf16 v[52:55], a[144:147], v[160:163], v[144:147]
    v_mfma_f32_16x16x32_bf16 v[52:55], a[148:151], v[164:167], v[52:55]
    v_mfma_f32_16x16x32_bf16 v[52:55], a[152:155], v[168:171], v[52:55]
    buffer_load_dwordx4 v26, s[24:27], s41 offen offset:0 nt lds
    v_exp_f32 v41, v97
    v_add_f32 v5, v5, v46
    v_mfma_f32_16x16x32_bf16 v[52:55], a[156:159], v[172:175], v[52:55]
    v_add_f32 v5, v5, v47
    v_cvt_pk_bf16_f32 v135, v46, v47
    v_exp_f32 v42, v98
    v_mfma_f32_16x16x32_bf16 a[16:19], a[176:179], v[112:115], a[16:19]
    ds_read_b64_tr_b16 a[188:189], v23 offset:16384
    v_exp_f32 v43, v99
    v_add_f32 v6, v40, v41
    v_mfma_f32_16x16x32_bf16 a[48:51], a[176:179], v[116:119], a[48:51]
    ds_read_b64_tr_b16 a[190:191], v23 offset:20480
    v_cvt_pk_bf16_f32 v136, v40, v41
    v_exp_f32 v44, v100
    v_mfma_f32_16x16x32_bf16 a[80:83], a[176:179], v[120:123], a[80:83]
    v_mfma_f32_16x16x32_bf16 a[112:115], a[176:179], v[124:127], a[112:115]
    v_mfma_f32_16x16x32_bf16 v[60:63], a[144:147], v[176:179], v[148:151]
    v_exp_f32 v45, v101
    v_add_f32 v6, v6, v42
    v_mfma_f32_16x16x32_bf16 v[60:63], a[148:151], v[180:183], v[60:63]
    v_mfma_f32_16x16x32_bf16 v[60:63], a[152:155], v[184:187], v[60:63]
    buffer_load_dwordx4 v27, s[24:27], s41 offen offset:1024 nt lds
    v_add_f32 v6, v6, v43
    v_cvt_pk_bf16_f32 v137, v42, v43
    s_add_u32 s41, s41, 2048
    v_mfma_f32_16x16x32_bf16 v[60:63], a[156:159], v[188:191], v[60:63]
    v_mfma_f32_16x16x32_bf16 a[20:23], a[180:183], v[112:115], a[20:23]
    v_exp_f32 v46, v102
    v_exp_f32 v47, v103
    v_mfma_f32_16x16x32_bf16 a[52:55], a[180:183], v[116:119], a[52:55]
    v_mfma_f32_16x16x32_bf16 a[84:87], a[180:183], v[120:123], a[84:87]
    v_mfma_f32_16x16x32_bf16 a[116:119], a[180:183], v[124:127], a[116:119]
    v_add_f32 v6, v6, v44
    v_add_f32 v6, v6, v45
    s_waitcnt vmcnt(10) lgkmcnt(0)
    s_barrier
    v_mfma_f32_16x16x32_bf16 v[68:71], a[144:147], v[192:195], v[152:155]
    ds_read_b128 a[128:131], v8 offset:40960
    v_cvt_pk_bf16_f32 v138, v44, v45
    v_exp_f32 v40, v104
    v_mfma_f32_16x16x32_bf16 v[68:71], a[148:151], v[196:199], v[68:71]
    ds_read_b128 a[132:135], v9 offset:40960
    v_exp_f32 v41, v105
    v_mfma_f32_16x16x32_bf16 v[68:71], a[152:155], v[200:203], v[68:71]
    ds_read_b128 a[136:139], v10 offset:40960
    v_add_f32 v6, v6, v46
    v_add_f32 v6, v6, v47
    v_mfma_f32_16x16x32_bf16 v[68:71], a[156:159], v[204:207], v[68:71]
    ds_read_b128 a[140:143], v11 offset:40960
    v_cvt_pk_bf16_f32 v139, v46, v47
    v_exp_f32 v42, v106
    v_mfma_f32_16x16x32_bf16 a[24:27], a[184:187], v[112:115], a[24:27]
    ds_read_b64_tr_b16 a[160:161], v16 offset:24576
    v_exp_f32 v43, v107
    v_add_f32 v7, v40, v41
    v_mfma_f32_16x16x32_bf16 a[56:59], a[184:187], v[116:119], a[56:59]
    ds_read_b64_tr_b16 a[162:163], v16 offset:28672
    v_cvt_pk_bf16_f32 v140, v40, v41
    v_exp_f32 v44, v108
    v_mfma_f32_16x16x32_bf16 a[88:91], a[184:187], v[120:123], a[88:91]
    v_exp_f32 v45, v109
    v_add_f32 v7, v7, v42
    v_add_f32 v7, v7, v43
    v_mfma_f32_16x16x32_bf16 a[120:123], a[184:187], v[124:127], a[120:123]
    v_mfma_f32_16x16x32_bf16 v[76:79], a[144:147], v[208:211], v[156:159]
    ds_read_b64_tr_b16 a[164:165], v17 offset:24576
    v_cvt_pk_bf16_f32 v141, v42, v43
    v_exp_f32 v46, v110
    v_mfma_f32_16x16x32_bf16 v[76:79], a[148:151], v[212:215], v[76:79]
    ds_read_b64_tr_b16 a[166:167], v17 offset:28672
    v_exp_f32 v47, v111
    v_mfma_f32_16x16x32_bf16 v[76:79], a[152:155], v[216:219], v[76:79]
    v_mfma_f32_16x16x32_bf16 v[76:79], a[156:159], v[220:223], v[76:79]
    v_add_f32 v7, v7, v44
    v_add_f32 v7, v7, v45
    v_cvt_pk_bf16_f32 v142, v44, v45
    v_mfma_f32_16x16x32_bf16 a[28:31], a[188:191], v[112:115], a[28:31]
    ds_read_b64_tr_b16 a[168:169], v18 offset:24576
    v_add_f32 v7, v7, v46
    v_add_f32 v7, v7, v47
    v_cvt_pk_bf16_f32 v143, v46, v47
    v_mfma_f32_16x16x32_bf16 a[60:63], a[188:191], v[116:119], a[60:63]
    ds_read_b64_tr_b16 a[170:171], v18 offset:28672
    v_max3_f32 v35, v4, v5, v6
    v_max_f32 v35, v35, v7
    v_cmp_lt_f32 vcc, s40, v35
    v_mfma_f32_16x16x32_bf16 a[92:95], a[188:191], v[120:123], a[92:95]
    v_mfma_f32_16x16x32_bf16 a[124:127], a[188:191], v[124:127], a[124:127]
    s_cbranch_vccnz L_rare_h0v2
L_ret_h0v2:
    s_waitcnt lgkmcnt(2)
    v_mfma_f32_16x16x32_bf16 v[80:83], a[128:131], v[160:163], v[144:147]
    ds_read_b128 a[144:147], v8 offset:45056
    v_add_f32 v244, v244, v4
    v_add_f32 v245, v245, v5
    v_add_f32 v246, v246, v6
    v_mfma_f32_16x16x32_bf16 v[80:83], a[132:135], v[164:167], v[80:83]
    v_mfma_f32_16x16x32_bf16 v[80:83], a[136:139], v[168:171], v[80:83]
    ds_read_b128 a[148:151], v9 offset:45056
    v_add_f32 v247, v247, v7
    v_exp_f32 v40, v48
    v_mfma_f32_16x16x32_bf16 v[80:83], a[140:143], v[172:175], v[80:83]
    v_exp_f32 v41, v49
    v_exp_f32 v42, v50
    v_mfma_f32_16x16x32_bf16 a[0:3], a[160:163], v[128:131], a[0:3]
    ds_read_b64_tr_b16 a[172:173], v19 offset:24576
    v_exp_f32 v43, v51
    v_mfma_f32_16x16x32_bf16 a[32:35], a[160:163], v[132:135], a[32:35]
    ds_read_b64_tr_b16 a[174:175], v19 offset:28672
    v_add_f32 v248, v40, v41
    s_mov_b32 m0, s44
    v_mfma_f32_16x16x32_bf16 a[64:67], a[160:163], v[136:139], a[64:67]
    buffer_load_dwordx4 v30, s[16:19], s43 offen offset:2048 nt lds
    v_cvt_pk_bf16_f32 v112, v40, v41
    v_exp_f32 v44, v52
    v_mfma_f32_16x16x32_bf16 a[96:99], a[160:163], v[140:143], a[96:99]
    v_mfma_f32_16x16x32_bf16 v[88:91], a[128:131], v[176:179], v[148:151]
    ds_read_b128 a[152:155], v10 offset:45056
    v_exp_f32 v45, v53
    v_mfma_f32_16x16x32_bf16 v[88:91], a[132:135], v[180:183], v[88:91]
    v_mfma_f32_16x16x32_bf16 v[88:91], a[136:139], v[184:187], v[88:91]
    ds_read_b128 a[156:159], v11 offset:45056
    v_add_f32 v248, v248, v42
    v_add_f32 v248, v248, v43
    v_mfma_f32_16x16x32_bf16 v[88:91], a[140:143], v[188:191], v[88:91]
    v_mfma_f32_16x16x32_bf16 a[4:7], a[164:167], v[128:131], a[4:7]
    ds_read_b64_tr_b16 a[176:177], v20 offset:24576
    v_cvt_pk_bf16_f32 v113, v42, v43
    v_exp_f32 v46, v54
    v_mfma_f32_16x16x32_bf16 a[36:39], a[164:167], v[132:135], a[36:39]
    ds_read_b64_tr_b16 a[178:179], v20 offset:28672
    v_exp_f32 v47, v55
    v_add_f32 v248, v248, v44
    v_mfma_f32_16x16x32_bf16 a[68:71], a[164:167], v[136:139], a[68:71]
    buffer_load_dwordx4 v31, s[16:19], s43 offen offset:3072 nt lds
    v_add_f32 v248, v248, v45
    v_cvt_pk_bf16_f32 v114, v44, v45
    s_add_u32 s44, s44, 4096
    v_mfma_f32_16x16x32_bf16 a[100:103], a[164:167], v[140:143], a[100:103]
    v_exp_f32 v40, v56
    s_add_u32 s43, s43, 4096
    s_waitcnt lgkmcnt(4)
    v_mfma_f32_16x16x32_bf16 v[96:99], a[128:131], v[192:195], v[152:155]
    v_exp_f32 v41, v57
    v_add_f32 v248, v248, v46
    v_add_f32 v248, v248, v47
    v_mfma_f32_16x16x32_bf16 v[96:99], a[132:135], v[196:199], v[96:99]
    v_cvt_pk_bf16_f32 v115, v46, v47
    v_exp_f32 v42, v58
    s_add_u32 m0, s35, 24576
    v_mfma_f32_16x16x32_bf16 v[96:99], a[136:139], v[200:203], v[96:99]
    buffer_load_dwordx4 v24, s[20:23], s37 offen offset:0 nt lds
    v_exp_f32 v43, v59
    v_add_f32 v249, v40, v41
    v_mfma_f32_16x16x32_bf16 v[96:99], a[140:143], v[204:207], v[96:99]
    v_mfma_f32_16x16x32_bf16 a[8:11], a[168:171], v[128:131], a[8:11]
    ds_read_b64_tr_b16 a[180:181], v21 offset:24576
    v_cvt_pk_bf16_f32 v116, v40, v41
    v_exp_f32 v44, v60
    v_mfma_f32_16x16x32_bf16 a[40:43], a[168:171], v[132:135], a[40:43]
    ds_read_b64_tr_b16 a[182:183], v21 offset:28672
    v_exp_f32 v45, v61
    v_mfma_f32_16x16x32_bf16 a[72:75], a[168:171], v[136:139], a[72:75]
    v_mfma_f32_16x16x32_bf16 a[104:107], a[168:171], v[140:143], a[104:107]
    v_mfma_f32_16x16x32_bf16 v[104:107], a[128:131], v[208:211], v[156:159]
    v_add_f32 v249, v249, v42
    v_add_f32 v249, v249, v43
    v_cvt_pk_bf16_f32 v117, v42, v43
    v_mfma_f32_16x16x32_bf16 v[104:107], a[132:135], v[212:215], v[104:107]
    v_mfma_f32_16x16x32_bf16 v[104:107], a[136:139], v[216:219], v[104:107]
    buffer_load_dwordx4 v25, s[20:23], s37 offen offset:1024 nt lds
    v_exp_f32 v46, v62
    s_add_u32 m0, s36, 8192
    v_mfma_f32_16x16x32_bf16 v[104:107], a[140:143], v[220:223], v[104:107]
    v_exp_f32 v47, v63
    s_add_u32 s37, s37, 2048
    v_mfma_f32_16x16x32_bf16 a[12:15], a[172:175], v[128:131], a[12:15]
    ds_read_b64_tr_b16 a[184:185], v22 offset:24576
    v_add_f32 v249, v249, v44
    v_add_f32 v249, v249, v45
    v_mfma_f32_16x16x32_bf16 a[44:47], a[172:175], v[132:135], a[44:47]
    ds_read_b64_tr_b16 a[186:187], v22 offset:28672
    v_cvt_pk_bf16_f32 v118, v44, v45
    v_exp_f32 v40, v64
    v_mfma_f32_16x16x32_bf16 a[76:79], a[172:175], v[136:139], a[76:79]
    v_mfma_f32_16x16x32_bf16 a[108:111], a[172:175], v[140:143], a[108:111]
    v_exp_f32 v41, v65
    v_add_f32 v249, v249, v46
    s_waitcnt lgkmcnt(2)
    v_mfma_f32_16x16x32_bf16 v[84:87], a[144:147], v[160:163], v[144:147]
    v_mfma_f32_16x16x32_bf16 v[84:87], a[148:151], v[164:167], v[84:87]
    v_add_f32 v249, v249, v47
    v_cvt_pk_bf16_f32 v119, v46, v47
    v_exp_f32 v42, v66
    v_mfma_f32_16x16x32_bf16 v[84:87], a[152:155], v[168:171], v[84:87]
    buffer_load_dwordx4 v26, s[24:27], s41 offen offset:0 nt lds
    v_exp_f32 v43, v67
    v_add_f32 v250, v40, v41
    v_mfma_f32_16x16x32_bf16 v[84:87], a[156:159], v[172:175], v[84:87]
    v_mfma_f32_16x16x32_bf16 a[16:19], a[176:179], v[128:131], a[16:19]
    ds_read_b64_tr_b16 a[188:189], v23 offset:24576
    v_cvt_pk_bf16_f32 v120, v40, v41
    v_exp_f32 v44, v68
    v_mfma_f32_16x16x32_bf16 a[48:51], a[176:179], v[132:135], a[48:51]
    ds_read_b64_tr_b16 a[190:191], v23 offset:28672
    v_exp_f32 v45, v69
    v_add_f32 v250, v250, v42
    v_mfma_f32_16x16x32_bf16 a[80:83], a[176:179], v[136:139], a[80:83]
    v_mfma_f32_16x16x32_bf16 a[112:115], a[176:179], v[140:143], a[112:115]
    v_mfma_f32_16x16x32_bf16 v[92:95], a[144:147], v[176:179], v[148:151]
    v_add_f32 v250, v250, v43
    v_cvt_pk_bf16_f32 v121, v42, v43
    v_exp_f32 v46, v70
    v_mfma_f32_16x16x32_bf16 v[92:95], a[148:151], v[180:183], v[92:95]
    v_mfma_f32_16x16x32_bf16 v[92:95], a[152:155], v[184:187], v[92:95]
    buffer_load_dwordx4 v27, s[24:27], s41 offen offset:1024 nt lds
    v_exp_f32 v47, v71
    s_add_u32 s41, s41, 2048
    v_mfma_f32_16x16x32_bf16 v[92:95], a[156:159], v[188:191], v[92:95]
    v_add_f32 v250, v250, v44
    s_cmp_eq_u32 s41, 65536
    s_cmov_b32 s41, 262144
    v_mfma_f32_16x16x32_bf16 a[20:23], a[180:183], v[128:131], a[20:23]
    v_mfma_f32_16x16x32_bf16 a[52:55], a[180:183], v[132:135], a[52:55]
    v_mfma_f32_16x16x32_bf16 a[84:87], a[180:183], v[136:139], a[84:87]
    v_add_f32 v250, v250, v45
    v_cvt_pk_bf16_f32 v122, v44, v45
    v_exp_f32 v40, v72
    v_mfma_f32_16x16x32_bf16 a[116:119], a[180:183], v[140:143], a[116:119]
    v_exp_f32 v41, v73
    s_waitcnt lgkmcnt(0)
    v_mfma_f32_16x16x32_bf16 v[100:103], a[144:147], v[192:195], v[152:155]
    ds_read_b128 a[128:131], v8 offset:0
    v_add_f32 v250, v250, v46
    v_add_f32 v250, v250, v47
    v_mfma_f32_16x16x32_bf16 v[100:103], a[148:151], v[196:199], v[100:103]
    ds_read_b128 a[132:135], v9 offset:0
    v_cvt_pk_bf16_f32 v123, v46, v47
    v_exp_f32 v42, v74
    v_mfma_f32_16x16x32_bf16 v[100:103], a[152:155], v[200:203], v[100:103]
    ds_read_b128 a[136:139], v10 offset:0
    v_exp_f32 v43, v75
    v_add_f32 v251, v40, v41
    v_mfma_f32_16x16x32_bf16 v[100:103], a[156:159], v[204:207], v[100:103]
    ds_read_b128 a[140:143], v11 offset:0
    v_cvt_pk_bf16_f32 v124, v40, v41
    v_exp_f32 v44, v76
    v_mfma_f32_16x16x32_bf16 a[24:27], a[184:187], v[128:131], a[24:27]
    ds_read_b64_tr_b16 a[160:161], v16 offset:32768
    v_exp_f32 v45, v77
    v_mfma_f32_16x16x32_bf16 a[56:59], a[184:187], v[132:135], a[56:59]
    ds_read_b64_tr_b16 a[162:163], v16 offset:36864
    v_add_f32 v251, v251, v42
    v_add_f32 v251, v251, v43
    v_mfma_f32_16x16x32_bf16 a[88:91], a[184:187], v[136:139], a[88:91]
    v_mfma_f32_16x16x32_bf16 a[120:123], a[184:187], v[140:143], a[120:123]
    v_mfma_f32_16x16x32_bf16 v[108:111], a[144:147], v[208:211], v[156:159]
    ds_read_b64_tr_b16 a[164:165], v17 offset:32768
    v_cvt_pk_bf16_f32 v125, v42, v43
    v_exp_f32 v46, v78
    v_mfma_f32_16x16x32_bf16 v[108:111], a[148:151], v[212:215], v[108:111]
    ds_read_b64_tr_b16 a[166:167], v17 offset:36864
    v_exp_f32 v47, v79
    v_mfma_f32_16x16x32_bf16 v[108:111], a[152:155], v[216:219], v[108:111]
    v_mfma_f32_16x16x32_bf16 v[108:111], a[156:159], v[220:223], v[108:111]
    v_add_f32 v251, v251, v44
    v_add_f32 v251, v251, v45
    v_cvt_pk_bf16_f32 v126, v44, v45
    v_mfma_f32_16x16x32_bf16 a[28:31], a[188:191], v[128:131], a[28:31]
    ds_read_b64_tr_b16 a[168:169], v18 offset:32768
    v_add_f32 v251, v251, v46
    v_add_f32 v251, v251, v47
    v_cvt_pk_bf16_f32 v127, v46, v47
    v_mfma_f32_16x16x32_bf16 a[60:63], a[188:191], v[132:135], a[60:63]
    ds_read_b64_tr_b16 a[170:171], v18 offset:36864
    v_max3_f32 v35, v248, v249, v250
    v_max_f32 v35, v35, v251
    v_cmp_lt_f32 vcc, s40, v35
    v_mfma_f32_16x16x32_bf16 a[92:95], a[188:191], v[136:139], a[92:95]
    v_mfma_f32_16x16x32_bf16 a[124:127], a[188:191], v[140:143], a[124:127]
    s_cbranch_vccnz L_rare_h0v3
L_ret_h0v3:
    s_waitcnt lgkmcnt(2)
    v_mfma_f32_16x16x32_bf16 v[48:51], a[128:131], v[160:163], v[144:147]
    ds_read_b128 a[144:147], v8 offset:4096
    v_add_f32 v244, v244, v248
    v_add_f32 v245, v245, v249
    v_mfma_f32_16x16x32_bf16 v[48:51], a[132:135], v[164:167], v[48:51]
    v_mfma_f32_16x16x32_bf16 v[48:51], a[136:139], v[168:171], v[48:51]
    ds_read_b128 a[148:151], v9 offset:4096
    v_add_f32 v246, v246, v250
    v_add_f32 v247, v247, v251
    v_mfma_f32_16x16x32_bf16 v[48:51], a[140:143], v[172:175], v[48:51]
    v_exp_f32 v40, v80
    v_exp_f32 v41, v81
    v_mfma_f32_16x16x32_bf16 a[0:3], a[160:163], v[112:115], a[0:3]
    ds_read_b64_tr_b16 a[172:173], v19 offset:32768
    v_exp_f32 v42, v82
    v_mfma_f32_16x16x32_bf16 a[32:35], a[160:163], v[116:119], a[32:35]
    ds_read_b64_tr_b16 a[174:175], v19 offset:36864
    v_exp_f32 v43, v83
    v_mfma_f32_16x16x32_bf16 a[64:67], a[160:163], v[120:123], a[64:67]
    v_mfma_f32_16x16x32_bf16 a[96:99], a[160:163], v[124:127], a[96:99]
    v_mfma_f32_16x16x32_bf16 v[56:59], a[128:131], v[176:179], v[148:151]
    ds_read_b128 a[152:155], v10 offset:4096
    v_add_f32 v4, v40, v41
    v_cvt_pk_bf16_f32 v128, v40, v41
    v_mfma_f32_16x16x32_bf16 v[56:59], a[132:135], v[180:183], v[56:59]
    v_exp_f32 v44, v84
    v_exp_f32 v45, v85
    v_mfma_f32_16x16x32_bf16 v[56:59], a[136:139], v[184:187], v[56:59]
    ds_read_b128 a[156:159], v11 offset:4096
    v_add_f32 v4, v4, v42
    v_add_f32 v4, v4, v43
    v_mfma_f32_16x16x32_bf16 v[56:59], a[140:143], v[188:191], v[56:59]
    v_mfma_f32_16x16x32_bf16 a[4:7], a[164:167], v[112:115], a[4:7]
    ds_read_b64_tr_b16 a[176:177], v20 offset:32768
    v_cvt_pk_bf16_f32 v129, v42, v43
    v_exp_f32 v46, v86
    v_mfma_f32_16x16x32_bf16 a[36:39], a[164:167], v[116:119], a[36:39]
    ds_read_b64_tr_b16 a[178:179], v20 offset:36864
    v_exp_f32 v47, v87
    v_mfma_f32_16x16x32_bf16 a[68:71], a[164:167], v[120:123], a[68:71]
    v_mfma_f32_16x16x32_bf16 a[100:103], a[164:167], v[124:127], a[100:103]
    v_add_f32 v4, v4, v44
    v_add_f32 v4, v4, v45
    s_waitcnt lgkmcnt(4)
    v_mfma_f32_16x16x32_bf16 v[64:67], a[128:131], v[192:195], v[152:155]
    v_cvt_pk_bf16_f32 v130, v44, v45
    v_exp_f32 v40, v88
    v_mfma_f32_16x16x32_bf16 v[64:67], a[132:135], v[196:199], v[64:67]
    v_exp_f32 v41, v89
    s_add_u32 m0, s35, 32768
    v_mfma_f32_16x16x32_bf16 v[64:67], a[136:139], v[200:203], v[64:67]
    buffer_load_dwordx4 v24, s[20:23], s37 offen offset:0 nt lds
    v_add_f32 v4, v4, v46
    v_add_f32 v4, v4, v47
    v_mfma_f32_16x16x32_bf16 v[64:67], a[140:143], v[204:207], v[64:67]
    v_mfma_f32_16x16x32_bf16 a[8:11], a[168:171], v[112:115], a[8:11]
    ds_read_b64_tr_b16 a[180:181], v21 offset:32768
    v_cvt_pk_bf16_f32 v131, v46, v47
    v_exp_f32 v42, v90
    v_mfma_f32_16x16x32_bf16 a[40:43], a[168:171], v[116:119], a[40:43]
    ds_read_b64_tr_b16 a[182:183], v21 offset:36864
    v_exp_f32 v43, v91
    v_mfma_f32_16x16x32_bf16 a[72:75], a[168:171], v[120:123], a[72:75]
    v_mfma_f32_16x16x32_bf16 a[104:107], a[168:171], v[124:127], a[104:107]
    v_add_f32 v5, v40, v41
    v_cvt_pk_bf16_f32 v132, v40, v41
    v_exp_f32 v44, v92
    v_mfma_f32_16x16x32_bf16 v[72:75], a[128:131], v[208:211], v[156:159]
    v_mfma_f32_16x16x32_bf16 v[72:75], a[132:135], v[212:215], v[72:75]
    v_mfma_f32_16x16x32_bf16 v[72:75], a[136:139], v[216:219], v[72:75]
    buffer_load_dwordx4 v25, s[20:23], s37 offen offset:1024 nt lds
    v_exp_f32 v45, v93
    s_add_u32 m0, s36, 16384
    v_mfma_f32_16x16x32_bf16 v[72:75], a[140:143], v[220:223], v[72:75]
    v_add_f32 v5, v5, v42
    v_add_f32 v5, v5, v43
    s_add_u32 s37, s37, 2048
    v_mfma_f32_16x16x32_bf16 a[12:15], a[172:175], v[112:115], a[12:15]
    ds_read_b64_tr_b16 a[184:185], v22 offset:32768
    v_cvt_pk_bf16_f32 v133, v42, v43
    v_exp_f32 v46, v94
    v_mfma_f32_16x16x32_bf16 a[44:47], a[172:175], v[116:119], a[44:47]
    ds_read_b64_tr_b16 a[186:187], v22 offset:36864
    v_exp_f32 v47, v95
    v_mfma_f32_16x16x32_bf16 a[76:79], a[172:175], v[120:123], a[76:79]
    v_add_f32 v5, v5, v44
    v_add_f32 v5, v5, v45
    v_cvt_pk_bf16_f32 v134, v44, v45
    v_mfma_f32_16x16x32_bf16 a[108:111], a[172:175], v[124:127], a[108:111]
    v_exp_f32 v40, v96
    s_waitcnt lgkmcnt(2)
    v_mfma_f32_16x16x32_bf16 v[52:55], a[144:147], v[160:163], v[144:147]
    v_mfma_f32_16x16x32_bf16 v[52:55], a[148:151], v[164:167], v[52:55]
    v_mfma_f32_16x16x32_bf16 v[52:55], a[152:155], v[168:171], v[52:55]
    buffer_load_dwordx4 v26, s[24:27], s41 offen offset:0 nt lds
    v_exp_f32 v41, v97
    v_add_f32 v5, v5, v46
    v_mfma_f32_16x16x32_bf16 v[52:55], a[156:159], v[172:175], v[52:55]
    v_add_f32 v5, v5, v47
    v_cvt_pk_bf16_f32 v135, v46, v47
    v_exp_f32 v42, v98
    v_mfma_f32_16x16x32_bf16 a[16:19], a[176:179], v[112:115], a[16:19]
    ds_read_b64_tr_b16 a[188:189], v23 offset:32768
    v_exp_f32 v43, v99
    v_add_f32 v6, v40, v41
    v_mfma_f32_16x16x32_bf16 a[48:51], a[176:179], v[116:119], a[48:51]
    ds_read_b64_tr_b16 a[190:191], v23 offset:36864
    v_cvt_pk_bf16_f32 v136, v40, v41
    v_exp_f32 v44, v100
    v_mfma_f32_16x16x32_bf16 a[80:83], a[176:179], v[120:123], a[80:83]
    v_mfma_f32_16x16x32_bf16 a[112:115], a[176:179], v[124:127], a[112:115]
    v_mfma_f32_16x16x32_bf16 v[60:63], a[144:147], v[176:179], v[148:151]
    v_exp_f32 v45, v101
    v_add_f32 v6, v6, v42
    v_mfma_f32_16x16x32_bf16 v[60:63], a[148:151], v[180:183], v[60:63]
    v_mfma_f32_16x16x32_bf16 v[60:63], a[152:155], v[184:187], v[60:63]
    buffer_load_dwordx4 v27, s[24:27], s41 offen offset:1024 nt lds
    v_add_f32 v6, v6, v43
    v_cvt_pk_bf16_f32 v137, v42, v43
    s_add_u32 s41, s41, 2048
    v_mfma_f32_16x16x32_bf16 v[60:63], a[156:159], v[188:191], v[60:63]
    v_mfma_f32_16x16x32_bf16 a[20:23], a[180:183], v[112:115], a[20:23]
    v_exp_f32 v46, v102
    v_exp_f32 v47, v103
    v_mfma_f32_16x16x32_bf16 a[52:55], a[180:183], v[116:119], a[52:55]
    v_mfma_f32_16x16x32_bf16 a[84:87], a[180:183], v[120:123], a[84:87]
    v_mfma_f32_16x16x32_bf16 a[116:119], a[180:183], v[124:127], a[116:119]
    v_add_f32 v6, v6, v44
    v_add_f32 v6, v6, v45
    s_waitcnt vmcnt(10) lgkmcnt(0)
    s_barrier
    v_mfma_f32_16x16x32_bf16 v[68:71], a[144:147], v[192:195], v[152:155]
    ds_read_b128 a[128:131], v8 offset:8192
    v_cvt_pk_bf16_f32 v138, v44, v45
    v_exp_f32 v40, v104
    v_mfma_f32_16x16x32_bf16 v[68:71], a[148:151], v[196:199], v[68:71]
    ds_read_b128 a[132:135], v9 offset:8192
    v_exp_f32 v41, v105
    v_mfma_f32_16x16x32_bf16 v[68:71], a[152:155], v[200:203], v[68:71]
    ds_read_b128 a[136:139], v10 offset:8192
    v_add_f32 v6, v6, v46
    v_add_f32 v6, v6, v47
    v_mfma_f32_16x16x32_bf16 v[68:71], a[156:159], v[204:207], v[68:71]
    ds_read_b128 a[140:143], v11 offset:8192
    v_cvt_pk_bf16_f32 v139, v46, v47
    v_exp_f32 v42, v106
    v_mfma_f32_16x16x32_bf16 a[24:27], a[184:187], v[112:115], a[24:27]
    ds_read_b64_tr_b16 a[160:161], v16 offset:40960
    v_exp_f32 v43, v107
    v_add_f32 v7, v40, v41
    v_mfma_f32_16x16x32_bf16 a[56:59], a[184:187], v[116:119], a[56:59]
    ds_read_b64_tr_b16 a[162:163], v16 offset:45056
    v_cvt_pk_bf16_f32 v140, v40, v41
    v_exp_f32 v44, v108
    v_mfma_f32_16x16x32_bf16 a[88:91], a[184:187], v[120:123], a[88:91]
    v_exp_f32 v45, v109
    v_add_f32 v7, v7, v42
    v_add_f32 v7, v7, v43
    v_mfma_f32_16x16x32_bf16 a[120:123], a[184:187], v[124:127], a[120:123]
    v_mfma_f32_16x16x32_bf16 v[76:79], a[144:147], v[208:211], v[156:159]
    ds_read_b64_tr_b16 a[164:165], v17 offset:40960
    v_cvt_pk_bf16_f32 v141, v42, v43
    v_exp_f32 v46, v110
    v_mfma_f32_16x16x32_bf16 v[76:79], a[148:151], v[212:215], v[76:79]
    ds_read_b64_tr_b16 a[166:167], v17 offset:45056
    v_exp_f32 v47, v111
    v_mfma_f32_16x16x32_bf16 v[76:79], a[152:155], v[216:219], v[76:79]
    v_mfma_f32_16x16x32_bf16 v[76:79], a[156:159], v[220:223], v[76:79]
    v_add_f32 v7, v7, v44
    v_add_f32 v7, v7, v45
    v_cvt_pk_bf16_f32 v142, v44, v45
    v_mfma_f32_16x16x32_bf16 a[28:31], a[188:191], v[112:115], a[28:31]
    ds_read_b64_tr_b16 a[168:169], v18 offset:40960
    v_add_f32 v7, v7, v46
    v_add_f32 v7, v7, v47
    v_cvt_pk_bf16_f32 v143, v46, v47
    v_mfma_f32_16x16x32_bf16 a[60:63], a[188:191], v[116:119], a[60:63]
    ds_read_b64_tr_b16 a[170:171], v18 offset:45056
    v_max3_f32 v35, v4, v5, v6
    v_max_f32 v35, v35, v7
    v_cmp_lt_f32 vcc, s40, v35
    v_mfma_f32_16x16x32_bf16 a[92:95], a[188:191], v[120:123], a[92:95]
    v_mfma_f32_16x16x32_bf16 a[124:127], a[188:191], v[124:127], a[124:127]
    s_cbranch_vccnz L_rare_h0v4
L_ret_h0v4:
    s_waitcnt lgkmcnt(2)
    v_mfma_f32_16x16x32_bf16 v[80:83], a[128:131], v[160:163], v[144:147]
    ds_read_b128 a[144:147], v8 offset:12288
    v_add_f32 v244, v244, v4
    v_add_f32 v245, v245, v5
    v_mfma_f32_16x16x32_bf16 v[80:83], a[132:135], v[164:167], v[80:83]
    v_mfma_f32_16x16x32_bf16 v[80:83], a[136:139], v[168:171], v[80:83]
    ds_read_b128 a[148:151], v9 offset:12288
    v_add_f32 v246, v246, v6
    v_add_f32 v247, v247, v7
    v_mfma_f32_16x16x32_bf16 v[80:83], a[140:143], v[172:175], v[80:83]
    v_exp_f32 v40, v48
    v_exp_f32 v41, v49
    v_mfma_f32_16x16x32_bf16 a[0:3], a[160:163], v[128:131], a[0:3]
    ds_read_b64_tr_b16 a[172:173], v19 offset:40960
    v_exp_f32 v42, v50
    v_mfma_f32_16x16x32_bf16 a[32:35], a[160:163], v[132:135], a[32:35]
    ds_read_b64_tr_b16 a[174:175], v19 offset:45056
    v_exp_f32 v43, v51
    v_mfma_f32_16x16x32_bf16 a[64:67], a[160:163], v[136:139], a[64:67]
    v_mfma_f32_16x16x32_bf16 a[96:99], a[160:163], v[140:143], a[96:99]
    v_mfma_f32_16x16x32_bf16 v[88:91], a[128:131], v[176:179], v[148:151]
    ds_read_b128 a[152:155], v10 offset:12288
    v_add_f32 v248, v40, v41
    v_cvt_pk_bf16_f32 v112, v40, v41
    v_mfma_f32_16x16x32_bf16 v[88:91], a[132:135], v[180:183], v[88:91]
    v_exp_f32 v44, v52
    v_exp_f32 v45, v53
    v_mfma_f32_16x16x32_bf16 v[88:91], a[136:139], v[184:187], v[88:91]
    ds_read_b128 a[156:159], v11 offset:12288
    v_add_f32 v248, v248, v42
    v_add_f32 v248, v248, v43
    v_mfma_f32_16x16x32_bf16 v[88:91], a[140:143], v[188:191], v[88:91]
    v_mfma_f32_16x16x32_bf16 a[4:7], a[164:167], v[128:131], a[4:7]
    ds_read_b64_tr_b16 a[176:177], v20 offset:40960
    v_cvt_pk_bf16_f32 v113, v42, v43
    v_exp_f32 v46, v54
    v_mfma_f32_16x16x32_bf16 a[36:39], a[164:167], v[132:135], a[36:39]
    ds_read_b64_tr_b16 a[178:179], v20 offset:45056
    v_exp_f32 v47, v55
    v_mfma_f32_16x16x32_bf16 a[68:71], a[164:167], v[136:139], a[68:71]
    v_mfma_f32_16x16x32_bf16 a[100:103], a[164:167], v[140:143], a[100:103]
    v_add_f32 v248, v248, v44
    v_add_f32 v248, v248, v45
    s_waitcnt lgkmcnt(4)
    v_mfma_f32_16x16x32_bf16 v[96:99], a[128:131], v[192:195], v[152:155]
    v_mfma_f32_16x16x32_bf16 v[96:99], a[132:135], v[196:199], v[96:99]
    v_cvt_pk_bf16_f32 v114, v44, v45
    v_exp_f32 v40, v56
    s_add_u32 m0, s35, 40960
    v_mfma_f32_16x16x32_bf16 v[96:99], a[136:139], v[200:203], v[96:99]
    buffer_load_dwordx4 v24, s[20:23], s37 offen offset:0 nt lds
    v_exp_f32 v41, v57
    v_add_f32 v248, v248, v46
    v_mfma_f32_16x16x32_bf16 v[96:99], a[140:143], v[204:207], v[96:99]
    v_add_f32 v248, v248, v47
    v_cvt_pk_bf16_f32 v115, v46, v47
    v_exp_f32 v42, v58
    v_mfma_f32_16x16x32_bf16 a[8:11], a[168:171], v[128:131], a[8:11]
    ds_read_b64_tr_b16 a[180:181], v21 offset:40960
    v_exp_f32 v43, v59
    v_mfma_f32_16x16x32_bf16 a[40:43], a[168:171], v[132:135], a[40:43]
    ds_read_b64_tr_b16 a[182:183], v21 offset:45056
    v_add_f32 v249, v40, v41
    v_cvt_pk_bf16_f32 v116, v40, v41
    v_mfma_f32_16x16x32_bf16 a[72:75], a[168:171], v[136:139], a[72:75]
    v_mfma_f32_16x16x32_bf16 a[104:107], a[168:171], v[140:143], a[104:107]
    v_mfma_f32_16x16x32_bf16 v[104:107], a[128:131], v[208:211], v[156:159]
    v_exp_f32 v44, v60
    v_exp_f32 v45, v61
    v_mfma_f32_16x16x32_bf16 v[104:107], a[132:135], v[212:215], v[104:107]
    v_mfma_f32_16x16x32_bf16 v[104:107], a[136:139], v[216:219], v[104:107]
    buffer_load_dwordx4 v25, s[20:23], s37 offen offset:1024 nt lds
    v_add_f32 v249, v249, v42
    v_add_f32 v249, v249, v43
    s_add_u32 m0, s36, 24576
    v_mfma_f32_16x16x32_bf16 v[104:107], a[140:143], v[220:223], v[104:107]
    v_cvt_pk_bf16_f32 v117, v42, v43
    v_exp_f32 v46, v62
    s_add_u32 s37, s37, 2048
    v_mfma_f32_16x16x32_bf16 a[12:15], a[172:175], v[128:131], a[12:15]
    ds_read_b64_tr_b16 a[184:185], v22 offset:40960
    v_exp_f32 v47, v63
    v_mfma_f32_16x16x32_bf16 a[44:47], a[172:175], v[132:135], a[44:47]
    ds_read_b64_tr_b16 a[186:187], v22 offset:45056
    v_add_f32 v249, v249, v44
    v_add_f32 v249, v249, v45
    v_mfma_f32_16x16x32_bf16 a[76:79], a[172:175], v[136:139], a[76:79]
    v_mfma_f32_16x16x32_bf16 a[108:111], a[172:175], v[140:143], a[108:111]
    v_cvt_pk_bf16_f32 v118, v44, v45
    v_exp_f32 v40, v64
    s_waitcnt lgkmcnt(2)
    v_mfma_f32_16x16x32_bf16 v[84:87], a[144:147], v[160:163], v[144:147]
    v_exp_f32 v41, v65
    v_add_f32 v249, v249, v46
    v_add_f32 v249, v249, v47
    v_mfma_f32_16x16x32_bf16 v[84:87], a[148:151], v[164:167], v[84:87]
    v_mfma_f32_16x16x32_bf16 v[84:87], a[152:155], v[168:171], v[84:87]
    buffer_load_dwordx4 v26, s[24:27], s41 offen offset:0 nt lds
    v_cvt_pk_bf16_f32 v119, v46, v47
    v_exp_f32 v42, v66
    v_mfma_f32_16x16x32_bf16 v[84:87], a[156:159], v[172:175], v[84:87]
    v_mfma_f32_16x16x32_bf16 a[16:19], a[176:179], v[128:131], a[16:19]
    ds_read_b64_tr_b16 a[188:189], v23 offset:40960
    v_exp_f32 v43, v67
    v_mfma_f32_16x16x32_bf16 a[48:51], a[176:179], v[132:135], a[48:51]
    ds_read_b64_tr_b16 a[190:191], v23 offset:45056
    v_add_f32 v250, v40, v41
    v_cvt_pk_bf16_f32 v120, v40, v41
    v_mfma_f32_16x16x32_bf16 a[80:83], a[176:179], v[136:139], a[80:83]
    v_exp_f32 v44, v68
    v_exp_f32 v45, v69
    v_mfma_f32_16x16x32_bf16 a[112:115], a[176:179], v[140:143], a[112:115]
    v_mfma_f32_16x16x32_bf16 v[92:95], a[144:147], v[176:179], v[148:151]
    v_mfma_f32_16x16x32_bf16 v[92:95], a[148:151], v[180:183], v[92:95]
    v_add_f32 v250, v250, v42
    v_add_f32 v250, v250, v43
    v_cvt_pk_bf16_f32 v121, v42, v43
    v_mfma_f32_16x16x32_bf16 v[92:95], a[152:155], v[184:187], v[92:95]
    buffer_load_dwordx4 v27, s[24:27], s41 offen offset:1024 nt lds
    v_exp_f32 v46, v70
    s_add_u32 s41, s41, 2048
    v_mfma_f32_16x16x32_bf16 v[92:95], a[156:159], v[188:191], v[92:95]
    v_mfma_f32_16x16x32_bf16 a[20:23], a[180:183], v[128:131], a[20:23]
    v_mfma_f32_16x16x32_bf16 a[52:55], a[180:183], v[132:135], a[52:55]
    v_mfma_f32_16x16x32_bf16 a[84:87], a[180:183], v[136:139], a[84:87]
    v_exp_f32 v47, v71
    v_add_f32 v250, v250, v44
    v_add_f32 v250, v250, v45
    v_mfma_f32_16x16x32_bf16 a[116:119], a[180:183], v[140:143], a[116:119]
    v_cvt_pk_bf16_f32 v122, v44, v45
    v_exp_f32 v40, v72
    s_waitcnt lgkmcnt(0)
    v_mfma_f32_16x16x32_bf16 v[100:103], a[144:147], v[192:195], v[152:155]
    ds_read_b128 a[128:131], v8 offset:16384
    v_exp_f32 v41, v73
    v_mfma_f32_16x16x32_bf16 v[100:103], a[148:151], v[196:199], v[100:103]
    ds_read_b128 a[132:135], v9 offset:16384
    v_add_f32 v250, v250, v46
    v_add_f32 v250, v250, v47
    v_mfma_f32_16x16x32_bf16 v[100:103], a[152:155], v[200:203], v[100:103]
    ds_read_b128 a[136:139], v10 offset:16384
    v_cvt_pk_bf16_f32 v123, v46, v47
    v_exp_f32 v42, v74
    v_mfma_f32_16x16x32_bf16 v[100:103], a[156:159], v[204:207], v[100:103]
    ds_read_b128 a[140:143], v11 offset:16384
    v_exp_f32 v43, v75
    v_add_f32 v251, v40, v41
    v_mfma_f32_16x16x32_bf16 a[24:27], a[184:187], v[128:131], a[24:27]
    ds_read_b64_tr_b16 a[160:161], v16 offset:0
    v_cvt_pk_bf16_f32 v124, v40, v41
    v_exp_f32 v44, v76
    v_mfma_f32_16x16x32_bf16 a[56:59], a[184:187], v[132:135], a[56:59]
    ds_read_b64_tr_b16 a[162:163], v16 offset:4096
    v_exp_f32 v45, v77
    v_mfma_f32_16x16x32_bf16 a[88:91], a[184:187], v[136:139], a[88:91]
    v_mfma_f32_16x16x32_bf16 a[120:123], a[184:187], v[140:143], a[120:123]
    v_mfma_f32_16x16x32_bf16 v[108:111], a[144:147], v[208:211], v[156:159]
    ds_read_b64_tr_b16 a[164:165], v17 offset:0
    v_add_f32 v251, v251, v42
    v_add_f32 v251, v251, v43
    v_mfma_f32_16x16x32_bf16 v[108:111], a[148:151], v[212:215], v[108:111]
    ds_read_b64_tr_b16 a[166:167], v17 offset:4096
    v_cvt_pk_bf16_f32 v125, v42, v43
    v_exp_f32 v46, v78
    v_mfma_f32_16x16x32_bf16 v[108:111], a[152:155], v[216:219], v[108:111]
    v_exp_f32 v47, v79
    s_sub_u32 s39, s39, 1
    v_mfma_f32_16x16x32_bf16 v[108:111], a[156:159], v[220:223], v[108:111]
    v_add_f32 v251, v251, v44
    v_add_f32 v251, v251, v45
    v_cvt_pk_bf16_f32 v126, v44, v45
    v_add_f32 v251, v251, v46
    v_mfma_f32_16x16x32_bf16 a[28:31], a[188:191], v[128:131], a[28:31]
    ds_read_b64_tr_b16 a[168:169], v18 offset:0
    v_add_f32 v251, v251, v47
    v_cvt_pk_bf16_f32 v127, v46, v47
    s_cmp_lg_u32 s39, 0
    v_mfma_f32_16x16x32_bf16 a[60:63], a[188:191], v[132:135], a[60:63]
    ds_read_b64_tr_b16 a[170:171], v18 offset:4096
    v_max3_f32 v35, v248, v249, v250
    v_max_f32 v35, v35, v251
    v_cmp_lt_f32 vcc, s40, v35
    v_mfma_f32_16x16x32_bf16 a[92:95], a[188:191], v[136:139], a[92:95]
    v_mfma_f32_16x16x32_bf16 a[124:127], a[188:191], v[140:143], a[124:127]
    s_cbranch_vccnz L_rare_h0v5
L_ret_h0v5:
    s_waitcnt lgkmcnt(2)
    s_cbranch_scc1 L_loops0
L_loopx0:
    v_mfma_f32_16x16x32_bf16 a[0:3], a[160:163], v[112:115], a[0:3]
    v_add_f32 v244, v244, v248
    v_add_f32 v245, v245, v249
    v_add_f32 v246, v246, v250
    v_add_f32 v247, v247, v251
    v_mfma_f32_16x16x32_bf16 a[32:35], a[160:163], v[116:119], a[32:35]
    v_exp_f32 v40, v80
    v_exp_f32 v41, v81
    v_mfma_f32_16x16x32_bf16 a[64:67], a[160:163], v[120:123], a[64:67]
    ds_read_b64_tr_b16 a[172:173], v19 offset:0
    v_exp_f32 v42, v82
    v_exp_f32 v43, v83
    v_mfma_f32_16x16x32_bf16 a[96:99], a[160:163], v[124:127], a[96:99]
    ds_read_b64_tr_b16 a[174:175], v19 offset:4096
    v_add_f32 v4, v40, v41
    v_cvt_pk_bf16_f32 v128, v40, v41
    v_exp_f32 v44, v84
    v_mfma_f32_16x16x32_bf16 a[4:7], a[164:167], v[112:115], a[4:7]
    v_exp_f32 v45, v85
    v_add_f32 v4, v4, v42
    v_add_f32 v4, v4, v43
    v_mfma_f32_16x16x32_bf16 a[36:39], a[164:167], v[116:119], a[36:39]
    v_cvt_pk_bf16_f32 v129, v42, v43
    v_exp_f32 v46, v86
    v_exp_f32 v47, v87
    v_mfma_f32_16x16x32_bf16 a[68:71], a[164:167], v[120:123], a[68:71]
    ds_read_b64_tr_b16 a[176:177], v20 offset:0
    v_add_f32 v4, v4, v44
    v_add_f32 v4, v4, v45
    s_add_u32 m0, s35, 0
    v_mfma_f32_16x16x32_bf16 a[100:103], a[164:167], v[124:127], a[100:103]
    ds_read_b64_tr_b16 a[178:179], v20 offset:4096
    buffer_load_dwordx4 v24, s[20:23], s37 offen offset:0 nt lds
    v_cvt_pk_bf16_f32 v130, v44, v45
    s_waitcnt lgkmcnt(2)
    v_mfma_f32_16x16x32_bf16 a[8:11], a[168:171], v[112:115], a[8:11]
    v_exp_f32 v40, v88
    v_exp_f32 v41, v89
    v_mfma_f32_16x16x32_bf16 a[40:43], a[168:171], v[116:119], a[40:43]
    v_add_f32 v4, v4, v46
    v_add_f32 v4, v4, v47
    v_cvt_pk_bf16_f32 v131, v46, v47
    v_exp_f32 v42, v90
    v_mfma_f32_16x16x32_bf16 a[72:75], a[168:171], v[120:123], a[72:75]
    ds_read_b64_tr_b16 a[180:181], v21 offset:0
    v_exp_f32 v43, v91
    v_add_f32 v5, v40, v41
    v_cvt_pk_bf16_f32 v132, v40, v41
    v_mfma_f32_16x16x32_bf16 a[104:107], a[168:171], v[124:127], a[104:107]
    ds_read_b64_tr_b16 a[182:183], v21 offset:4096
    buffer_load_dwordx4 v25, s[20:23], s37 offen offset:1024 nt lds
    v_exp_f32 v44, v92
    s_add_u32 m0, s36, 32768
    v_mfma_f32_16x16x32_bf16 a[12:15], a[172:175], v[112:115], a[12:15]
    v_exp_f32 v45, v93
    v_add_f32 v5, v5, v42
    v_add_f32 v5, v5, v43
    s_add_u32 s37, s37, 2048
    v_mfma_f32_16x16x32_bf16 a[44:47], a[172:175], v[116:119], a[44:47]
    v_cvt_pk_bf16_f32 v133, v42, v43
    v_exp_f32 v46, v94
    v_exp_f32 v47, v95
    v_mfma_f32_16x16x32_bf16 a[76:79], a[172:175], v[120:123], a[76:79]
    ds_read_b64_tr_b16 a[184:185], v22 offset:0
    v_add_f32 v5, v5, v44
    v_add_f32 v5, v5, v45
    v_cvt_pk_bf16_f32 v134, v44, v45
    v_mfma_f32_16x16x32_bf16 a[108:111], a[172:175], v[124:127], a[108:111]
    ds_read_b64_tr_b16 a[186:187], v22 offset:4096
    buffer_load_dwordx4 v26, s[24:27], s41 offen offset:0 nt lds
    v_exp_f32 v40, v96
    s_waitcnt lgkmcnt(2)
    v_mfma_f32_16x16x32_bf16 a[16:19], a[176:179], v[112:115], a[16:19]
    v_exp_f32 v41, v97
    v_add_f32 v5, v5, v46
    v_add_f32 v5, v5, v47
    v_mfma_f32_16x16x32_bf16 a[48:51], a[176:179], v[116:119], a[48:51]
    v_cvt_pk_bf16_f32 v135, v46, v47
    v_exp_f32 v42, v98
    v_exp_f32 v43, v99
    v_mfma_f32_16x16x32_bf16 a[80:83], a[176:179], v[120:123], a[80:83]
    ds_read_b64_tr_b16 a[188:189], v23 offset:0
    v_add_f32 v6, v40, v41
    v_cvt_pk_bf16_f32 v136, v40, v41
    v_exp_f32 v44, v100
    v_mfma_f32_16x16x32_bf16 a[112:115], a[176:179], v[124:127], a[112:115]
    ds_read_b64_tr_b16 a[190:191], v23 offset:4096
    buffer_load_dwordx4 v27, s[24:27], s41 offen offset:1024 nt lds
    v_exp_f32 v45, v101
    s_add_u32 s41, s41, 2048
    v_mfma_f32_16x16x32_bf16 a[20:23], a[180:183], v[112:115], a[20:23]
    v_add_f32 v6, v6, v42
    v_add_f32 v6, v6, v43
    v_cvt_pk_bf16_f32 v137, v42, v43
    v_exp_f32 v46, v102
    v_mfma_f32_16x16x32_bf16 a[52:55], a[180:183], v[116:119], a[52:55]
    v_exp_f32 v47, v103
    v_add_f32 v6, v6, v44
    v_add_f32 v6, v6, v45
    v_mfma_f32_16x16x32_bf16 a[84:87], a[180:183], v[120:123], a[84:87]
    v_cvt_pk_bf16_f32 v138, v44, v45
    v_exp_f32 v40, v104
    v_exp_f32 v41, v105
    v_mfma_f32_16x16x32_bf16 a[116:119], a[180:183], v[124:127], a[116:119]
    v_add_f32 v6, v6, v46
    v_add_f32 v6, v6, v47
    s_waitcnt vmcnt(8) lgkmcnt(0)
    s_barrier
    v_mfma_f32_16x16x32_bf16 a[24:27], a[184:187], v[112:115], a[24:27]
    v_cvt_pk_bf16_f32 v139, v46, v47
    v_exp_f32 v42, v106
    v_exp_f32 v43, v107
    v_mfma_f32_16x16x32_bf16 a[56:59], a[184:187], v[116:119], a[56:59]
    v_add_f32 v7, v40, v41
    v_cvt_pk_bf16_f32 v140, v40, v41
    v_exp_f32 v44, v108
    v_mfma_f32_16x16x32_bf16 a[88:91], a[184:187], v[120:123], a[88:91]
    ds_read_b64_tr_b16 a[160:161], v16 offset:8192
    v_exp_f32 v45, v109
    v_add_f32 v7, v7, v42
    v_add_f32 v7, v7, v43
    v_mfma_f32_16x16x32_bf16 a[120:123], a[184:187], v[124:127], a[120:123]
    ds_read_b64_tr_b16 a[162:163], v16 offset:12288
    v_cvt_pk_bf16_f32 v141, v42, v43
    v_exp_f32 v46, v110
    v_mfma_f32_16x16x32_bf16 a[28:31], a[188:191], v[112:115], a[28:31]
    ds_read_b64_tr_b16 a[164:165], v17 offset:8192
    v_exp_f32 v47, v111
    v_add_f32 v7, v7, v44
    v_mfma_f32_16x16x32_bf16 a[60:63], a[188:191], v[116:119], a[60:63]
    ds_read_b64_tr_b16 a[166:167], v17 offset:12288
    v_add_f32 v7, v7, v45
    v_cvt_pk_bf16_f32 v142, v44, v45
    v_add_f32 v7, v7, v46
    v_add_f32 v7, v7, v47
    v_mfma_f32_16x16x32_bf16 a[92:95], a[188:191], v[120:123], a[92:95]
    ds_read_b64_tr_b16 a[168:169], v18 offset:8192
    v_cvt_pk_bf16_f32 v143, v46, v47
    v_max3_f32 v35, v4, v5, v6
    v_max_f32 v35, v35, v7
    v_cmp_lt_f32 vcc, s40, v35
    v_mfma_f32_16x16x32_bf16 a[124:127], a[188:191], v[124:127], a[124:127]
    ds_read_b64_tr_b16 a[170:171], v18 offset:12288
    s_cbranch_vccnz L_rare_h0s31
L_ret_h0s31:
    s_waitcnt lgkmcnt(2)
    v_mfma_f32_16x16x32_bf16 a[0:3], a[160:163], v[128:131], a[0:3]
    ds_read_b64_tr_b16 a[172:173], v19 offset:8192
    ds_read_b64_tr_b16 a[174:175], v19 offset:12288
    v_add_f32 v176, v244, v4
    v_add_f32 v177, v245, v5
    v_add_f32 v178, v246, v6
    v_mfma_f32_16x16x32_bf16 a[32:35], a[160:163], v[132:135], a[32:35]
    ds_read_b64_tr_b16 a[176:177], v20 offset:8192
    ds_read_b64_tr_b16 a[178:179], v20 offset:12288
    v_add_f32 v179, v247, v7
    v_mov_b32 v180, v176
    v_mov_b32 v181, v177
    v_mfma_f32_16x16x32_bf16 a[4:7], a[164:167], v[128:131], a[4:7]
    ds_read_b64_tr_b16 a[180:181], v21 offset:8192
    ds_read_b64_tr_b16 a[182:183], v21 offset:12288
    v_mov_b32 v182, v178
    v_mov_b32 v183, v179
    v_permlane16_swap_b32 v180, v176
    v_mfma_f32_16x16x32_bf16 a[36:39], a[164:167], v[132:135], a[36:39]
    ds_read_b64_tr_b16 a[184:185], v22 offset:8192
    ds_read_b64_tr_b16 a[186:187], v22 offset:12288
    v_permlane16_swap_b32 v181, v177
    v_permlane16_swap_b32 v182, v178
    v_permlane16_swap_b32 v183, v179
    s_waitcnt lgkmcnt(6)
    v_mfma_f32_16x16x32_bf16 a[8:11], a[168:171], v[128:131], a[8:11]
    ds_read_b64_tr_b16 a[188:189], v23 offset:8192
    ds_read_b64_tr_b16 a[190:191], v23 offset:12288
    ds_read_b128 v[48:51], v12 offset:0
    v_add_f32 v176, v176, v180
    v_add_f32 v177, v177, v181
    v_add_f32 v178, v178, v182
    v_mfma_f32_16x16x32_bf16 a[40:43], a[168:171], v[132:135], a[40:43]
    ds_read_b128 v[52:55], v13 offset:0
    v_add_f32 v179, v179, v183
    v_mov_b32 v180, v176
    v_mov_b32 v181, v177
    v_mfma_f32_16x16x32_bf16 a[12:15], a[172:175], v[128:131], a[12:15]
    ds_read_b128 v[56:59], v14 offset:0
    v_mov_b32 v182, v178
    v_mov_b32 v183, v179
    v_permlane32_swap_b32 v180, v176
    v_mfma_f32_16x16x32_bf16 a[44:47], a[172:175], v[132:135], a[44:47]
    ds_read_b128 v[60:63], v15 offset:0
    v_permlane32_swap_b32 v181, v177
    v_permlane32_swap_b32 v182, v178
    v_permlane32_swap_b32 v183, v179
    s_waitcnt lgkmcnt(8)
    v_mfma_f32_16x16x32_bf16 a[16:19], a[176:179], v[128:131], a[16:19]
    ds_read_b128 v[64:67], v12 offset:4096
    v_add_f32 v176, v176, v180
    v_add_f32 v177, v177, v181
    v_add_f32 v178, v178, v182
    v_mfma_f32_16x16x32_bf16 a[48:51], a[176:179], v[132:135], a[48:51]
    ds_read_b128 v[68:71], v13 offset:4096
    v_add_f32 v179, v179, v183
    v_rcp_f32 v168, v176
    v_rcp_f32 v170, v177
    v_mfma_f32_16x16x32_bf16 a[20:23], a[180:183], v[128:131], a[20:23]
    ds_read_b128 v[72:75], v14 offset:4096
    v_rcp_f32 v172, v178
    v_rcp_f32 v174, v179
    v_and_b32 v36, 15, v0
    v_mfma_f32_16x16x32_bf16 a[52:55], a[180:183], v[132:135], a[52:55]
    ds_read_b128 v[76:79], v15 offset:4096
    v_lshlrev_b32 v160, 8, v36
    v_lshrrev_b32 v37, 5, v0
    v_and_b32 v36, 7, v0
    s_waitcnt lgkmcnt(8)
    v_mfma_f32_16x16x32_bf16 a[24:27], a[184:187], v[128:131], a[24:27]
    ds_read_b128 v[80:83], v12 offset:8192
    v_xor_b32 v36, v36, v37
    v_lshl_add_u32 v160, v36, 4, v160
    v_bfe_u32 v36, v0, 4, 1
    v_mfma_f32_16x16x32_bf16 a[56:59], a[184:187], v[132:135], a[56:59]
    ds_read_b128 v[84:87], v13 offset:8192
    v_lshl_add_u32 v160, v36, 3, v160
    v_add_u32 v160, s42, v160
    v_xor_b32 v161, 32, v160
    v_mfma_f32_16x16x32_bf16 a[28:31], a[188:191], v[128:131], a[28:31]
    ds_read_b128 v[88:91], v14 offset:8192
    v_xor_b32 v162, 64, v160
    v_xor_b32 v163, 96, v160
    v_xor_b32 v164, 128, v160
    v_mfma_f32_16x16x32_bf16 a[60:63], a[188:191], v[132:135], a[60:63]
    ds_read_b128 v[92:95], v15 offset:8192
    v_xor_b32 v165, 160, v160
    v_xor_b32 v166, 192, v160
    v_xor_b32 v167, 224, v160
    ds_read_b128 v[96:99], v12 offset:12288
    ds_read_b128 v[100:103], v13 offset:12288
    ds_read_b128 v[104:107], v14 offset:12288
    ds_read_b128 v[108:111], v15 offset:12288
    s_add_u32 m0, s35, 8192
    s_nop 0
    buffer_load_dwordx4 v24, s[20:23], s37 offen offset:0 nt lds
    buffer_load_dwordx4 v25, s[20:23], s37 offen offset:1024 nt lds
    s_add_u32 m0, s36, 40960
    s_nop 0
    buffer_load_dwordx4 v26, s[24:27], s41 offen offset:0 nt lds
    buffer_load_dwordx4 v27, s[24:27], s41 offen offset:1024 nt lds
    s_add_u32 s37, s37, 2048
    s_add_u32 s41, s41, 2048
    v_mfma_f32_16x16x32_bf16 a[64:67], a[160:163], v[136:139], a[64:67]
    v_accvgpr_read_b32 v184, a0
    v_accvgpr_read_b32 v185, a1
    v_accvgpr_read_b32 v186, a2
    v_accvgpr_read_b32 v187, a3
    v_pk_mul_f32 v[184:185], v[184:185], v[168:169] op_sel_hi:[1,0]
    v_pk_mul_f32 v[186:187], v[186:187], v[168:169] op_sel_hi:[1,0]
    v_cvt_pk_bf16_f32 v192, v184, v185
    v_cvt_pk_bf16_f32 v193, v186, v187
    v_mfma_f32_16x16x32_bf16 a[96:99], a[160:163], v[140:143], a[96:99]
    v_accvgpr_read_b32 v188, a4
    v_accvgpr_read_b32 v189, a5
    v_accvgpr_read_b32 v190, a6
    v_accvgpr_read_b32 v191, a7
    v_pk_mul_f32 v[188:189], v[188:189], v[168:169] op_sel_hi:[1,0]
    v_pk_mul_f32 v[190:191], v[190:191], v[168:169] op_sel_hi:[1,0]
    v_cvt_pk_bf16_f32 v194, v188, v189
    v_cvt_pk_bf16_f32 v195, v190, v191
    v_mfma_f32_16x16x32_bf16 a[68:71], a[164:167], v[136:139], a[68:71]
    v_accvgpr_read_b32 v184, a8
    v_accvgpr_read_b32 v185, a9
    v_accvgpr_read_b32 v186, a10
    v_accvgpr_read_b32 v187, a11
    v_pk_mul_f32 v[184:185], v[184:185], v[168:169] op_sel_hi:[1,0]
    v_pk_mul_f32 v[186:187], v[186:187], v[168:169] op_sel_hi:[1,0]
    v_cvt_pk_bf16_f32 v196, v184, v185
    v_cvt_pk_bf16_f32 v197, v186, v187
    v_mfma_f32_16x16x32_bf16 a[100:103], a[164:167], v[140:143], a[100:103]
    v_accvgpr_read_b32 v188, a12
    v_accvgpr_read_b32 v189, a13
    v_accvgpr_read_b32 v190, a14
    v_accvgpr_read_b32 v191, a15
    v_pk_mul_f32 v[188:189], v[188:189], v[168:169] op_sel_hi:[1,0]
    v_pk_mul_f32 v[190:191], v[190:191], v[168:169] op_sel_hi:[1,0]
    v_cvt_pk_bf16_f32 v198, v188, v189
    v_cvt_pk_bf16_f32 v199, v190, v191
    v_mfma_f32_16x16x32_bf16 a[72:75], a[168:171], v[136:139], a[72:75]
    ds_write_b64 v160, v[192:193] offset:0
    ds_write_b64 v161, v[194:195] offset:0
    ds_write_b64 v162, v[196:197] offset:0
    ds_write_b64 v163, v[198:199] offset:0
    v_mfma_f32_16x16x32_bf16 a[104:107], a[168:171], v[140:143], a[104:107]
    v_accvgpr_read_b32 v184, a16
    v_accvgpr_read_b32 v185, a17
    v_accvgpr_read_b32 v186, a18
    v_accvgpr_read_b32 v187, a19
    v_pk_mul_f32 v[184:185], v[184:185], v[168:169] op_sel_hi:[1,0]
    v_pk_mul_f32 v[186:187], v[186:187], v[168:169] op_sel_hi:[1,0]
    v_cvt_pk_bf16_f32 v200, v184, v185
    v_cvt_pk_bf16_f32 v201, v186, v187
    v_mfma_f32_16x16x32_bf16 a[76:79], a[172:175], v[136:139], a[76:79]
    v_accvgpr_read_b32 v188, a20
    v_accvgpr_read_b32 v189, a21
    v_accvgpr_read_b32 v190, a22
    v_accvgpr_read_b32 v191, a23
    v_pk_mul_f32 v[188:189], v[188:189], v[168:169] op_sel_hi:[1,0]
    v_pk_mul_f32 v[190:191], v[190:191], v[168:169] op_sel_hi:[1,0]
    v_cvt_pk_bf16_f32 v202, v188, v189
    v_cvt_pk_bf16_f32 v203, v190, v191
    v_mfma_f32_16x16x32_bf16 a[108:111], a[172:175], v[140:143], a[108:111]
    v_accvgpr_read_b32 v184, a24
    v_accvgpr_read_b32 v185, a25
    v_accvgpr_read_b32 v186, a26
    v_accvgpr_read_b32 v187, a27
    v_pk_mul_f32 v[184:185], v[184:185], v[168:169] op_sel_hi:[1,0]
    v_pk_mul_f32 v[186:187], v[186:187], v[168:169] op_sel_hi:[1,0]
    v_cvt_pk_bf16_f32 v204, v184, v185
    v_cvt_pk_bf16_f32 v205, v186, v187
    v_mfma_f32_16x16x32_bf16 a[80:83], a[176:179], v[136:139], a[80:83]
    v_accvgpr_read_b32 v188, a28
    v_accvgpr_read_b32 v189, a29
    v_accvgpr_read_b32 v190, a30
    v_accvgpr_read_b32 v191, a31
    v_pk_mul_f32 v[188:189], v[188:189], v[168:169] op_sel_hi:[1,0]
    v_pk_mul_f32 v[190:191], v[190:191], v[168:169] op_sel_hi:[1,0]
    v_cvt_pk_bf16_f32 v206, v188, v189
    v_cvt_pk_bf16_f32 v207, v190, v191
    v_mfma_f32_16x16x32_bf16 a[112:115], a[176:179], v[140:143], a[112:115]
    ds_write_b64 v164, v[200:201] offset:0
    ds_write_b64 v165, v[202:203] offset:0
    ds_write_b64 v166, v[204:205] offset:0
    ds_write_b64 v167, v[206:207] offset:0
    v_mfma_f32_16x16x32_bf16 a[84:87], a[180:183], v[136:139], a[84:87]
    v_accvgpr_read_b32 v184, a32
    v_accvgpr_read_b32 v185, a33
    v_accvgpr_read_b32 v186, a34
    v_accvgpr_read_b32 v187, a35
    v_pk_mul_f32 v[184:185], v[184:185], v[170:171] op_sel_hi:[1,0]
    v_pk_mul_f32 v[186:187], v[186:187], v[170:171] op_sel_hi:[1,0]
    v_cvt_pk_bf16_f32 v192, v184, v185
    v_cvt_pk_bf16_f32 v193, v186, v187
    v_mfma_f32_16x16x32_bf16 a[116:119], a[180:183], v[140:143], a[116:119]
    v_accvgpr_read_b32 v188, a36
    v_accvgpr_read_b32 v189, a37
    v_accvgpr_read_b32 v190, a38
    v_accvgpr_read_b32 v191, a39
    v_pk_mul_f32 v[188:189], v[188:189], v[170:171] op_sel_hi:[1,0]
    v_pk_mul_f32 v[190:191], v[190:191], v[170:171] op_sel_hi:[1,0]
    v_cvt_pk_bf16_f32 v194, v188, v189
    v_cvt_pk_bf16_f32 v195, v190, v191
    v_mfma_f32_16x16x32_bf16 a[88:91], a[184:187], v[136:139], a[88:91]
    v_accvgpr_read_b32 v184, a40
    v_accvgpr_read_b32 v185, a41
    v_accvgpr_read_b32 v186, a42
    v_accvgpr_read_b32 v187, a43
    v_pk_mul_f32 v[184:185], v[184:185], v[170:171] op_sel_hi:[1,0]
    v_pk_mul_f32 v[186:187], v[186:187], v[170:171] op_sel_hi:[1,0]
    v_cvt_pk_bf16_f32 v196, v184, v185
    v_cvt_pk_bf16_f32 v197, v186, v187
    v_mfma_f32_16x16x32_bf16 a[120:123], a[184:187], v[140:143], a[120:123]
    v_accvgpr_read_b32 v188, a44
    v_accvgpr_read_b32 v189, a45
    v_accvgpr_read_b32 v190, a46
    v_accvgpr_read_b32 v191, a47
    v_pk_mul_f32 v[188:189], v[188:189], v[170:171] op_sel_hi:[1,0]
    v_pk_mul_f32 v[190:191], v[190:191], v[170:171] op_sel_hi:[1,0]
    v_cvt_pk_bf16_f32 v198, v188, v189
    v_cvt_pk_bf16_f32 v199, v190, v191
    v_mfma_f32_16x16x32_bf16 a[92:95], a[188:191], v[136:139], a[92:95]
    ds_write_b64 v160, v[192:193] offset:4096
    ds_write_b64 v161, v[194:195] offset:4096
    ds_write_b64 v162, v[196:197] offset:4096
    ds_write_b64 v163, v[198:199] offset:4096
    v_mfma_f32_16x16x32_bf16 a[124:127], a[188:191], v[140:143], a[124:127]
    v_accvgpr_read_b32 v184, a48
    v_accvgpr_read_b32 v185, a49
    v_accvgpr_read_b32 v186, a50
    v_accvgpr_read_b32 v187, a51
    v_pk_mul_f32 v[184:185], v[184:185], v[170:171] op_sel_hi:[1,0]
    v_pk_mul_f32 v[186:187], v[186:187], v[170:171] op_sel_hi:[1,0]
    v_cvt_pk_bf16_f32 v200, v184, v185
    v_cvt_pk_bf16_f32 v201, v186, v187
    v_accvgpr_read_b32 v188, a52
    v_accvgpr_read_b32 v189, a53
    v_accvgpr_read_b32 v190, a54
    v_accvgpr_read_b32 v191, a55
    v_pk_mul_f32 v[188:189], v[188:189], v[170:171] op_sel_hi:[1,0]
    v_pk_mul_f32 v[190:191], v[190:191], v[170:171] op_sel_hi:[1,0]
    v_cvt_pk_bf16_f32 v202, v188, v189
    v_cvt_pk_bf16_f32 v203, v190, v191
    v_accvgpr_read_b32 v184, a56
    v_accvgpr_read_b32 v185, a57
    v_accvgpr_read_b32 v186, a58
    v_accvgpr_read_b32 v187, a59
    v_pk_mul_f32 v[184:185], v[184:185], v[170:171] op_sel_hi:[1,0]
    v_pk_mul_f32 v[186:187], v[186:187], v[170:171] op_sel_hi:[1,0]
    v_cvt_pk_bf16_f32 v204, v184, v185
    v_cvt_pk_bf16_f32 v205, v186, v187
    v_accvgpr_read_b32 v188, a60
    v_accvgpr_read_b32 v189, a61
    v_accvgpr_read_b32 v190, a62
    v_accvgpr_read_b32 v191, a63
    v_pk_mul_f32 v[188:189], v[188:189], v[170:171] op_sel_hi:[1,0]
    v_pk_mul_f32 v[190:191], v[190:191], v[170:171] op_sel_hi:[1,0]
    v_cvt_pk_bf16_f32 v206, v188, v189
    v_cvt_pk_bf16_f32 v207, v190, v191
    ds_write_b64 v164, v[200:201] offset:4096
    ds_write_b64 v165, v[202:203] offset:4096
    ds_write_b64 v166, v[204:205] offset:4096
    ds_write_b64 v167, v[206:207] offset:4096
    v_accvgpr_read_b32 v184, a64
    v_accvgpr_read_b32 v185, a65
    v_accvgpr_read_b32 v186, a66
    v_accvgpr_read_b32 v187, a67
    v_pk_mul_f32 v[184:185], v[184:185], v[172:173] op_sel_hi:[1,0]
    v_pk_mul_f32 v[186:187], v[186:187], v[172:173] op_sel_hi:[1,0]
    v_cvt_pk_bf16_f32 v192, v184, v185
    v_cvt_pk_bf16_f32 v193, v186, v187
    v_accvgpr_read_b32 v188, a68
    v_accvgpr_read_b32 v189, a69
    v_accvgpr_read_b32 v190, a70
    v_accvgpr_read_b32 v191, a71
    v_pk_mul_f32 v[188:189], v[188:189], v[172:173] op_sel_hi:[1,0]
    v_pk_mul_f32 v[190:191], v[190:191], v[172:173] op_sel_hi:[1,0]
    v_cvt_pk_bf16_f32 v194, v188, v189
    v_cvt_pk_bf16_f32 v195, v190, v191
    v_accvgpr_read_b32 v184, a72
    v_accvgpr_read_b32 v185, a73
    v_accvgpr_read_b32 v186, a74
    v_accvgpr_read_b32 v187, a75
    v_pk_mul_f32 v[184:185], v[184:185], v[172:173] op_sel_hi:[1,0]
    v_pk_mul_f32 v[186:187], v[186:187], v[172:173] op_sel_hi:[1,0]
    v_cvt_pk_bf16_f32 v196, v184, v185
    v_cvt_pk_bf16_f32 v197, v186, v187
    v_accvgpr_read_b32 v188, a76
    v_accvgpr_read_b32 v189, a77
    v_accvgpr_read_b32 v190, a78
    v_accvgpr_read_b32 v191, a79
    v_pk_mul_f32 v[188:189], v[188:189], v[172:173] op_sel_hi:[1,0]
    v_pk_mul_f32 v[190:191], v[190:191], v[172:173] op_sel_hi:[1,0]
    v_cvt_pk_bf16_f32 v198, v188, v189
    v_cvt_pk_bf16_f32 v199, v190, v191
    ds_write_b64 v160, v[192:193] offset:8192
    ds_write_b64 v161, v[194:195] offset:8192
    ds_write_b64 v162, v[196:197] offset:8192
    ds_write_b64 v163, v[198:199] offset:8192
    v_accvgpr_read_b32 v184, a80
    v_accvgpr_read_b32 v185, a81
    v_accvgpr_read_b32 v186, a82
    v_accvgpr_read_b32 v187, a83
    v_pk_mul_f32 v[184:185], v[184:185], v[172:173] op_sel_hi:[1,0]
    v_pk_mul_f32 v[186:187], v[186:187], v[172:173] op_sel_hi:[1,0]
    v_cvt_pk_bf16_f32 v200, v184, v185
    v_cvt_pk_bf16_f32 v201, v186, v187
    v_accvgpr_read_b32 v188, a84
    v_accvgpr_read_b32 v189, a85
    v_accvgpr_read_b32 v190, a86
    v_accvgpr_read_b32 v191, a87
    v_pk_mul_f32 v[188:189], v[188:189], v[172:173] op_sel_hi:[1,0]
    v_pk_mul_f32 v[190:191], v[190:191], v[172:173] op_sel_hi:[1,0]
    v_cvt_pk_bf16_f32 v202, v188, v189
    v_cvt_pk_bf16_f32 v203, v190, v191
    v_accvgpr_read_b32 v184, a88
    v_accvgpr_read_b32 v185, a89
    v_accvgpr_read_b32 v186, a90
    v_accvgpr_read_b32 v187, a91
    v_pk_mul_f32 v[184:185], v[184:185], v[172:173] op_sel_hi:[1,0]
    v_pk_mul_f32 v[186:187], v[186:187], v[172:173] op_sel_hi:[1,0]
    v_cvt_pk_bf16_f32 v204, v184, v185
    v_cvt_pk_bf16_f32 v205, v186, v187
    v_accvgpr_read_b32 v188, a92
    v_accvgpr_read_b32 v189, a93
    v_accvgpr_read_b32 v190, a94
    v_accvgpr_read_b32 v191, a95
    v_pk_mul_f32 v[188:189], v[188:189], v[172:173] op_sel_hi:[1,0]
    v_pk_mul_f32 v[190:191], v[190:191], v[172:173] op_sel_hi:[1,0]
    v_cvt_pk_bf16_f32 v206, v188, v189
    v_cvt_pk_bf16_f32 v207, v190, v191
    ds_write_b64 v164, v[200:201] offset:8192
    ds_write_b64 v165, v[202:203] offset:8192
    ds_write_b64 v166, v[204:205] offset:8192
    ds_write_b64 v167, v[206:207] offset:8192
    v_accvgpr_read_b32 v184, a96
    v_accvgpr_read_b32 v185, a97
    v_accvgpr_read_b32 v186, a98
    v_accvgpr_read_b32 v187, a99
    v_pk_mul_f32 v[184:185], v[184:185], v[174:175] op_sel_hi:[1,0]
    v_pk_mul_f32 v[186:187], v[186:187], v[174:175] op_sel_hi:[1,0]
    v_cvt_pk_bf16_f32 v192, v184, v185
    v_cvt_pk_bf16_f32 v193, v186, v187
    v_accvgpr_read_b32 v188, a100
    v_accvgpr_read_b32 v189, a101
    v_accvgpr_read_b32 v190, a102
    v_accvgpr_read_b32 v191, a103
    v_pk_mul_f32 v[188:189], v[188:189], v[174:175] op_sel_hi:[1,0]
    v_pk_mul_f32 v[190:191], v[190:191], v[174:175] op_sel_hi:[1,0]
    v_cvt_pk_bf16_f32 v194, v188, v189
    v_cvt_pk_bf16_f32 v195, v190, v191
    v_accvgpr_read_b32 v184, a104
    v_accvgpr_read_b32 v185, a105
    v_accvgpr_read_b32 v186, a106
    v_accvgpr_read_b32 v187, a107
    v_pk_mul_f32 v[184:185], v[184:185], v[174:175] op_sel_hi:[1,0]
    v_pk_mul_f32 v[186:187], v[186:187], v[174:175] op_sel_hi:[1,0]
    v_cvt_pk_bf16_f32 v196, v184, v185
    v_cvt_pk_bf16_f32 v197, v186, v187
    v_accvgpr_read_b32 v188, a108
    v_accvgpr_read_b32 v189, a109
    v_accvgpr_read_b32 v190, a110
    v_accvgpr_read_b32 v191, a111
    v_pk_mul_f32 v[188:189], v[188:189], v[174:175] op_sel_hi:[1,0]
    v_pk_mul_f32 v[190:191], v[190:191], v[174:175] op_sel_hi:[1,0]
    v_cvt_pk_bf16_f32 v198, v188, v189
    v_cvt_pk_bf16_f32 v199, v190, v191
    ds_write_b64 v160, v[192:193] offset:12288
    ds_write_b64 v161, v[194:195] offset:12288
    ds_write_b64 v162, v[196:197] offset:12288
    ds_write_b64 v163, v[198:199] offset:12288
    v_accvgpr_read_b32 v184, a112
    v_accvgpr_read_b32 v185, a113
    v_accvgpr_read_b32 v186, a114
    v_accvgpr_read_b32 v187, a115
    v_pk_mul_f32 v[184:185], v[184:185], v[174:175] op_sel_hi:[1,0]
    v_pk_mul_f32 v[186:187], v[186:187], v[174:175] op_sel_hi:[1,0]
    v_cvt_pk_bf16_f32 v200, v184, v185
    v_cvt_pk_bf16_f32 v201, v186, v187
    v_accvgpr_read_b32 v188, a116
    v_accvgpr_read_b32 v189, a117
    v_accvgpr_read_b32 v190, a118
    v_accvgpr_read_b32 v191, a119
    v_pk_mul_f32 v[188:189], v[188:189], v[174:175] op_sel_hi:[1,0]
    v_pk_mul_f32 v[190:191], v[190:191], v[174:175] op_sel_hi:[1,0]
    v_cvt_pk_bf16_f32 v202, v188, v189
    v_cvt_pk_bf16_f32 v203, v190, v191
    v_accvgpr_read_b32 v184, a120
    v_accvgpr_read_b32 v185, a121
    v_accvgpr_read_b32 v186, a122
    v_accvgpr_read_b32 v187, a123
    v_pk_mul_f32 v[184:185], v[184:185], v[174:175] op_sel_hi:[1,0]
    v_pk_mul_f32 v[186:187], v[186:187], v[174:175] op_sel_hi:[1,0]
    v_cvt_pk_bf16_f32 v204, v184, v185
    v_cvt_pk_bf16_f32 v205, v186, v187
    v_accvgpr_read_b32 v188, a124
    v_accvgpr_read_b32 v189, a125
    v_accvgpr_read_b32 v190, a126
    v_accvgpr_read_b32 v191, a127
    v_pk_mul_f32 v[188:189], v[188:189], v[174:175] op_sel_hi:[1,0]
    v_pk_mul_f32 v[190:191], v[190:191], v[174:175] op_sel_hi:[1,0]
    v_cvt_pk_bf16_f32 v206, v188, v189
    v_cvt_pk_bf16_f32 v207, v190, v191
    ds_write_b64 v164, v[200:201] offset:12288
    ds_write_b64 v165, v[202:203] offset:12288
    ds_write_b64 v166, v[204:205] offset:12288
    ds_write_b64 v167, v[206:207] offset:12288
    ds_read_b128 a[128:131], v8 offset:16384
    ds_read_b128 a[132:135], v9 offset:16384
    ds_read_b128 a[136:139], v10 offset:16384
    ds_read_b128 a[140:143], v11 offset:16384
    ds_read_b128 a[144:147], v8 offset:20480
    ds_read_b128 a[148:151], v9 offset:20480
    ds_read_b128 a[152:155], v10 offset:20480
    ds_read_b128 a[156:159], v11 offset:20480
    s_mov_b32 s52, 0
    ds_read_b128 v[224:227], v32 offset:0
    s_mov_b32 s53, 4096
    s_mov_b32 s54, 8192
    s_mov_b32 s55, 12288
    s_waitcnt lgkmcnt(14)
    v_lshlrev_b32 v40, 16, v48
    v_and_b32 v41, s51, v48
    v_pk_mul_f32 v[40:41], v[40:41], s[46:47]
    v_cvt_pk_bf16_f32 v160, v40, v41
    v_lshlrev_b32 v42, 16, v49
    v_and_b32 v43, s51, v49
    v_pk_mul_f32 v[42:43], v[42:43], s[46:47]
    v_cvt_pk_bf16_f32 v161, v42, v43
    v_lshlrev_b32 v44, 16, v50
    s_waitcnt lgkmcnt(0)
    buffer_store_dwordx4 v[224:227], v34, s[28:31], s52 offen offset:0 sc0 sc1
    v_and_b32 v45, s51, v50
    v_pk_mul_f32 v[44:45], v[44:45], s[46:47]
    v_cvt_pk_bf16_f32 v162, v44, v45
    v_lshlrev_b32 v46, 16, v51
    v_and_b32 v47, s51, v51
    v_pk_mul_f32 v[46:47], v[46:47], s[46:47]
    v_cvt_pk_bf16_f32 v163, v46, v47
    s_waitcnt lgkmcnt(14)
    v_lshlrev_b32 v40, 16, v52
    ds_read_b128 v[228:231], v33 offset:1024
    v_and_b32 v41, s51, v52
    v_pk_mul_f32 v[40:41], v[40:41], s[46:47]
    v_cvt_pk_bf16_f32 v164, v40, v41
    v_lshlrev_b32 v42, 16, v53
    v_and_b32 v43, s51, v53
    v_pk_mul_f32 v[42:43], v[42:43], s[46:47]
    v_cvt_pk_bf16_f32 v165, v42, v43
    v_lshlrev_b32 v44, 16, v54
    v_and_b32 v45, s51, v54
    v_pk_mul_f32 v[44:45], v[44:45], s[46:47]
    v_cvt_pk_bf16_f32 v166, v44, v45
    v_lshlrev_b32 v46, 16, v55
    v_and_b32 v47, s51, v55
    v_pk_mul_f32 v[46:47], v[46:47], s[46:47]
    s_waitcnt lgkmcnt(0)
    buffer_store_dwordx4 v[228:231], v34, s[28:31], s52 offen offset:1024 sc0 sc1
    v_cvt_pk_bf16_f32 v167, v46, v47
    s_waitcnt lgkmcnt(14)
    v_lshlrev_b32 v40, 16, v56
    v_and_b32 v41, s51, v56
    v_pk_mul_f32 v[40:41], v[40:41], s[46:47]
    v_cvt_pk_bf16_f32 v168, v40, v41
    v_lshlrev_b32 v42, 16, v57
    v_and_b32 v43, s51, v57
    v_pk_mul_f32 v[42:43], v[42:43], s[46:47]
    v_cvt_pk_bf16_f32 v169, v42, v43
    ds_read_b128 v[232:235], v32 offset:2048
    v_lshlrev_b32 v44, 16, v58
    v_and_b32 v45, s51, v58
    v_pk_mul_f32 v[44:45], v[44:45], s[46:47]
    v_cvt_pk_bf16_f32 v170, v44, v45
    v_lshlrev_b32 v46, 16, v59
    v_and_b32 v47, s51, v59
    v_pk_mul_f32 v[46:47], v[46:47], s[46:47]
    v_cvt_pk_bf16_f32 v171, v46, v47
    s_waitcnt lgkmcnt(14)
    v_lshlrev_b32 v40, 16, v60
    v_and_b32 v41, s51, v60
    v_pk_mul_f32 v[40:41], v[40:41], s[46:47]
    v_cvt_pk_bf16_f32 v172, v40, v41
    v_lshlrev_b32 v42, 16, v61
    s_waitcnt lgkmcnt(0)
    buffer_store_dwordx4 v[232:235], v34, s[28:31], s52 offen offset:2048 sc0 sc1
    v_and_b32 v43, s51, v61
    v_pk_mul_f32 v[42:43], v[42:43], s[46:47]
    v_cvt_pk_bf16_f32 v173, v42, v43
    v_lshlrev_b32 v44, 16, v62
    v_and_b32 v45, s51, v62
    v_pk_mul_f32 v[44:45], v[44:45], s[46:47]
    v_cvt_pk_bf16_f32 v174, v44, v45
    v_lshlrev_b32 v46, 16, v63
    v_and_b32 v47, s51, v63
    v_pk_mul_f32 v[46:47], v[46:47], s[46:47]
    v_cvt_pk_bf16_f32 v175, v46, v47
    s_waitcnt lgkmcnt(3)
    s_waitcnt lgkmcnt(14)
    ds_read_b128 v[236:239], v33 offset:3072
    v_mfma_f32_16x16x32_bf16 v[48:51], a[128:131], v[160:163], 0
    v_lshlrev_b32 v40, 16, v64
    v_and_b32 v41, s51, v64
    v_pk_mul_f32 v[40:41], v[40:41], s[46:47]
    v_cvt_pk_bf16_f32 v176, v40, v41
    v_lshlrev_b32 v42, 16, v65
    v_and_b32 v43, s51, v65
    v_pk_mul_f32 v[42:43], v[42:43], s[46:47]
    v_cvt_pk_bf16_f32 v177, v42, v43
    v_mfma_f32_16x16x32_bf16 v[48:51], a[132:135], v[164:167], v[48:51]
    v_lshlrev_b32 v44, 16, v66
    v_and_b32 v45, s51, v66
    v_pk_mul_f32 v[44:45], v[44:45], s[46:47]
    v_cvt_pk_bf16_f32 v178, v44, v45
    s_waitcnt lgkmcnt(0)
    buffer_store_dwordx4 v[236:239], v34, s[28:31], s52 offen offset:3072 sc0 sc1
    v_lshlrev_b32 v46, 16, v67
    v_and_b32 v47, s51, v67
    v_pk_mul_f32 v[46:47], v[46:47], s[46:47]
    v_cvt_pk_bf16_f32 v179, v46, v47
    s_waitcnt lgkmcnt(14)
    v_mfma_f32_16x16x32_bf16 v[48:51], a[136:139], v[168:171], v[48:51]
    v_lshlrev_b32 v40, 16, v68
    v_and_b32 v41, s51, v68
    v_pk_mul_f32 v[40:41], v[40:41], s[46:47]
    ds_read_b128 v[224:227], v32 offset:4096
    v_cvt_pk_bf16_f32 v180, v40, v41
    v_lshlrev_b32 v42, 16, v69
    v_and_b32 v43, s51, v69
    v_pk_mul_f32 v[42:43], v[42:43], s[46:47]
    v_cvt_pk_bf16_f32 v181, v42, v43
    v_mfma_f32_16x16x32_bf16 v[48:51], a[140:143], v[172:175], v[48:51]
    v_lshlrev_b32 v44, 16, v70
    v_and_b32 v45, s51, v70
    v_pk_mul_f32 v[44:45], v[44:45], s[46:47]
    v_cvt_pk_bf16_f32 v182, v44, v45
    v_lshlrev_b32 v46, 16, v71
    v_and_b32 v47, s51, v71
    v_pk_mul_f32 v[46:47], v[46:47], s[46:47]
    v_cvt_pk_bf16_f32 v183, v46, v47
    s_waitcnt lgkmcnt(14)
    s_waitcnt lgkmcnt(0)
    buffer_store_dwordx4 v[224:227], v34, s[28:31], s53 offen offset:0 sc0 sc1
    v_mfma_f32_16x16x32_bf16 v[52:55], a[144:147], v[160:163], 0
    v_lshlrev_b32 v40, 16, v72
    v_and_b32 v41, s51, v72
    v_pk_mul_f32 v[40:41], v[40:41], s[46:47]
    v_cvt_pk_bf16_f32 v184, v40, v41
    v_lshlrev_b32 v42, 16, v73
    v_and_b32 v43, s51, v73
    v_pk_mul_f32 v[42:43], v[42:43], s[46:47]
    v_cvt_pk_bf16_f32 v185, v42, v43
    v_mfma_f32_16x16x32_bf16 v[52:55], a[148:151], v[164:167], v[52:55]
    v_lshlrev_b32 v44, 16, v74
    ds_read_b128 v[228:231], v33 offset:5120
    v_and_b32 v45, s51, v74
    v_pk_mul_f32 v[44:45], v[44:45], s[46:47]
    v_cvt_pk_bf16_f32 v186, v44, v45
    v_lshlrev_b32 v46, 16, v75
    v_and_b32 v47, s51, v75
    v_pk_mul_f32 v[46:47], v[46:47], s[46:47]
    v_cvt_pk_bf16_f32 v187, v46, v47
    s_waitcnt lgkmcnt(14)
    v_mfma_f32_16x16x32_bf16 v[52:55], a[152:155], v[168:171], v[52:55]
    v_lshlrev_b32 v40, 16, v76
    v_and_b32 v41, s51, v76
    v_pk_mul_f32 v[40:41], v[40:41], s[46:47]
    v_cvt_pk_bf16_f32 v188, v40, v41
    v_lshlrev_b32 v42, 16, v77
    v_and_b32 v43, s51, v77
    s_waitcnt lgkmcnt(0)
    buffer_store_dwordx4 v[228:231], v34, s[28:31], s53 offen offset:1024 sc0 sc1
    v_pk_mul_f32 v[42:43], v[42:43], s[46:47]
    v_cvt_pk_bf16_f32 v189, v42, v43
    v_mfma_f32_16x16x32_bf16 v[52:55], a[156:159], v[172:175], v[52:55]
    v_lshlrev_b32 v44, 16, v78
    v_and_b32 v45, s51, v78
    v_pk_mul_f32 v[44:45], v[44:45], s[46:47]
    v_cvt_pk_bf16_f32 v190, v44, v45
    v_lshlrev_b32 v46, 16, v79
    v_and_b32 v47, s51, v79
    v_pk_mul_f32 v[46:47], v[46:47], s[46:47]
    v_cvt_pk_bf16_f32 v191, v46, v47
    s_waitcnt lgkmcnt(14)
    ds_read_b128 v[232:235], v32 offset:6144
    v_mfma_f32_16x16x32_bf16 v[56:59], a[128:131], v[176:179], 0
    v_lshlrev_b32 v40, 16, v80
    v_and_b32 v41, s51, v80
    v_pk_mul_f32 v[40:41], v[40:41], s[46:47]
    v_cvt_pk_bf16_f32 v192, v40, v41
    v_lshlrev_b32 v42, 16, v81
    v_and_b32 v43, s51, v81
    v_pk_mul_f32 v[42:43], v[42:43], s[46:47]
    v_cvt_pk_bf16_f32 v193, v42, v43
    v_mfma_f32_16x16x32_bf16 v[56:59], a[132:135], v[180:183], v[56:59]
    v_lshlrev_b32 v44, 16, v82
    v_and_b32 v45, s51, v82
    v_pk_mul_f32 v[44:45], v[44:45], s[46:47]
    v_cvt_pk_bf16_f32 v194, v44, v45
    s_waitcnt lgkmcnt(0)
    buffer_store_dwordx4 v[232:235], v34, s[28:31], s53 offen offset:2048 sc0 sc1
    v_lshlrev_b32 v46, 16, v83
    v_and_b32 v47, s51, v83
    v_pk_mul_f32 v[46:47], v[46:47], s[46:47]
    v_cvt_pk_bf16_f32 v195, v46, v47
    s_waitcnt lgkmcnt(14)
    v_mfma_f32_16x16x32_bf16 v[56:59], a[136:139], v[184:187], v[56:59]
    v_lshlrev_b32 v40, 16, v84
    v_and_b32 v41, s51, v84
    v_pk_mul_f32 v[40:41], v[40:41], s[46:47]
    ds_read_b128 v[236:239], v33 offset:7168
    v_cvt_pk_bf16_f32 v196, v40, v41
    v_lshlrev_b32 v42, 16, v85
    v_and_b32 v43, s51, v85
    v_pk_mul_f32 v[42:43], v[42:43], s[46:47]
    v_cvt_pk_bf16_f32 v197, v42, v43
    v_mfma_f32_16x16x32_bf16 v[56:59], a[140:143], v[188:191], v[56:59]
    v_lshlrev_b32 v44, 16, v86
    v_and_b32 v45, s51, v86
    v_pk_mul_f32 v[44:45], v[44:45], s[46:47]
    v_cvt_pk_bf16_f32 v198, v44, v45
    v_lshlrev_b32 v46, 16, v87
    v_and_b32 v47, s51, v87
    v_pk_mul_f32 v[46:47], v[46:47], s[46:47]
    v_cvt_pk_bf16_f32 v199, v46, v47
    s_waitcnt lgkmcnt(14)
    s_waitcnt lgkmcnt(0)
    buffer_store_dwordx4 v[236:239], v34, s[28:31], s53 offen offset:3072 sc0 sc1
    v_mfma_f32_16x16x32_bf16 v[60:63], a[144:147], v[176:179], 0
    v_lshlrev_b32 v40, 16, v88
    v_and_b32 v41, s51, v88
    v_pk_mul_f32 v[40:41], v[40:41], s[46:47]
    v_cvt_pk_bf16_f32 v200, v40, v41
    v_lshlrev_b32 v42, 16, v89
    v_and_b32 v43, s51, v89
    v_pk_mul_f32 v[42:43], v[42:43], s[46:47]
    v_cvt_pk_bf16_f32 v201, v42, v43
    v_mfma_f32_16x16x32_bf16 v[60:63], a[148:151], v[180:183], v[60:63]
    v_lshlrev_b32 v44, 16, v90
    ds_read_b128 v[224:227], v32 offset:8192
    v_and_b32 v45, s51, v90
    v_pk_mul_f32 v[44:45], v[44:45], s[46:47]
    v_cvt_pk_bf16_f32 v202, v44, v45
    v_lshlrev_b32 v46, 16, v91
    v_and_b32 v47, s51, v91
    v_pk_mul_f32 v[46:47], v[46:47], s[46:47]
    v_cvt_pk_bf16_f32 v203, v46, v47
    s_waitcnt lgkmcnt(14)
    v_mfma_f32_16x16x32_bf16 v[60:63], a[152:155], v[184:187], v[60:63]
    v_lshlrev_b32 v40, 16, v92
    v_and_b32 v41, s51, v92
    v_pk_mul_f32 v[40:41], v[40:41], s[46:47]
    v_cvt_pk_bf16_f32 v204, v40, v41
    v_lshlrev_b32 v42, 16, v93
    v_and_b32 v43, s51, v93
    s_waitcnt lgkmcnt(0)
    buffer_store_dwordx4 v[224:227], v34, s[28:31], s54 offen offset:0 sc0 sc1
    v_pk_mul_f32 v[42:43], v[42:43], s[46:47]
    v_cvt_pk_bf16_f32 v205, v42, v43
    v_mfma_f32_16x16x32_bf16 v[60:63], a[156:159], v[188:191], v[60:63]
    v_lshlrev_b32 v44, 16, v94
    v_and_b32 v45, s51, v94
    v_pk_mul_f32 v[44:45], v[44:45], s[46:47]
    v_cvt_pk_bf16_f32 v206, v44, v45
    v_lshlrev_b32 v46, 16, v95
    v_and_b32 v47, s51, v95
    v_pk_mul_f32 v[46:47], v[46:47], s[46:47]
    v_cvt_pk_bf16_f32 v207, v46, v47
    s_waitcnt lgkmcnt(14)
    ds_read_b128 v[228:231], v33 offset:9216
    v_mfma_f32_16x16x32_bf16 v[64:67], a[128:131], v[192:195], 0
    v_lshlrev_b32 v40, 16, v96
    v_and_b32 v41, s51, v96
    v_pk_mul_f32 v[40:41], v[40:41], s[46:47]
    v_cvt_pk_bf16_f32 v208, v40, v41
    v_lshlrev_b32 v42, 16, v97
    v_and_b32 v43, s51, v97
    v_pk_mul_f32 v[42:43], v[42:43], s[46:47]
    v_cvt_pk_bf16_f32 v209, v42, v43
    v_mfma_f32_16x16x32_bf16 v[64:67], a[132:135], v[196:199], v[64:67]
    v_lshlrev_b32 v44, 16, v98
    v_and_b32 v45, s51, v98
    v_pk_mul_f32 v[44:45], v[44:45], s[46:47]
    v_cvt_pk_bf16_f32 v210, v44, v45
    s_waitcnt lgkmcnt(0)
    buffer_store_dwordx4 v[228:231], v34, s[28:31], s54 offen offset:1024 sc0 sc1
    v_lshlrev_b32 v46, 16, v99
    v_and_b32 v47, s51, v99
    v_pk_mul_f32 v[46:47], v[46:47], s[46:47]
    v_cvt_pk_bf16_f32 v211, v46, v47
    s_waitcnt lgkmcnt(14)
    v_mfma_f32_16x16x32_bf16 v[64:67], a[136:139], v[200:203], v[64:67]
    v_lshlrev_b32 v40, 16, v100
    v_and_b32 v41, s51, v100
    v_pk_mul_f32 v[40:41], v[40:41], s[46:47]
    ds_read_b128 v[232:235], v32 offset:10240
    v_cvt_pk_bf16_f32 v212, v40, v41
    v_lshlrev_b32 v42, 16, v101
    v_and_b32 v43, s51, v101
    v_pk_mul_f32 v[42:43], v[42:43], s[46:47]
    v_cvt_pk_bf16_f32 v213, v42, v43
    v_mfma_f32_16x16x32_bf16 v[64:67], a[140:143], v[204:207], v[64:67]
    v_lshlrev_b32 v44, 16, v102
    v_and_b32 v45, s51, v102
    v_pk_mul_f32 v[44:45], v[44:45], s[46:47]
    v_cvt_pk_bf16_f32 v214, v44, v45
    v_lshlrev_b32 v46, 16, v103
    v_and_b32 v47, s51, v103
    v_pk_mul_f32 v[46:47], v[46:47], s[46:47]
    v_cvt_pk_bf16_f32 v215, v46, v47
    s_waitcnt lgkmcnt(14)
    s_waitcnt lgkmcnt(0)
    buffer_store_dwordx4 v[232:235], v34, s[28:31], s54 offen offset:2048 sc0 sc1
    v_mfma_f32_16x16x32_bf16 v[68:71], a[144:147], v[192:195], 0
    v_lshlrev_b32 v40, 16, v104
    v_and_b32 v41, s51, v104
    v_pk_mul_f32 v[40:41], v[40:41], s[46:47]
    v_cvt_pk_bf16_f32 v216, v40, v41
    v_lshlrev_b32 v42, 16, v105
    v_and_b32 v43, s51, v105
    v_pk_mul_f32 v[42:43], v[42:43], s[46:47]
    v_cvt_pk_bf16_f32 v217, v42, v43
    v_mfma_f32_16x16x32_bf16 v[68:71], a[148:151], v[196:199], v[68:71]
    v_lshlrev_b32 v44, 16, v106
    ds_read_b128 v[236:239], v33 offset:11264
    v_and_b32 v45, s51, v106
    v_pk_mul_f32 v[44:45], v[44:45], s[46:47]
    v_cvt_pk_bf16_f32 v218, v44, v45
    v_lshlrev_b32 v46, 16, v107
    v_and_b32 v47, s51, v107
    v_pk_mul_f32 v[46:47], v[46:47], s[46:47]
    v_cvt_pk_bf16_f32 v219, v46, v47
    s_waitcnt lgkmcnt(14)
    v_mfma_f32_16x16x32_bf16 v[68:71], a[152:155], v[200:203], v[68:71]
    v_lshlrev_b32 v40, 16, v108
    v_and_b32 v41, s51, v108
    v_pk_mul_f32 v[40:41], v[40:41], s[46:47]
    v_cvt_pk_bf16_f32 v220, v40, v41
    v_lshlrev_b32 v42, 16, v109
    v_and_b32 v43, s51, v109
    s_waitcnt lgkmcnt(0)
    buffer_store_dwordx4 v[236:239], v34, s[28:31], s54 offen offset:3072 sc0 sc1
    v_pk_mul_f32 v[42:43], v[42:43], s[46:47]
    v_cvt_pk_bf16_f32 v221, v42, v43
    v_mfma_f32_16x16x32_bf16 v[68:71], a[156:159], v[204:207], v[68:71]
    v_lshlrev_b32 v44, 16, v110
    v_and_b32 v45, s51, v110
    v_pk_mul_f32 v[44:45], v[44:45], s[46:47]
    v_cvt_pk_bf16_f32 v222, v44, v45
    v_lshlrev_b32 v46, 16, v111
    v_and_b32 v47, s51, v111
    v_pk_mul_f32 v[46:47], v[46:47], s[46:47]
    v_cvt_pk_bf16_f32 v223, v46, v47
    s_nop 1
    v_mfma_f32_16x16x32_bf16 v[72:75], a[128:131], v[208:211], 0
    v_mov_b32 v244, 0
    v_mov_b32 v245, 0
    v_mfma_f32_16x16x32_bf16 v[72:75], a[132:135], v[212:215], v[72:75]
    v_mov_b32 v246, 0
    v_mov_b32 v247, 0
    v_mfma_f32_16x16x32_bf16 v[72:75], a[136:139], v[216:219], v[72:75]
    v_max3_f32 v240, v48, v49, v50
    v_max3_f32 v240, v240, v51, v52
    v_mfma_f32_16x16x32_bf16 v[72:75], a[140:143], v[220:223], v[72:75]
    ds_read_b128 a[128:131], v8 offset:24576
    ds_read_b128 a[132:135], v9 offset:24576
    ds_read_b128 a[136:139], v10 offset:24576
    ds_read_b128 a[140:143], v11 offset:24576
    v_max3_f32 v240, v240, v53, v54
    v_max_f32 v240, v240, v55
    v_mfma_f32_16x16x32_bf16 v[76:79], a[144:147], v[208:211], 0
    v_max3_f32 v241, v56, v57, v58
    v_max3_f32 v241, v241, v59, v60
    v_mfma_f32_16x16x32_bf16 v[76:79], a[148:151], v[212:215], v[76:79]
    v_max3_f32 v241, v241, v61, v62
    v_max_f32 v241, v241, v63
    v_mfma_f32_16x16x32_bf16 v[76:79], a[152:155], v[216:219], v[76:79]
    v_max3_f32 v242, v64, v65, v66
    v_max3_f32 v242, v242, v67, v68
    v_mfma_f32_16x16x32_bf16 v[76:79], a[156:159], v[220:223], v[76:79]
    v_max3_f32 v242, v242, v69, v70
    v_max_f32 v242, v242, v71
    s_nop 5
    v_max3_f32 v243, v72, v73, v74
    v_max3_f32 v243, v243, v75, v76
    v_max3_f32 v243, v243, v77, v78
    v_max_f32 v243, v243, v79
    v_mov_b32 v40, v240
    v_mov_b32 v41, v241
    v_mov_b32 v42, v242
    v_mov_b32 v43, v243
    v_permlane16_swap_b32 v40, v240
    v_permlane16_swap_b32 v41, v241
    v_permlane16_swap_b32 v42, v242
    v_permlane16_swap_b32 v43, v243
    v_max_f32 v240, v240, v40
    v_max_f32 v241, v241, v41
    v_max_f32 v242, v242, v42
    v_max_f32 v243, v243, v43
    v_mov_b32 v40, v240
    v_mov_b32 v41, v241
    v_mov_b32 v42, v242
    v_mov_b32 v43, v243
    v_permlane32_swap_b32 v40, v240
    v_permlane32_swap_b32 v41, v241
    v_permlane32_swap_b32 v42, v242
    v_permlane32_swap_b32 v43, v243
    v_max_f32 v240, v240, v40
    v_max_f32 v241, v241, v41
    v_max_f32 v242, v242, v42
    v_max_f32 v243, v243, v43
    v_sub_f32 v144, 0, v240
    v_sub_f32 v145, 0, v240
    v_sub_f32 v148, 0, v241
    v_sub_f32 v149, 0, v241
    v_sub_f32 v152, 0, v242
    v_sub_f32 v153, 0, v242
    v_sub_f32 v156, 0, v243
    v_sub_f32 v157, 0, v243
    v_pk_mov_b32 v[146:147], v[144:145], v[144:145] op_sel:[0,1]
    v_pk_add_f32 v[48:49], v[48:49], v[144:145]
    v_pk_add_f32 v[50:51], v[50:51], v[144:145]
    v_pk_add_f32 v[52:53], v[52:53], v[144:145]
    v_pk_add_f32 v[54:55], v[54:55], v[144:145]
    v_pk_mov_b32 v[150:151], v[148:149], v[148:149] op_sel:[0,1]
    v_pk_add_f32 v[56:57], v[56:57], v[148:149]
    v_pk_add_f32 v[58:59], v[58:59], v[148:149]
    v_pk_add_f32 v[60:61], v[60:61], v[148:149]
    v_pk_add_f32 v[62:63], v[62:63], v[148:149]
    v_pk_mov_b32 v[154:155], v[152:153], v[152:153] op_sel:[0,1]
    v_pk_add_f32 v[64:65], v[64:65], v[152:153]
    v_pk_add_f32 v[66:67], v[66:67], v[152:153]
    v_pk_add_f32 v[68:69], v[68:69], v[152:153]
    v_pk_add_f32 v[70:71], v[70:71], v[152:153]
    v_pk_mov_b32 v[158:159], v[156:157], v[156:157] op_sel:[0,1]
    v_pk_add_f32 v[72:73], v[72:73], v[156:157]
    v_pk_add_f32 v[74:75], v[74:75], v[156:157]
    v_pk_add_f32 v[76:77], v[76:77], v[156:157]
    v_pk_add_f32 v[78:79], v[78:79], v[156:157]
    s_waitcnt lgkmcnt(0)
    v_mfma_f32_16x16x32_bf16 v[80:83], a[128:131], v[160:163], v[144:147]
    ds_read_b128 a[144:147], v8 offset:28672
    v_exp_f32 v40, v48
    v_exp_f32 v41, v49
    v_mfma_f32_16x16x32_bf16 v[80:83], a[132:135], v[164:167], v[80:83]
    ds_read_b128 a[148:151], v9 offset:28672
    ds_read_b128 v[224:227], v32 offset:12288
    v_exp_f32 v42, v50
    v_mfma_f32_16x16x32_bf16 v[80:83], a[136:139], v[168:171], v[80:83]
    v_exp_f32 v43, v51
    v_add_f32 v248, v40, v41
    v_cvt_pk_bf16_f32 v112, v40, v41
    v_mfma_f32_16x16x32_bf16 v[80:83], a[140:143], v[172:175], v[80:83]
    v_exp_f32 v44, v52
    v_exp_f32 v45, v53
    v_add_f32 v248, v248, v42
    v_mfma_f32_16x16x32_bf16 v[88:91], a[128:131], v[176:179], v[148:151]
    ds_read_b128 a[152:155], v10 offset:28672
    v_add_f32 v248, v248, v43
    v_cvt_pk_bf16_f32 v113, v42, v43
    v_exp_f32 v46, v54
    v_mfma_f32_16x16x32_bf16 v[88:91], a[132:135], v[180:183], v[88:91]
    ds_read_b128 a[156:159], v11 offset:28672
    v_exp_f32 v47, v55
    v_add_f32 v248, v248, v44
    v_mfma_f32_16x16x32_bf16 v[88:91], a[136:139], v[184:187], v[88:91]
    v_add_f32 v248, v248, v45
    v_cvt_pk_bf16_f32 v114, v44, v45
    v_exp_f32 v40, v56
    v_mfma_f32_16x16x32_bf16 v[88:91], a[140:143], v[188:191], v[88:91]
    s_waitcnt lgkmcnt(2)
    buffer_store_dwordx4 v[224:227], v34, s[28:31], s55 offen offset:0 sc0 sc1
    ds_read_b128 v[228:231], v33 offset:13312
    v_exp_f32 v41, v57
    v_mfma_f32_16x16x32_bf16 v[96:99], a[128:131], v[192:195], v[152:155]
    v_add_f32 v248, v248, v46
    v_add_f32 v248, v248, v47
    v_cvt_pk_bf16_f32 v115, v46, v47
    v_exp_f32 v42, v58
    v_mfma_f32_16x16x32_bf16 v[96:99], a[132:135], v[196:199], v[96:99]
    v_exp_f32 v43, v59
    v_add_f32 v249, v40, v41
    v_cvt_pk_bf16_f32 v116, v40, v41
    v_mfma_f32_16x16x32_bf16 v[96:99], a[136:139], v[200:203], v[96:99]
    v_exp_f32 v44, v60
    v_exp_f32 v45, v61
    v_mfma_f32_16x16x32_bf16 v[96:99], a[140:143], v[204:207], v[96:99]
    v_add_f32 v249, v249, v42
    v_add_f32 v249, v249, v43
    v_cvt_pk_bf16_f32 v117, v42, v43
    v_exp_f32 v46, v62
    v_mfma_f32_16x16x32_bf16 v[104:107], a[128:131], v[208:211], v[156:159]
    v_exp_f32 v47, v63
    v_add_f32 v249, v249, v44
    v_add_f32 v249, v249, v45
    v_mfma_f32_16x16x32_bf16 v[104:107], a[132:135], v[212:215], v[104:107]
    s_waitcnt lgkmcnt(0)
    buffer_store_dwordx4 v[228:231], v34, s[28:31], s55 offen offset:1024 sc0 sc1
    ds_read_b128 v[232:235], v32 offset:14336
    v_cvt_pk_bf16_f32 v118, v44, v45
    v_mfma_f32_16x16x32_bf16 v[104:107], a[136:139], v[216:219], v[104:107]
    v_exp_f32 v40, v64
    v_exp_f32 v41, v65
    v_mfma_f32_16x16x32_bf16 v[104:107], a[140:143], v[220:223], v[104:107]
    v_add_f32 v249, v249, v46
    v_add_f32 v249, v249, v47
    v_cvt_pk_bf16_f32 v119, v46, v47
    s_waitcnt lgkmcnt(2)
    v_mfma_f32_16x16x32_bf16 v[84:87], a[144:147], v[160:163], v[144:147]
    v_exp_f32 v42, v66
    v_exp_f32 v43, v67
    v_mfma_f32_16x16x32_bf16 v[84:87], a[148:151], v[164:167], v[84:87]
    v_add_f32 v250, v40, v41
    v_cvt_pk_bf16_f32 v120, v40, v41
    v_exp_f32 v44, v68
    v_mfma_f32_16x16x32_bf16 v[84:87], a[152:155], v[168:171], v[84:87]
    v_exp_f32 v45, v69
    v_add_f32 v250, v250, v42
    v_add_f32 v250, v250, v43
    v_cvt_pk_bf16_f32 v121, v42, v43
    v_mfma_f32_16x16x32_bf16 v[84:87], a[156:159], v[172:175], v[84:87]
    s_waitcnt lgkmcnt(0)
    buffer_store_dwordx4 v[232:235], v34, s[28:31], s55 offen offset:2048 sc0 sc1
    ds_read_b128 v[236:239], v33 offset:15360
    v_exp_f32 v46, v70
    v_mfma_f32_16x16x32_bf16 v[92:95], a[144:147], v[176:179], v[148:151]
    v_exp_f32 v47, v71
    v_add_f32 v250, v250, v44
    v_add_f32 v250, v250, v45
    v_mfma_f32_16x16x32_bf16 v[92:95], a[148:151], v[180:183], v[92:95]
    v_cvt_pk_bf16_f32 v122, v44, v45
    v_exp_f32 v40, v72
    v_exp_f32 v41, v73
    v_mfma_f32_16x16x32_bf16 v[92:95], a[152:155], v[184:187], v[92:95]
    v_add_f32 v250, v250, v46
    v_add_f32 v250, v250, v47
    v_cvt_pk_bf16_f32 v123, v46, v47
    v_exp_f32 v42, v74
    v_mfma_f32_16x16x32_bf16 v[92:95], a[156:159], v[188:191], v[92:95]
    v_exp_f32 v43, v75
    v_add_f32 v251, v40, v41
    s_waitcnt vmcnt(27)
    s_barrier
    v_mfma_f32_16x16x32_bf16 v[100:103], a[144:147], v[192:195], v[152:155]
    ds_read_b128 a[128:131], v8 offset:32768
    ds_read_b128 a[132:135], v9 offset:32768
    v_cvt_pk_bf16_f32 v124, v40, v41
    v_exp_f32 v44, v76
    v_mfma_f32_16x16x32_bf16 v[100:103], a[148:151], v[196:199], v[100:103]
    ds_read_b128 a[136:139], v10 offset:32768
    ds_read_b128 a[140:143], v11 offset:32768
    s_waitcnt lgkmcnt(4)
    buffer_store_dwordx4 v[236:239], v34, s[28:31], s55 offen offset:3072 sc0 sc1
    v_mfma_f32_16x16x32_bf16 v[100:103], a[152:155], v[200:203], v[100:103]
    ds_read_b64_tr_b16 a[160:161], v16 offset:16384
    v_exp_f32 v45, v77
    v_add_f32 v251, v251, v42
    v_mfma_f32_16x16x32_bf16 v[100:103], a[156:159], v[204:207], v[100:103]
    ds_read_b64_tr_b16 a[162:163], v16 offset:20480
    v_add_f32 v251, v251, v43
    v_cvt_pk_bf16_f32 v125, v42, v43
    v_exp_f32 v46, v78
    v_mfma_f32_16x16x32_bf16 v[108:111], a[144:147], v[208:211], v[156:159]
    ds_read_b64_tr_b16 a[164:165], v17 offset:16384
    v_exp_f32 v47, v79
    v_add_f32 v251, v251, v44
    v_mfma_f32_16x16x32_bf16 v[108:111], a[148:151], v[212:215], v[108:111]
    ds_read_b64_tr_b16 a[166:167], v17 offset:20480
    v_add_f32 v251, v251, v45
    v_cvt_pk_bf16_f32 v126, v44, v45
    v_add_f32 v251, v251, v46
    v_add_f32 v251, v251, v47
    v_mfma_f32_16x16x32_bf16 v[108:111], a[152:155], v[216:219], v[108:111]
    ds_read_b64_tr_b16 a[168:169], v18 offset:16384
    v_cvt_pk_bf16_f32 v127, v46, v47
    v_max3_f32 v35, v248, v249, v250
    v_max_f32 v35, v35, v251
    v_cmp_lt_f32 vcc, s40, v35
    v_mfma_f32_16x16x32_bf16 v[108:111], a[156:159], v[220:223], v[108:111]
    ds_read_b64_tr_b16 a[170:171], v18 offset:20480
    s_cbranch_vccnz L_rare_h1s0
L_ret_h1s0:
    s_waitcnt lgkmcnt(2)
    s_cmp_ge_u32 s38, 2
    s_cbranch_scc1 L_even1
    v_mfma_f32_16x16x32_bf16 v[48:51], a[128:131], v[160:163], v[144:147]
    ds_read_b128 a[144:147], v8 offset:36864
    v_add_f32 v244, v244, v248
    v_mfma_f32_16x16x32_bf16 v[48:51], a[132:135], v[164:167], v[48:51]
    v_add_f32 v245, v245, v249
    v_add_f32 v246, v246, v250
    v_mfma_f32_16x16x32_bf16 v[48:51], a[136:139], v[168:171], v[48:51]
    ds_read_b128 a[148:151], v9 offset:36864
    v_add_f32 v247, v247, v251
    v_mfma_f32_16x16x32_bf16 v[48:51], a[140:143], v[172:175], v[48:51]
    v_exp_f32 v40, v80
    v_mfma_f32_16x16x32_bf16 a[0:3], a[160:163], v[112:115], 0
    ds_read_b64_tr_b16 a[172:173], v19 offset:16384
    v_exp_f32 v41, v81
    v_mfma_f32_16x16x32_bf16 a[32:35], a[160:163], v[116:119], 0
    ds_read_b64_tr_b16 a[174:175], v19 offset:20480
    v_exp_f32 v42, v82
    v_mfma_f32_16x16x32_bf16 a[64:67], a[160:163], v[120:123], 0
    v_exp_f32 v43, v83
    v_mfma_f32_16x16x32_bf16 a[96:99], a[160:163], v[124:127], 0
    v_add_f32 v4, v40, v41
    v_cvt_pk_bf16_f32 v128, v40, v41
    v_mfma_f32_16x16x32_bf16 v[56:59], a[128:131], v[176:179], v[148:151]
    ds_read_b128 a[152:155], v10 offset:36864
    v_exp_f32 v44, v84
    v_mfma_f32_16x16x32_bf16 v[56:59], a[132:135], v[180:183], v[56:59]
    v_exp_f32 v45, v85
    v_mfma_f32_16x16x32_bf16 v[56:59], a[136:139], v[184:187], v[56:59]
    ds_read_b128 a[156:159], v11 offset:36864
    v_add_f32 v4, v4, v42
    v_mfma_f32_16x16x32_bf16 v[56:59], a[140:143], v[188:191], v[56:59]
    v_add_f32 v4, v4, v43
    v_cvt_pk_bf16_f32 v129, v42, v43
    v_mfma_f32_16x16x32_bf16 a[4:7], a[164:167], v[112:115], 0
    ds_read_b64_tr_b16 a[176:177], v20 offset:16384
    v_exp_f32 v46, v86
    v_mfma_f32_16x16x32_bf16 a[36:39], a[164:167], v[116:119], 0
    ds_read_b64_tr_b16 a[178:179], v20 offset:20480
    v_exp_f32 v47, v87
    v_mfma_f32_16x16x32_bf16 a[68:71], a[164:167], v[120:123], 0
    v_add_f32 v4, v4, v44
    v_add_f32 v4, v4, v45
    v_mfma_f32_16x16x32_bf16 a[100:103], a[164:167], v[124:127], 0
    v_cvt_pk_bf16_f32 v130, v44, v45
    s_waitcnt lgkmcnt(4)
    v_mfma_f32_16x16x32_bf16 v[64:67], a[128:131], v[192:195], v[152:155]
    v_exp_f32 v40, v88
    v_mfma_f32_16x16x32_bf16 v[64:67], a[132:135], v[196:199], v[64:67]
    v_exp_f32 v41, v89
    s_add_u32 m0, s35, 16384
    v_mfma_f32_16x16x32_bf16 v[64:67], a[136:139], v[200:203], v[64:67]
    buffer_load_dwordx4 v24, s[20:23], s37 offen offset:0 nt lds
    v_add_f32 v4, v4, v46
    v_mfma_f32_16x16x32_bf16 v[64:67], a[140:143], v[204:207], v[64:67]
    v_add_f32 v4, v4, v47
    v_cvt_pk_bf16_f32 v131, v46, v47
    v_mfma_f32_16x16x32_bf16 a[8:11], a[168:171], v[112:115], 0
    ds_read_b64_tr_b16 a[180:181], v21 offset:16384
    v_exp_f32 v42, v90
    v_mfma_f32_16x16x32_bf16 a[40:43], a[168:171], v[116:119], 0
    ds_read_b64_tr_b16 a[182:183], v21 offset:20480
    v_exp_f32 v43, v91
    v_mfma_f32_16x16x32_bf16 a[72:75], a[168:171], v[120:123], 0
    v_add_f32 v5, v40, v41
    v_cvt_pk_bf16_f32 v132, v40, v41
    v_mfma_f32_16x16x32_bf16 a[104:107], a[168:171], v[124:127], 0
    v_exp_f32 v44, v92
    v_mfma_f32_16x16x32_bf16 v[72:75], a[128:131], v[208:211], v[156:159]
    v_exp_f32 v45, v93
    v_mfma_f32_16x16x32_bf16 v[72:75], a[132:135], v[212:215], v[72:75]
    v_add_f32 v5, v5, v42
    v_add_f32 v5, v5, v43
    v_mfma_f32_16x16x32_bf16 v[72:75], a[136:139], v[216:219], v[72:75]
    buffer_load_dwordx4 v25, s[20:23], s37 offen offset:1024 nt lds
    s_add_u32 m0, s36, 0
    v_mfma_f32_16x16x32_bf16 v[72:75], a[140:143], v[220:223], v[72:75]
    v_cvt_pk_bf16_f32 v133, v42, v43
    s_add_u32 s37, s37, 2048
    v_mfma_f32_16x16x32_bf16 a[12:15], a[172:175], v[112:115], 0
    ds_read_b64_tr_b16 a[184:185], v22 offset:16384
    v_exp_f32 v46, v94
    v_mfma_f32_16x16x32_bf16 a[44:47], a[172:175], v[116:119], 0
    ds_read_b64_tr_b16 a[186:187], v22 offset:20480
    v_exp_f32 v47, v95
    v_mfma_f32_16x16x32_bf16 a[76:79], a[172:175], v[120:123], 0
    v_add_f32 v5, v5, v44
    v_add_f32 v5, v5, v45
    v_mfma_f32_16x16x32_bf16 a[108:111], a[172:175], v[124:127], 0
    v_cvt_pk_bf16_f32 v134, v44, v45
    s_waitcnt lgkmcnt(2)
    v_mfma_f32_16x16x32_bf16 v[52:55], a[144:147], v[160:163], v[144:147]
    v_exp_f32 v40, v96
    v_mfma_f32_16x16x32_bf16 v[52:55], a[148:151], v[164:167], v[52:55]
    v_exp_f32 v41, v97
    v_mfma_f32_16x16x32_bf16 v[52:55], a[152:155], v[168:171], v[52:55]
    buffer_load_dwordx4 v26, s[24:27], s41 offen offset:0 nt lds
    v_add_f32 v5, v5, v46
    v_mfma_f32_16x16x32_bf16 v[52:55], a[156:159], v[172:175], v[52:55]
    v_add_f32 v5, v5, v47
    v_cvt_pk_bf16_f32 v135, v46, v47
    v_mfma_f32_16x16x32_bf16 a[16:19], a[176:179], v[112:115], 0
    ds_read_b64_tr_b16 a[188:189], v23 offset:16384
    v_exp_f32 v42, v98
    v_mfma_f32_16x16x32_bf16 a[48:51], a[176:179], v[116:119], 0
    ds_read_b64_tr_b16 a[190:191], v23 offset:20480
    v_exp_f32 v43, v99
    v_mfma_f32_16x16x32_bf16 a[80:83], a[176:179], v[120:123], 0
    v_add_f32 v6, v40, v41
    v_cvt_pk_bf16_f32 v136, v40, v41
    v_mfma_f32_16x16x32_bf16 a[112:115], a[176:179], v[124:127], 0
    v_exp_f32 v44, v100
    v_mfma_f32_16x16x32_bf16 v[60:63], a[144:147], v[176:179], v[148:151]
    v_exp_f32 v45, v101
    v_mfma_f32_16x16x32_bf16 v[60:63], a[148:151], v[180:183], v[60:63]
    v_add_f32 v6, v6, v42
    v_add_f32 v6, v6, v43
    v_mfma_f32_16x16x32_bf16 v[60:63], a[152:155], v[184:187], v[60:63]
    buffer_load_dwordx4 v27, s[24:27], s41 offen offset:1024 nt lds
    s_add_u32 s41, s41, 2048
    v_mfma_f32_16x16x32_bf16 v[60:63], a[156:159], v[188:191], v[60:63]
    v_cvt_pk_bf16_f32 v137, v42, v43
    v_exp_f32 v46, v102
    v_mfma_f32_16x16x32_bf16 a[20:23], a[180:183], v[112:115], 0
    v_exp_f32 v47, v103
    v_mfma_f32_16x16x32_bf16 a[52:55], a[180:183], v[116:119], 0
    v_add_f32 v6, v6, v44
    v_add_f32 v6, v6, v45
    v_mfma_f32_16x16x32_bf16 a[84:87], a[180:183], v[120:123], 0
    v_cvt_pk_bf16_f32 v138, v44, v45
    v_exp_f32 v40, v104
    v_mfma_f32_16x16x32_bf16 a[116:119], a[180:183], v[124:127], 0
    s_waitcnt vmcnt(24) lgkmcnt(0)
    s_barrier
    v_mfma_f32_16x16x32_bf16 v[68:71], a[144:147], v[192:195], v[152:155]
    ds_read_b128 a[128:131], v8 offset:40960
    v_exp_f32 v41, v105
    v_mfma_f32_16x16x32_bf16 v[68:71], a[148:151], v[196:199], v[68:71]
    ds_read_b128 a[132:135], v9 offset:40960
    v_add_f32 v6, v6, v46
    v_mfma_f32_16x16x32_bf16 v[68:71], a[152:155], v[200:203], v[68:71]
    ds_read_b128 a[136:139], v10 offset:40960
    v_add_f32 v6, v6, v47
    v_cvt_pk_bf16_f32 v139, v46, v47
    v_mfma_f32_16x16x32_bf16 v[68:71], a[156:159], v[204:207], v[68:71]
    ds_read_b128 a[140:143], v11 offset:40960
    v_exp_f32 v42, v106
    v_mfma_f32_16x16x32_bf16 a[24:27], a[184:187], v[112:115], 0
    ds_read_b64_tr_b16 a[160:161], v16 offset:24576
    v_exp_f32 v43, v107
    v_mfma_f32_16x16x32_bf16 a[56:59], a[184:187], v[116:119], 0
    ds_read_b64_tr_b16 a[162:163], v16 offset:28672
    v_add_f32 v7, v40, v41
    v_mfma_f32_16x16x32_bf16 a[88:91], a[184:187], v[120:123], 0
    v_cvt_pk_bf16_f32 v140, v40, v41
    v_exp_f32 v44, v108
    v_mfma_f32_16x16x32_bf16 a[120:123], a[184:187], v[124:127], 0
    v_exp_f32 v45, v109
    v_add_f32 v7, v7, v42
    v_mfma_f32_16x16x32_bf16 v[76:79], a[144:147], v[208:211], v[156:159]
    ds_read_b64_tr_b16 a[164:165], v17 offset:24576
    v_add_f32 v7, v7, v43
    v_cvt_pk_bf16_f32 v141, v42, v43
    v_mfma_f32_16x16x32_bf16 v[76:79], a[148:151], v[212:215], v[76:79]
    ds_read_b64_tr_b16 a[166:167], v17 offset:28672
    v_exp_f32 v46, v110
    v_mfma_f32_16x16x32_bf16 v[76:79], a[152:155], v[216:219], v[76:79]
    v_exp_f32 v47, v111
    v_mfma_f32_16x16x32_bf16 v[76:79], a[156:159], v[220:223], v[76:79]
    v_add_f32 v7, v7, v44
    v_add_f32 v7, v7, v45
    v_mfma_f32_16x16x32_bf16 a[28:31], a[188:191], v[112:115], 0
    ds_read_b64_tr_b16 a[168:169], v18 offset:24576
    v_cvt_pk_bf16_f32 v142, v44, v45
    v_add_f32 v7, v7, v46
    v_mfma_f32_16x16x32_bf16 a[60:63], a[188:191], v[116:119], 0
    ds_read_b64_tr_b16 a[170:171], v18 offset:28672
    v_add_f32 v7, v7, v47
    v_cvt_pk_bf16_f32 v143, v46, v47
    v_mfma_f32_16x16x32_bf16 a[92:95], a[188:191], v[120:123], 0
    v_max3_f32 v35, v4, v5, v6
    v_max_f32 v35, v35, v7
    v_cmp_lt_f32 vcc, s40, v35
    v_mfma_f32_16x16x32_bf16 a[124:127], a[188:191], v[124:127], 0
    s_cbranch_vccnz L_rare_h1p1
L_ret_h1p1:
    s_waitcnt lgkmcnt(2)
    v_mfma_f32_16x16x32_bf16 v[80:83], a[128:131], v[160:163], v[144:147]
    ds_read_b128 a[144:147], v8 offset:45056
    v_add_f32 v244, v244, v4
    v_mfma_f32_16x16x32_bf16 v[80:83], a[132:135], v[164:167], v[80:83]
    v_add_f32 v245, v245, v5
    v_add_f32 v246, v246, v6
    v_mfma_f32_16x16x32_bf16 v[80:83], a[136:139], v[168:171], v[80:83]
    ds_read_b128 a[148:151], v9 offset:45056
    v_add_f32 v247, v247, v7
    v_mfma_f32_16x16x32_bf16 v[80:83], a[140:143], v[172:175], v[80:83]
    v_exp_f32 v40, v48
    v_mfma_f32_16x16x32_bf16 a[0:3], a[160:163], v[128:131], a[0:3]
    ds_read_b64_tr_b16 a[172:173], v19 offset:24576
    v_exp_f32 v41, v49
    v_mfma_f32_16x16x32_bf16 a[32:35], a[160:163], v[132:135], a[32:35]
    ds_read_b64_tr_b16 a[174:175], v19 offset:28672
    v_exp_f32 v42, v50
    v_mfma_f32_16x16x32_bf16 a[64:67], a[160:163], v[136:139], a[64:67]
    v_exp_f32 v43, v51
    v_mfma_f32_16x16x32_bf16 a[96:99], a[160:163], v[140:143], a[96:99]
    v_add_f32 v248, v40, v41
    v_cvt_pk_bf16_f32 v112, v40, v41
    v_mfma_f32_16x16x32_bf16 v[88:91], a[128:131], v[176:179], v[148:151]
    ds_read_b128 a[152:155], v10 offset:45056
    v_exp_f32 v44, v52
    v_mfma_f32_16x16x32_bf16 v[88:91], a[132:135], v[180:183], v[88:91]
    v_exp_f32 v45, v53
    v_mfma_f32_16x16x32_bf16 v[88:91], a[136:139], v[184:187], v[88:91]
    ds_read_b128 a[156:159], v11 offset:45056
    v_add_f32 v248, v248, v42
    v_mfma_f32_16x16x32_bf16 v[88:91], a[140:143], v[188:191], v[88:91]
    v_add_f32 v248, v248, v43
    v_cvt_pk_bf16_f32 v113, v42, v43
    v_mfma_f32_16x16x32_bf16 a[4:7], a[164:167], v[128:131], a[4:7]
    ds_read_b64_tr_b16 a[176:177], v20 offset:24576
    v_exp_f32 v46, v54
    v_mfma_f32_16x16x32_bf16 a[36:39], a[164:167], v[132:135], a[36:39]
    ds_read_b64_tr_b16 a[178:179], v20 offset:28672
    v_exp_f32 v47, v55
    v_mfma_f32_16x16x32_bf16 a[68:71], a[164:167], v[136:139], a[68:71]
    v_add_f32 v248, v248, v44
    v_add_f32 v248, v248, v45
    v_mfma_f32_16x16x32_bf16 a[100:103], a[164:167], v[140:143], a[100:103]
    v_cvt_pk_bf16_f32 v114, v44, v45
    s_waitcnt lgkmcnt(4)
    v_mfma_f32_16x16x32_bf16 v[96:99], a[128:131], v[192:195], v[152:155]
    v_exp_f32 v40, v56
    v_mfma_f32_16x16x32_bf16 v[96:99], a[132:135], v[196:199], v[96:99]
    v_exp_f32 v41, v57
    s_add_u32 m0, s35, 24576
    v_mfma_f32_16x16x32_bf16 v[96:99], a[136:139], v[200:203], v[96:99]
    buffer_load_dwordx4 v24, s[20:23], s37 offen offset:0 nt lds
    v_add_f32 v248, v248, v46
    v_mfma_f32_16x16x32_bf16 v[96:99], a[140:143], v[204:207], v[96:99]
    v_add_f32 v248, v248, v47
    v_cvt_pk_bf16_f32 v115, v46, v47
    v_mfma_f32_16x16x32_bf16 a[8:11], a[168:171], v[128:131], a[8:11]
    ds_read_b64_tr_b16 a[180:181], v21 offset:24576
    v_exp_f32 v42, v58
    v_mfma_f32_16x16x32_bf16 a[40:43], a[168:171], v[132:135], a[40:43]
    ds_read_b64_tr_b16 a[182:183], v21 offset:28672
    v_exp_f32 v43, v59
    v_mfma_f32_16x16x32_bf16 a[72:75], a[168:171], v[136:139], a[72:75]
    v_add_f32 v249, v40, v41
    v_cvt_pk_bf16_f32 v116, v40, v41
    v_mfma_f32_16x16x32_bf16 a[104:107], a[168:171], v[140:143], a[104:107]
    v_exp_f32 v44, v60
    v_mfma_f32_16x16x32_bf16 v[104:107], a[128:131], v[208:211], v[156:159]
    v_exp_f32 v45, v61
    v_mfma_f32_16x16x32_bf16 v[104:107], a[132:135], v[212:215], v[104:107]
    v_add_f32 v249, v249, v42
    v_add_f32 v249, v249, v43
    v_mfma_f32_16x16x32_bf16 v[104:107], a[136:139], v[216:219], v[104:107]
    buffer_load_dwordx4 v25, s[20:23], s37 offen offset:1024 nt lds
    s_add_u32 m0, s36, 8192
    v_mfma_f32_16x16x32_bf16 v[104:107], a[140:143], v[220:223], v[104:107]
    v_cvt_pk_bf16_f32 v117, v42, v43
    s_add_u32 s37, s37, 2048
    v_mfma_f32_16x16x32_bf16 a[12:15], a[172:175], v[128:131], a[12:15]
    ds_read_b64_tr_b16 a[184:185], v22 offset:24576
    v_exp_f32 v46, v62
    v_mfma_f32_16x16x32_bf16 a[44:47], a[172:175], v[132:135], a[44:47]
    ds_read_b64_tr_b16 a[186:187], v22 offset:28672
    v_exp_f32 v47, v63
    v_mfma_f32_16x16x32_bf16 a[76:79], a[172:175], v[136:139], a[76:79]
    v_add_f32 v249, v249, v44
    v_add_f32 v249, v249, v45
    v_mfma_f32_16x16x32_bf16 a[108:111], a[172:175], v[140:143], a[108:111]
    v_cvt_pk_bf16_f32 v118, v44, v45
    s_waitcnt lgkmcnt(2)
    v_mfma_f32_16x16x32_bf16 v[84:87], a[144:147], v[160:163], v[144:147]
    v_exp_f32 v40, v64
    v_mfma_f32_16x16x32_bf16 v[84:87], a[148:151], v[164:167], v[84:87]
    v_exp_f32 v41, v65
    v_mfma_f32_16x16x32_bf16 v[84:87], a[152:155], v[168:171], v[84:87]
    buffer_load_dwordx4 v26, s[24:27], s41 offen offset:0 nt lds
    v_add_f32 v249, v249, v46
    v_mfma_f32_16x16x32_bf16 v[84:87], a[156:159], v[172:175], v[84:87]
    v_add_f32 v249, v249, v47
    v_cvt_pk_bf16_f32 v119, v46, v47
    v_mfma_f32_16x16x32_bf16 a[16:19], a[176:179], v[128:131], a[16:19]
    ds_read_b64_tr_b16 a[188:189], v23 offset:24576
    v_exp_f32 v42, v66
    v_mfma_f32_16x16x32_bf16 a[48:51], a[176:179], v[132:135], a[48:51]
    ds_read_b64_tr_b16 a[190:191], v23 offset:28672
    v_exp_f32 v43, v67
    v_mfma_f32_16x16x32_bf16 a[80:83], a[176:179], v[136:139], a[80:83]
    v_add_f32 v250, v40, v41
    v_cvt_pk_bf16_f32 v120, v40, v41
    v_mfma_f32_16x16x32_bf16 a[112:115], a[176:179], v[140:143], a[112:115]
    v_exp_f32 v44, v68
    v_mfma_f32_16x16x32_bf16 v[92:95], a[144:147], v[176:179], v[148:151]
    v_exp_f32 v45, v69
    v_mfma_f32_16x16x32_bf16 v[92:95], a[148:151], v[180:183], v[92:95]
    v_add_f32 v250, v250, v42
    v_add_f32 v250, v250, v43
    v_mfma_f32_16x16x32_bf16 v[92:95], a[152:155], v[184:187], v[92:95]
    buffer_load_dwordx4 v27, s[24:27], s41 offen offset:1024 nt lds
    s_add_u32 s41, s41, 2048
    v_mfma_f32_16x16x32_bf16 v[92:95], a[156:159], v[188:191], v[92:95]
    v_cvt_pk_bf16_f32 v121, v42, v43
    v_exp_f32 v46, v70
    v_mfma_f32_16x16x32_bf16 a[20:23], a[180:183], v[128:131], a[20:23]
    v_exp_f32 v47, v71
    v_mfma_f32_16x16x32_bf16 a[52:55], a[180:183], v[132:135], a[52:55]
    v_add_f32 v250, v250, v44
    v_add_f32 v250, v250, v45
    v_mfma_f32_16x16x32_bf16 a[84:87], a[180:183], v[136:139], a[84:87]
    v_cvt_pk_bf16_f32 v122, v44, v45
    v_exp_f32 v40, v72
    v_mfma_f32_16x16x32_bf16 a[116:119], a[180:183], v[140:143], a[116:119]
    v_exp_f32 v41, v73
    s_waitcnt lgkmcnt(0)
    v_mfma_f32_16x16x32_bf16 v[100:103], a[144:147], v[192:195], v[152:155]
    ds_read_b128 a[128:131], v8 offset:0
    v_add_f32 v250, v250, v46
    v_mfma_f32_16x16x32_bf16 v[100:103], a[148:151], v[196:199], v[100:103]
    ds_read_b128 a[132:135], v9 offset:0
    v_add_f32 v250, v250, v47
    v_mfma_f32_16x16x32_bf16 v[100:103], a[152:155], v[200:203], v[100:103]
    ds_read_b128 a[136:139], v10 offset:0
    v_cvt_pk_bf16_f32 v123, v46, v47
    v_mfma_f32_16x16x32_bf16 v[100:103], a[156:159], v[204:207], v[100:103]
    ds_read_b128 a[140:143], v11 offset:0
    v_exp_f32 v42, v74
    v_mfma_f32_16x16x32_bf16 a[24:27], a[184:187], v[128:131], a[24:27]
    ds_read_b64_tr_b16 a[160:161], v16 offset:32768
    v_exp_f32 v43, v75
    v_mfma_f32_16x16x32_bf16 a[56:59], a[184:187], v[132:135], a[56:59]
    ds_read_b64_tr_b16 a[162:163], v16 offset:36864
    v_add_f32 v251, v40, v41
    v_mfma_f32_16x16x32_bf16 a[88:91], a[184:187], v[136:139], a[88:91]
    v_cvt_pk_bf16_f32 v124, v40, v41
    v_exp_f32 v44, v76
    v_mfma_f32_16x16x32_bf16 a[120:123], a[184:187], v[140:143], a[120:123]
    v_exp_f32 v45, v77
    v_add_f32 v251, v251, v42
    v_mfma_f32_16x16x32_bf16 v[108:111], a[144:147], v[208:211], v[156:159]
    ds_read_b64_tr_b16 a[164:165], v17 offset:32768
    v_add_f32 v251, v251, v43
    v_cvt_pk_bf16_f32 v125, v42, v43
    v_mfma_f32_16x16x32_bf16 v[108:111], a[148:151], v[212:215], v[108:111]
    ds_read_b64_tr_b16 a[166:167], v17 offset:36864
    v_exp_f32 v46, v78
    v_mfma_f32_16x16x32_bf16 v[108:111], a[152:155], v[216:219], v[108:111]
    v_exp_f32 v47, v79
    v_mfma_f32_16x16x32_bf16 v[108:111], a[156:159], v[220:223], v[108:111]
    v_add_f32 v251, v251, v44
    v_add_f32 v251, v251, v45
    v_mfma_f32_16x16x32_bf16 a[28:31], a[188:191], v[128:131], a[28:31]
    ds_read_b64_tr_b16 a[168:169], v18 offset:32768
    v_cvt_pk_bf16_f32 v126, v44, v45
    v_add_f32 v251, v251, v46
    v_mfma_f32_16x16x32_bf16 a[60:63], a[188:191], v[132:135], a[60:63]
    ds_read_b64_tr_b16 a[170:171], v18 offset:36864
    v_add_f32 v251, v251, v47
    v_cvt_pk_bf16_f32 v127, v46, v47
    v_mfma_f32_16x16x32_bf16 a[92:95], a[188:191], v[136:139], a[92:95]
    v_max3_f32 v35, v248, v249, v250
    v_max_f32 v35, v35, v251
    v_cmp_lt_f32 vcc, s40, v35
    v_mfma_f32_16x16x32_bf16 a[124:127], a[188:191], v[140:143], a[124:127]
    s_cbranch_vccnz L_rare_h1p2
L_ret_h1p2:
    s_waitcnt lgkmcnt(2)
    v_mfma_f32_16x16x32_bf16 v[48:51], a[128:131], v[160:163], v[144:147]
    ds_read_b128 a[144:147], v8 offset:4096
    v_add_f32 v244, v244, v248
    v_mfma_f32_16x16x32_bf16 v[48:51], a[132:135], v[164:167], v[48:51]
    v_add_f32 v245, v245, v249
    v_add_f32 v246, v246, v250
    v_mfma_f32_16x16x32_bf16 v[48:51], a[136:139], v[168:171], v[48:51]
    ds_read_b128 a[148:151], v9 offset:4096
    v_add_f32 v247, v247, v251
    v_mfma_f32_16x16x32_bf16 v[48:51], a[140:143], v[172:175], v[48:51]
    v_exp_f32 v40, v80
    v_mfma_f32_16x16x32_bf16 a[0:3], a[160:163], v[112:115], a[0:3]
    ds_read_b64_tr_b16 a[172:173], v19 offset:32768
    v_exp_f32 v41, v81
    v_mfma_f32_16x16x32_bf16 a[32:35], a[160:163], v[116:119], a[32:35]
    ds_read_b64_tr_b16 a[174:175], v19 offset:36864
    v_exp_f32 v42, v82
    v_mfma_f32_16x16x32_bf16 a[64:67], a[160:163], v[120:123], a[64:67]
    v_exp_f32 v43, v83
    v_mfma_f32_16x16x32_bf16 a[96:99], a[160:163], v[124:127], a[96:99]
    v_add_f32 v4, v40, v41
    v_cvt_pk_bf16_f32 v128, v40, v41
    v_mfma_f32_16x16x32_bf16 v[56:59], a[128:131], v[176:179], v[148:151]
    ds_read_b128 a[152:155], v10 offset:4096
    v_exp_f32 v44, v84
    v_mfma_f32_16x16x32_bf16 v[56:59], a[132:135], v[180:183], v[56:59]
    v_exp_f32 v45, v85
    v_mfma_f32_16x16x32_bf16 v[56:59], a[136:139], v[184:187], v[56:59]
    ds_read_b128 a[156:159], v11 offset:4096
    v_add_f32 v4, v4, v42
    v_mfma_f32_16x16x32_bf16 v[56:59], a[140:143], v[188:191], v[56:59]
    v_add_f32 v4, v4, v43
    v_cvt_pk_bf16_f32 v129, v42, v43
    v_mfma_f32_16x16x32_bf16 a[4:7], a[164:167], v[112:115], a[4:7]
    ds_read_b64_tr_b16 a[176:177], v20 offset:32768
    v_exp_f32 v46, v86
    v_mfma_f32_16x16x32_bf16 a[36:39], a[164:167], v[116:119], a[36:39]
    ds_read_b64_tr_b16 a[178:179], v20 offset:36864
    v_exp_f32 v47, v87
    v_mfma_f32_16x16x32_bf16 a[68:71], a[164:167], v[120:123], a[68:71]
    v_add_f32 v4, v4, v44
    v_add_f32 v4, v4, v45
    v_mfma_f32_16x16x32_bf16 a[100:103], a[164:167], v[124:127], a[100:103]
    v_cvt_pk_bf16_f32 v130, v44, v45
    s_waitcnt lgkmcnt(4)
    v_mfma_f32_16x16x32_bf16 v[64:67], a[128:131], v[192:195], v[152:155]
    v_exp_f32 v40, v88
    v_mfma_f32_16x16x32_bf16 v[64:67], a[132:135], v[196:199], v[64:67]
    v_exp_f32 v41, v89
    s_add_u32 m0, s35, 32768
    v_mfma_f32_16x16x32_bf16 v[64:67], a[136:139], v[200:203], v[64:67]
    buffer_load_dwordx4 v24, s[20:23], s37 offen offset:0 nt lds
    v_add_f32 v4, v4, v46
    v_mfma_f32_16x16x32_bf16 v[64:67], a[140:143], v[204:207], v[64:67]
    v_add_f32 v4, v4, v47
    v_cvt_pk_bf16_f32 v131, v46, v47
    v_mfma_f32_16x16x32_bf16 a[8:11], a[168:171], v[112:115], a[8:11]
    ds_read_b64_tr_b16 a[180:181], v21 offset:32768
    v_exp_f32 v42, v90
    v_mfma_f32_16x16x32_bf16 a[40:43], a[168:171], v[116:119], a[40:43]
    ds_read_b64_tr_b16 a[182:183], v21 offset:36864
    v_exp_f32 v43, v91
    v_mfma_f32_16x16x32_bf16 a[72:75], a[168:171], v[120:123], a[72:75]
    v_add_f32 v5, v40, v41
    v_cvt_pk_bf16_f32 v132, v40, v41
    v_mfma_f32_16x16x32_bf16 a[104:107], a[168:171], v[124:127], a[104:107]
    v_exp_f32 v44, v92
    v_mfma_f32_16x16x32_bf16 v[72:75], a[128:131], v[208:211], v[156:159]
    v_exp_f32 v45, v93
    v_mfma_f32_16x16x32_bf16 v[72:75], a[132:135], v[212:215], v[72:75]
    v_add_f32 v5, v5, v42
    v_add_f32 v5, v5, v43
    v_mfma_f32_16x16x32_bf16 v[72:75], a[136:139], v[216:219], v[72:75]
    buffer_load_dwordx4 v25, s[20:23], s37 offen offset:1024 nt lds
    s_add_u32 m0, s36, 16384
    v_mfma_f32_16x16x32_bf16 v[72:75], a[140:143], v[220:223], v[72:75]
    v_cvt_pk_bf16_f32 v133, v42, v43
    s_add_u32 s37, s37, 2048
    v_mfma_f32_16x16x32_bf16 a[12:15], a[172:175], v[112:115], a[12:15]
    ds_read_b64_tr_b16 a[184:185], v22 offset:32768
    v_exp_f32 v46, v94
    v_mfma_f32_16x16x32_bf16 a[44:47], a[172:175], v[116:119], a[44:47]
    ds_read_b64_tr_b16 a[186:187], v22 offset:36864
    v_exp_f32 v47, v95
    v_mfma_f32_16x16x32_bf16 a[76:79], a[172:175], v[120:123], a[76:79]
    v_add_f32 v5, v5, v44
    v_add_f32 v5, v5, v45
    v_mfma_f32_16x16x32_bf16 a[108:111], a[172:175], v[124:127], a[108:111]
    v_cvt_pk_bf16_f32 v134, v44, v45
    s_waitcnt lgkmcnt(2)
    v_mfma_f32_16x16x32_bf16 v[52:55], a[144:147], v[160:163], v[144:147]
    v_exp_f32 v40, v96
    v_mfma_f32_16x16x32_bf16 v[52:55], a[148:151], v[164:167], v[52:55]
    v_exp_f32 v41, v97
    v_mfma_f32_16x16x32_bf16 v[52:55], a[152:155], v[168:171], v[52:55]
    buffer_load_dwordx4 v26, s[24:27], s41 offen offset:0 nt lds
    v_add_f32 v5, v5, v46
    v_mfma_f32_16x16x32_bf16 v[52:55], a[156:159], v[172:175], v[52:55]
    v_add_f32 v5, v5, v47
    v_cvt_pk_bf16_f32 v135, v46, v47
    v_mfma_f32_16x16x32_bf16 a[16:19], a[176:179], v[112:115], a[16:19]
    ds_read_b64_tr_b16 a[188:189], v23 offset:32768
    v_exp_f32 v42, v98
    v_mfma_f32_16x16x32_bf16 a[48:51], a[176:179], v[116:119], a[48:51]
    ds_read_b64_tr_b16 a[190:191], v23 offset:36864
    v_exp_f32 v43, v99
    v_mfma_f32_16x16x32_bf16 a[80:83], a[176:179], v[120:123], a[80:83]
    v_add_f32 v6, v40, v41
    v_cvt_pk_bf16_f32 v136, v40, v41
    v_mfma_f32_16x16x32_bf16 a[112:115], a[176:179], v[124:127], a[112:115]
    v_exp_f32 v44, v100
    v_mfma_f32_16x16x32_bf16 v[60:63], a[144:147], v[176:179], v[148:151]
    v_exp_f32 v45, v101
    v_mfma_f32_16x16x32_bf16 v[60:63], a[148:151], v[180:183], v[60:63]
    v_add_f32 v6, v6, v42
    v_add_f32 v6, v6, v43
    v_mfma_f32_16x16x32_bf16 v[60:63], a[152:155], v[184:187], v[60:63]
    buffer_load_dwordx4 v27, s[24:27], s41 offen offset:1024 nt lds
    s_add_u32 s41, s41, 2048
    v_mfma_f32_16x16x32_bf16 v[60:63], a[156:159], v[188:191], v[60:63]
    v_cvt_pk_bf16_f32 v137, v42, v43
    v_exp_f32 v46, v102
    v_mfma_f32_16x16x32_bf16 a[20:23], a[180:183], v[112:115], a[20:23]
    v_exp_f32 v47, v103
    v_mfma_f32_16x16x32_bf16 a[52:55], a[180:183], v[116:119], a[52:55]
    v_add_f32 v6, v6, v44
    v_add_f32 v6, v6, v45
    v_mfma_f32_16x16x32_bf16 a[84:87], a[180:183], v[120:123], a[84:87]
    v_cvt_pk_bf16_f32 v138, v44, v45
    v_exp_f32 v40, v104
    v_mfma_f32_16x16x32_bf16 a[116:119], a[180:183], v[124:127], a[116:119]
    s_waitcnt vmcnt(8) lgkmcnt(0)
    s_barrier
    v_mfma_f32_16x16x32_bf16 v[68:71], a[144:147], v[192:195], v[152:155]
    ds_read_b128 a[128:131], v8 offset:8192
    v_exp_f32 v41, v105
    v_mfma_f32_16x16x32_bf16 v[68:71], a[148:151], v[196:199], v[68:71]
    ds_read_b128 a[132:135], v9 offset:8192
    v_add_f32 v6, v6, v46
    v_mfma_f32_16x16x32_bf16 v[68:71], a[152:155], v[200:203], v[68:71]
    ds_read_b128 a[136:139], v10 offset:8192
    v_add_f32 v6, v6, v47
    v_cvt_pk_bf16_f32 v139, v46, v47
    v_mfma_f32_16x16x32_bf16 v[68:71], a[156:159], v[204:207], v[68:71]
    ds_read_b128 a[140:143], v11 offset:8192
    v_exp_f32 v42, v106
    v_mfma_f32_16x16x32_bf16 a[24:27], a[184:187], v[112:115], a[24:27]
    ds_read_b64_tr_b16 a[160:161], v16 offset:40960
    v_exp_f32 v43, v107
    v_mfma_f32_16x16x32_bf16 a[56:59], a[184:187], v[116:119], a[56:59]
    ds_read_b64_tr_b16 a[162:163], v16 offset:45056
    v_add_f32 v7, v40, v41
    v_mfma_f32_16x16x32_bf16 a[88:91], a[184:187], v[120:123], a[88:91]
    v_cvt_pk_bf16_f32 v140, v40, v41
    v_exp_f32 v44, v108
    v_mfma_f32_16x16x32_bf16 a[120:123], a[184:187], v[124:127], a[120:123]
    v_exp_f32 v45, v109
    v_add_f32 v7, v7, v42
    v_mfma_f32_16x16x32_bf16 v[76:79], a[144:147], v[208:211], v[156:159]
    ds_read_b64_tr_b16 a[164:165], v17 offset:40960
    v_add_f32 v7, v7, v43
    v_cvt_pk_bf16_f32 v141, v42, v43
    v_mfma_f32_16x16x32_bf16 v[76:79], a[148:151], v[212:215], v[76:79]
    ds_read_b64_tr_b16 a[166:167], v17 offset:45056
    v_exp_f32 v46, v110
    v_mfma_f32_16x16x32_bf16 v[76:79], a[152:155], v[216:219], v[76:79]
    v_exp_f32 v47, v111
    v_mfma_f32_16x16x32_bf16 v[76:79], a[156:159], v[220:223], v[76:79]
    v_add_f32 v7, v7, v44
    v_add_f32 v7, v7, v45
    v_mfma_f32_16x16x32_bf16 a[28:31], a[188:191], v[112:115], a[28:31]
    ds_read_b64_tr_b16 a[168:169], v18 offset:40960
    v_cvt_pk_bf16_f32 v142, v44, v45
    v_add_f32 v7, v7, v46
    v_mfma_f32_16x16x32_bf16 a[60:63], a[188:191], v[116:119], a[60:63]
    ds_read_b64_tr_b16 a[170:171], v18 offset:45056
    v_add_f32 v7, v7, v47
    v_cvt_pk_bf16_f32 v143, v46, v47
    v_mfma_f32_16x16x32_bf16 a[92:95], a[188:191], v[120:123], a[92:95]
    v_max3_f32 v35, v4, v5, v6
    v_max_f32 v35, v35, v7
    v_cmp_lt_f32 vcc, s40, v35
    v_mfma_f32_16x16x32_bf16 a[124:127], a[188:191], v[124:127], a[124:127]
    s_cbranch_vccnz L_rare_h1p3
L_ret_h1p3:
    s_waitcnt lgkmcnt(2)
    v_mfma_f32_16x16x32_bf16 v[80:83], a[128:131], v[160:163], v[144:147]
    ds_read_b128 a[144:147], v8 offset:12288
    v_add_f32 v244, v244, v4
    v_mfma_f32_16x16x32_bf16 v[80:83], a[132:135], v[164:167], v[80:83]
    v_add_f32 v245, v245, v5
    v_add_f32 v246, v246, v6
    v_mfma_f32_16x16x32_bf16 v[80:83], a[136:139], v[168:171], v[80:83]
    ds_read_b128 a[148:151], v9 offset:12288
    v_add_f32 v247, v247, v7
    v_mfma_f32_16x16x32_bf16 v[80:83], a[140:143], v[172:175], v[80:83]
    v_exp_f32 v40, v48
    v_mfma_f32_16x16x32_bf16 a[0:3], a[160:163], v[128:131], a[0:3]
    ds_read_b64_tr_b16 a[172:173], v19 offset:40960
    v_exp_f32 v41, v49
    v_mfma_f32_16x16x32_bf16 a[32:35], a[160:163], v[132:135], a[32:35]
    ds_read_b64_tr_b16 a[174:175], v19 offset:45056
    v_exp_f32 v42, v50
    v_mfma_f32_16x16x32_bf16 a[64:67], a[160:163], v[136:139], a[64:67]
    v_exp_f32 v43, v51
    v_mfma_f32_16x16x32_bf16 a[96:99], a[160:163], v[140:143], a[96:99]
    v_add_f32 v248, v40, v41
    v_cvt_pk_bf16_f32 v112, v40, v41
    v_mfma_f32_16x16x32_bf16 v[88:91], a[128:131], v[176:179], v[148:151]
    ds_read_b128 a[152:155], v10 offset:12288
    v_exp_f32 v44, v52
    v_mfma_f32_16x16x32_bf16 v[88:91], a[132:135], v[180:183], v[88:91]
    v_exp_f32 v45, v53
    v_mfma_f32_16x16x32_bf16 v[88:91], a[136:139], v[184:187], v[88:91]
    ds_read_b128 a[156:159], v11 offset:12288
    v_add_f32 v248, v248, v42
    v_mfma_f32_16x16x32_bf16 v[88:91], a[140:143], v[188:191], v[88:91]
    v_add_f32 v248, v248, v43
    v_cvt_pk_bf16_f32 v113, v42, v43
    v_mfma_f32_16x16x32_bf16 a[4:7], a[164:167], v[128:131], a[4:7]
    ds_read_b64_tr_b16 a[176:177], v20 offset:40960
    v_exp_f32 v46, v54
    v_mfma_f32_16x16x32_bf16 a[36:39], a[164:167], v[132:135], a[36:39]
    ds_read_b64_tr_b16 a[178:179], v20 offset:45056
    v_exp_f32 v47, v55
    v_mfma_f32_16x16x32_bf16 a[68:71], a[164:167], v[136:139], a[68:71]
    v_add_f32 v248, v248, v44
    v_add_f32 v248, v248, v45
    v_mfma_f32_16x16x32_bf16 a[100:103], a[164:167], v[140:143], a[100:103]
    v_cvt_pk_bf16_f32 v114, v44, v45
    s_waitcnt lgkmcnt(4)
    v_mfma_f32_16x16x32_bf16 v[96:99], a[128:131], v[192:195], v[152:155]
    v_exp_f32 v40, v56
    v_mfma_f32_16x16x32_bf16 v[96:99], a[132:135], v[196:199], v[96:99]
    v_exp_f32 v41, v57
    s_add_u32 m0, s35, 40960
    v_mfma_f32_16x16x32_bf16 v[96:99], a[136:139], v[200:203], v[96:99]
    buffer_load_dwordx4 v24, s[20:23], s37 offen offset:0 nt lds
    v_add_f32 v248, v248, v46
    v_mfma_f32_16x16x32_bf16 v[96:99], a[140:143], v[204:207], v[96:99]
    v_add_f32 v248, v248, v47
    v_cvt_pk_bf16_f32 v115, v46, v47
    v_mfma_f32_16x16x32_bf16 a[8:11], a[168:171], v[128:131], a[8:11]
    ds_read_b64_tr_b16 a[180:181], v21 offset:40960
    v_exp_f32 v42, v58
    v_mfma_f32_16x16x32_bf16 a[40:43], a[168:171], v[132:135], a[40:43]
    ds_read_b64_tr_b16 a[182:183], v21 offset:45056
    v_exp_f32 v43, v59
    v_mfma_f32_16x16x32_bf16 a[72:75], a[168:171], v[136:139], a[72:75]
    v_add_f32 v249, v40, v41
    v_cvt_pk_bf16_f32 v116, v40, v41
    v_mfma_f32_16x16x32_bf16 a[104:107], a[168:171], v[140:143], a[104:107]
    v_exp_f32 v44, v60
    v_mfma_f32_16x16x32_bf16 v[104:107], a[128:131], v[208:211], v[156:159]
    v_exp_f32 v45, v61
    v_mfma_f32_16x16x32_bf16 v[104:107], a[132:135], v[212:215], v[104:107]
    v_add_f32 v249, v249, v42
    v_add_f32 v249, v249, v43
    v_mfma_f32_16x16x32_bf16 v[104:107], a[136:139], v[216:219], v[104:107]
    buffer_load_dwordx4 v25, s[20:23], s37 offen offset:1024 nt lds
    s_add_u32 m0, s36, 24576
    v_mfma_f32_16x16x32_bf16 v[104:107], a[140:143], v[220:223], v[104:107]
    v_cvt_pk_bf16_f32 v117, v42, v43
    s_add_u32 s37, s37, 2048
    v_mfma_f32_16x16x32_bf16 a[12:15], a[172:175], v[128:131], a[12:15]
    ds_read_b64_tr_b16 a[184:185], v22 offset:40960
    v_exp_f32 v46, v62
    v_mfma_f32_16x16x32_bf16 a[44:47], a[172:175], v[132:135], a[44:47]
    ds_read_b64_tr_b16 a[186:187], v22 offset:45056
    v_exp_f32 v47, v63
    v_mfma_f32_16x16x32_bf16 a[76:79], a[172:175], v[136:139], a[76:79]
    v_add_f32 v249, v249, v44
    v_add_f32 v249, v249, v45
    v_mfma_f32_16x16x32_bf16 a[108:111], a[172:175], v[140:143], a[108:111]
    v_cvt_pk_bf16_f32 v118, v44, v45
    s_waitcnt lgkmcnt(2)
    v_mfma_f32_16x16x32_bf16 v[84:87], a[144:147], v[160:163], v[144:147]
    v_exp_f32 v40, v64
    v_mfma_f32_16x16x32_bf16 v[84:87], a[148:151], v[164:167], v[84:87]
    v_exp_f32 v41, v65
    v_mfma_f32_16x16x32_bf16 v[84:87], a[152:155], v[168:171], v[84:87]
    buffer_load_dwordx4 v26, s[24:27], s41 offen offset:0 nt lds
    v_add_f32 v249, v249, v46
    v_mfma_f32_16x16x32_bf16 v[84:87], a[156:159], v[172:175], v[84:87]
    v_add_f32 v249, v249, v47
    v_cvt_pk_bf16_f32 v119, v46, v47
    v_mfma_f32_16x16x32_bf16 a[16:19], a[176:179], v[128:131], a[16:19]
    ds_read_b64_tr_b16 a[188:189], v23 offset:40960
    v_exp_f32 v42, v66
    v_mfma_f32_16x16x32_bf16 a[48:51], a[176:179], v[132:135], a[48:51]
    ds_read_b64_tr_b16 a[190:191], v23 offset:45056
    v_exp_f32 v43, v67
    v_mfma_f32_16x16x32_bf16 a[80:83], a[176:179], v[136:139], a[80:83]
    v_add_f32 v250, v40, v41
    v_cvt_pk_bf16_f32 v120, v40, v41
    v_mfma_f32_16x16x32_bf16 a[112:115], a[176:179], v[140:143], a[112:115]
    v_exp_f32 v44, v68
    v_mfma_f32_16x16x32_bf16 v[92:95], a[144:147], v[176:179], v[148:151]
    v_exp_f32 v45, v69
    v_mfma_f32_16x16x32_bf16 v[92:95], a[148:151], v[180:183], v[92:95]
    v_add_f32 v250, v250, v42
    v_add_f32 v250, v250, v43
    v_mfma_f32_16x16x32_bf16 v[92:95], a[152:155], v[184:187], v[92:95]
    buffer_load_dwordx4 v27, s[24:27], s41 offen offset:1024 nt lds
    s_add_u32 s41, s41, 2048
    v_mfma_f32_16x16x32_bf16 v[92:95], a[156:159], v[188:191], v[92:95]
    v_cvt_pk_bf16_f32 v121, v42, v43
    v_exp_f32 v46, v70
    v_mfma_f32_16x16x32_bf16 a[20:23], a[180:183], v[128:131], a[20:23]
    v_exp_f32 v47, v71
    v_mfma_f32_16x16x32_bf16 a[52:55], a[180:183], v[132:135], a[52:55]
    v_add_f32 v250, v250, v44
    v_add_f32 v250, v250, v45
    v_mfma_f32_16x16x32_bf16 a[84:87], a[180:183], v[136:139], a[84:87]
    v_cvt_pk_bf16_f32 v122, v44, v45
    v_exp_f32 v40, v72
    v_mfma_f32_16x16x32_bf16 a[116:119], a[180:183], v[140:143], a[116:119]
    v_exp_f32 v41, v73
    s_waitcnt lgkmcnt(0)
    v_mfma_f32_16x16x32_bf16 v[100:103], a[144:147], v[192:195], v[152:155]
    ds_read_b128 a[128:131], v8 offset:16384
    v_add_f32 v250, v250, v46
    v_mfma_f32_16x16x32_bf16 v[100:103], a[148:151], v[196:199], v[100:103]
    ds_read_b128 a[132:135], v9 offset:16384
    v_add_f32 v250, v250, v47
    v_mfma_f32_16x16x32_bf16 v[100:103], a[152:155], v[200:203], v[100:103]
    ds_read_b128 a[136:139], v10 offset:16384
    v_cvt_pk_bf16_f32 v123, v46, v47
    v_mfma_f32_16x16x32_bf16 v[100:103], a[156:159], v[204:207], v[100:103]
    ds_read_b128 a[140:143], v11 offset:16384
    v_exp_f32 v42, v74
    v_mfma_f32_16x16x32_bf16 a[24:27], a[184:187], v[128:131], a[24:27]
    ds_read_b64_tr_b16 a[160:161], v16 offset:0
    v_exp_f32 v43, v75
    v_mfma_f32_16x16x32_bf16 a[56:59], a[184:187], v[132:135], a[56:59]
    ds_read_b64_tr_b16 a[162:163], v16 offset:4096
    v_add_f32 v251, v40, v41
    v_mfma_f32_16x16x32_bf16 a[88:91], a[184:187], v[136:139], a[88:91]
    v_cvt_pk_bf16_f32 v124, v40, v41
    v_exp_f32 v44, v76
    v_mfma_f32_16x16x32_bf16 a[120:123], a[184:187], v[140:143], a[120:123]
    v_exp_f32 v45, v77
    v_add_f32 v251, v251, v42
    v_mfma_f32_16x16x32_bf16 v[108:111], a[144:147], v[208:211], v[156:159]
    ds_read_b64_tr_b16 a[164:165], v17 offset:0
    v_add_f32 v251, v251, v43
    v_cvt_pk_bf16_f32 v125, v42, v43
    v_mfma_f32_16x16x32_bf16 v[108:111], a[148:151], v[212:215], v[108:111]
    ds_read_b64_tr_b16 a[166:167], v17 offset:4096
    v_exp_f32 v46, v78
    v_mfma_f32_16x16x32_bf16 v[108:111], a[152:155], v[216:219], v[108:111]
    v_exp_f32 v47, v79
    v_mfma_f32_16x16x32_bf16 v[108:111], a[156:159], v[220:223], v[108:111]
    v_add_f32 v251, v251, v44
    v_add_f32 v251, v251, v45
    v_mfma_f32_16x16x32_bf16 a[28:31], a[188:191], v[128:131], a[28:31]
    ds_read_b64_tr_b16 a[168:169], v18 offset:0
    v_cvt_pk_bf16_f32 v126, v44, v45
    v_add_f32 v251, v251, v46
    v_mfma_f32_16x16x32_bf16 a[60:63], a[188:191], v[132:135], a[60:63]
    ds_read_b64_tr_b16 a[170:171], v18 offset:4096
    v_add_f32 v251, v251, v47
    v_cvt_pk_bf16_f32 v127, v46, v47
    v_mfma_f32_16x16x32_bf16 a[92:95], a[188:191], v[136:139], a[92:95]
    v_max3_f32 v35, v248, v249, v250
    v_max_f32 v35, v35, v251
    v_cmp_lt_f32 vcc, s40, v35
    v_mfma_f32_16x16x32_bf16 a[124:127], a[188:191], v[140:143], a[124:127]
    s_cbranch_vccnz L_rare_h1p4
L_ret_h1p4:
    s_waitcnt lgkmcnt(2)
    v_mfma_f32_16x16x32_bf16 v[48:51], a[128:131], v[160:163], v[144:147]
    ds_read_b128 a[144:147], v8 offset:20480
    v_add_f32 v244, v244, v248
    v_mfma_f32_16x16x32_bf16 v[48:51], a[132:135], v[164:167], v[48:51]
    v_add_f32 v245, v245, v249
    v_add_f32 v246, v246, v250
    v_mfma_f32_16x16x32_bf16 v[48:51], a[136:139], v[168:171], v[48:51]
    ds_read_b128 a[148:151], v9 offset:20480
    v_add_f32 v247, v247, v251
    v_mfma_f32_16x16x32_bf16 v[48:51], a[140:143], v[172:175], v[48:51]
    v_exp_f32 v40, v80
    v_mfma_f32_16x16x32_bf16 a[0:3], a[160:163], v[112:115], a[0:3]
    ds_read_b64_tr_b16 a[172:173], v19 offset:0
    v_exp_f32 v41, v81
    v_mfma_f32_16x16x32_bf16 a[32:35], a[160:163], v[116:119], a[32:35]
    ds_read_b64_tr_b16 a[174:175], v19 offset:4096
    v_exp_f32 v42, v82
    v_mfma_f32_16x16x32_bf16 a[64:67], a[160:163], v[120:123], a[64:67]
    v_exp_f32 v43, v83
    v_mfma_f32_16x16x32_bf16 a[96:99], a[160:163], v[124:127], a[96:99]
    v_add_f32 v4, v40, v41
    v_cvt_pk_bf16_f32 v128, v40, v41
    v_mfma_f32_16x16x32_bf16 v[56:59], a[128:131], v[176:179], v[148:151]
    ds_read_b128 a[152:155], v10 offset:20480
    v_exp_f32 v44, v84
    v_mfma_f32_16x16x32_bf16 v[56:59], a[132:135], v[180:183], v[56:59]
    v_exp_f32 v45, v85
    v_mfma_f32_16x16x32_bf16 v[56:59], a[136:139], v[184:187], v[56:59]
    ds_read_b128 a[156:159], v11 offset:20480
    v_add_f32 v4, v4, v42
    v_mfma_f32_16x16x32_bf16 v[56:59], a[140:143], v[188:191], v[56:59]
    v_add_f32 v4, v4, v43
    v_cvt_pk_bf16_f32 v129, v42, v43
    v_mfma_f32_16x16x32_bf16 a[4:7], a[164:167], v[112:115], a[4:7]
    ds_read_b64_tr_b16 a[176:177], v20 offset:0
    v_exp_f32 v46, v86
    v_mfma_f32_16x16x32_bf16 a[36:39], a[164:167], v[116:119], a[36:39]
    ds_read_b64_tr_b16 a[178:179], v20 offset:4096
    v_exp_f32 v47, v87
    v_mfma_f32_16x16x32_bf16 a[68:71], a[164:167], v[120:123], a[68:71]
    v_add_f32 v4, v4, v44
    v_add_f32 v4, v4, v45
    v_mfma_f32_16x16x32_bf16 a[100:103], a[164:167], v[124:127], a[100:103]
    v_cvt_pk_bf16_f32 v130, v44, v45
    s_waitcnt lgkmcnt(4)
    v_mfma_f32_16x16x32_bf16 v[64:67], a[128:131], v[192:195], v[152:155]
    v_exp_f32 v40, v88
    v_mfma_f32_16x16x32_bf16 v[64:67], a[132:135], v[196:199], v[64:67]
    v_exp_f32 v41, v89
    s_add_u32 m0, s35, 0
    v_mfma_f32_16x16x32_bf16 v[64:67], a[136:139], v[200:203], v[64:67]
    buffer_load_dwordx4 v24, s[20:23], s37 offen offset:0 nt lds
    v_add_f32 v4, v4, v46
    v_mfma_f32_16x16x32_bf16 v[64:67], a[140:143], v[204:207], v[64:67]
    v_add_f32 v4, v4, v47
    v_cvt_pk_bf16_f32 v131, v46, v47
    v_mfma_f32_16x16x32_bf16 a[8:11], a[168:171], v[112:115], a[8:11]
    ds_read_b64_tr_b16 a[180:181], v21 offset:0
    v_exp_f32 v42, v90
    v_mfma_f32_16x16x32_bf16 a[40:43], a[168:171], v[116:119], a[40:43]
    ds_read_b64_tr_b16 a[182:183], v21 offset:4096
    v_exp_f32 v43, v91
    v_mfma_f32_16x16x32_bf16 a[72:75], a[168:171], v[120:123], a[72:75]
    v_add_f32 v5, v40, v41
    v_cvt_pk_bf16_f32 v132, v40, v41
    v_mfma_f32_16x16x32_bf16 a[104:107], a[168:171], v[124:127], a[104:107]
    v_exp_f32 v44, v92
    v_mfma_f32_16x16x32_bf16 v[72:75], a[128:131], v[208:211], v[156:159]
    v_exp_f32 v45, v93
    v_mfma_f32_16x16x32_bf16 v[72:75], a[132:135], v[212:215], v[72:75]
    v_add_f32 v5, v5, v42
    v_add_f32 v5, v5, v43
    v_mfma_f32_16x16x32_bf16 v[72:75], a[136:139], v[216:219], v[72:75]
    buffer_load_dwordx4 v25, s[20:23], s37 offen offset:1024 nt lds
    s_add_u32 m0, s36, 32768
    v_mfma_f32_16x16x32_bf16 v[72:75], a[140:143], v[220:223], v[72:75]
    v_cvt_pk_bf16_f32 v133, v42, v43
    s_add_u32 s37, s37, 2048
    v_mfma_f32_16x16x32_bf16 a[12:15], a[172:175], v[112:115], a[12:15]
    ds_read_b64_tr_b16 a[184:185], v22 offset:0
    v_exp_f32 v46, v94
    v_mfma_f32_16x16x32_bf16 a[44:47], a[172:175], v[116:119], a[44:47]
    ds_read_b64_tr_b16 a[186:187], v22 offset:4096
    v_exp_f32 v47, v95
    v_mfma_f32_16x16x32_bf16 a[76:79], a[172:175], v[120:123], a[76:79]
    v_add_f32 v5, v5, v44
    v_add_f32 v5, v5, v45
    v_mfma_f32_16x16x32_bf16 a[108:111], a[172:175], v[124:127], a[108:111]
    v_cvt_pk_bf16_f32 v134, v44, v45
    s_waitcnt lgkmcnt(2)
    v_mfma_f32_16x16x32_bf16 v[52:55], a[144:147], v[160:163], v[144:147]
    v_exp_f32 v40, v96
    v_mfma_f32_16x16x32_bf16 v[52:55], a[148:151], v[164:167], v[52:55]
    v_exp_f32 v41, v97
    v_mfma_f32_16x16x32_bf16 v[52:55], a[152:155], v[168:171], v[52:55]
    buffer_load_dwordx4 v26, s[24:27], s41 offen offset:0 nt lds
    v_add_f32 v5, v5, v46
    v_mfma_f32_16x16x32_bf16 v[52:55], a[156:159], v[172:175], v[52:55]
    v_add_f32 v5, v5, v47
    v_cvt_pk_bf16_f32 v135, v46, v47
    v_mfma_f32_16x16x32_bf16 a[16:19], a[176:179], v[112:115], a[16:19]
    ds_read_b64_tr_b16 a[188:189], v23 offset:0
    v_exp_f32 v42, v98
    v_mfma_f32_16x16x32_bf16 a[48:51], a[176:179], v[116:119], a[48:51]
    ds_read_b64_tr_b16 a[190:191], v23 offset:4096
    v_exp_f32 v43, v99
    v_mfma_f32_16x16x32_bf16 a[80:83], a[176:179], v[120:123], a[80:83]
    v_add_f32 v6, v40, v41
    v_cvt_pk_bf16_f32 v136, v40, v41
    v_mfma_f32_16x16x32_bf16 a[112:115], a[176:179], v[124:127], a[112:115]
    v_exp_f32 v44, v100
    v_mfma_f32_16x16x32_bf16 v[60:63], a[144:147], v[176:179], v[148:151]
    v_exp_f32 v45, v101
    v_mfma_f32_16x16x32_bf16 v[60:63], a[148:151], v[180:183], v[60:63]
    v_add_f32 v6, v6, v42
    v_add_f32 v6, v6, v43
    v_mfma_f32_16x16x32_bf16 v[60:63], a[152:155], v[184:187], v[60:63]
    buffer_load_dwordx4 v27, s[24:27], s41 offen offset:1024 nt lds
    s_add_u32 s41, s41, 2048
    v_mfma_f32_16x16x32_bf16 v[60:63], a[156:159], v[188:191], v[60:63]
    v_cvt_pk_bf16_f32 v137, v42, v43
    v_exp_f32 v46, v102
    v_mfma_f32_16x16x32_bf16 a[20:23], a[180:183], v[112:115], a[20:23]
    v_exp_f32 v47, v103
    v_mfma_f32_16x16x32_bf16 a[52:55], a[180:183], v[116:119], a[52:55]
    v_add_f32 v6, v6, v44
    v_add_f32 v6, v6, v45
    v_mfma_f32_16x16x32_bf16 a[84:87], a[180:183], v[120:123], a[84:87]
    v_cvt_pk_bf16_f32 v138, v44, v45
    v_exp_f32 v40, v104
    v_mfma_f32_16x16x32_bf16 a[116:119], a[180:183], v[124:127], a[116:119]
    s_waitcnt vmcnt(8) lgkmcnt(0)
    s_barrier
    v_mfma_f32_16x16x32_bf16 v[68:71], a[144:147], v[192:195], v[152:155]
    ds_read_b128 a[128:131], v8 offset:24576
    v_exp_f32 v41, v105
    v_mfma_f32_16x16x32_bf16 v[68:71], a[148:151], v[196:199], v[68:71]
    ds_read_b128 a[132:135], v9 offset:24576
    v_add_f32 v6, v6, v46
    v_mfma_f32_16x16x32_bf16 v[68:71], a[152:155], v[200:203], v[68:71]
    ds_read_b128 a[136:139], v10 offset:24576
    v_add_f32 v6, v6, v47
    v_cvt_pk_bf16_f32 v139, v46, v47
    v_mfma_f32_16x16x32_bf16 v[68:71], a[156:159], v[204:207], v[68:71]
    ds_read_b128 a[140:143], v11 offset:24576
    v_exp_f32 v42, v106
    v_mfma_f32_16x16x32_bf16 a[24:27], a[184:187], v[112:115], a[24:27]
    ds_read_b64_tr_b16 a[160:161], v16 offset:8192
    v_exp_f32 v43, v107
    v_mfma_f32_16x16x32_bf16 a[56:59], a[184:187], v[116:119], a[56:59]
    ds_read_b64_tr_b16 a[162:163], v16 offset:12288
    v_add_f32 v7, v40, v41
    v_mfma_f32_16x16x32_bf16 a[88:91], a[184:187], v[120:123], a[88:91]
    v_cvt_pk_bf16_f32 v140, v40, v41
    v_exp_f32 v44, v108
    v_mfma_f32_16x16x32_bf16 a[120:123], a[184:187], v[124:127], a[120:123]
    v_exp_f32 v45, v109
    v_add_f32 v7, v7, v42
    v_mfma_f32_16x16x32_bf16 v[76:79], a[144:147], v[208:211], v[156:159]
    ds_read_b64_tr_b16 a[164:165], v17 offset:8192
    v_add_f32 v7, v7, v43
    v_cvt_pk_bf16_f32 v141, v42, v43
    v_mfma_f32_16x16x32_bf16 v[76:79], a[148:151], v[212:215], v[76:79]
    ds_read_b64_tr_b16 a[166:167], v17 offset:12288
    v_exp_f32 v46, v110
    v_mfma_f32_16x16x32_bf16 v[76:79], a[152:155], v[216:219], v[76:79]
    v_exp_f32 v47, v111
    v_mfma_f32_16x16x32_bf16 v[76:79], a[156:159], v[220:223], v[76:79]
    v_add_f32 v7, v7, v44
    v_add_f32 v7, v7, v45
    v_mfma_f32_16x16x32_bf16 a[28:31], a[188:191], v[112:115], a[28:31]
    ds_read_b64_tr_b16 a[168:169], v18 offset:8192
    v_cvt_pk_bf16_f32 v142, v44, v45
    v_add_f32 v7, v7, v46
    v_mfma_f32_16x16x32_bf16 a[60:63], a[188:191], v[116:119], a[60:63]
    ds_read_b64_tr_b16 a[170:171], v18 offset:12288
    v_add_f32 v7, v7, v47
    v_cvt_pk_bf16_f32 v143, v46, v47
    v_mfma_f32_16x16x32_bf16 a[92:95], a[188:191], v[120:123], a[92:95]
    v_max3_f32 v35, v4, v5, v6
    v_max_f32 v35, v35, v7
    v_cmp_lt_f32 vcc, s40, v35
    v_mfma_f32_16x16x32_bf16 a[124:127], a[188:191], v[124:127], a[124:127]
    s_cbranch_vccnz L_rare_h1p5
L_ret_h1p5:
    s_waitcnt lgkmcnt(2)
    v_mfma_f32_16x16x32_bf16 v[80:83], a[128:131], v[160:163], v[144:147]
    ds_read_b128 a[144:147], v8 offset:28672
    v_add_f32 v244, v244, v4
    v_mfma_f32_16x16x32_bf16 v[80:83], a[132:135], v[164:167], v[80:83]
    v_add_f32 v245, v245, v5
    v_add_f32 v246, v246, v6
    v_mfma_f32_16x16x32_bf16 v[80:83], a[136:139], v[168:171], v[80:83]
    ds_read_b128 a[148:151], v9 offset:28672
    v_add_f32 v247, v247, v7
    v_mfma_f32_16x16x32_bf16 v[80:83], a[140:143], v[172:175], v[80:83]
    v_exp_f32 v40, v48
    v_mfma_f32_16x16x32_bf16 a[0:3], a[160:163], v[128:131], a[0:3]
    ds_read_b64_tr_b16 a[172:173], v19 offset:8192
    v_exp_f32 v41, v49
    v_mfma_f32_16x16x32_bf16 a[32:35], a[160:163], v[132:135], a[32:35]
    ds_read_b64_tr_b16 a[174:175], v19 offset:12288
    v_exp_f32 v42, v50
    v_mfma_f32_16x16x32_bf16 a[64:67], a[160:163], v[136:139], a[64:67]
    v_exp_f32 v43, v51
    v_mfma_f32_16x16x32_bf16 a[96:99], a[160:163], v[140:143], a[96:99]
    v_add_f32 v248, v40, v41
    v_cvt_pk_bf16_f32 v112, v40, v41
    v_mfma_f32_16x16x32_bf16 v[88:91], a[128:131], v[176:179], v[148:151]
    ds_read_b128 a[152:155], v10 offset:28672
    v_exp_f32 v44, v52
    v_mfma_f32_16x16x32_bf16 v[88:91], a[132:135], v[180:183], v[88:91]
    v_exp_f32 v45, v53
    v_mfma_f32_16x16x32_bf16 v[88:91], a[136:139], v[184:187], v[88:91]
    ds_read_b128 a[156:159], v11 offset:28672
    v_add_f32 v248, v248, v42
    v_mfma_f32_16x16x32_bf16 v[88:91], a[140:143], v[188:191], v[88:91]
    v_add_f32 v248, v248, v43
    v_cvt_pk_bf16_f32 v113, v42, v43
    v_mfma_f32_16x16x32_bf16 a[4:7], a[164:167], v[128:131], a[4:7]
    ds_read_b64_tr_b16 a[176:177], v20 offset:8192
    v_exp_f32 v46, v54
    v_mfma_f32_16x16x32_bf16 a[36:39], a[164:167], v[132:135], a[36:39]
    ds_read_b64_tr_b16 a[178:179], v20 offset:12288
    v_exp_f32 v47, v55
    v_mfma_f32_16x16x32_bf16 a[68:71], a[164:167], v[136:139], a[68:71]
    v_add_f32 v248, v248, v44
    v_add_f32 v248, v248, v45
    v_mfma_f32_16x16x32_bf16 a[100:103], a[164:167], v[140:143], a[100:103]
    v_cvt_pk_bf16_f32 v114, v44, v45
    s_waitcnt lgkmcnt(4)
    v_mfma_f32_16x16x32_bf16 v[96:99], a[128:131], v[192:195], v[152:155]
    v_exp_f32 v40, v56
    v_mfma_f32_16x16x32_bf16 v[96:99], a[132:135], v[196:199], v[96:99]
    v_exp_f32 v41, v57
    s_add_u32 m0, s35, 8192
    v_mfma_f32_16x16x32_bf16 v[96:99], a[136:139], v[200:203], v[96:99]
    buffer_load_dwordx4 v24, s[20:23], s37 offen offset:0 nt lds
    v_add_f32 v248, v248, v46
    v_mfma_f32_16x16x32_bf16 v[96:99], a[140:143], v[204:207], v[96:99]
    v_add_f32 v248, v248, v47
    v_cvt_pk_bf16_f32 v115, v46, v47
    v_mfma_f32_16x16x32_bf16 a[8:11], a[168:171], v[128:131], a[8:11]
    ds_read_b64_tr_b16 a[180:181], v21 offset:8192
    v_exp_f32 v42, v58
    v_mfma_f32_16x16x32_bf16 a[40:43], a[168:171], v[132:135], a[40:43]
    ds_read_b64_tr_b16 a[182:183], v21 offset:12288
    v_exp_f32 v43, v59
    v_mfma_f32_16x16x32_bf16 a[72:75], a[168:171], v[136:139], a[72:75]
    v_add_f32 v249, v40, v41
    v_cvt_pk_bf16_f32 v116, v40, v41
    v_mfma_f32_16x16x32_bf16 a[104:107], a[168:171], v[140:143], a[104:107]
    v_exp_f32 v44, v60
    v_mfma_f32_16x16x32_bf16 v[104:107], a[128:131], v[208:211], v[156:159]
    v_exp_f32 v45, v61
    v_mfma_f32_16x16x32_bf16 v[104:107], a[132:135], v[212:215], v[104:107]
    v_add_f32 v249, v249, v42
    v_add_f32 v249, v249, v43
    v_mfma_f32_16x16x32_bf16 v[104:107], a[136:139], v[216:219], v[104:107]
    buffer_load_dwordx4 v25, s[20:23], s37 offen offset:1024 nt lds
    s_add_u32 m0, s36, 40960
    v_mfma_f32_16x16x32_bf16 v[104:107], a[140:143], v[220:223], v[104:107]
    v_cvt_pk_bf16_f32 v117, v42, v43
    s_add_u32 s37, s37, 2048
    v_mfma_f32_16x16x32_bf16 a[12:15], a[172:175], v[128:131], a[12:15]
    ds_read_b64_tr_b16 a[184:185], v22 offset:8192
    v_exp_f32 v46, v62
    v_mfma_f32_16x16x32_bf16 a[44:47], a[172:175], v[132:135], a[44:47]
    ds_read_b64_tr_b16 a[186:187], v22 offset:12288
    v_exp_f32 v47, v63
    v_mfma_f32_16x16x32_bf16 a[76:79], a[172:175], v[136:139], a[76:79]
    v_add_f32 v249, v249, v44
    v_add_f32 v249, v249, v45
    v_mfma_f32_16x16x32_bf16 a[108:111], a[172:175], v[140:143], a[108:111]
    v_cvt_pk_bf16_f32 v118, v44, v45
    s_waitcnt lgkmcnt(2)
    v_mfma_f32_16x16x32_bf16 v[84:87], a[144:147], v[160:163], v[144:147]
    v_exp_f32 v40, v64
    v_mfma_f32_16x16x32_bf16 v[84:87], a[148:151], v[164:167], v[84:87]
    v_exp_f32 v41, v65
    v_mfma_f32_16x16x32_bf16 v[84:87], a[152:155], v[168:171], v[84:87]
    buffer_load_dwordx4 v26, s[24:27], s41 offen offset:0 nt lds
    v_add_f32 v249, v249, v46
    v_mfma_f32_16x16x32_bf16 v[84:87], a[156:159], v[172:175], v[84:87]
    v_add_f32 v249, v249, v47
    v_cvt_pk_bf16_f32 v119, v46, v47
    v_mfma_f32_16x16x32_bf16 a[16:19], a[176:179], v[128:131], a[16:19]
    ds_read_b64_tr_b16 a[188:189], v23 offset:8192
    v_exp_f32 v42, v66
    v_mfma_f32_16x16x32_bf16 a[48:51], a[176:179], v[132:135], a[48:51]
    ds_read_b64_tr_b16 a[190:191], v23 offset:12288
    v_exp_f32 v43, v67
    v_mfma_f32_16x16x32_bf16 a[80:83], a[176:179], v[136:139], a[80:83]
    v_add_f32 v250, v40, v41
    v_cvt_pk_bf16_f32 v120, v40, v41
    v_mfma_f32_16x16x32_bf16 a[112:115], a[176:179], v[140:143], a[112:115]
    v_exp_f32 v44, v68
    v_mfma_f32_16x16x32_bf16 v[92:95], a[144:147], v[176:179], v[148:151]
    v_exp_f32 v45, v69
    v_mfma_f32_16x16x32_bf16 v[92:95], a[148:151], v[180:183], v[92:95]
    v_add_f32 v250, v250, v42
    v_add_f32 v250, v250, v43
    v_mfma_f32_16x16x32_bf16 v[92:95], a[152:155], v[184:187], v[92:95]
    buffer_load_dwordx4 v27, s[24:27], s41 offen offset:1024 nt lds
    s_add_u32 s41, s41, 2048
    v_mfma_f32_16x16x32_bf16 v[92:95], a[156:159], v[188:191], v[92:95]
    v_cvt_pk_bf16_f32 v121, v42, v43
    v_exp_f32 v46, v70
    v_mfma_f32_16x16x32_bf16 a[20:23], a[180:183], v[128:131], a[20:23]
    v_exp_f32 v47, v71
    v_mfma_f32_16x16x32_bf16 a[52:55], a[180:183], v[132:135], a[52:55]
    v_add_f32 v250, v250, v44
    v_add_f32 v250, v250, v45
    v_mfma_f32_16x16x32_bf16 a[84:87], a[180:183], v[136:139], a[84:87]
    v_cvt_pk_bf16_f32 v122, v44, v45
    v_exp_f32 v40, v72
    v_mfma_f32_16x16x32_bf16 a[116:119], a[180:183], v[140:143], a[116:119]
    v_exp_f32 v41, v73
    s_waitcnt lgkmcnt(0)
    v_mfma_f32_16x16x32_bf16 v[100:103], a[144:147], v[192:195], v[152:155]
    ds_read_b128 a[128:131], v8 offset:32768
    v_add_f32 v250, v250, v46
    v_mfma_f32_16x16x32_bf16 v[100:103], a[148:151], v[196:199], v[100:103]
    ds_read_b128 a[132:135], v9 offset:32768
    v_add_f32 v250, v250, v47
    v_mfma_f32_16x16x32_bf16 v[100:103], a[152:155], v[200:203], v[100:103]
    ds_read_b128 a[136:139], v10 offset:32768
    v_cvt_pk_bf16_f32 v123, v46, v47
    v_mfma_f32_16x16x32_bf16 v[100:103], a[156:159], v[204:207], v[100:103]
    ds_read_b128 a[140:143], v11 offset:32768
    v_exp_f32 v42, v74
    v_mfma_f32_16x16x32_bf16 a[24:27], a[184:187], v[128:131], a[24:27]
    ds_read_b64_tr_b16 a[160:161], v16 offset:16384
    v_exp_f32 v43, v75
    v_mfma_f32_16x16x32_bf16 a[56:59], a[184:187], v[132:135], a[56:59]
    ds_read_b64_tr_b16 a[162:163], v16 offset:20480
    v_add_f32 v251, v40, v41
    v_mfma_f32_16x16x32_bf16 a[88:91], a[184:187], v[136:139], a[88:91]
    v_cvt_pk_bf16_f32 v124, v40, v41
    v_exp_f32 v44, v76
    v_mfma_f32_16x16x32_bf16 a[120:123], a[184:187], v[140:143], a[120:123]
    v_exp_f32 v45, v77
    v_add_f32 v251, v251, v42
    v_mfma_f32_16x16x32_bf16 v[108:111], a[144:147], v[208:211], v[156:159]
    ds_read_b64_tr_b16 a[164:165], v17 offset:16384
    v_add_f32 v251, v251, v43
    v_cvt_pk_bf16_f32 v125, v42, v43
    v_mfma_f32_16x16x32_bf16 v[108:111], a[148:151], v[212:215], v[108:111]
    ds_read_b64_tr_b16 a[166:167], v17 offset:20480
    v_exp_f32 v46, v78
    v_mfma_f32_16x16x32_bf16 v[108:111], a[152:155], v[216:219], v[108:111]
    v_exp_f32 v47, v79
    v_mfma_f32_16x16x32_bf16 v[108:111], a[156:159], v[220:223], v[108:111]
    v_add_f32 v251, v251, v44
    v_add_f32 v251, v251, v45
    v_mfma_f32_16x16x32_bf16 a[28:31], a[188:191], v[128:131], a[28:31]
    ds_read_b64_tr_b16 a[168:169], v18 offset:16384
    v_cvt_pk_bf16_f32 v126, v44, v45
    v_add_f32 v251, v251, v46
    v_mfma_f32_16x16x32_bf16 a[60:63], a[188:191], v[132:135], a[60:63]
    ds_read_b64_tr_b16 a[170:171], v18 offset:20480
    v_add_f32 v251, v251, v47
    v_cvt_pk_bf16_f32 v127, v46, v47
    v_mfma_f32_16x16x32_bf16 a[92:95], a[188:191], v[136:139], a[92:95]
    v_max3_f32 v35, v248, v249, v250
    v_max_f32 v35, v35, v251
    v_cmp_lt_f32 vcc, s40, v35
    v_mfma_f32_16x16x32_bf16 a[124:127], a[188:191], v[140:143], a[124:127]
    s_cbranch_vccnz L_rare_h1p6
L_ret_h1p6:
    s_waitcnt lgkmcnt(2)
    s_mov_b32 s39, 4
L_loop1:
    v_mfma_f32_16x16x32_bf16 v[48:51], a[128:131], v[160:163], v[144:147]
    ds_read_b128 a[144:147], v8 offset:36864
    v_add_f32 v244, v244, v248
    v_mfma_f32_16x16x32_bf16 v[48:51], a[132:135], v[164:167], v[48:51]
    v_add_f32 v245, v245, v249
    v_add_f32 v246, v246, v250
    v_mfma_f32_16x16x32_bf16 v[48:51], a[136:139], v[168:171], v[48:51]
    ds_read_b128 a[148:151], v9 offset:36864
    v_add_f32 v247, v247, v251
    v_mfma_f32_16x16x32_bf16 v[48:51], a[140:143], v[172:175], v[48:51]
    v_exp_f32 v40, v80
    v_mfma_f32_16x16x32_bf16 a[0:3], a[160:163], v[112:115], a[0:3]
    ds_read_b64_tr_b16 a[172:173], v19 offset:16384
    v_exp_f32 v41, v81
    v_mfma_f32_16x16x32_bf16 a[32:35], a[160:163], v[116:119], a[32:35]
    ds_read_b64_tr_b16 a[174:175], v19 offset:20480
    v_exp_f32 v42, v82
    v_mfma_f32_16x16x32_bf16 a[64:67], a[160:163], v[120:123], a[64:67]
    v_exp_f32 v43, v83
    v_mfma_f32_16x16x32_bf16 a[96:99], a[160:163], v[124:127], a[96:99]
    v_add_f32 v4, v40, v41
    v_cvt_pk_bf16_f32 v128, v40, v41
    v_mfma_f32_16x16x32_bf16 v[56:59], a[128:131], v[176:179], v[148:151]
    ds_read_b128 a[152:155], v10 offset:36864
    v_exp_f32 v44, v84
    v_mfma_f32_16x16x32_bf16 v[56:59], a[132:135], v[180:183], v[56:59]
    v_exp_f32 v45, v85
    v_mfma_f32_16x16x32_bf16 v[56:59], a[136:139], v[184:187], v[56:59]
    ds_read_b128 a[156:159], v11 offset:36864
    v_add_f32 v4, v4, v42
    v_mfma_f32_16x16x32_bf16 v[56:59], a[140:143], v[188:191], v[56:59]
    v_add_f32 v4, v4, v43
    v_cvt_pk_bf16_f32 v129, v42, v43
    v_mfma_f32_16x16x32_bf16 a[4:7], a[164:167], v[112:115], a[4:7]
    ds_read_b64_tr_b16 a[176:177], v20 offset:16384
    v_exp_f32 v46, v86
    v_mfma_f32_16x16x32_bf16 a[36:39], a[164:167], v[116:119], a[36:39]
    ds_read_b64_tr_b16 a[178:179], v20 offset:20480
    v_exp_f32 v47, v87
    v_mfma_f32_16x16x32_bf16 a[68:71], a[164:167], v[120:123], a[68:71]
    v_add_f32 v4, v4, v44
    v_add_f32 v4, v4, v45
    v_mfma_f32_16x16x32_bf16 a[100:103], a[164:167], v[124:127], a[100:103]
    v_cvt_pk_bf16_f32 v130, v44, v45
    s_waitcnt lgkmcnt(4)
    v_mfma_f32_16x16x32_bf16 v[64:67], a[128:131], v[192:195], v[152:155]
    v_exp_f32 v40, v88
    v_mfma_f32_16x16x32_bf16 v[64:67], a[132:135], v[196:199], v[64:67]
    v_exp_f32 v41, v89
    s_add_u32 m0, s35, 16384
    v_mfma_f32_16x16x32_bf16 v[64:67], a[136:139], v[200:203], v[64:67]
    buffer_load_dwordx4 v24, s[20:23], s37 offen offset:0 nt lds
    v_add_f32 v4, v4, v46
    v_mfma_f32_16x16x32_bf16 v[64:67], a[140:143], v[204:207], v[64:67]
    v_add_f32 v4, v4, v47
    v_cvt_pk_bf16_f32 v131, v46, v47
    v_mfma_f32_16x16x32_bf16 a[8:11], a[168:171], v[112:115], a[8:11]
    ds_read_b64_tr_b16 a[180:181], v21 offset:16384
    v_exp_f32 v42, v90
    v_mfma_f32_16x16x32_bf16 a[40:43], a[168:171], v[116:119], a[40:43]
    ds_read_b64_tr_b16 a[182:183], v21 offset:20480
    v_exp_f32 v43, v91
    v_mfma_f32_16x16x32_bf16 a[72:75], a[168:171], v[120:123], a[72:75]
    v_add_f32 v5, v40, v41
    v_cvt_pk_bf16_f32 v132, v40, v41
    v_mfma_f32_16x16x32_bf16 a[104:107], a[168:171], v[124:127], a[104:107]
    v_exp_f32 v44, v92
    v_mfma_f32_16x16x32_bf16 v[72:75], a[128:131], v[208:211], v[156:159]
    v_exp_f32 v45, v93
    v_mfma_f32_16x16x32_bf16 v[72:75], a[132:135], v[212:215], v[72:75]
    v_add_f32 v5, v5, v42
    v_add_f32 v5, v5, v43
    v_mfma_f32_16x16x32_bf16 v[72:75], a[136:139], v[216:219], v[72:75]
    buffer_load_dwordx4 v25, s[20:23], s37 offen offset:1024 nt lds
    s_add_u32 m0, s36, 0
    v_mfma_f32_16x16x32_bf16 v[72:75], a[140:143], v[220:223], v[72:75]
    v_cvt_pk_bf16_f32 v133, v42, v43
    s_add_u32 s37, s37, 2048
    v_mfma_f32_16x16x32_bf16 a[12:15], a[172:175], v[112:115], a[12:15]
    ds_read_b64_tr_b16 a[184:185], v22 offset:16384
    v_exp_f32 v46, v94
    v_mfma_f32_16x16x32_bf16 a[44:47], a[172:175], v[116:119], a[44:47]
    ds_read_b64_tr_b16 a[186:187], v22 offset:20480
    v_exp_f32 v47, v95
    v_mfma_f32_16x16x32_bf16 a[76:79], a[172:175], v[120:123], a[76:79]
    v_add_f32 v5, v5, v44
    v_add_f32 v5, v5, v45
    v_mfma_f32_16x16x32_bf16 a[108:111], a[172:175], v[124:127], a[108:111]
    v_cvt_pk_bf16_f32 v134, v44, v45
    s_waitcnt lgkmcnt(2)
    v_mfma_f32_16x16x32_bf16 v[52:55], a[144:147], v[160:163], v[144:147]
    v_exp_f32 v40, v96
    v_mfma_f32_16x16x32_bf16 v[52:55], a[148:151], v[164:167], v[52:55]
    v_exp_f32 v41, v97
    v_mfma_f32_16x16x32_bf16 v[52:55], a[152:155], v[168:171], v[52:55]
    buffer_load_dwordx4 v26, s[24:27], s41 offen offset:0 nt lds
    v_add_f32 v5, v5, v46
    v_mfma_f32_16x16x32_bf16 v[52:55], a[156:159], v[172:175], v[52:55]
    v_add_f32 v5, v5, v47
    v_cvt_pk_bf16_f32 v135, v46, v47
    v_mfma_f32_16x16x32_bf16 a[16:19], a[176:179], v[112:115], a[16:19]
    ds_read_b64_tr_b16 a[188:189], v23 offset:16384
    v_exp_f32 v42, v98
    v_mfma_f32_16x16x32_bf16 a[48:51], a[176:179], v[116:119], a[48:51]
    ds_read_b64_tr_b16 a[190:191], v23 offset:20480
    v_exp_f32 v43, v99
    v_mfma_f32_16x16x32_bf16 a[80:83], a[176:179], v[120:123], a[80:83]
    v_add_f32 v6, v40, v41
    v_cvt_pk_bf16_f32 v136, v40, v41
    v_mfma_f32_16x16x32_bf16 a[112:115], a[176:179], v[124:127], a[112:115]
    v_exp_f32 v44, v100
    v_mfma_f32_16x16x32_bf16 v[60:63], a[144:147], v[176:179], v[148:151]
    v_exp_f32 v45, v101
    v_mfma_f32_16x16x32_bf16 v[60:63], a[148:151], v[180:183], v[60:63]
    v_add_f32 v6, v6, v42
    v_add_f32 v6, v6, v43
    v_mfma_f32_16x16x32_bf16 v[60:63], a[152:155], v[184:187], v[60:63]
    buffer_load_dwordx4 v27, s[24:27], s41 offen offset:1024 nt lds
    s_add_u32 s41, s41, 2048
    v_mfma_f32_16x16x32_bf16 v[60:63], a[156:159], v[188:191], v[60:63]
    v_cvt_pk_bf16_f32 v137, v42, v43
    v_exp_f32 v46, v102
    v_mfma_f32_16x16x32_bf16 a[20:23], a[180:183], v[112:115], a[20:23]
    v_exp_f32 v47, v103
    v_mfma_f32_16x16x32_bf16 a[52:55], a[180:183], v[116:119], a[52:55]
    v_add_f32 v6, v6, v44
    v_add_f32 v6, v6, v45
    v_mfma_f32_16x16x32_bf16 a[84:87], a[180:183], v[120:123], a[84:87]
    v_cvt_pk_bf16_f32 v138, v44, v45
    v_exp_f32 v40, v104
    v_mfma_f32_16x16x32_bf16 a[116:119], a[180:183], v[124:127], a[116:119]
    s_waitcnt vmcnt(8) lgkmcnt(0)
    s_barrier
    v_mfma_f32_16x16x32_bf16 v[68:71], a[144:147], v[192:195], v[152:155]
    ds_read_b128 a[128:131], v8 offset:40960
    v_exp_f32 v41, v105
    v_mfma_f32_16x16x32_bf16 v[68:71], a[148:151], v[196:199], v[68:71]
    ds_read_b128 a[132:135], v9 offset:40960
    v_add_f32 v6, v6, v46
    v_mfma_f32_16x16x32_bf16 v[68:71], a[152:155], v[200:203], v[68:71]
    ds_read_b128 a[136:139], v10 offset:40960
    v_add_f32 v6, v6, v47
    v_cvt_pk_bf16_f32 v139, v46, v47
    v_mfma_f32_16x16x32_bf16 v[68:71], a[156:159], v[204:207], v[68:71]
    ds_read_b128 a[140:143], v11 offset:40960
    v_exp_f32 v42, v106
    v_mfma_f32_16x16x32_bf16 a[24:27], a[184:187], v[112:115], a[24:27]
    ds_read_b64_tr_b16 a[160:161], v16 offset:24576
    v_exp_f32 v43, v107
    v_mfma_f32_16x16x32_bf16 a[56:59], a[184:187], v[116:119], a[56:59]
    ds_read_b64_tr_b16 a[162:163], v16 offset:28672
    v_add_f32 v7, v40, v41
    v_mfma_f32_16x16x32_bf16 a[88:91], a[184:187], v[120:123], a[88:91]
    v_cvt_pk_bf16_f32 v140, v40, v41
    v_exp_f32 v44, v108
    v_mfma_f32_16x16x32_bf16 a[120:123], a[184:187], v[124:127], a[120:123]
    v_exp_f32 v45, v109
    v_add_f32 v7, v7, v42
    v_mfma_f32_16x16x32_bf16 v[76:79], a[144:147], v[208:211], v[156:159]
    ds_read_b64_tr_b16 a[164:165], v17 offset:24576
    v_add_f32 v7, v7, v43
    v_cvt_pk_bf16_f32 v141, v42, v43
    v_mfma_f32_16x16x32_bf16 v[76:79], a[148:151], v[212:215], v[76:79]
    ds_read_b64_tr_b16 a[166:167], v17 offset:28672
    v_exp_f32 v46, v110
    v_mfma_f32_16x16x32_bf16 v[76:79], a[152:155], v[216:219], v[76:79]
    v_exp_f32 v47, v111
    v_mfma_f32_16x16x32_bf16 v[76:79], a[156:159], v[220:223], v[76:79]
    v_add_f32 v7, v7, v44
    v_add_f32 v7, v7, v45
    v_mfma_f32_16x16x32_bf16 a[28:31], a[188:191], v[112:115], a[28:31]
    ds_read_b64_tr_b16 a[168:169], v18 offset:24576
    v_cvt_pk_bf16_f32 v142, v44, v45
    v_add_f32 v7, v7, v46
    v_mfma_f32_16x16x32_bf16 a[60:63], a[188:191], v[116:119], a[60:63]
    ds_read_b64_tr_b16 a[170:171], v18 offset:28672
    v_add_f32 v7, v7, v47
    v_cvt_pk_bf16_f32 v143, v46, v47
    v_mfma_f32_16x16x32_bf16 a[92:95], a[188:191], v[120:123], a[92:95]
    v_max3_f32 v35, v4, v5, v6
    v_max_f32 v35, v35, v7
    v_cmp_lt_f32 vcc, s40, v35
    v_mfma_f32_16x16x32_bf16 a[124:127], a[188:191], v[124:127], a[124:127]
    s_cbranch_vccnz L_rare_h1u0
L_ret_h1u0:
    s_waitcnt lgkmcnt(2)
    v_mfma_f32_16x16x32_bf16 v[80:83], a[128:131], v[160:163], v[144:147]
    ds_read_b128 a[144:147], v8 offset:45056
    v_add_f32 v244, v244, v4
    v_mfma_f32_16x16x32_bf16 v[80:83], a[132:135], v[164:167], v[80:83]
    v_add_f32 v245, v245, v5
    v_add_f32 v246, v246, v6
    v_mfma_f32_16x16x32_bf16 v[80:83], a[136:139], v[168:171], v[80:83]
    ds_read_b128 a[148:151], v9 offset:45056
    v_add_f32 v247, v247, v7
    v_mfma_f32_16x16x32_bf16 v[80:83], a[140:143], v[172:175], v[80:83]
    v_exp_f32 v40, v48
    v_mfma_f32_16x16x32_bf16 a[0:3], a[160:163], v[128:131], a[0:3]
    ds_read_b64_tr_b16 a[172:173], v19 offset:24576
    v_exp_f32 v41, v49
    v_mfma_f32_16x16x32_bf16 a[32:35], a[160:163], v[132:135], a[32:35]
    ds_read_b64_tr_b16 a[174:175], v19 offset:28672
    v_exp_f32 v42, v50
    v_mfma_f32_16x16x32_bf16 a[64:67], a[160:163], v[136:139], a[64:67]
    v_exp_f32 v43, v51
    v_mfma_f32_16x16x32_bf16 a[96:99], a[160:163], v[140:143], a[96:99]
    v_add_f32 v248, v40, v41
    v_cvt_pk_bf16_f32 v112, v40, v41
    v_mfma_f32_16x16x32_bf16 v[88:91], a[128:131], v[176:179], v[148:151]
    ds_read_b128 a[152:155], v10 offset:45056
    v_exp_f32 v44, v52
    v_mfma_f32_16x16x32_bf16 v[88:91], a[132:135], v[180:183], v[88:91]
    v_exp_f32 v45, v53
    v_mfma_f32_16x16x32_bf16 v[88:91], a[136:139], v[184:187], v[88:91]
    ds_read_b128 a[156:159], v11 offset:45056
    v_add_f32 v248, v248, v42
    v_mfma_f32_16x16x32_bf16 v[88:91], a[140:143], v[188:191], v[88:91]
    v_add_f32 v248, v248, v43
    v_cvt_pk_bf16_f32 v113, v42, v43
    v_mfma_f32_16x16x32_bf16 a[4:7], a[164:167], v[128:131], a[4:7]
    ds_read_b64_tr_b16 a[176:177], v20 offset:24576
    v_exp_f32 v46, v54
    v_mfma_f32_16x16x32_bf16 a[36:39], a[164:167], v[132:135], a[36:39]
    ds_read_b64_tr_b16 a[178:179], v20 offset:28672
    v_exp_f32 v47, v55
    v_mfma_f32_16x16x32_bf16 a[68:71], a[164:167], v[136:139], a[68:71]
    v_add_f32 v248, v248, v44
    v_add_f32 v248, v248, v45
    v_mfma_f32_16x16x32_bf16 a[100:103], a[164:167], v[140:143], a[100:103]
    v_cvt_pk_bf16_f32 v114, v44, v45
    s_waitcnt lgkmcnt(4)
    v_mfma_f32_16x16x32_bf16 v[96:99], a[128:131], v[192:195], v[152:155]
    v_exp_f32 v40, v56
    v_mfma_f32_16x16x32_bf16 v[96:99], a[132:135], v[196:199], v[96:99]
    v_exp_f32 v41, v57
    s_add_u32 m0, s35, 24576
    v_mfma_f32_16x16x32_bf16 v[96:99], a[136:139], v[200:203], v[96:99]
    buffer_load_dwordx4 v24, s[20:23], s37 offen offset:0 nt lds
    v_add_f32 v248, v248, v46
    v_mfma_f32_16x16x32_bf16 v[96:99], a[140:143], v[204:207], v[96:99]
    v_add_f32 v248, v248, v47
    v_cvt_pk_bf16_f32 v115, v46, v47
    v_mfma_f32_16x16x32_bf16 a[8:11], a[168:171], v[128:131], a[8:11]
    ds_read_b64_tr_b16 a[180:181], v21 offset:24576
    v_exp_f32 v42, v58
    v_mfma_f32_16x16x32_bf16 a[40:43], a[168:171], v[132:135], a[40:43]
    ds_read_b64_tr_b16 a[182:183], v21 offset:28672
    v_exp_f32 v43, v59
    v_mfma_f32_16x16x32_bf16 a[72:75], a[168:171], v[136:139], a[72:75]
    v_add_f32 v249, v40, v41
    v_cvt_pk_bf16_f32 v116, v40, v41
    v_mfma_f32_16x16x32_bf16 a[104:107], a[168:171], v[140:143], a[104:107]
    v_exp_f32 v44, v60
    v_mfma_f32_16x16x32_bf16 v[104:107], a[128:131], v[208:211], v[156:159]
    v_exp_f32 v45, v61
    v_mfma_f32_16x16x32_bf16 v[104:107], a[132:135], v[212:215], v[104:107]
    v_add_f32 v249, v249, v42
    v_add_f32 v249, v249, v43
    v_mfma_f32_16x16x32_bf16 v[104:107], a[136:139], v[216:219], v[104:107]
    buffer_load_dwordx4 v25, s[20:23], s37 offen offset:1024 nt lds
    s_add_u32 m0, s36, 8192
    v_mfma_f32_16x16x32_bf16 v[104:107], a[140:143], v[220:223], v[104:107]
    v_cvt_pk_bf16_f32 v117, v42, v43
    s_add_u32 s37, s37, 2048
    v_mfma_f32_16x16x32_bf16 a[12:15], a[172:175], v[128:131], a[12:15]
    ds_read_b64_tr_b16 a[184:185], v22 offset:24576
    s_cmp_eq_u32 s37, 327680
    s_cmov_b32 s37, 268435456
    v_mfma_f32_16x16x32_bf16 a[44:47], a[172:175], v[132:135], a[44:47]
    ds_read_b64_tr_b16 a[186:187], v22 offset:28672
    v_exp_f32 v46, v62
    v_mfma_f32_16x16x32_bf16 a[76:79], a[172:175], v[136:139], a[76:79]
    v_exp_f32 v47, v63
    v_mfma_f32_16x16x32_bf16 a[108:111], a[172:175], v[140:143], a[108:111]
    v_add_f32 v249, v249, v44
    s_waitcnt lgkmcnt(2)
    v_mfma_f32_16x16x32_bf16 v[84:87], a[144:147], v[160:163], v[144:147]
    v_add_f32 v249, v249, v45
    v_cvt_pk_bf16_f32 v118, v44, v45
    v_mfma_f32_16x16x32_bf16 v[84:87], a[148:151], v[164:167], v[84:87]
    v_exp_f32 v40, v64
    v_mfma_f32_16x16x32_bf16 v[84:87], a[152:155], v[168:171], v[84:87]
    buffer_load_dwordx4 v26, s[24:27], s41 offen offset:0 nt lds
    v_exp_f32 v41, v65
    v_mfma_f32_16x16x32_bf16 v[84:87], a[156:159], v[172:175], v[84:87]
    v_add_f32 v249, v249, v46
    v_add_f32 v249, v249, v47
    v_mfma_f32_16x16x32_bf16 a[16:19], a[176:179], v[128:131], a[16:19]
    ds_read_b64_tr_b16 a[188:189], v23 offset:24576
    v_cvt_pk_bf16_f32 v119, v46, v47
    v_mfma_f32_16x16x32_bf16 a[48:51], a[176:179], v[132:135], a[48:51]
    ds_read_b64_tr_b16 a[190:191], v23 offset:28672
    v_exp_f32 v42, v66
    v_mfma_f32_16x16x32_bf16 a[80:83], a[176:179], v[136:139], a[80:83]
    v_exp_f32 v43, v67
    v_mfma_f32_16x16x32_bf16 a[112:115], a[176:179], v[140:143], a[112:115]
    v_add_f32 v250, v40, v41
    v_cvt_pk_bf16_f32 v120, v40, v41
    v_mfma_f32_16x16x32_bf16 v[92:95], a[144:147], v[176:179], v[148:151]
    v_exp_f32 v44, v68
    v_mfma_f32_16x16x32_bf16 v[92:95], a[148:151], v[180:183], v[92:95]
    v_exp_f32 v45, v69
    v_mfma_f32_16x16x32_bf16 v[92:95], a[152:155], v[184:187], v[92:95]
    buffer_load_dwordx4 v27, s[24:27], s41 offen offset:1024 nt lds
    s_add_u32 s41, s41, 2048
    v_mfma_f32_16x16x32_bf16 v[92:95], a[156:159], v[188:191], v[92:95]
    v_add_f32 v250, v250, v42
    v_add_f32 v250, v250, v43
    v_mfma_f32_16x16x32_bf16 a[20:23], a[180:183], v[128:131], a[20:23]
    v_cvt_pk_bf16_f32 v121, v42, v43
    v_exp_f32 v46, v70
    v_mfma_f32_16x16x32_bf16 a[52:55], a[180:183], v[132:135], a[52:55]
    v_exp_f32 v47, v71
    v_mfma_f32_16x16x32_bf16 a[84:87], a[180:183], v[136:139], a[84:87]
    v_add_f32 v250, v250, v44
    v_add_f32 v250, v250, v45
    v_cvt_pk_bf16_f32 v122, v44, v45
    v_mfma_f32_16x16x32_bf16 a[116:119], a[180:183], v[140:143], a[116:119]
    v_exp_f32 v40, v72
    s_waitcnt lgkmcnt(0)
    v_mfma_f32_16x16x32_bf16 v[100:103], a[144:147], v[192:195], v[152:155]
    ds_read_b128 a[128:131], v8 offset:0
    v_exp_f32 v41, v73
    v_mfma_f32_16x16x32_bf16 v[100:103], a[148:151], v[196:199], v[100:103]
    ds_read_b128 a[132:135], v9 offset:0
    v_add_f32 v250, v250, v46
    v_mfma_f32_16x16x32_bf16 v[100:103], a[152:155], v[200:203], v[100:103]
    ds_read_b128 a[136:139], v10 offset:0
    v_add_f32 v250, v250, v47
    v_cvt_pk_bf16_f32 v123, v46, v47
    v_mfma_f32_16x16x32_bf16 v[100:103], a[156:159], v[204:207], v[100:103]
    ds_read_b128 a[140:143], v11 offset:0
    v_exp_f32 v42, v74
    v_mfma_f32_16x16x32_bf16 a[24:27], a[184:187], v[128:131], a[24:27]
    ds_read_b64_tr_b16 a[160:161], v16 offset:32768
    v_exp_f32 v43, v75
    v_mfma_f32_16x16x32_bf16 a[56:59], a[184:187], v[132:135], a[56:59]
    ds_read_b64_tr_b16 a[162:163], v16 offset:36864
    v_add_f32 v251, v40, v41
    v_mfma_f32_16x16x32_bf16 a[88:91], a[184:187], v[136:139], a[88:91]
    v_cvt_pk_bf16_f32 v124, v40, v41
    v_exp_f32 v44, v76
    v_mfma_f32_16x16x32_bf16 a[120:123], a[184:187], v[140:143], a[120:123]
    v_exp_f32 v45, v77
    v_add_f32 v251, v251, v42
    v_mfma_f32_16x16x32_bf16 v[108:111], a[144:147], v[208:211], v[156:159]
    ds_read_b64_tr_b16 a[164:165], v17 offset:32768
    v_add_f32 v251, v251, v43
    v_cvt_pk_bf16_f32 v125, v42, v43
    v_mfma_f32_16x16x32_bf16 v[108:111], a[148:151], v[212:215], v[108:111]
    ds_read_b64_tr_b16 a[166:167], v17 offset:36864
    v_exp_f32 v46, v78
    v_mfma_f32_16x16x32_bf16 v[108:111], a[152:155], v[216:219], v[108:111]
    v_exp_f32 v47, v79
    v_mfma_f32_16x16x32_bf16 v[108:111], a[156:159], v[220:223], v[108:111]
    v_add_f32 v251, v251, v44
    v_add_f32 v251, v251, v45
    v_mfma_f32_16x16x32_bf16 a[28:31], a[188:191], v[128:131], a[28:31]
    ds_read_b64_tr_b16 a[168:169], v18 offset:32768
    v_cvt_pk_bf16_f32 v126, v44, v45
    v_add_f32 v251, v251, v46
    v_mfma_f32_16x16x32_bf16 a[60:63], a[188:191], v[132:135], a[60:63]
    ds_read_b64_tr_b16 a[170:171], v18 offset:36864
    v_add_f32 v251, v251, v47
    v_cvt_pk_bf16_f32 v127, v46, v47
    v_mfma_f32_16x16x32_bf16 a[92:95], a[188:191], v[136:139], a[92:95]
    v_max3_f32 v35, v248, v249, v250
    v_max_f32 v35, v35, v251
    v_cmp_lt_f32 vcc, s40, v35
    v_mfma_f32_16x16x32_bf16 a[124:127], a[188:191], v[140:143], a[124:127]
    s_cbranch_vccnz L_rare_h1u1
L_ret_h1u1:
    s_waitcnt lgkmcnt(2)
    v_mfma_f32_16x16x32_bf16 v[48:51], a[128:131], v[160:163], v[144:147]
    ds_read_b128 a[144:147], v8 offset:4096
    v_add_f32 v244, v244, v248
    v_mfma_f32_16x16x32_bf16 v[48:51], a[132:135], v[164:167], v[48:51]
    v_add_f32 v245, v245, v249
    v_add_f32 v246, v246, v250
    v_mfma_f32_16x16x32_bf16 v[48:51], a[136:139], v[168:171], v[48:51]
    ds_read_b128 a[148:151], v9 offset:4096
    v_add_f32 v247, v247, v251
    v_mfma_f32_16x16x32_bf16 v[48:51], a[140:143], v[172:175], v[48:51]
    v_exp_f32 v40, v80
    v_mfma_f32_16x16x32_bf16 a[0:3], a[160:163], v[112:115], a[0:3]
    ds_read_b64_tr_b16 a[172:173], v19 offset:32768
    v_exp_f32 v41, v81
    v_mfma_f32_16x16x32_bf16 a[32:35], a[160:163], v[116:119], a[32:35]
    ds_read_b64_tr_b16 a[174:175], v19 offset:36864
    v_exp_f32 v42, v82
    v_mfma_f32_16x16x32_bf16 a[64:67], a[160:163], v[120:123], a[64:67]
    v_exp_f32 v43, v83
    v_mfma_f32_16x16x32_bf16 a[96:99], a[160:163], v[124:127], a[96:99]
    v_add_f32 v4, v40, v41
    v_cvt_pk_bf16_f32 v128, v40, v41
    v_mfma_f32_16x16x32_bf16 v[56:59], a[128:131], v[176:179], v[148:151]
    ds_read_b128 a[152:155], v10 offset:4096
    v_exp_f32 v44, v84
    v_mfma_f32_16x16x32_bf16 v[56:59], a[132:135], v[180:183], v[56:59]
    v_exp_f32 v45, v85
    v_mfma_f32_16x16x32_bf16 v[56:59], a[136:139], v[184:187], v[56:59]
    ds_read_b128 a[156:159], v11 offset:4096
    v_add_f32 v4, v4, v42
    v_mfma_f32_16x16x32_bf16 v[56:59], a[140:143], v[188:191], v[56:59]
    v_add_f32 v4, v4, v43
    v_cvt_pk_bf16_f32 v129, v42, v43
    v_mfma_f32_16x16x32_bf16 a[4:7], a[164:167], v[112:115], a[4:7]
    ds_read_b64_tr_b16 a[176:177], v20 offset:32768
    v_exp_f32 v46, v86
    v_mfma_f32_16x16x32_bf16 a[36:39], a[164:167], v[116:119], a[36:39]
    ds_read_b64_tr_b16 a[178:179], v20 offset:36864
    v_exp_f32 v47, v87
    v_mfma_f32_16x16x32_bf16 a[68:71], a[164:167], v[120:123], a[68:71]
    v_add_f32 v4, v4, v44
    v_add_f32 v4, v4, v45
    v_mfma_f32_16x16x32_bf16 a[100:103], a[164:167], v[124:127], a[100:103]
    v_cvt_pk_bf16_f32 v130, v44, v45
    s_waitcnt lgkmcnt(4)
    v_mfma_f32_16x16x32_bf16 v[64:67], a[128:131], v[192:195], v[152:155]
    v_exp_f32 v40, v88
    v_mfma_f32_16x16x32_bf16 v[64:67], a[132:135], v[196:199], v[64:67]
    v_exp_f32 v41, v89
    s_add_u32 m0, s35, 32768
    v_mfma_f32_16x16x32_bf16 v[64:67], a[136:139], v[200:203], v[64:67]
    buffer_load_dwordx4 v24, s[20:23], s37 offen offset:0 nt lds
    v_add_f32 v4, v4, v46
    v_mfma_f32_16x16x32_bf16 v[64:67], a[140:143], v[204:207], v[64:67]
    v_add_f32 v4, v4, v47
    v_cvt_pk_bf16_f32 v131, v46, v47
    v_mfma_f32_16x16x32_bf16 a[8:11], a[168:171], v[112:115], a[8:11]
    ds_read_b64_tr_b16 a[180:181], v21 offset:32768
    v_exp_f32 v42, v90
    v_mfma_f32_16x16x32_bf16 a[40:43], a[168:171], v[116:119], a[40:43]
    ds_read_b64_tr_b16 a[182:183], v21 offset:36864
    v_exp_f32 v43, v91
    v_mfma_f32_16x16x32_bf16 a[72:75], a[168:171], v[120:123], a[72:75]
    v_add_f32 v5, v40, v41
    v_cvt_pk_bf16_f32 v132, v40, v41
    v_mfma_f32_16x16x32_bf16 a[104:107], a[168:171], v[124:127], a[104:107]
    v_exp_f32 v44, v92
    v_mfma_f32_16x16x32_bf16 v[72:75], a[128:131], v[208:211], v[156:159]
    v_exp_f32 v45, v93
    v_mfma_f32_16x16x32_bf16 v[72:75], a[132:135], v[212:215], v[72:75]
    v_add_f32 v5, v5, v42
    v_add_f32 v5, v5, v43
    v_mfma_f32_16x16x32_bf16 v[72:75], a[136:139], v[216:219], v[72:75]
    buffer_load_dwordx4 v25, s[20:23], s37 offen offset:1024 nt lds
    s_add_u32 m0, s36, 16384
    v_mfma_f32_16x16x32_bf16 v[72:75], a[140:143], v[220:223], v[72:75]
    v_cvt_pk_bf16_f32 v133, v42, v43
    s_add_u32 s37, s37, 2048
    v_mfma_f32_16x16x32_bf16 a[12:15], a[172:175], v[112:115], a[12:15]
    ds_read_b64_tr_b16 a[184:185], v22 offset:32768
    v_exp_f32 v46, v94
    v_mfma_f32_16x16x32_bf16 a[44:47], a[172:175], v[116:119], a[44:47]
    ds_read_b64_tr_b16 a[186:187], v22 offset:36864
    v_exp_f32 v47, v95
    v_mfma_f32_16x16x32_bf16 a[76:79], a[172:175], v[120:123], a[76:79]
    v_add_f32 v5, v5, v44
    v_add_f32 v5, v5, v45
    v_mfma_f32_16x16x32_bf16 a[108:111], a[172:175], v[124:127], a[108:111]
    v_cvt_pk_bf16_f32 v134, v44, v45
    s_waitcnt lgkmcnt(2)
    v_mfma_f32_16x16x32_bf16 v[52:55], a[144:147], v[160:163], v[144:147]
    v_exp_f32 v40, v96
    v_mfma_f32_16x16x32_bf16 v[52:55], a[148:151], v[164:167], v[52:55]
    v_exp_f32 v41, v97
    v_mfma_f32_16x16x32_bf16 v[52:55], a[152:155], v[168:171], v[52:55]
    buffer_load_dwordx4 v26, s[24:27], s41 offen offset:0 nt lds
    v_add_f32 v5, v5, v46
    v_mfma_f32_16x16x32_bf16 v[52:55], a[156:159], v[172:175], v[52:55]
    v_add_f32 v5, v5, v47
    v_cvt_pk_bf16_f32 v135, v46, v47
    v_mfma_f32_16x16x32_bf16 a[16:19], a[176:179], v[112:115], a[16:19]
    ds_read_b64_tr_b16 a[188:189], v23 offset:32768
    v_exp_f32 v42, v98
    v_mfma_f32_16x16x32_bf16 a[48:51], a[176:179], v[116:119], a[48:51]
    ds_read_b64_tr_b16 a[190:191], v23 offset:36864
    v_exp_f32 v43, v99
    v_mfma_f32_16x16x32_bf16 a[80:83], a[176:179], v[120:123], a[80:83]
    v_add_f32 v6, v40, v41
    v_cvt_pk_bf16_f32 v136, v40, v41
    v_mfma_f32_16x16x32_bf16 a[112:115], a[176:179], v[124:127], a[112:115]
    v_exp_f32 v44, v100
    v_mfma_f32_16x16x32_bf16 v[60:63], a[144:147], v[176:179], v[148:151]
    v_exp_f32 v45, v101
    v_mfma_f32_16x16x32_bf16 v[60:63], a[148:151], v[180:183], v[60:63]
    v_add_f32 v6, v6, v42
    v_add_f32 v6, v6, v43
    v_mfma_f32_16x16x32_bf16 v[60:63], a[152:155], v[184:187], v[60:63]
    buffer_load_dwordx4 v27, s[24:27], s41 offen offset:1024 nt lds
    s_add_u32 s41, s41, 2048
    v_mfma_f32_16x16x32_bf16 v[60:63], a[156:159], v[188:191], v[60:63]
    v_cvt_pk_bf16_f32 v137, v42, v43
    v_exp_f32 v46, v102
    v_mfma_f32_16x16x32_bf16 a[20:23], a[180:183], v[112:115], a[20:23]
    v_exp_f32 v47, v103
    v_mfma_f32_16x16x32_bf16 a[52:55], a[180:183], v[116:119], a[52:55]
    v_add_f32 v6, v6, v44
    v_add_f32 v6, v6, v45
    v_mfma_f32_16x16x32_bf16 a[84:87], a[180:183], v[120:123], a[84:87]
    v_cvt_pk_bf16_f32 v138, v44, v45
    v_exp_f32 v40, v104
    v_mfma_f32_16x16x32_bf16 a[116:119], a[180:183], v[124:127], a[116:119]
    s_waitcnt vmcnt(8) lgkmcnt(0)
    s_barrier
    v_mfma_f32_16x16x32_bf16 v[68:71], a[144:147], v[192:195], v[152:155]
    ds_read_b128 a[128:131], v8 offset:8192
    v_exp_f32 v41, v105
    v_mfma_f32_16x16x32_bf16 v[68:71], a[148:151], v[196:199], v[68:71]
    ds_read_b128 a[132:135], v9 offset:8192
    v_add_f32 v6, v6, v46
    v_mfma_f32_16x16x32_bf16 v[68:71], a[152:155], v[200:203], v[68:71]
    ds_read_b128 a[136:139], v10 offset:8192
    v_add_f32 v6, v6, v47
    v_cvt_pk_bf16_f32 v139, v46, v47
    v_mfma_f32_16x16x32_bf16 v[68:71], a[156:159], v[204:207], v[68:71]
    ds_read_b128 a[140:143], v11 offset:8192
    v_exp_f32 v42, v106
    v_mfma_f32_16x16x32_bf16 a[24:27], a[184:187], v[112:115], a[24:27]
    ds_read_b64_tr_b16 a[160:161], v16 offset:40960
    v_exp_f32 v43, v107
    v_mfma_f32_16x16x32_bf16 a[56:59], a[184:187], v[116:119], a[56:59]
    ds_read_b64_tr_b16 a[162:163], v16 offset:45056
    v_add_f32 v7, v40, v41
    v_mfma_f32_16x16x32_bf16 a[88:91], a[184:187], v[120:123], a[88:91]
    v_cvt_pk_bf16_f32 v140, v40, v41
    v_exp_f32 v44, v108
    v_mfma_f32_16x16x32_bf16 a[120:123], a[184:187], v[124:127], a[120:123]
    v_exp_f32 v45, v109
    v_add_f32 v7, v7, v42
    v_mfma_f32_16x16x32_bf16 v[76:79], a[144:147], v[208:211], v[156:159]
    ds_read_b64_tr_b16 a[164:165], v17 offset:40960
    v_add_f32 v7, v7, v43
    v_cvt_pk_bf16_f32 v141, v42, v43
    v_mfma_f32_16x16x32_bf16 v[76:79], a[148:151], v[212:215], v[76:79]
    ds_read_b64_tr_b16 a[166:167], v17 offset:45056
    v_exp_f32 v46, v110
    v_mfma_f32_16x16x32_bf16 v[76:79], a[152:155], v[216:219], v[76:79]
    v_exp_f32 v47, v111
    v_mfma_f32_16x16x32_bf16 v[76:79], a[156:159], v[220:223], v[76:79]
    v_add_f32 v7, v7, v44
    v_add_f32 v7, v7, v45
    v_mfma_f32_16x16x32_bf16 a[28:31], a[188:191], v[112:115], a[28:31]
    ds_read_b64_tr_b16 a[168:169], v18 offset:40960
    v_cvt_pk_bf16_f32 v142, v44, v45
    v_add_f32 v7, v7, v46
    v_mfma_f32_16x16x32_bf16 a[60:63], a[188:191], v[116:119], a[60:63]
    ds_read_b64_tr_b16 a[170:171], v18 offset:45056
    v_add_f32 v7, v7, v47
    v_cvt_pk_bf16_f32 v143, v46, v47
    v_mfma_f32_16x16x32_bf16 a[92:95], a[188:191], v[120:123], a[92:95]
    v_max3_f32 v35, v4, v5, v6
    v_max_f32 v35, v35, v7
    v_cmp_lt_f32 vcc, s40, v35
    v_mfma_f32_16x16x32_bf16 a[124:127], a[188:191], v[124:127], a[124:127]
    s_cbranch_vccnz L_rare_h1u2
L_ret_h1u2:
    s_waitcnt lgkmcnt(2)
    v_mfma_f32_16x16x32_bf16 v[80:83], a[128:131], v[160:163], v[144:147]
    ds_read_b128 a[144:147], v8 offset:12288
    v_add_f32 v244, v244, v4
    v_mfma_f32_16x16x32_bf16 v[80:83], a[132:135], v[164:167], v[80:83]
    v_add_f32 v245, v245, v5
    v_add_f32 v246, v246, v6
    v_mfma_f32_16x16x32_bf16 v[80:83], a[136:139], v[168:171], v[80:83]
    ds_read_b128 a[148:151], v9 offset:12288
    v_add_f32 v247, v247, v7
    v_mfma_f32_16x16x32_bf16 v[80:83], a[140:143], v[172:175], v[80:83]
    v_exp_f32 v40, v48
    v_mfma_f32_16x16x32_bf16 a[0:3], a[160:163], v[128:131], a[0:3]
    ds_read_b64_tr_b16 a[172:173], v19 offset:40960
    v_exp_f32 v41, v49
    v_mfma_f32_16x16x32_bf16 a[32:35], a[160:163], v[132:135], a[32:35]
    ds_read_b64_tr_b16 a[174:175], v19 offset:45056
    v_exp_f32 v42, v50
    v_mfma_f32_16x16x32_bf16 a[64:67], a[160:163], v[136:139], a[64:67]
    v_exp_f32 v43, v51
    v_mfma_f32_16x16x32_bf16 a[96:99], a[160:163], v[140:143], a[96:99]
    v_add_f32 v248, v40, v41
    v_cvt_pk_bf16_f32 v112, v40, v41
    v_mfma_f32_16x16x32_bf16 v[88:91], a[128:131], v[176:179], v[148:151]
    ds_read_b128 a[152:155], v10 offset:12288
    v_exp_f32 v44, v52
    v_mfma_f32_16x16x32_bf16 v[88:91], a[132:135], v[180:183], v[88:91]
    v_exp_f32 v45, v53
    v_mfma_f32_16x16x32_bf16 v[88:91], a[136:139], v[184:187], v[88:91]
    ds_read_b128 a[156:159], v11 offset:12288
    v_add_f32 v248, v248, v42
    v_mfma_f32_16x16x32_bf16 v[88:91], a[140:143], v[188:191], v[88:91]
    v_add_f32 v248, v248, v43
    v_cvt_pk_bf16_f32 v113, v42, v43
    v_mfma_f32_16x16x32_bf16 a[4:7], a[164:167], v[128:131], a[4:7]
    ds_read_b64_tr_b16 a[176:177], v20 offset:40960
    v_exp_f32 v46, v54
    v_mfma_f32_16x16x32_bf16 a[36:39], a[164:167], v[132:135], a[36:39]
    ds_read_b64_tr_b16 a[178:179], v20 offset:45056
    v_exp_f32 v47, v55
    v_mfma_f32_16x16x32_bf16 a[68:71], a[164:167], v[136:139], a[68:71]
    v_add_f32 v248, v248, v44
    v_add_f32 v248, v248, v45
    v_mfma_f32_16x16x32_bf16 a[100:103], a[164:167], v[140:143], a[100:103]
    v_cvt_pk_bf16_f32 v114, v44, v45
    s_waitcnt lgkmcnt(4)
    v_mfma_f32_16x16x32_bf16 v[96:99], a[128:131], v[192:195], v[152:155]
    v_exp_f32 v40, v56
    v_mfma_f32_16x16x32_bf16 v[96:99], a[132:135], v[196:199], v[96:99]
    v_exp_f32 v41, v57
    s_add_u32 m0, s35, 40960
    v_mfma_f32_16x16x32_bf16 v[96:99], a[136:139], v[200:203], v[96:99]
    buffer_load_dwordx4 v24, s[20:23], s37 offen offset:0 nt lds
    v_add_f32 v248, v248, v46
    v_mfma_f32_16x16x32_bf16 v[96:99], a[140:143], v[204:207], v[96:99]
    v_add_f32 v248, v248, v47
    v_cvt_pk_bf16_f32 v115, v46, v47
    v_mfma_f32_16x16x32_bf16 a[8:11], a[168:171], v[128:131], a[8:11]
    ds_read_b64_tr_b16 a[180:181], v21 offset:40960
    v_exp_f32 v42, v58
    v_mfma_f32_16x16x32_bf16 a[40:43], a[168:171], v[132:135], a[40:43]
    ds_read_b64_tr_b16 a[182:183], v21 offset:45056
    v_exp_f32 v43, v59
    v_mfma_f32_16x16x32_bf16 a[72:75], a[168:171], v[136:139], a[72:75]
    v_add_f32 v249, v40, v41
    v_cvt_pk_bf16_f32 v116, v40, v41
    v_mfma_f32_16x16x32_bf16 a[104:107], a[168:171], v[140:143], a[104:107]
    v_exp_f32 v44, v60
    v_mfma_f32_16x16x32_bf16 v[104:107], a[128:131], v[208:211], v[156:159]
    v_exp_f32 v45, v61
    v_mfma_f32_16x16x32_bf16 v[104:107], a[132:135], v[212:215], v[104:107]
    v_add_f32 v249, v249, v42
    v_add_f32 v249, v249, v43
    v_mfma_f32_16x16x32_bf16 v[104:107], a[136:139], v[216:219], v[104:107]
    buffer_load_dwordx4 v25, s[20:23], s37 offen offset:1024 nt lds
    s_add_u32 m0, s36, 24576
    v_mfma_f32_16x16x32_bf16 v[104:107], a[140:143], v[220:223], v[104:107]
    v_cvt_pk_bf16_f32 v117, v42, v43
    s_add_u32 s37, s37, 2048
    v_mfma_f32_16x16x32_bf16 a[12:15], a[172:175], v[128:131], a[12:15]
    ds_read_b64_tr_b16 a[184:185], v22 offset:40960
    v_exp_f32 v46, v62
    v_mfma_f32_16x16x32_bf16 a[44:47], a[172:175], v[132:135], a[44:47]
    ds_read_b64_tr_b16 a[186:187], v22 offset:45056
    v_exp_f32 v47, v63
    v_mfma_f32_16x16x32_bf16 a[76:79], a[172:175], v[136:139], a[76:79]
    v_add_f32 v249, v249, v44
    v_add_f32 v249, v249, v45
    v_mfma_f32_16x16x32_bf16 a[108:111], a[172:175], v[140:143], a[108:111]
    v_cvt_pk_bf16_f32 v118, v44, v45
    s_waitcnt lgkmcnt(2)
    v_mfma_f32_16x16x32_bf16 v[84:87], a[144:147], v[160:163], v[144:147]
    v_exp_f32 v40, v64
    v_mfma_f32_16x16x32_bf16 v[84:87], a[148:151], v[164:167], v[84:87]
    v_exp_f32 v41, v65
    v_mfma_f32_16x16x32_bf16 v[84:87], a[152:155], v[168:171], v[84:87]
    buffer_load_dwordx4 v26, s[24:27], s41 offen offset:0 nt lds
    v_add_f32 v249, v249, v46
    v_mfma_f32_16x16x32_bf16 v[84:87], a[156:159], v[172:175], v[84:87]
    v_add_f32 v249, v249, v47
    v_cvt_pk_bf16_f32 v119, v46, v47
    v_mfma_f32_16x16x32_bf16 a[16:19], a[176:179], v[128:131], a[16:19]
    ds_read_b64_tr_b16 a[188:189], v23 offset:40960
    v_exp_f32 v42, v66
    v_mfma_f32_16x16x32_bf16 a[48:51], a[176:179], v[132:135], a[48:51]
    ds_read_b64_tr_b16 a[190:191], v23 offset:45056
    v_exp_f32 v43, v67
    v_mfma_f32_16x16x32_bf16 a[80:83], a[176:179], v[136:139], a[80:83]
    v_add_f32 v250, v40, v41
    v_cvt_pk_bf16_f32 v120, v40, v41
    v_mfma_f32_16x16x32_bf16 a[112:115], a[176:179], v[140:143], a[112:115]
    v_exp_f32 v44, v68
    v_mfma_f32_16x16x32_bf16 v[92:95], a[144:147], v[176:179], v[148:151]
    v_exp_f32 v45, v69
    v_mfma_f32_16x16x32_bf16 v[92:95], a[148:151], v[180:183], v[92:95]
    v_add_f32 v250, v250, v42
    v_add_f32 v250, v250, v43
    v_mfma_f32_16x16x32_bf16 v[92:95], a[152:155], v[184:187], v[92:95]
    buffer_load_dwordx4 v27, s[24:27], s41 offen offset:1024 nt lds
    s_add_u32 s41, s41, 2048
    v_mfma_f32_16x16x32_bf16 v[92:95], a[156:159], v[188:191], v[92:95]
    s_cmp_eq_u32 s41, 327680
    s_cmov_b32 s41, 268435456
    v_mfma_f32_16x16x32_bf16 a[20:23], a[180:183], v[128:131], a[20:23]
    v_cvt_pk_bf16_f32 v121, v42, v43
    v_exp_f32 v46, v70
    v_mfma_f32_16x16x32_bf16 a[52:55], a[180:183], v[132:135], a[52:55]
    v_exp_f32 v47, v71
    v_mfma_f32_16x16x32_bf16 a[84:87], a[180:183], v[136:139], a[84:87]
    v_add_f32 v250, v250, v44
    v_add_f32 v250, v250, v45
    v_cvt_pk_bf16_f32 v122, v44, v45
    v_mfma_f32_16x16x32_bf16 a[116:119], a[180:183], v[140:143], a[116:119]
    v_exp_f32 v40, v72
    s_waitcnt lgkmcnt(0)
    v_mfma_f32_16x16x32_bf16 v[100:103], a[144:147], v[192:195], v[152:155]
    ds_read_b128 a[128:131], v8 offset:16384
    v_exp_f32 v41, v73
    v_mfma_f32_16x16x32_bf16 v[100:103], a[148:151], v[196:199], v[100:103]
    ds_read_b128 a[132:135], v9 offset:16384
    v_add_f32 v250, v250, v46
    v_mfma_f32_16x16x32_bf16 v[100:103], a[152:155], v[200:203], v[100:103]
    ds_read_b128 a[136:139], v10 offset:16384
    v_add_f32 v250, v250, v47
    v_cvt_pk_bf16_f32 v123, v46, v47
    v_mfma_f32_16x16x32_bf16 v[100:103], a[156:159], v[204:207], v[100:103]
    ds_read_b128 a[140:143], v11 offset:16384
    v_exp_f32 v42, v74
    v_mfma_f32_16x16x32_bf16 a[24:27], a[184:187], v[128:131], a[24:27]
    ds_read_b64_tr_b16 a[160:161], v16 offset:0
    v_exp_f32 v43, v75
    v_mfma_f32_16x16x32_bf16 a[56:59], a[184:187], v[132:135], a[56:59]
    ds_read_b64_tr_b16 a[162:163], v16 offset:4096
    v_add_f32 v251, v40, v41
    v_mfma_f32_16x16x32_bf16 a[88:91], a[184:187], v[136:139], a[88:91]
    v_cvt_pk_bf16_f32 v124, v40, v41
    v_exp_f32 v44, v76
    v_mfma_f32_16x16x32_bf16 a[120:123], a[184:187], v[140:143], a[120:123]
    v_exp_f32 v45, v77
    v_add_f32 v251, v251, v42
    v_mfma_f32_16x16x32_bf16 v[108:111], a[144:147], v[208:211], v[156:159]
    ds_read_b64_tr_b16 a[164:165], v17 offset:0
    v_add_f32 v251, v251, v43
    v_cvt_pk_bf16_f32 v125, v42, v43
    v_mfma_f32_16x16x32_bf16 v[108:111], a[148:151], v[212:215], v[108:111]
    ds_read_b64_tr_b16 a[166:167], v17 offset:4096
    v_exp_f32 v46, v78
    v_mfma_f32_16x16x32_bf16 v[108:111], a[152:155], v[216:219], v[108:111]
    v_exp_f32 v47, v79
    v_mfma_f32_16x16x32_bf16 v[108:111], a[156:159], v[220:223], v[108:111]
    v_add_f32 v251, v251, v44
    v_add_f32 v251, v251, v45
    v_mfma_f32_16x16x32_bf16 a[28:31], a[188:191], v[128:131], a[28:31]
    ds_read_b64_tr_b16 a[168:169], v18 offset:0
    v_cvt_pk_bf16_f32 v126, v44, v45
    v_add_f32 v251, v251, v46
    v_mfma_f32_16x16x32_bf16 a[60:63], a[188:191], v[132:135], a[60:63]
    ds_read_b64_tr_b16 a[170:171], v18 offset:4096
    v_add_f32 v251, v251, v47
    v_cvt_pk_bf16_f32 v127, v46, v47
    v_mfma_f32_16x16x32_bf16 a[92:95], a[188:191], v[136:139], a[92:95]
    v_max3_f32 v35, v248, v249, v250
    v_max_f32 v35, v35, v251
    v_cmp_lt_f32 vcc, s40, v35
    v_mfma_f32_16x16x32_bf16 a[124:127], a[188:191], v[140:143], a[124:127]
    s_cbranch_vccnz L_rare_h1u3
L_ret_h1u3:
    s_waitcnt lgkmcnt(2)
    v_mfma_f32_16x16x32_bf16 v[48:51], a[128:131], v[160:163], v[144:147]
    ds_read_b128 a[144:147], v8 offset:20480
    v_add_f32 v244, v244, v248
    v_mfma_f32_16x16x32_bf16 v[48:51], a[132:135], v[164:167], v[48:51]
    v_add_f32 v245, v245, v249
    v_add_f32 v246, v246, v250
    v_mfma_f32_16x16x32_bf16 v[48:51], a[136:139], v[168:171], v[48:51]
    ds_read_b128 a[148:151], v9 offset:20480
    v_add_f32 v247, v247, v251
    v_mfma_f32_16x16x32_bf16 v[48:51], a[140:143], v[172:175], v[48:51]
    v_exp_f32 v40, v80
    v_mfma_f32_16x16x32_bf16 a[0:3], a[160:163], v[112:115], a[0:3]
    ds_read_b64_tr_b16 a[172:173], v19 offset:0
    v_exp_f32 v41, v81
    v_mfma_f32_16x16x32_bf16 a[32:35], a[160:163], v[116:119], a[32:35]
    ds_read_b64_tr_b16 a[174:175], v19 offset:4096
    v_exp_f32 v42, v82
    v_mfma_f32_16x16x32_bf16 a[64:67], a[160:163], v[120:123], a[64:67]
    v_exp_f32 v43, v83
    v_mfma_f32_16x16x32_bf16 a[96:99], a[160:163], v[124:127], a[96:99]
    v_add_f32 v4, v40, v41
    v_cvt_pk_bf16_f32 v128, v40, v41
    v_mfma_f32_16x16x32_bf16 v[56:59], a[128:131], v[176:179], v[148:151]
    ds_read_b128 a[152:155], v10 offset:20480
    v_exp_f32 v44, v84
    v_mfma_f32_16x16x32_bf16 v[56:59], a[132:135], v[180:183], v[56:59]
    v_exp_f32 v45, v85
    v_mfma_f32_16x16x32_bf16 v[56:59], a[136:139], v[184:187], v[56:59]
    ds_read_b128 a[156:159], v11 offset:20480
    v_add_f32 v4, v4, v42
    v_mfma_f32_16x16x32_bf16 v[56:59], a[140:143], v[188:191], v[56:59]
    v_add_f32 v4, v4, v43
    v_cvt_pk_bf16_f32 v129, v42, v43
    v_mfma_f32_16x16x32_bf16 a[4:7], a[164:167], v[112:115], a[4:7]
    ds_read_b64_tr_b16 a[176:177], v20 offset:0
    v_exp_f32 v46, v86
    v_mfma_f32_16x16x32_bf16 a[36:39], a[164:167], v[116:119], a[36:39]
    ds_read_b64_tr_b16 a[178:179], v20 offset:4096
    v_exp_f32 v47, v87
    v_mfma_f32_16x16x32_bf16 a[68:71], a[164:167], v[120:123], a[68:71]
    v_add_f32 v4, v4, v44
    v_add_f32 v4, v4, v45
    v_mfma_f32_16x16x32_bf16 a[100:103], a[164:167], v[124:127], a[100:103]
    v_cvt_pk_bf16_f32 v130, v44, v45
    s_waitcnt lgkmcnt(4)
    v_mfma_f32_16x16x32_bf16 v[64:67], a[128:131], v[192:195], v[152:155]
    v_exp_f32 v40, v88
    v_mfma_f32_16x16x32_bf16 v[64:67], a[132:135], v[196:199], v[64:67]
    v_exp_f32 v41, v89
    s_add_u32 m0, s35, 0
    v_mfma_f32_16x16x32_bf16 v[64:67], a[136:139], v[200:203], v[64:67]
    buffer_load_dwordx4 v24, s[20:23], s37 offen offset:0 nt lds
    v_add_f32 v4, v4, v46
    v_mfma_f32_16x16x32_bf16 v[64:67], a[140:143], v[204:207], v[64:67]
    v_add_f32 v4, v4, v47
    v_cvt_pk_bf16_f32 v131, v46, v47
    v_mfma_f32_16x16x32_bf16 a[8:11], a[168:171], v[112:115], a[8:11]
    ds_read_b64_tr_b16 a[180:181], v21 offset:0
    v_exp_f32 v42, v90
    v_mfma_f32_16x16x32_bf16 a[40:43], a[168:171], v[116:119], a[40:43]
    ds_read_b64_tr_b16 a[182:183], v21 offset:4096
    v_exp_f32 v43, v91
    v_mfma_f32_16x16x32_bf16 a[72:75], a[168:171], v[120:123], a[72:75]
    v_add_f32 v5, v40, v41
    v_cvt_pk_bf16_f32 v132, v40, v41
    v_mfma_f32_16x16x32_bf16 a[104:107], a[168:171], v[124:127], a[104:107]
    v_exp_f32 v44, v92
    v_mfma_f32_16x16x32_bf16 v[72:75], a[128:131], v[208:211], v[156:159]
    v_exp_f32 v45, v93
    v_mfma_f32_16x16x32_bf16 v[72:75], a[132:135], v[212:215], v[72:75]
    v_add_f32 v5, v5, v42
    v_add_f32 v5, v5, v43
    v_mfma_f32_16x16x32_bf16 v[72:75], a[136:139], v[216:219], v[72:75]
    buffer_load_dwordx4 v25, s[20:23], s37 offen offset:1024 nt lds
    s_add_u32 m0, s36, 32768
    v_mfma_f32_16x16x32_bf16 v[72:75], a[140:143], v[220:223], v[72:75]
    v_cvt_pk_bf16_f32 v133, v42, v43
    s_add_u32 s37, s37, 2048
    v_mfma_f32_16x16x32_bf16 a[12:15], a[172:175], v[112:115], a[12:15]
    ds_read_b64_tr_b16 a[184:185], v22 offset:0
    v_exp_f32 v46, v94
    v_mfma_f32_16x16x32_bf16 a[44:47], a[172:175], v[116:119], a[44:47]
    ds_read_b64_tr_b16 a[186:187], v22 offset:4096
    v_exp_f32 v47, v95
    v_mfma_f32_16x16x32_bf16 a[76:79], a[172:175], v[120:123], a[76:79]
    v_add_f32 v5, v5, v44
    v_add_f32 v5, v5, v45
    v_mfma_f32_16x16x32_bf16 a[108:111], a[172:175], v[124:127], a[108:111]
    v_cvt_pk_bf16_f32 v134, v44, v45
    s_waitcnt lgkmcnt(2)
    v_mfma_f32_16x16x32_bf16 v[52:55], a[144:147], v[160:163], v[144:147]
    v_exp_f32 v40, v96
    v_mfma_f32_16x16x32_bf16 v[52:55], a[148:151], v[164:167], v[52:55]
    v_exp_f32 v41, v97
    v_mfma_f32_16x16x32_bf16 v[52:55], a[152:155], v[168:171], v[52:55]
    buffer_load_dwordx4 v26, s[24:27], s41 offen offset:0 nt lds
    v_add_f32 v5, v5, v46
    v_mfma_f32_16x16x32_bf16 v[52:55], a[156:159], v[172:175], v[52:55]
    v_add_f32 v5, v5, v47
    v_cvt_pk_bf16_f32 v135, v46, v47
    v_mfma_f32_16x16x32_bf16 a[16:19], a[176:179], v[112:115], a[16:19]
    ds_read_b64_tr_b16 a[188:189], v23 offset:0
    v_exp_f32 v42, v98
    v_mfma_f32_16x16x32_bf16 a[48:51], a[176:179], v[116:119], a[48:51]
    ds_read_b64_tr_b16 a[190:191], v23 offset:4096
    v_exp_f32 v43, v99
    v_mfma_f32_16x16x32_bf16 a[80:83], a[176:179], v[120:123], a[80:83]
    v_add_f32 v6, v40, v41
    v_cvt_pk_bf16_f32 v136, v40, v41
    v_mfma_f32_16x16x32_bf16 a[112:115], a[176:179], v[124:127], a[112:115]
    v_exp_f32 v44, v100
    v_mfma_f32_16x16x32_bf16 v[60:63], a[144:147], v[176:179], v[148:151]
    v_exp_f32 v45, v101
    v_mfma_f32_16x16x32_bf16 v[60:63], a[148:151], v[180:183], v[60:63]
    v_add_f32 v6, v6, v42
    v_add_f32 v6, v6, v43
    v_mfma_f32_16x16x32_bf16 v[60:63], a[152:155], v[184:187], v[60:63]
    buffer_load_dwordx4 v27, s[24:27], s41 offen offset:1024 nt lds
    s_add_u32 s41, s41, 2048
    v_mfma_f32_16x16x32_bf16 v[60:63], a[156:159], v[188:191], v[60:63]
    v_cvt_pk_bf16_f32 v137, v42, v43
    v_exp_f32 v46, v102
    v_mfma_f32_16x16x32_bf16 a[20:23], a[180:183], v[112:115], a[20:23]
    v_exp_f32 v47, v103
    v_mfma_f32_16x16x32_bf16 a[52:55], a[180:183], v[116:119], a[52:55]
    v_add_f32 v6, v6, v44
    v_add_f32 v6, v6, v45
    v_mfma_f32_16x16x32_bf16 a[84:87], a[180:183], v[120:123], a[84:87]
    v_cvt_pk_bf16_f32 v138, v44, v45
    v_exp_f32 v40, v104
    v_mfma_f32_16x16x32_bf16 a[116:119], a[180:183], v[124:127], a[116:119]
    s_waitcnt vmcnt(8) lgkmcnt(0)
    s_barrier
    v_mfma_f32_16x16x32_bf16 v[68:71], a[144:147], v[192:195], v[152:155]
    ds_read_b128 a[128:131], v8 offset:24576
    v_exp_f32 v41, v105
    v_mfma_f32_16x16x32_bf16 v[68:71], a[148:151], v[196:199], v[68:71]
    ds_read_b128 a[132:135], v9 offset:24576
    v_add_f32 v6, v6, v46
    v_mfma_f32_16x16x32_bf16 v[68:71], a[152:155], v[200:203], v[68:71]
    ds_read_b128 a[136:139], v10 offset:24576
    v_add_f32 v6, v6, v47
    v_cvt_pk_bf16_f32 v139, v46, v47
    v_mfma_f32_16x16x32_bf16 v[68:71], a[156:159], v[204:207], v[68:71]
    ds_read_b128 a[140:143], v11 offset:24576
    v_exp_f32 v42, v106
    v_mfma_f32_16x16x32_bf16 a[24:27], a[184:187], v[112:115], a[24:27]
    ds_read_b64_tr_b16 a[160:161], v16 offset:8192
    v_exp_f32 v43, v107
    v_mfma_f32_16x16x32_bf16 a[56:59], a[184:187], v[116:119], a[56:59]
    ds_read_b64_tr_b16 a[162:163], v16 offset:12288
    v_add_f32 v7, v40, v41
    v_mfma_f32_16x16x32_bf16 a[88:91], a[184:187], v[120:123], a[88:91]
    v_cvt_pk_bf16_f32 v140, v40, v41
    v_exp_f32 v44, v108
    v_mfma_f32_16x16x32_bf16 a[120:123], a[184:187], v[124:127], a[120:123]
    v_exp_f32 v45, v109
    v_add_f32 v7, v7, v42
    v_mfma_f32_16x16x32_bf16 v[76:79], a[144:147], v[208:211], v[156:159]
    ds_read_b64_tr_b16 a[164:165], v17 offset:8192
    v_add_f32 v7, v7, v43
    v_cvt_pk_bf16_f32 v141, v42, v43
    v_mfma_f32_16x16x32_bf16 v[76:79], a[148:151], v[212:215], v[76:79]
    ds_read_b64_tr_b16 a[166:167], v17 offset:12288
    v_exp_f32 v46, v110
    v_mfma_f32_16x16x32_bf16 v[76:79], a[152:155], v[216:219], v[76:79]
    v_exp_f32 v47, v111
    v_mfma_f32_16x16x32_bf16 v[76:79], a[156:159], v[220:223], v[76:79]
    v_add_f32 v7, v7, v44
    v_add_f32 v7, v7, v45
    v_mfma_f32_16x16x32_bf16 a[28:31], a[188:191], v[112:115], a[28:31]
    ds_read_b64_tr_b16 a[168:169], v18 offset:8192
    v_cvt_pk_bf16_f32 v142, v44, v45
    v_add_f32 v7, v7, v46
    v_mfma_f32_16x16x32_bf16 a[60:63], a[188:191], v[116:119], a[60:63]
    ds_read_b64_tr_b16 a[170:171], v18 offset:12288
    v_add_f32 v7, v7, v47
    v_cvt_pk_bf16_f32 v143, v46, v47
    v_mfma_f32_16x16x32_bf16 a[92:95], a[188:191], v[120:123], a[92:95]
    v_max3_f32 v35, v4, v5, v6
    v_max_f32 v35, v35, v7
    v_cmp_lt_f32 vcc, s40, v35
    v_mfma_f32_16x16x32_bf16 a[124:127], a[188:191], v[124:127], a[124:127]
    s_cbranch_vccnz L_rare_h1u4
L_ret_h1u4:
    s_waitcnt lgkmcnt(2)
    v_mfma_f32_16x16x32_bf16 v[80:83], a[128:131], v[160:163], v[144:147]
    ds_read_b128 a[144:147], v8 offset:28672
    v_add_f32 v244, v244, v4
    v_mfma_f32_16x16x32_bf16 v[80:83], a[132:135], v[164:167], v[80:83]
    v_add_f32 v245, v245, v5
    v_add_f32 v246, v246, v6
    v_mfma_f32_16x16x32_bf16 v[80:83], a[136:139], v[168:171], v[80:83]
    ds_read_b128 a[148:151], v9 offset:28672
    v_add_f32 v247, v247, v7
    v_mfma_f32_16x16x32_bf16 v[80:83], a[140:143], v[172:175], v[80:83]
    v_exp_f32 v40, v48
    v_mfma_f32_16x16x32_bf16 a[0:3], a[160:163], v[128:131], a[0:3]
    ds_read_b64_tr_b16 a[172:173], v19 offset:8192
    v_exp_f32 v41, v49
    v_mfma_f32_16x16x32_bf16 a[32:35], a[160:163], v[132:135], a[32:35]
    ds_read_b64_tr_b16 a[174:175], v19 offset:12288
    v_exp_f32 v42, v50
    v_mfma_f32_16x16x32_bf16 a[64:67], a[160:163], v[136:139], a[64:67]
    v_exp_f32 v43, v51
    v_mfma_f32_16x16x32_bf16 a[96:99], a[160:163], v[140:143], a[96:99]
    v_add_f32 v248, v40, v41
    v_cvt_pk_bf16_f32 v112, v40, v41
    v_mfma_f32_16x16x32_bf16 v[88:91], a[128:131], v[176:179], v[148:151]
    ds_read_b128 a[152:155], v10 offset:28672
    v_exp_f32 v44, v52
    v_mfma_f32_16x16x32_bf16 v[88:91], a[132:135], v[180:183], v[88:91]
    v_exp_f32 v45, v53
    v_mfma_f32_16x16x32_bf16 v[88:91], a[136:139], v[184:187], v[88:91]
    ds_read_b128 a[156:159], v11 offset:28672
    v_add_f32 v248, v248, v42
    v_mfma_f32_16x16x32_bf16 v[88:91], a[140:143], v[188:191], v[88:91]
    v_add_f32 v248, v248, v43
    v_cvt_pk_bf16_f32 v113, v42, v43
    v_mfma_f32_16x16x32_bf16 a[4:7], a[164:167], v[128:131], a[4:7]
    ds_read_b64_tr_b16 a[176:177], v20 offset:8192
    v_exp_f32 v46, v54
    v_mfma_f32_16x16x32_bf16 a[36:39], a[164:167], v[132:135], a[36:39]
    ds_read_b64_tr_b16 a[178:179], v20 offset:12288
    v_exp_f32 v47, v55
    v_mfma_f32_16x16x32_bf16 a[68:71], a[164:167], v[136:139], a[68:71]
    v_add_f32 v248, v248, v44
    v_add_f32 v248, v248, v45
    v_mfma_f32_16x16x32_bf16 a[100:103], a[164:167], v[140:143], a[100:103]
    v_cvt_pk_bf16_f32 v114, v44, v45
    s_waitcnt lgkmcnt(4)
    v_mfma_f32_16x16x32_bf16 v[96:99], a[128:131], v[192:195], v[152:155]
    v_exp_f32 v40, v56
    v_mfma_f32_16x16x32_bf16 v[96:99], a[132:135], v[196:199], v[96:99]
    v_exp_f32 v41, v57
    s_add_u32 m0, s35, 8192
    v_mfma_f32_16x16x32_bf16 v[96:99], a[136:139], v[200:203], v[96:99]
    buffer_load_dwordx4 v24, s[20:23], s37 offen offset:0 nt lds
    v_add_f32 v248, v248, v46
    v_mfma_f32_16x16x32_bf16 v[96:99], a[140:143], v[204:207], v[96:99]
    v_add_f32 v248, v248, v47
    v_cvt_pk_bf16_f32 v115, v46, v47
    v_mfma_f32_16x16x32_bf16 a[8:11], a[168:171], v[128:131], a[8:11]
    ds_read_b64_tr_b16 a[180:181], v21 offset:8192
    v_exp_f32 v42, v58
    v_mfma_f32_16x16x32_bf16 a[40:43], a[168:171], v[132:135], a[40:43]
    ds_read_b64_tr_b16 a[182:183], v21 offset:12288
    v_exp_f32 v43, v59
    v_mfma_f32_16x16x32_bf16 a[72:75], a[168:171], v[136:139], a[72:75]
    v_add_f32 v249, v40, v41
    v_cvt_pk_bf16_f32 v116, v40, v41
    v_mfma_f32_16x16x32_bf16 a[104:107], a[168:171], v[140:143], a[104:107]
    v_exp_f32 v44, v60
    v_mfma_f32_16x16x32_bf16 v[104:107], a[128:131], v[208:211], v[156:159]
    v_exp_f32 v45, v61
    v_mfma_f32_16x16x32_bf16 v[104:107], a[132:135], v[212:215], v[104:107]
    v_add_f32 v249, v249, v42
    v_add_f32 v249, v249, v43
    v_mfma_f32_16x16x32_bf16 v[104:107], a[136:139], v[216:219], v[104:107]
    buffer_load_dwordx4 v25, s[20:23], s37 offen offset:1024 nt lds
    s_add_u32 m0, s36, 40960
    v_mfma_f32_16x16x32_bf16 v[104:107], a[140:143], v[220:223], v[104:107]
    v_cvt_pk_bf16_f32 v117, v42, v43
    s_add_u32 s37, s37, 2048
    v_mfma_f32_16x16x32_bf16 a[12:15], a[172:175], v[128:131], a[12:15]
    ds_read_b64_tr_b16 a[184:185], v22 offset:8192
    v_exp_f32 v46, v62
    v_mfma_f32_16x16x32_bf16 a[44:47], a[172:175], v[132:135], a[44:47]
    ds_read_b64_tr_b16 a[186:187], v22 offset:12288
    v_exp_f32 v47, v63
    v_mfma_f32_16x16x32_bf16 a[76:79], a[172:175], v[136:139], a[76:79]
    v_add_f32 v249, v249, v44
    v_add_f32 v249, v249, v45
    v_mfma_f32_16x16x32_bf16 a[108:111], a[172:175], v[140:143], a[108:111]
    v_cvt_pk_bf16_f32 v118, v44, v45
    s_waitcnt lgkmcnt(2)
    v_mfma_f32_16x16x32_bf16 v[84:87], a[144:147], v[160:163], v[144:147]
    v_exp_f32 v40, v64
    v_mfma_f32_16x16x32_bf16 v[84:87], a[148:151], v[164:167], v[84:87]
    v_exp_f32 v41, v65
    v_mfma_f32_16x16x32_bf16 v[84:87], a[152:155], v[168:171], v[84:87]
    buffer_load_dwordx4 v26, s[24:27], s41 offen offset:0 nt lds
    v_add_f32 v249, v249, v46
    v_mfma_f32_16x16x32_bf16 v[84:87], a[156:159], v[172:175], v[84:87]
    v_add_f32 v249, v249, v47
    v_cvt_pk_bf16_f32 v119, v46, v47
    v_mfma_f32_16x16x32_bf16 a[16:19], a[176:179], v[128:131], a[16:19]
    ds_read_b64_tr_b16 a[188:189], v23 offset:8192
    v_exp_f32 v42, v66
    v_mfma_f32_16x16x32_bf16 a[48:51], a[176:179], v[132:135], a[48:51]
    ds_read_b64_tr_b16 a[190:191], v23 offset:12288
    v_exp_f32 v43, v67
    v_mfma_f32_16x16x32_bf16 a[80:83], a[176:179], v[136:139], a[80:83]
    v_add_f32 v250, v40, v41
    v_cvt_pk_bf16_f32 v120, v40, v41
    v_mfma_f32_16x16x32_bf16 a[112:115], a[176:179], v[140:143], a[112:115]
    v_exp_f32 v44, v68
    v_mfma_f32_16x16x32_bf16 v[92:95], a[144:147], v[176:179], v[148:151]
    v_exp_f32 v45, v69
    v_mfma_f32_16x16x32_bf16 v[92:95], a[148:151], v[180:183], v[92:95]
    v_add_f32 v250, v250, v42
    v_add_f32 v250, v250, v43
    v_mfma_f32_16x16x32_bf16 v[92:95], a[152:155], v[184:187], v[92:95]
    buffer_load_dwordx4 v27, s[24:27], s41 offen offset:1024 nt lds
    s_add_u32 s41, s41, 2048
    v_mfma_f32_16x16x32_bf16 v[92:95], a[156:159], v[188:191], v[92:95]
    v_cvt_pk_bf16_f32 v121, v42, v43
    v_exp_f32 v46, v70
    v_mfma_f32_16x16x32_bf16 a[20:23], a[180:183], v[128:131], a[20:23]
    v_exp_f32 v47, v71
    v_mfma_f32_16x16x32_bf16 a[52:55], a[180:183], v[132:135], a[52:55]
    v_add_f32 v250, v250, v44
    v_add_f32 v250, v250, v45
    v_mfma_f32_16x16x32_bf16 a[84:87], a[180:183], v[136:139], a[84:87]
    v_cvt_pk_bf16_f32 v122, v44, v45
    v_exp_f32 v40, v72
    v_mfma_f32_16x16x32_bf16 a[116:119], a[180:183], v[140:143], a[116:119]
    v_exp_f32 v41, v73
    s_waitcnt lgkmcnt(0)
    v_mfma_f32_16x16x32_bf16 v[100:103], a[144:147], v[192:195], v[152:155]
    ds_read_b128 a[128:131], v8 offset:32768
    v_add_f32 v250, v250, v46
    v_mfma_f32_16x16x32_bf16 v[100:103], a[148:151], v[196:199], v[100:103]
    ds_read_b128 a[132:135], v9 offset:32768
    v_add_f32 v250, v250, v47
    v_mfma_f32_16x16x32_bf16 v[100:103], a[152:155], v[200:203], v[100:103]
    ds_read_b128 a[136:139], v10 offset:32768
    v_cvt_pk_bf16_f32 v123, v46, v47
    v_mfma_f32_16x16x32_bf16 v[100:103], a[156:159], v[204:207], v[100:103]
    ds_read_b128 a[140:143], v11 offset:32768
    v_exp_f32 v42, v74
    v_mfma_f32_16x16x32_bf16 a[24:27], a[184:187], v[128:131], a[24:27]
    ds_read_b64_tr_b16 a[160:161], v16 offset:16384
    v_exp_f32 v43, v75
    v_mfma_f32_16x16x32_bf16 a[56:59], a[184:187], v[132:135], a[56:59]
    ds_read_b64_tr_b16 a[162:163], v16 offset:20480
    v_add_f32 v251, v40, v41
    v_mfma_f32_16x16x32_bf16 a[88:91], a[184:187], v[136:139], a[88:91]
    v_cvt_pk_bf16_f32 v124, v40, v41
    v_exp_f32 v44, v76
    v_mfma_f32_16x16x32_bf16 a[120:123], a[184:187], v[140:143], a[120:123]
    v_exp_f32 v45, v77
    v_add_f32 v251, v251, v42
    v_mfma_f32_16x16x32_bf16 v[108:111], a[144:147], v[208:211], v[156:159]
    ds_read_b64_tr_b16 a[164:165], v17 offset:16384
    v_add_f32 v251, v251, v43
    v_cvt_pk_bf16_f32 v125, v42, v43
    v_mfma_f32_16x16x32_bf16 v[108:111], a[148:151], v[212:215], v[108:111]
    ds_read_b64_tr_b16 a[166:167], v17 offset:20480
    v_exp_f32 v46, v78
    v_mfma_f32_16x16x32_bf16 v[108:111], a[152:155], v[216:219], v[108:111]
    v_exp_f32 v47, v79
    s_sub_u32 s39, s39, 1
    v_mfma_f32_16x16x32_bf16 v[108:111], a[156:159], v[220:223], v[108:111]
    v_add_f32 v251, v251, v44
    v_add_f32 v251, v251, v45
    v_cvt_pk_bf16_f32 v126, v44, v45
    v_mfma_f32_16x16x32_bf16 a[28:31], a[188:191], v[128:131], a[28:31]
    ds_read_b64_tr_b16 a[168:169], v18 offset:16384
    v_add_f32 v251, v251, v46
    s_cmp_lg_u32 s39, 0
    v_mfma_f32_16x16x32_bf16 a[60:63], a[188:191], v[132:135], a[60:63]
    ds_read_b64_tr_b16 a[170:171], v18 offset:20480
    v_add_f32 v251, v251, v47
    v_cvt_pk_bf16_f32 v127, v46, v47
    v_mfma_f32_16x16x32_bf16 a[92:95], a[188:191], v[136:139], a[92:95]
    v_max3_f32 v35, v248, v249, v250
    v_max_f32 v35, v35, v251
    v_cmp_lt_f32 vcc, s40, v35
    v_mfma_f32_16x16x32_bf16 a[124:127], a[188:191], v[140:143], a[124:127]
    s_cbranch_vccnz L_rare_h1u5
L_ret_h1u5:
    s_waitcnt lgkmcnt(2)
    s_cbranch_scc1 L_loop1
    s_branch L_loopx1
L_even1:
    v_mfma_f32_16x16x32_bf16 v[48:51], a[128:131], v[160:163], v[144:147]
    ds_read_b128 a[144:147], v8 offset:36864
    v_add_f32 v244, v244, v248
    v_add_f32 v245, v245, v249
    v_add_f32 v246, v246, v250
    v_mfma_f32_16x16x32_bf16 v[48:51], a[132:135], v[164:167], v[48:51]
    v_mfma_f32_16x16x32_bf16 v[48:51], a[136:139], v[168:171], v[48:51]
    ds_read_b128 a[148:151], v9 offset:36864
    v_add_f32 v247, v247, v251
    v_exp_f32 v40, v80
    v_mfma_f32_16x16x32_bf16 v[48:51], a[140:143], v[172:175], v[48:51]
    v_mfma_f32_16x16x32_bf16 a[0:3], a[160:163], v[112:115], 0
    ds_read_b64_tr_b16 a[172:173], v19 offset:16384
    v_exp_f32 v41, v81
    v_mfma_f32_16x16x32_bf16 a[32:35], a[160:163], v[116:119], 0
    ds_read_b64_tr_b16 a[174:175], v19 offset:20480
    v_exp_f32 v42, v82
    v_mfma_f32_16x16x32_bf16 a[64:67], a[160:163], v[120:123], 0
    v_exp_f32 v43, v83
    v_add_f32 v4, v40, v41
    v_mfma_f32_16x16x32_bf16 a[96:99], a[160:163], v[124:127], 0
    v_mfma_f32_16x16x32_bf16 v[56:59], a[128:131], v[176:179], v[148:151]
    ds_read_b128 a[152:155], v10 offset:36864
    v_cvt_pk_bf16_f32 v128, v40, v41
    v_exp_f32 v44, v84
    v_mfma_f32_16x16x32_bf16 v[56:59], a[132:135], v[180:183], v[56:59]
    v_mfma_f32_16x16x32_bf16 v[56:59], a[136:139], v[184:187], v[56:59]
    ds_read_b128 a[156:159], v11 offset:36864
    v_exp_f32 v45, v85
    v_add_f32 v4, v4, v42
    v_mfma_f32_16x16x32_bf16 v[56:59], a[140:143], v[188:191], v[56:59]
    v_mfma_f32_16x16x32_bf16 a[4:7], a[164:167], v[112:115], 0
    ds_read_b64_tr_b16 a[176:177], v20 offset:16384
    v_add_f32 v4, v4, v43
    v_cvt_pk_bf16_f32 v129, v42, v43
    v_exp_f32 v46, v86
    v_mfma_f32_16x16x32_bf16 a[36:39], a[164:167], v[116:119], 0
    ds_read_b64_tr_b16 a[178:179], v20 offset:20480
    v_exp_f32 v47, v87
    v_add_f32 v4, v4, v44
    v_mfma_f32_16x16x32_bf16 a[68:71], a[164:167], v[120:123], 0
    v_mfma_f32_16x16x32_bf16 a[100:103], a[164:167], v[124:127], 0
    v_add_f32 v4, v4, v45
    v_cvt_pk_bf16_f32 v130, v44, v45
    v_exp_f32 v40, v88
    s_waitcnt lgkmcnt(4)
    v_mfma_f32_16x16x32_bf16 v[64:67], a[128:131], v[192:195], v[152:155]
    v_exp_f32 v41, v89
    v_add_f32 v4, v4, v46
    v_add_f32 v4, v4, v47
    v_mfma_f32_16x16x32_bf16 v[64:67], a[132:135], v[196:199], v[64:67]
    v_cvt_pk_bf16_f32 v131, v46, v47
    v_exp_f32 v42, v90
    s_add_u32 m0, s35, 16384
    v_mfma_f32_16x16x32_bf16 v[64:67], a[136:139], v[200:203], v[64:67]
    buffer_load_dwordx4 v24, s[20:23], s37 offen offset:0 nt lds
    v_exp_f32 v43, v91
    v_add_f32 v5, v40, v41
    v_mfma_f32_16x16x32_bf16 v[64:67], a[140:143], v[204:207], v[64:67]
    v_mfma_f32_16x16x32_bf16 a[8:11], a[168:171], v[112:115], 0
    ds_read_b64_tr_b16 a[180:181], v21 offset:16384
    v_cvt_pk_bf16_f32 v132, v40, v41
    v_exp_f32 v44, v92
    v_mfma_f32_16x16x32_bf16 a[40:43], a[168:171], v[116:119], 0
    ds_read_b64_tr_b16 a[182:183], v21 offset:20480
    v_exp_f32 v45, v93
    v_add_f32 v5, v5, v42
    v_mfma_f32_16x16x32_bf16 a[72:75], a[168:171], v[120:123], 0
    v_mfma_f32_16x16x32_bf16 a[104:107], a[168:171], v[124:127], 0
    v_mfma_f32_16x16x32_bf16 v[72:75], a[128:131], v[208:211], v[156:159]
    v_mfma_f32_16x16x32_bf16 v[72:75], a[132:135], v[212:215], v[72:75]
    v_add_f32 v5, v5, v43
    v_cvt_pk_bf16_f32 v133, v42, v43
    v_exp_f32 v46, v94
    v_mfma_f32_16x16x32_bf16 v[72:75], a[136:139], v[216:219], v[72:75]
    buffer_load_dwordx4 v25, s[20:23], s37 offen offset:1024 nt lds
    v_exp_f32 v47, v95
    s_add_u32 m0, s36, 0
    v_mfma_f32_16x16x32_bf16 v[72:75], a[140:143], v[220:223], v[72:75]
    v_add_f32 v5, v5, v44
    v_add_f32 v5, v5, v45
    s_add_u32 s37, s37, 2048
    v_mfma_f32_16x16x32_bf16 a[12:15], a[172:175], v[112:115], 0
    ds_read_b64_tr_b16 a[184:185], v22 offset:16384
    v_cvt_pk_bf16_f32 v134, v44, v45
    v_exp_f32 v40, v96
    v_mfma_f32_16x16x32_bf16 a[44:47], a[172:175], v[116:119], 0
    ds_read_b64_tr_b16 a[186:187], v22 offset:20480
    v_exp_f32 v41, v97
    v_mfma_f32_16x16x32_bf16 a[76:79], a[172:175], v[120:123], 0
    v_mfma_f32_16x16x32_bf16 a[108:111], a[172:175], v[124:127], 0
    v_add_f32 v5, v5, v46
    v_add_f32 v5, v5, v47
    s_waitcnt lgkmcnt(2)
    v_mfma_f32_16x16x32_bf16 v[52:55], a[144:147], v[160:163], v[144:147]
    v_mfma_f32_16x16x32_bf16 v[52:55], a[148:151], v[164:167], v[52:55]
    v_mfma_f32_16x16x32_bf16 v[52:55], a[152:155], v[168:171], v[52:55]
    buffer_load_dwordx4 v26, s[24:27], s41 offen offset:0 nt lds
    v_cvt_pk_bf16_f32 v135, v46, v47
    v_exp_f32 v42, v98
    v_mfma_f32_16x16x32_bf16 v[52:55], a[156:159], v[172:175], v[52:55]
    v_mfma_f32_16x16x32_bf16 a[16:19], a[176:179], v[112:115], 0
    ds_read_b64_tr_b16 a[188:189], v23 offset:16384
    v_exp_f32 v43, v99
    v_add_f32 v6, v40, v41
    v_mfma_f32_16x16x32_bf16 a[48:51], a[176:179], v[116:119], 0
    ds_read_b64_tr_b16 a[190:191], v23 offset:20480
    v_cvt_pk_bf16_f32 v136, v40, v41
    v_exp_f32 v44, v100
    v_mfma_f32_16x16x32_bf16 a[80:83], a[176:179], v[120:123], 0
    v_exp_f32 v45, v101
    v_add_f32 v6, v6, v42
    v_mfma_f32_16x16x32_bf16 a[112:115], a[176:179], v[124:127], 0
    v_mfma_f32_16x16x32_bf16 v[60:63], a[144:147], v[176:179], v[148:151]
    v_mfma_f32_16x16x32_bf16 v[60:63], a[148:151], v[180:183], v[60:63]
    v_mfma_f32_16x16x32_bf16 v[60:63], a[152:155], v[184:187], v[60:63]
    buffer_load_dwordx4 v27, s[24:27], s41 offen offset:1024 nt lds
    v_add_f32 v6, v6, v43
    v_cvt_pk_bf16_f32 v137, v42, v43
    s_add_u32 s41, s41, 2048
    v_mfma_f32_16x16x32_bf16 v[60:63], a[156:159], v[188:191], v[60:63]
    v_mfma_f32_16x16x32_bf16 a[20:23], a[180:183], v[112:115], 0
    v_exp_f32 v46, v102
    v_exp_f32 v47, v103
    v_mfma_f32_16x16x32_bf16 a[52:55], a[180:183], v[116:119], 0
    v_mfma_f32_16x16x32_bf16 a[84:87], a[180:183], v[120:123], 0
    v_mfma_f32_16x16x32_bf16 a[116:119], a[180:183], v[124:127], 0
    v_add_f32 v6, v6, v44
    v_add_f32 v6, v6, v45
    s_waitcnt vmcnt(24) lgkmcnt(0)
    s_barrier
    v_mfma_f32_16x16x32_bf16 v[68:71], a[144:147], v[192:195], v[152:155]
    ds_read_b128 a[128:131], v8 offset:40960
    v_cvt_pk_bf16_f32 v138, v44, v45
    v_exp_f32 v40, v104
    v_mfma_f32_16x16x32_bf16 v[68:71], a[148:151], v[196:199], v[68:71]
    ds_read_b128 a[132:135], v9 offset:40960
    v_exp_f32 v41, v105
    v_mfma_f32_16x16x32_bf16 v[68:71], a[152:155], v[200:203], v[68:71]
    ds_read_b128 a[136:139], v10 offset:40960
    v_add_f32 v6, v6, v46
    v_add_f32 v6, v6, v47
    v_mfma_f32_16x16x32_bf16 v[68:71], a[156:159], v[204:207], v[68:71]
    ds_read_b128 a[140:143], v11 offset:40960
    v_cvt_pk_bf16_f32 v139, v46, v47
    v_exp_f32 v42, v106
    v_mfma_f32_16x16x32_bf16 a[24:27], a[184:187], v[112:115], 0
    ds_read_b64_tr_b16 a[160:161], v16 offset:24576
    v_exp_f32 v43, v107
    v_add_f32 v7, v40, v41
    v_mfma_f32_16x16x32_bf16 a[56:59], a[184:187], v[116:119], 0
    ds_read_b64_tr_b16 a[162:163], v16 offset:28672
    v_cvt_pk_bf16_f32 v140, v40, v41
    v_exp_f32 v44, v108
    v_mfma_f32_16x16x32_bf16 a[88:91], a[184:187], v[120:123], 0
    v_mfma_f32_16x16x32_bf16 a[120:123], a[184:187], v[124:127], 0
    v_mfma_f32_16x16x32_bf16 v[76:79], a[144:147], v[208:211], v[156:159]
    ds_read_b64_tr_b16 a[164:165], v17 offset:24576
    v_exp_f32 v45, v109
    v_add_f32 v7, v7, v42
    v_mfma_f32_16x16x32_bf16 v[76:79], a[148:151], v[212:215], v[76:79]
    ds_read_b64_tr_b16 a[166:167], v17 offset:28672
    v_add_f32 v7, v7, v43
    v_cvt_pk_bf16_f32 v141, v42, v43
    v_exp_f32 v46, v110
    v_mfma_f32_16x16x32_bf16 v[76:79], a[152:155], v[216:219], v[76:79]
    v_exp_f32 v47, v111
    v_add_f32 v7, v7, v44
    v_add_f32 v7, v7, v45
    v_mfma_f32_16x16x32_bf16 v[76:79], a[156:159], v[220:223], v[76:79]
    v_mfma_f32_16x16x32_bf16 a[28:31], a[188:191], v[112:115], 0
    ds_read_b64_tr_b16 a[168:169], v18 offset:24576
    v_cvt_pk_bf16_f32 v142, v44, v45
    v_add_f32 v7, v7, v46
    v_add_f32 v7, v7, v47
    v_mfma_f32_16x16x32_bf16 a[60:63], a[188:191], v[116:119], 0
    ds_read_b64_tr_b16 a[170:171], v18 offset:28672
    v_cvt_pk_bf16_f32 v143, v46, v47
    v_max3_f32 v35, v4, v5, v6
    v_max_f32 v35, v35, v7
    v_cmp_lt_f32 vcc, s40, v35
    v_mfma_f32_16x16x32_bf16 a[92:95], a[188:191], v[120:123], 0
    v_mfma_f32_16x16x32_bf16 a[124:127], a[188:191], v[124:127], 0
    s_cbranch_vccnz L_rare_h1q1
L_ret_h1q1:
    s_waitcnt lgkmcnt(2)
    v_mfma_f32_16x16x32_bf16 v[80:83], a[128:131], v[160:163], v[144:147]
    ds_read_b128 a[144:147], v8 offset:45056
    v_add_f32 v244, v244, v4
    v_add_f32 v245, v245, v5
    v_add_f32 v246, v246, v6
    v_mfma_f32_16x16x32_bf16 v[80:83], a[132:135], v[164:167], v[80:83]
    v_mfma_f32_16x16x32_bf16 v[80:83], a[136:139], v[168:171], v[80:83]
    ds_read_b128 a[148:151], v9 offset:45056
    v_add_f32 v247, v247, v7
    v_exp_f32 v40, v48
    v_mfma_f32_16x16x32_bf16 v[80:83], a[140:143], v[172:175], v[80:83]
    v_mfma_f32_16x16x32_bf16 a[0:3], a[160:163], v[128:131], a[0:3]
    ds_read_b64_tr_b16 a[172:173], v19 offset:24576
    v_exp_f32 v41, v49
    v_mfma_f32_16x16x32_bf16 a[32:35], a[160:163], v[132:135], a[32:35]
    ds_read_b64_tr_b16 a[174:175], v19 offset:28672
    v_exp_f32 v42, v50
    v_mfma_f32_16x16x32_bf16 a[64:67], a[160:163], v[136:139], a[64:67]
    v_exp_f32 v43, v51
    v_add_f32 v248, v40, v41
    v_mfma_f32_16x16x32_bf16 a[96:99], a[160:163], v[140:143], a[96:99]
    v_mfma_f32_16x16x32_bf16 v[88:91], a[128:131], v[176:179], v[148:151]
    ds_read_b128 a[152:155], v10 offset:45056
    v_cvt_pk_bf16_f32 v112, v40, v41
    v_exp_f32 v44, v52
    v_mfma_f32_16x16x32_bf16 v[88:91], a[132:135], v[180:183], v[88:91]
    v_mfma_f32_16x16x32_bf16 v[88:91], a[136:139], v[184:187], v[88:91]
    ds_read_b128 a[156:159], v11 offset:45056
    v_exp_f32 v45, v53
    v_add_f32 v248, v248, v42
    v_mfma_f32_16x16x32_bf16 v[88:91], a[140:143], v[188:191], v[88:91]
    v_mfma_f32_16x16x32_bf16 a[4:7], a[164:167], v[128:131], a[4:7]
    ds_read_b64_tr_b16 a[176:177], v20 offset:24576
    v_add_f32 v248, v248, v43
    v_cvt_pk_bf16_f32 v113, v42, v43
    v_exp_f32 v46, v54
    v_mfma_f32_16x16x32_bf16 a[36:39], a[164:167], v[132:135], a[36:39]
    ds_read_b64_tr_b16 a[178:179], v20 offset:28672
    v_exp_f32 v47, v55
    v_add_f32 v248, v248, v44
    v_mfma_f32_16x16x32_bf16 a[68:71], a[164:167], v[136:139], a[68:71]
    v_mfma_f32_16x16x32_bf16 a[100:103], a[164:167], v[140:143], a[100:103]
    v_add_f32 v248, v248, v45
    v_cvt_pk_bf16_f32 v114, v44, v45
    v_exp_f32 v40, v56
    s_waitcnt lgkmcnt(4)
    v_mfma_f32_16x16x32_bf16 v[96:99], a[128:131], v[192:195], v[152:155]
    v_exp_f32 v41, v57
    v_add_f32 v248, v248, v46
    v_add_f32 v248, v248, v47
    v_mfma_f32_16x16x32_bf16 v[96:99], a[132:135], v[196:199], v[96:99]
    v_cvt_pk_bf16_f32 v115, v46, v47
    v_exp_f32 v42, v58
    s_add_u32 m0, s35, 24576
    v_mfma_f32_16x16x32_bf16 v[96:99], a[136:139], v[200:203], v[96:99]
    buffer_load_dwordx4 v24, s[20:23], s37 offen offset:0 nt lds
    v_exp_f32 v43, v59
    v_add_f32 v249, v40, v41
    v_mfma_f32_16x16x32_bf16 v[96:99], a[140:143], v[204:207], v[96:99]
    v_mfma_f32_16x16x32_bf16 a[8:11], a[168:171], v[128:131], a[8:11]
    ds_read_b64_tr_b16 a[180:181], v21 offset:24576
    v_cvt_pk_bf16_f32 v116, v40, v41
    v_exp_f32 v44, v60
    v_mfma_f32_16x16x32_bf16 a[40:43], a[168:171], v[132:135], a[40:43]
    ds_read_b64_tr_b16 a[182:183], v21 offset:28672
    v_exp_f32 v45, v61
    v_add_f32 v249, v249, v42
    v_mfma_f32_16x16x32_bf16 a[72:75], a[168:171], v[136:139], a[72:75]
    v_mfma_f32_16x16x32_bf16 a[104:107], a[168:171], v[140:143], a[104:107]
    v_mfma_f32_16x16x32_bf16 v[104:107], a[128:131], v[208:211], v[156:159]
    v_mfma_f32_16x16x32_bf16 v[104:107], a[132:135], v[212:215], v[104:107]
    v_add_f32 v249, v249, v43
    v_cvt_pk_bf16_f32 v117, v42, v43
    v_exp_f32 v46, v62
    v_mfma_f32_16x16x32_bf16 v[104:107], a[136:139], v[216:219], v[104:107]
    buffer_load_dwordx4 v25, s[20:23], s37 offen offset:1024 nt lds
    v_exp_f32 v47, v63
    s_add_u32 m0, s36, 8192
    v_mfma_f32_16x16x32_bf16 v[104:107], a[140:143], v[220:223], v[104:107]
    v_add_f32 v249, v249, v44
    v_add_f32 v249, v249, v45
    s_add_u32 s37, s37, 2048
    v_mfma_f32_16x16x32_bf16 a[12:15], a[172:175], v[128:131], a[12:15]
    ds_read_b64_tr_b16 a[184:185], v22 offset:24576
    v_cvt_pk_bf16_f32 v118, v44, v45
    v_exp_f32 v40, v64
    v_mfma_f32_16x16x32_bf16 a[44:47], a[172:175], v[132:135], a[44:47]
    ds_read_b64_tr_b16 a[186:187], v22 offset:28672
    v_exp_f32 v41, v65
    v_mfma_f32_16x16x32_bf16 a[76:79], a[172:175], v[136:139], a[76:79]
    v_mfma_f32_16x16x32_bf16 a[108:111], a[172:175], v[140:143], a[108:111]
    v_add_f32 v249, v249, v46
    v_add_f32 v249, v249, v47
    s_waitcnt lgkmcnt(2)
    v_mfma_f32_16x16x32_bf16 v[84:87], a[144:147], v[160:163], v[144:147]
    v_mfma_f32_16x16x32_bf16 v[84:87], a[148:151], v[164:167], v[84:87]
    v_mfma_f32_16x16x32_bf16 v[84:87], a[152:155], v[168:171], v[84:87]
    buffer_load_dwordx4 v26, s[24:27], s41 offen offset:0 nt lds
    v_cvt_pk_bf16_f32 v119, v46, v47
    v_exp_f32 v42, v66
    v_mfma_f32_16x16x32_bf16 v[84:87], a[156:159], v[172:175], v[84:87]
    v_mfma_f32_16x16x32_bf16 a[16:19], a[176:179], v[128:131], a[16:19]
    ds_read_b64_tr_b16 a[188:189], v23 offset:24576
    v_exp_f32 v43, v67
    v_add_f32 v250, v40, v41
    v_mfma_f32_16x16x32_bf16 a[48:51], a[176:179], v[132:135], a[48:51]
    ds_read_b64_tr_b16 a[190:191], v23 offset:28672
    v_cvt_pk_bf16_f32 v120, v40, v41
    v_exp_f32 v44, v68
    v_mfma_f32_16x16x32_bf16 a[80:83], a[176:179], v[136:139], a[80:83]
    v_exp_f32 v45, v69
    v_add_f32 v250, v250, v42
    v_mfma_f32_16x16x32_bf16 a[112:115], a[176:179], v[140:143], a[112:115]
    v_mfma_f32_16x16x32_bf16 v[92:95], a[144:147], v[176:179], v[148:151]
    v_mfma_f32_16x16x32_bf16 v[92:95], a[148:151], v[180:183], v[92:95]
    v_mfma_f32_16x16x32_bf16 v[92:95], a[152:155], v[184:187], v[92:95]
    buffer_load_dwordx4 v27, s[24:27], s41 offen offset:1024 nt lds
    v_add_f32 v250, v250, v43
    v_cvt_pk_bf16_f32 v121, v42, v43
    s_add_u32 s41, s41, 2048
    v_mfma_f32_16x16x32_bf16 v[92:95], a[156:159], v[188:191], v[92:95]
    v_mfma_f32_16x16x32_bf16 a[20:23], a[180:183], v[128:131], a[20:23]
    v_exp_f32 v46, v70
    v_exp_f32 v47, v71
    v_mfma_f32_16x16x32_bf16 a[52:55], a[180:183], v[132:135], a[52:55]
    v_mfma_f32_16x16x32_bf16 a[84:87], a[180:183], v[136:139], a[84:87]
    v_mfma_f32_16x16x32_bf16 a[116:119], a[180:183], v[140:143], a[116:119]
    v_add_f32 v250, v250, v44
    v_add_f32 v250, v250, v45
    s_waitcnt lgkmcnt(0)
    v_mfma_f32_16x16x32_bf16 v[100:103], a[144:147], v[192:195], v[152:155]
    ds_read_b128 a[128:131], v8 offset:0
    v_cvt_pk_bf16_f32 v122, v44, v45
    v_exp_f32 v40, v72
    v_mfma_f32_16x16x32_bf16 v[100:103], a[148:151], v[196:199], v[100:103]
    ds_read_b128 a[132:135], v9 offset:0
    v_exp_f32 v41, v73
    v_mfma_f32_16x16x32_bf16 v[100:103], a[152:155], v[200:203], v[100:103]
    ds_read_b128 a[136:139], v10 offset:0
    v_add_f32 v250, v250, v46
    v_add_f32 v250, v250, v47
    v_mfma_f32_16x16x32_bf16 v[100:103], a[156:159], v[204:207], v[100:103]
    ds_read_b128 a[140:143], v11 offset:0
    v_cvt_pk_bf16_f32 v123, v46, v47
    v_exp_f32 v42, v74
    v_mfma_f32_16x16x32_bf16 a[24:27], a[184:187], v[128:131], a[24:27]
    ds_read_b64_tr_b16 a[160:161], v16 offset:32768
    v_exp_f32 v43, v75
    v_add_f32 v251, v40, v41
    v_mfma_f32_16x16x32_bf16 a[56:59], a[184:187], v[132:135], a[56:59]
    ds_read_b64_tr_b16 a[162:163], v16 offset:36864
    v_cvt_pk_bf16_f32 v124, v40, v41
    v_exp_f32 v44, v76
    v_mfma_f32_16x16x32_bf16 a[88:91], a[184:187], v[136:139], a[88:91]
    v_mfma_f32_16x16x32_bf16 a[120:123], a[184:187], v[140:143], a[120:123]
    v_mfma_f32_16x16x32_bf16 v[108:111], a[144:147], v[208:211], v[156:159]
    ds_read_b64_tr_b16 a[164:165], v17 offset:32768
    v_exp_f32 v45, v77
    v_add_f32 v251, v251, v42
    v_mfma_f32_16x16x32_bf16 v[108:111], a[148:151], v[212:215], v[108:111]
    ds_read_b64_tr_b16 a[166:167], v17 offset:36864
    v_add_f32 v251, v251, v43
    v_cvt_pk_bf16_f32 v125, v42, v43
    v_exp_f32 v46, v78
    v_mfma_f32_16x16x32_bf16 v[108:111], a[152:155], v[216:219], v[108:111]
    v_exp_f32 v47, v79
    v_add_f32 v251, v251, v44
    v_add_f32 v251, v251, v45
    v_mfma_f32_16x16x32_bf16 v[108:111], a[156:159], v[220:223], v[108:111]
    v_mfma_f32_16x16x32_bf16 a[28:31], a[188:191], v[128:131], a[28:31]
    ds_read_b64_tr_b16 a[168:169], v18 offset:32768
    v_cvt_pk_bf16_f32 v126, v44, v45
    v_add_f32 v251, v251, v46
    v_add_f32 v251, v251, v47
    v_mfma_f32_16x16x32_bf16 a[60:63], a[188:191], v[132:135], a[60:63]
    ds_read_b64_tr_b16 a[170:171], v18 offset:36864
    v_cvt_pk_bf16_f32 v127, v46, v47
    v_max3_f32 v35, v248, v249, v250
    v_max_f32 v35, v35, v251
    v_cmp_lt_f32 vcc, s40, v35
    v_mfma_f32_16x16x32_bf16 a[92:95], a[188:191], v[136:139], a[92:95]
    v_mfma_f32_16x16x32_bf16 a[124:127], a[188:191], v[140:143], a[124:127]
    s_cbranch_vccnz L_rare_h1q2
L_ret_h1q2:
    s_waitcnt lgkmcnt(2)
    v_mfma_f32_16x16x32_bf16 v[48:51], a[128:131], v[160:163], v[144:147]
    ds_read_b128 a[144:147], v8 offset:4096
    v_add_f32 v244, v244, v248
    v_add_f32 v245, v245, v249
    v_add_f32 v246, v246, v250
    v_mfma_f32_16x16x32_bf16 v[48:51], a[132:135], v[164:167], v[48:51]
    v_mfma_f32_16x16x32_bf16 v[48:51], a[136:139], v[168:171], v[48:51]
    ds_read_b128 a[148:151], v9 offset:4096
    v_add_f32 v247, v247, v251
    v_exp_f32 v40, v80
    v_mfma_f32_16x16x32_bf16 v[48:51], a[140:143], v[172:175], v[48:51]
    v_mfma_f32_16x16x32_bf16 a[0:3], a[160:163], v[112:115], a[0:3]
    ds_read_b64_tr_b16 a[172:173], v19 offset:32768
    v_exp_f32 v41, v81
    v_mfma_f32_16x16x32_bf16 a[32:35], a[160:163], v[116:119], a[32:35]
    ds_read_b64_tr_b16 a[174:175], v19 offset:36864
    v_exp_f32 v42, v82
    v_mfma_f32_16x16x32_bf16 a[64:67], a[160:163], v[120:123], a[64:67]
    v_exp_f32 v43, v83
    v_add_f32 v4, v40, v41
    v_mfma_f32_16x16x32_bf16 a[96:99], a[160:163], v[124:127], a[96:99]
    v_mfma_f32_16x16x32_bf16 v[56:59], a[128:131], v[176:179], v[148:151]
    ds_read_b128 a[152:155], v10 offset:4096
    v_cvt_pk_bf16_f32 v128, v40, v41
    v_exp_f32 v44, v84
    v_mfma_f32_16x16x32_bf16 v[56:59], a[132:135], v[180:183], v[56:59]
    v_mfma_f32_16x16x32_bf16 v[56:59], a[136:139], v[184:187], v[56:59]
    ds_read_b128 a[156:159], v11 offset:4096
    v_exp_f32 v45, v85
    v_add_f32 v4, v4, v42
    v_mfma_f32_16x16x32_bf16 v[56:59], a[140:143], v[188:191], v[56:59]
    v_mfma_f32_16x16x32_bf16 a[4:7], a[164:167], v[112:115], a[4:7]
    ds_read_b64_tr_b16 a[176:177], v20 offset:32768
    v_add_f32 v4, v4, v43
    v_cvt_pk_bf16_f32 v129, v42, v43
    v_exp_f32 v46, v86
    v_mfma_f32_16x16x32_bf16 a[36:39], a[164:167], v[116:119], a[36:39]
    ds_read_b64_tr_b16 a[178:179], v20 offset:36864
    v_exp_f32 v47, v87
    v_add_f32 v4, v4, v44
    v_mfma_f32_16x16x32_bf16 a[68:71], a[164:167], v[120:123], a[68:71]
    v_mfma_f32_16x16x32_bf16 a[100:103], a[164:167], v[124:127], a[100:103]
    v_add_f32 v4, v4, v45
    v_cvt_pk_bf16_f32 v130, v44, v45
    v_exp_f32 v40, v88
    s_waitcnt lgkmcnt(4)
    v_mfma_f32_16x16x32_bf16 v[64:67], a[128:131], v[192:195], v[152:155]
    v_exp_f32 v41, v89
    v_add_f32 v4, v4, v46
    v_add_f32 v4, v4, v47
    v_mfma_f32_16x16x32_bf16 v[64:67], a[132:135], v[196:199], v[64:67]
    v_cvt_pk_bf16_f32 v131, v46, v47
    v_exp_f32 v42, v90
    s_add_u32 m0, s35, 32768
    v_mfma_f32_16x16x32_bf16 v[64:67], a[136:139], v[200:203], v[64:67]
    buffer_load_dwordx4 v24, s[20:23], s37 offen offset:0 nt lds
    v_exp_f32 v43, v91
    v_add_f32 v5, v40, v41
    v_mfma_f32_16x16x32_bf16 v[64:67], a[140:143], v[204:207], v[64:67]
    v_mfma_f32_16x16x32_bf16 a[8:11], a[168:171], v[112:115], a[8:11]
    ds_read_b64_tr_b16 a[180:181], v21 offset:32768
    v_cvt_pk_bf16_f32 v132, v40, v41
    v_exp_f32 v44, v92
    v_mfma_f32_16x16x32_bf16 a[40:43], a[168:171], v[116:119], a[40:43]
    ds_read_b64_tr_b16 a[182:183], v21 offset:36864
    v_exp_f32 v45, v93
    v_add_f32 v5, v5, v42
    v_mfma_f32_16x16x32_bf16 a[72:75], a[168:171], v[120:123], a[72:75]
    v_mfma_f32_16x16x32_bf16 a[104:107], a[168:171], v[124:127], a[104:107]
    v_mfma_f32_16x16x32_bf16 v[72:75], a[128:131], v[208:211], v[156:159]
    v_mfma_f32_16x16x32_bf16 v[72:75], a[132:135], v[212:215], v[72:75]
    v_add_f32 v5, v5, v43
    v_cvt_pk_bf16_f32 v133, v42, v43
    v_exp_f32 v46, v94
    v_mfma_f32_16x16x32_bf16 v[72:75], a[136:139], v[216:219], v[72:75]
    buffer_load_dwordx4 v25, s[20:23], s37 offen offset:1024 nt lds
    v_exp_f32 v47, v95
    s_add_u32 m0, s36, 16384
    v_mfma_f32_16x16x32_bf16 v[72:75], a[140:143], v[220:223], v[72:75]
    v_add_f32 v5, v5, v44
    v_add_f32 v5, v5, v45
    s_add_u32 s37, s37, 2048
    v_mfma_f32_16x16x32_bf16 a[12:15], a[172:175], v[112:115], a[12:15]
    ds_read_b64_tr_b16 a[184:185], v22 offset:32768
    v_cvt_pk_bf16_f32 v134, v44, v45
    v_exp_f32 v40, v96
    v_mfma_f32_16x16x32_bf16 a[44:47], a[172:175], v[116:119], a[44:47]
    ds_read_b64_tr_b16 a[186:187], v22 offset:36864
    v_exp_f32 v41, v97
    v_mfma_f32_16x16x32_bf16 a[76:79], a[172:175], v[120:123], a[76:79]
    v_mfma_f32_16x16x32_bf16 a[108:111], a[172:175], v[124:127], a[108:111]
    v_add_f32 v5, v5, v46
    v_add_f32 v5, v5, v47
    s_waitcnt lgkmcnt(2)
    v_mfma_f32_16x16x32_bf16 v[52:55], a[144:147], v[160:163], v[144:147]
    v_mfma_f32_16x16x32_bf16 v[52:55], a[148:151], v[164:167], v[52:55]
    v_mfma_f32_16x16x32_bf16 v[52:55], a[152:155], v[168:171], v[52:55]
    buffer_load_dwordx4 v26, s[24:27], s41 offen offset:0 nt lds
    v_cvt_pk_bf16_f32 v135, v46, v47
    v_exp_f32 v42, v98
    v_mfma_f32_16x16x32_bf16 v[52:55], a[156:159], v[172:175], v[52:55]
    v_mfma_f32_16x16x32_bf16 a[16:19], a[176:179], v[112:115], a[16:19]
    ds_read_b64_tr_b16 a[188:189], v23 offset:32768
    v_exp_f32 v43, v99
    v_add_f32 v6, v40, v41
    v_mfma_f32_16x16x32_bf16 a[48:51], a[176:179], v[116:119], a[48:51]
    ds_read_b64_tr_b16 a[190:191], v23 offset:36864
    v_cvt_pk_bf16_f32 v136, v40, v41
    v_exp_f32 v44, v100
    v_mfma_f32_16x16x32_bf16 a[80:83], a[176:179], v[120:123], a[80:83]
    v_exp_f32 v45, v101
    v_add_f32 v6, v6, v42
    v_mfma_f32_16x16x32_bf16 a[112:115], a[176:179], v[124:127], a[112:115]
    v_mfma_f32_16x16x32_bf16 v[60:63], a[144:147], v[176:179], v[148:151]
    v_mfma_f32_16x16x32_bf16 v[60:63], a[148:151], v[180:183], v[60:63]
    v_mfma_f32_16x16x32_bf16 v[60:63], a[152:155], v[184:187], v[60:63]
    buffer_load_dwordx4 v27, s[24:27], s41 offen offset:1024 nt lds
    v_add_f32 v6, v6, v43
    v_cvt_pk_bf16_f32 v137, v42, v43
    s_add_u32 s41, s41, 2048
    v_mfma_f32_16x16x32_bf16 v[60:63], a[156:159], v[188:191], v[60:63]
    v_mfma_f32_16x16x32_bf16 a[20:23], a[180:183], v[112:115], a[20:23]
    v_exp_f32 v46, v102
    v_exp_f32 v47, v103
    v_mfma_f32_16x16x32_bf16 a[52:55], a[180:183], v[116:119], a[52:55]
    v_mfma_f32_16x16x32_bf16 a[84:87], a[180:183], v[120:123], a[84:87]
    v_mfma_f32_16x16x32_bf16 a[116:119], a[180:183], v[124:127], a[116:119]
    v_add_f32 v6, v6, v44
    v_add_f32 v6, v6, v45
    s_waitcnt vmcnt(8) lgkmcnt(0)
    s_barrier
    v_mfma_f32_16x16x32_bf16 v[68:71], a[144:147], v[192:195], v[152:155]
    ds_read_b128 a[128:131], v8 offset:8192
    v_cvt_pk_bf16_f32 v138, v44, v45
    v_exp_f32 v40, v104
    v_mfma_f32_16x16x32_bf16 v[68:71], a[148:151], v[196:199], v[68:71]
    ds_read_b128 a[132:135], v9 offset:8192
    v_exp_f32 v41, v105
    v_mfma_f32_16x16x32_bf16 v[68:71], a[152:155], v[200:203], v[68:71]
    ds_read_b128 a[136:139], v10 offset:8192
    v_add_f32 v6, v6, v46
    v_add_f32 v6, v6, v47
    v_mfma_f32_16x16x32_bf16 v[68:71], a[156:159], v[204:207], v[68:71]
    ds_read_b128 a[140:143], v11 offset:8192
    v_cvt_pk_bf16_f32 v139, v46, v47
    v_exp_f32 v42, v106
    v_mfma_f32_16x16x32_bf16 a[24:27], a[184:187], v[112:115], a[24:27]
    ds_read_b64_tr_b16 a[160:161], v16 offset:40960
    v_exp_f32 v43, v107
    v_add_f32 v7, v40, v41
    v_mfma_f32_16x16x32_bf16 a[56:59], a[184:187], v[116:119], a[56:59]
    ds_read_b64_tr_b16 a[162:163], v16 offset:45056
    v_cvt_pk_bf16_f32 v140, v40, v41
    v_exp_f32 v44, v108
    v_mfma_f32_16x16x32_bf16 a[88:91], a[184:187], v[120:123], a[88:91]
    v_mfma_f32_16x16x32_bf16 a[120:123], a[184:187], v[124:127], a[120:123]
    v_mfma_f32_16x16x32_bf16 v[76:79], a[144:147], v[208:211], v[156:159]
    ds_read_b64_tr_b16 a[164:165], v17 offset:40960
    v_exp_f32 v45, v109
    v_add_f32 v7, v7, v42
    v_mfma_f32_16x16x32_bf16 v[76:79], a[148:151], v[212:215], v[76:79]
    ds_read_b64_tr_b16 a[166:167], v17 offset:45056
    v_add_f32 v7, v7, v43
    v_cvt_pk_bf16_f32 v141, v42, v43
    v_exp_f32 v46, v110
    v_mfma_f32_16x16x32_bf16 v[76:79], a[152:155], v[216:219], v[76:79]
    v_exp_f32 v47, v111
    v_add_f32 v7, v7, v44
    v_add_f32 v7, v7, v45
    v_mfma_f32_16x16x32_bf16 v[76:79], a[156:159], v[220:223], v[76:79]
    v_mfma_f32_16x16x32_bf16 a[28:31], a[188:191], v[112:115], a[28:31]
    ds_read_b64_tr_b16 a[168:169], v18 offset:40960
    v_cvt_pk_bf16_f32 v142, v44, v45
    v_add_f32 v7, v7, v46
    v_add_f32 v7, v7, v47
    v_mfma_f32_16x16x32_bf16 a[60:63], a[188:191], v[116:119], a[60:63]
    ds_read_b64_tr_b16 a[170:171], v18 offset:45056
    v_cvt_pk_bf16_f32 v143, v46, v47
    v_max3_f32 v35, v4, v5, v6
    v_max_f32 v35, v35, v7
    v_cmp_lt_f32 vcc, s40, v35
    v_mfma_f32_16x16x32_bf16 a[92:95], a[188:191], v[120:123], a[92:95]
    v_mfma_f32_16x16x32_bf16 a[124:127], a[188:191], v[124:127], a[124:127]
    s_cbranch_vccnz L_rare_h1q3
L_ret_h1q3:
    s_waitcnt lgkmcnt(2)
    v_mfma_f32_16x16x32_bf16 v[80:83], a[128:131], v[160:163], v[144:147]
    ds_read_b128 a[144:147], v8 offset:12288
    v_add_f32 v244, v244, v4
    v_add_f32 v245, v245, v5
    v_mfma_f32_16x16x32_bf16 v[80:83], a[132:135], v[164:167], v[80:83]
    v_mfma_f32_16x16x32_bf16 v[80:83], a[136:139], v[168:171], v[80:83]
    ds_read_b128 a[148:151], v9 offset:12288
    v_add_f32 v246, v246, v6
    v_add_f32 v247, v247, v7
    v_mfma_f32_16x16x32_bf16 v[80:83], a[140:143], v[172:175], v[80:83]
    v_exp_f32 v40, v48
    v_exp_f32 v41, v49
    v_mfma_f32_16x16x32_bf16 a[0:3], a[160:163], v[128:131], a[0:3]
    ds_read_b64_tr_b16 a[172:173], v19 offset:40960
    v_exp_f32 v42, v50
    v_mfma_f32_16x16x32_bf16 a[32:35], a[160:163], v[132:135], a[32:35]
    ds_read_b64_tr_b16 a[174:175], v19 offset:45056
    v_exp_f32 v43, v51
    v_mfma_f32_16x16x32_bf16 a[64:67], a[160:163], v[136:139], a[64:67]
    v_mfma_f32_16x16x32_bf16 a[96:99], a[160:163], v[140:143], a[96:99]
    v_mfma_f32_16x16x32_bf16 v[88:91], a[128:131], v[176:179], v[148:151]
    ds_read_b128 a[152:155], v10 offset:12288
    v_add_f32 v248, v40, v41
    v_cvt_pk_bf16_f32 v112, v40, v41
    v_mfma_f32_16x16x32_bf16 v[88:91], a[132:135], v[180:183], v[88:91]
    v_exp_f32 v44, v52
    v_exp_f32 v45, v53
    v_mfma_f32_16x16x32_bf16 v[88:91], a[136:139], v[184:187], v[88:91]
    ds_read_b128 a[156:159], v11 offset:12288
    v_add_f32 v248, v248, v42
    v_add_f32 v248, v248, v43
    v_mfma_f32_16x16x32_bf16 v[88:91], a[140:143], v[188:191], v[88:91]
    v_mfma_f32_16x16x32_bf16 a[4:7], a[164:167], v[128:131], a[4:7]
    ds_read_b64_tr_b16 a[176:177], v20 offset:40960
    v_cvt_pk_bf16_f32 v113, v42, v43
    v_exp_f32 v46, v54
    v_mfma_f32_16x16x32_bf16 a[36:39], a[164:167], v[132:135], a[36:39]
    ds_read_b64_tr_b16 a[178:179], v20 offset:45056
    v_exp_f32 v47, v55
    v_mfma_f32_16x16x32_bf16 a[68:71], a[164:167], v[136:139], a[68:71]
    v_mfma_f32_16x16x32_bf16 a[100:103], a[164:167], v[140:143], a[100:103]
    v_add_f32 v248, v248, v44
    v_add_f32 v248, v248, v45
    s_waitcnt lgkmcnt(4)
    v_mfma_f32_16x16x32_bf16 v[96:99], a[128:131], v[192:195], v[152:155]
    v_cvt_pk_bf16_f32 v114, v44, v45
    v_exp_f32 v40, v56
    v_mfma_f32_16x16x32_bf16 v[96:99], a[132:135], v[196:199], v[96:99]
    v_exp_f32 v41, v57
    s_add_u32 m0, s35, 40960
    v_mfma_f32_16x16x32_bf16 v[96:99], a[136:139], v[200:203], v[96:99]
    buffer_load_dwordx4 v24, s[20:23], s37 offen offset:0 nt lds
    v_add_f32 v248, v248, v46
    v_add_f32 v248, v248, v47
    v_mfma_f32_16x16x32_bf16 v[96:99], a[140:143], v[204:207], v[96:99]
    v_mfma_f32_16x16x32_bf16 a[8:11], a[168:171], v[128:131], a[8:11]
    ds_read_b64_tr_b16 a[180:181], v21 offset:40960
    v_cvt_pk_bf16_f32 v115, v46, v47
    v_exp_f32 v42, v58
    v_mfma_f32_16x16x32_bf16 a[40:43], a[168:171], v[132:135], a[40:43]
    ds_read_b64_tr_b16 a[182:183], v21 offset:45056
    v_exp_f32 v43, v59
    v_mfma_f32_16x16x32_bf16 a[72:75], a[168:171], v[136:139], a[72:75]
    v_mfma_f32_16x16x32_bf16 a[104:107], a[168:171], v[140:143], a[104:107]
    v_add_f32 v249, v40, v41
    v_cvt_pk_bf16_f32 v116, v40, v41
    v_exp_f32 v44, v60
    v_mfma_f32_16x16x32_bf16 v[104:107], a[128:131], v[208:211], v[156:159]
    v_mfma_f32_16x16x32_bf16 v[104:107], a[132:135], v[212:215], v[104:107]
    v_mfma_f32_16x16x32_bf16 v[104:107], a[136:139], v[216:219], v[104:107]
    buffer_load_dwordx4 v25, s[20:23], s37 offen offset:1024 nt lds
    v_exp_f32 v45, v61
    s_add_u32 m0, s36, 24576
    v_mfma_f32_16x16x32_bf16 v[104:107], a[140:143], v[220:223], v[104:107]
    v_add_f32 v249, v249, v42
    v_add_f32 v249, v249, v43
    s_add_u32 s37, s37, 2048
    v_mfma_f32_16x16x32_bf16 a[12:15], a[172:175], v[128:131], a[12:15]
    ds_read_b64_tr_b16 a[184:185], v22 offset:40960
    v_cvt_pk_bf16_f32 v117, v42, v43
    v_exp_f32 v46, v62
    v_mfma_f32_16x16x32_bf16 a[44:47], a[172:175], v[132:135], a[44:47]
    ds_read_b64_tr_b16 a[186:187], v22 offset:45056
    v_exp_f32 v47, v63
    v_mfma_f32_16x16x32_bf16 a[76:79], a[172:175], v[136:139], a[76:79]
    v_add_f32 v249, v249, v44
    v_add_f32 v249, v249, v45
    v_cvt_pk_bf16_f32 v118, v44, v45
    v_mfma_f32_16x16x32_bf16 a[108:111], a[172:175], v[140:143], a[108:111]
    v_exp_f32 v40, v64
    s_waitcnt lgkmcnt(2)
    v_mfma_f32_16x16x32_bf16 v[84:87], a[144:147], v[160:163], v[144:147]
    v_mfma_f32_16x16x32_bf16 v[84:87], a[148:151], v[164:167], v[84:87]
    v_mfma_f32_16x16x32_bf16 v[84:87], a[152:155], v[168:171], v[84:87]
    buffer_load_dwordx4 v26, s[24:27], s41 offen offset:0 nt lds
    v_exp_f32 v41, v65
    v_add_f32 v249, v249, v46
    v_mfma_f32_16x16x32_bf16 v[84:87], a[156:159], v[172:175], v[84:87]
    v_add_f32 v249, v249, v47
    v_cvt_pk_bf16_f32 v119, v46, v47
    v_exp_f32 v42, v66
    v_mfma_f32_16x16x32_bf16 a[16:19], a[176:179], v[128:131], a[16:19]
    ds_read_b64_tr_b16 a[188:189], v23 offset:40960
    v_exp_f32 v43, v67
    v_add_f32 v250, v40, v41
    v_mfma_f32_16x16x32_bf16 a[48:51], a[176:179], v[132:135], a[48:51]
    ds_read_b64_tr_b16 a[190:191], v23 offset:45056
    v_cvt_pk_bf16_f32 v120, v40, v41
    v_exp_f32 v44, v68
    v_mfma_f32_16x16x32_bf16 a[80:83], a[176:179], v[136:139], a[80:83]
    v_mfma_f32_16x16x32_bf16 a[112:115], a[176:179], v[140:143], a[112:115]
    v_mfma_f32_16x16x32_bf16 v[92:95], a[144:147], v[176:179], v[148:151]
    v_exp_f32 v45, v69
    v_add_f32 v250, v250, v42
    v_mfma_f32_16x16x32_bf16 v[92:95], a[148:151], v[180:183], v[92:95]
    v_mfma_f32_16x16x32_bf16 v[92:95], a[152:155], v[184:187], v[92:95]
    buffer_load_dwordx4 v27, s[24:27], s41 offen offset:1024 nt lds
    v_add_f32 v250, v250, v43
    v_cvt_pk_bf16_f32 v121, v42, v43
    s_add_u32 s41, s41, 2048
    v_mfma_f32_16x16x32_bf16 v[92:95], a[156:159], v[188:191], v[92:95]
    v_mfma_f32_16x16x32_bf16 a[20:23], a[180:183], v[128:131], a[20:23]
    v_exp_f32 v46, v70
    v_exp_f32 v47, v71
    v_mfma_f32_16x16x32_bf16 a[52:55], a[180:183], v[132:135], a[52:55]
    v_mfma_f32_16x16x32_bf16 a[84:87], a[180:183], v[136:139], a[84:87]
    v_mfma_f32_16x16x32_bf16 a[116:119], a[180:183], v[140:143], a[116:119]
    v_add_f32 v250, v250, v44
    v_add_f32 v250, v250, v45
    s_waitcnt lgkmcnt(0)
    v_mfma_f32_16x16x32_bf16 v[100:103], a[144:147], v[192:195], v[152:155]
    ds_read_b128 a[128:131], v8 offset:16384
    v_cvt_pk_bf16_f32 v122, v44, v45
    v_exp_f32 v40, v72
    v_mfma_f32_16x16x32_bf16 v[100:103], a[148:151], v[196:199], v[100:103]
    ds_read_b128 a[132:135], v9 offset:16384
    v_exp_f32 v41, v73
    v_mfma_f32_16x16x32_bf16 v[100:103], a[152:155], v[200:203], v[100:103]
    ds_read_b128 a[136:139], v10 offset:16384
    v_add_f32 v250, v250, v46
    v_add_f32 v250, v250, v47
    v_mfma_f32_16x16x32_bf16 v[100:103], a[156:159], v[204:207], v[100:103]
    ds_read_b128 a[140:143], v11 offset:16384
    v_cvt_pk_bf16_f32 v123, v46, v47
    v_exp_f32 v42, v74
    v_mfma_f32_16x16x32_bf16 a[24:27], a[184:187], v[128:131], a[24:27]
    ds_read_b64_tr_b16 a[160:161], v16 offset:0
    v_exp_f32 v43, v75
    v_add_f32 v251, v40, v41
    v_mfma_f32_16x16x32_bf16 a[56:59], a[184:187], v[132:135], a[56:59]
    ds_read_b64_tr_b16 a[162:163], v16 offset:4096
    v_cvt_pk_bf16_f32 v124, v40, v41
    v_exp_f32 v44, v76
    v_mfma_f32_16x16x32_bf16 a[88:91], a[184:187], v[136:139], a[88:91]
    v_exp_f32 v45, v77
    v_add_f32 v251, v251, v42
    v_add_f32 v251, v251, v43
    v_mfma_f32_16x16x32_bf16 a[120:123], a[184:187], v[140:143], a[120:123]
    v_mfma_f32_16x16x32_bf16 v[108:111], a[144:147], v[208:211], v[156:159]
    ds_read_b64_tr_b16 a[164:165], v17 offset:0
    v_cvt_pk_bf16_f32 v125, v42, v43
    v_exp_f32 v46, v78
    v_mfma_f32_16x16x32_bf16 v[108:111], a[148:151], v[212:215], v[108:111]
    ds_read_b64_tr_b16 a[166:167], v17 offset:4096
    v_exp_f32 v47, v79
    v_mfma_f32_16x16x32_bf16 v[108:111], a[152:155], v[216:219], v[108:111]
    v_mfma_f32_16x16x32_bf16 v[108:111], a[156:159], v[220:223], v[108:111]
    v_add_f32 v251, v251, v44
    v_add_f32 v251, v251, v45
    v_cvt_pk_bf16_f32 v126, v44, v45
    v_mfma_f32_16x16x32_bf16 a[28:31], a[188:191], v[128:131], a[28:31]
    ds_read_b64_tr_b16 a[168:169], v18 offset:0
    v_add_f32 v251, v251, v46
    v_add_f32 v251, v251, v47
    v_cvt_pk_bf16_f32 v127, v46, v47
    v_mfma_f32_16x16x32_bf16 a[60:63], a[188:191], v[132:135], a[60:63]
    ds_read_b64_tr_b16 a[170:171], v18 offset:4096
    v_max3_f32 v35, v248, v249, v250
    v_max_f32 v35, v35, v251
    v_cmp_lt_f32 vcc, s40, v35
    v_mfma_f32_16x16x32_bf16 a[92:95], a[188:191], v[136:139], a[92:95]
    v_mfma_f32_16x16x32_bf16 a[124:127], a[188:191], v[140:143], a[124:127]
    s_cbranch_vccnz L_rare_h1q4
L_ret_h1q4:
    s_waitcnt lgkmcnt(2)
    v_mfma_f32_16x16x32_bf16 v[48:51], a[128:131], v[160:163], v[144:147]
    ds_read_b128 a[144:147], v8 offset:20480
    v_add_f32 v244, v244, v248
    v_add_f32 v245, v245, v249
    v_mfma_f32_16x16x32_bf16 v[48:51], a[132:135], v[164:167], v[48:51]
    v_mfma_f32_16x16x32_bf16 v[48:51], a[136:139], v[168:171], v[48:51]
    ds_read_b128 a[148:151], v9 offset:20480
    v_add_f32 v246, v246, v250
    v_add_f32 v247, v247, v251
    v_mfma_f32_16x16x32_bf16 v[48:51], a[140:143], v[172:175], v[48:51]
    v_exp_f32 v40, v80
    v_exp_f32 v41, v81
    v_mfma_f32_16x16x32_bf16 a[0:3], a[160:163], v[112:115], a[0:3]
    ds_read_b64_tr_b16 a[172:173], v19 offset:0
    v_exp_f32 v42, v82
    v_mfma_f32_16x16x32_bf16 a[32:35], a[160:163], v[116:119], a[32:35]
    ds_read_b64_tr_b16 a[174:175], v19 offset:4096
    v_exp_f32 v43, v83
    v_mfma_f32_16x16x32_bf16 a[64:67], a[160:163], v[120:123], a[64:67]
    v_mfma_f32_16x16x32_bf16 a[96:99], a[160:163], v[124:127], a[96:99]
    v_mfma_f32_16x16x32_bf16 v[56:59], a[128:131], v[176:179], v[148:151]
    ds_read_b128 a[152:155], v10 offset:20480
    v_add_f32 v4, v40, v41
    v_cvt_pk_bf16_f32 v128, v40, v41
    v_mfma_f32_16x16x32_bf16 v[56:59], a[132:135], v[180:183], v[56:59]
    v_exp_f32 v44, v84
    v_exp_f32 v45, v85
    v_mfma_f32_16x16x32_bf16 v[56:59], a[136:139], v[184:187], v[56:59]
    ds_read_b128 a[156:159], v11 offset:20480
    v_add_f32 v4, v4, v42
    v_add_f32 v4, v4, v43
    v_mfma_f32_16x16x32_bf16 v[56:59], a[140:143], v[188:191], v[56:59]
    v_mfma_f32_16x16x32_bf16 a[4:7], a[164:167], v[112:115], a[4:7]
    ds_read_b64_tr_b16 a[176:177], v20 offset:0
    v_cvt_pk_bf16_f32 v129, v42, v43
    v_exp_f32 v46, v86
    v_mfma_f32_16x16x32_bf16 a[36:39], a[164:167], v[116:119], a[36:39]
    ds_read_b64_tr_b16 a[178:179], v20 offset:4096
    v_exp_f32 v47, v87
    v_mfma_f32_16x16x32_bf16 a[68:71], a[164:167], v[120:123], a[68:71]
    v_mfma_f32_16x16x32_bf16 a[100:103], a[164:167], v[124:127], a[100:103]
    v_add_f32 v4, v4, v44
    v_add_f32 v4, v4, v45
    s_waitcnt lgkmcnt(4)
    v_mfma_f32_16x16x32_bf16 v[64:67], a[128:131], v[192:195], v[152:155]
    v_cvt_pk_bf16_f32 v130, v44, v45
    v_exp_f32 v40, v88
    v_mfma_f32_16x16x32_bf16 v[64:67], a[132:135], v[196:199], v[64:67]
    v_exp_f32 v41, v89
    s_add_u32 m0, s35, 0
    v_mfma_f32_16x16x32_bf16 v[64:67], a[136:139], v[200:203], v[64:67]
    buffer_load_dwordx4 v24, s[20:23], s37 offen offset:0 nt lds
    v_add_f32 v4, v4, v46
    v_add_f32 v4, v4, v47
    v_mfma_f32_16x16x32_bf16 v[64:67], a[140:143], v[204:207], v[64:67]
    v_mfma_f32_16x16x32_bf16 a[8:11], a[168:171], v[112:115], a[8:11]
    ds_read_b64_tr_b16 a[180:181], v21 offset:0
    v_cvt_pk_bf16_f32 v131, v46, v47
    v_exp_f32 v42, v90
    v_mfma_f32_16x16x32_bf16 a[40:43], a[168:171], v[116:119], a[40:43]
    ds_read_b64_tr_b16 a[182:183], v21 offset:4096
    v_exp_f32 v43, v91
    v_mfma_f32_16x16x32_bf16 a[72:75], a[168:171], v[120:123], a[72:75]
    v_mfma_f32_16x16x32_bf16 a[104:107], a[168:171], v[124:127], a[104:107]
    v_add_f32 v5, v40, v41
    v_cvt_pk_bf16_f32 v132, v40, v41
    v_exp_f32 v44, v92
    v_mfma_f32_16x16x32_bf16 v[72:75], a[128:131], v[208:211], v[156:159]
    v_mfma_f32_16x16x32_bf16 v[72:75], a[132:135], v[212:215], v[72:75]
    v_mfma_f32_16x16x32_bf16 v[72:75], a[136:139], v[216:219], v[72:75]
    buffer_load_dwordx4 v25, s[20:23], s37 offen offset:1024 nt lds
    v_exp_f32 v45, v93
    s_add_u32 m0, s36, 32768
    v_mfma_f32_16x16x32_bf16 v[72:75], a[140:143], v[220:223], v[72:75]
    v_add_f32 v5, v5, v42
    v_add_f32 v5, v5, v43
    s_add_u32 s37, s37, 2048
    v_mfma_f32_16x16x32_bf16 a[12:15], a[172:175], v[112:115], a[12:15]
    ds_read_b64_tr_b16 a[184:185], v22 offset:0
    v_cvt_pk_bf16_f32 v133, v42, v43
    v_exp_f32 v46, v94
    v_mfma_f32_16x16x32_bf16 a[44:47], a[172:175], v[116:119], a[44:47]
    ds_read_b64_tr_b16 a[186:187], v22 offset:4096
    v_exp_f32 v47, v95
    v_mfma_f32_16x16x32_bf16 a[76:79], a[172:175], v[120:123], a[76:79]
    v_add_f32 v5, v5, v44
    v_add_f32 v5, v5, v45
    v_cvt_pk_bf16_f32 v134, v44, v45
    v_mfma_f32_16x16x32_bf16 a[108:111], a[172:175], v[124:127], a[108:111]
    v_exp_f32 v40, v96
    s_waitcnt lgkmcnt(2)
    v_mfma_f32_16x16x32_bf16 v[52:55], a[144:147], v[160:163], v[144:147]
    v_mfma_f32_16x16x32_bf16 v[52:55], a[148:151], v[164:167], v[52:55]
    v_mfma_f32_16x16x32_bf16 v[52:55], a[152:155], v[168:171], v[52:55]
    buffer_load_dwordx4 v26, s[24:27], s41 offen offset:0 nt lds
    v_exp_f32 v41, v97
    v_add_f32 v5, v5, v46
    v_mfma_f32_16x16x32_bf16 v[52:55], a[156:159], v[172:175], v[52:55]
    v_add_f32 v5, v5, v47
    v_cvt_pk_bf16_f32 v135, v46, v47
    v_exp_f32 v42, v98
    v_mfma_f32_16x16x32_bf16 a[16:19], a[176:179], v[112:115], a[16:19]
    ds_read_b64_tr_b16 a[188:189], v23 offset:0
    v_exp_f32 v43, v99
    v_add_f32 v6, v40, v41
    v_mfma_f32_16x16x32_bf16 a[48:51], a[176:179], v[116:119], a[48:51]
    ds_read_b64_tr_b16 a[190:191], v23 offset:4096
    v_cvt_pk_bf16_f32 v136, v40, v41
    v_exp_f32 v44, v100
    v_mfma_f32_16x16x32_bf16 a[80:83], a[176:179], v[120:123], a[80:83]
    v_mfma_f32_16x16x32_bf16 a[112:115], a[176:179], v[124:127], a[112:115]
    v_mfma_f32_16x16x32_bf16 v[60:63], a[144:147], v[176:179], v[148:151]
    v_exp_f32 v45, v101
    v_add_f32 v6, v6, v42
    v_mfma_f32_16x16x32_bf16 v[60:63], a[148:151], v[180:183], v[60:63]
    v_mfma_f32_16x16x32_bf16 v[60:63], a[152:155], v[184:187], v[60:63]
    buffer_load_dwordx4 v27, s[24:27], s41 offen offset:1024 nt lds
    v_add_f32 v6, v6, v43
    v_cvt_pk_bf16_f32 v137, v42, v43
    s_add_u32 s41, s41, 2048
    v_mfma_f32_16x16x32_bf16 v[60:63], a[156:159], v[188:191], v[60:63]
    v_mfma_f32_16x16x32_bf16 a[20:23], a[180:183], v[112:115], a[20:23]
    v_exp_f32 v46, v102
    v_exp_f32 v47, v103
    v_mfma_f32_16x16x32_bf16 a[52:55], a[180:183], v[116:119], a[52:55]
    v_mfma_f32_16x16x32_bf16 a[84:87], a[180:183], v[120:123], a[84:87]
    v_mfma_f32_16x16x32_bf16 a[116:119], a[180:183], v[124:127], a[116:119]
    v_add_f32 v6, v6, v44
    v_add_f32 v6, v6, v45
    s_waitcnt vmcnt(8) lgkmcnt(0)
    s_barrier
    v_mfma_f32_16x16x32_bf16 v[68:71], a[144:147], v[192:195], v[152:155]
    ds_read_b128 a[128:131], v8 offset:24576
    v_cvt_pk_bf16_f32 v138, v44, v45
    v_exp_f32 v40, v104
    v_mfma_f32_16x16x32_bf16 v[68:71], a[148:151], v[196:199], v[68:71]
    ds_read_b128 a[132:135], v9 offset:24576
    v_exp_f32 v41, v105
    v_mfma_f32_16x16x32_bf16 v[68:71], a[152:155], v[200:203], v[68:71]
    ds_read_b128 a[136:139], v10 offset:24576
    v_add_f32 v6, v6, v46
    v_add_f32 v6, v6, v47
    v_mfma_f32_16x16x32_bf16 v[68:71], a[156:159], v[204:207], v[68:71]
    ds_read_b128 a[140:143], v11 offset:24576
    v_cvt_pk_bf16_f32 v139, v46, v47
    v_exp_f32 v42, v106
    v_mfma_f32_16x16x32_bf16 a[24:27], a[184:187], v[112:115], a[24:27]
    ds_read_b64_tr_b16 a[160:161], v16 offset:8192
    v_exp_f32 v43, v107
    v_add_f32 v7, v40, v41
    v_mfma_f32_16x16x32_bf16 a[56:59], a[184:187], v[116:119], a[56:59]
    ds_read_b64_tr_b16 a[162:163], v16 offset:12288
    v_cvt_pk_bf16_f32 v140, v40, v41
    v_exp_f32 v44, v108
    v_mfma_f32_16x16x32_bf16 a[88:91], a[184:187], v[120:123], a[88:91]
    v_exp_f32 v45, v109
    v_add_f32 v7, v7, v42
    v_add_f32 v7, v7, v43
    v_mfma_f32_16x16x32_bf16 a[120:123], a[184:187], v[124:127], a[120:123]
    v_mfma_f32_16x16x32_bf16 v[76:79], a[144:147], v[208:211], v[156:159]
    ds_read_b64_tr_b16 a[164:165], v17 offset:8192
    v_cvt_pk_bf16_f32 v141, v42, v43
    v_exp_f32 v46, v110
    v_mfma_f32_16x16x32_bf16 v[76:79], a[148:151], v[212:215], v[76:79]
    ds_read_b64_tr_b16 a[166:167], v17 offset:12288
    v_exp_f32 v47, v111
    v_mfma_f32_16x16x32_bf16 v[76:79], a[152:155], v[216:219], v[76:79]
    v_mfma_f32_16x16x32_bf16 v[76:79], a[156:159], v[220:223], v[76:79]
    v_add_f32 v7, v7, v44
    v_add_f32 v7, v7, v45
    v_cvt_pk_bf16_f32 v142, v44, v45
    v_mfma_f32_16x16x32_bf16 a[28:31], a[188:191], v[112:115], a[28:31]
    ds_read_b64_tr_b16 a[168:169], v18 offset:8192
    v_add_f32 v7, v7, v46
    v_add_f32 v7, v7, v47
    v_cvt_pk_bf16_f32 v143, v46, v47
    v_mfma_f32_16x16x32_bf16 a[60:63], a[188:191], v[116:119], a[60:63]
    ds_read_b64_tr_b16 a[170:171], v18 offset:12288
    v_max3_f32 v35, v4, v5, v6
    v_max_f32 v35, v35, v7
    v_cmp_lt_f32 vcc, s40, v35
    v_mfma_f32_16x16x32_bf16 a[92:95], a[188:191], v[120:123], a[92:95]
    v_mfma_f32_16x16x32_bf16 a[124:127], a[188:191], v[124:127], a[124:127]
    s_cbranch_vccnz L_rare_h1q5
L_ret_h1q5:
    s_waitcnt lgkmcnt(2)
    v_mfma_f32_16x16x32_bf16 v[80:83], a[128:131], v[160:163], v[144:147]
    ds_read_b128 a[144:147], v8 offset:28672
    v_add_f32 v244, v244, v4
    v_add_f32 v245, v245, v5
    v_mfma_f32_16x16x32_bf16 v[80:83], a[132:135], v[164:167], v[80:83]
    v_mfma_f32_16x16x32_bf16 v[80:83], a[136:139], v[168:171], v[80:83]
    ds_read_b128 a[148:151], v9 offset:28672
    v_add_f32 v246, v246, v6
    v_add_f32 v247, v247, v7
    v_mfma_f32_16x16x32_bf16 v[80:83], a[140:143], v[172:175], v[80:83]
    v_exp_f32 v40, v48
    v_exp_f32 v41, v49
    v_mfma_f32_16x16x32_bf16 a[0:3], a[160:163], v[128:131], a[0:3]
    ds_read_b64_tr_b16 a[172:173], v19 offset:8192
    v_exp_f32 v42, v50
    v_mfma_f32_16x16x32_bf16 a[32:35], a[160:163], v[132:135], a[32:35]
    ds_read_b64_tr_b16 a[174:175], v19 offset:12288
    v_exp_f32 v43, v51
    v_mfma_f32_16x16x32_bf16 a[64:67], a[160:163], v[136:139], a[64:67]
    v_mfma_f32_16x16x32_bf16 a[96:99], a[160:163], v[140:143], a[96:99]
    v_mfma_f32_16x16x32_bf16 v[88:91], a[128:131], v[176:179], v[148:151]
    ds_read_b128 a[152:155], v10 offset:28672
    v_add_f32 v248, v40, v41
    v_cvt_pk_bf16_f32 v112, v40, v41
    v_mfma_f32_16x16x32_bf16 v[88:91], a[132:135], v[180:183], v[88:91]
    v_exp_f32 v44, v52
    v_exp_f32 v45, v53
    v_mfma_f32_16x16x32_bf16 v[88:91], a[136:139], v[184:187], v[88:91]
    ds_read_b128 a[156:159], v11 offset:28672
    v_add_f32 v248, v248, v42
    v_add_f32 v248, v248, v43
    v_mfma_f32_16x16x32_bf16 v[88:91], a[140:143], v[188:191], v[88:91]
    v_mfma_f32_16x16x32_bf16 a[4:7], a[164:167], v[128:131], a[4:7]
    ds_read_b64_tr_b16 a[176:177], v20 offset:8192
    v_cvt_pk_bf16_f32 v113, v42, v43
    v_exp_f32 v46, v54
    v_mfma_f32_16x16x32_bf16 a[36:39], a[164:167], v[132:135], a[36:39]
    ds_read_b64_tr_b16 a[178:179], v20 offset:12288
    v_exp_f32 v47, v55
    v_mfma_f32_16x16x32_bf16 a[68:71], a[164:167], v[136:139], a[68:71]
    v_mfma_f32_16x16x32_bf16 a[100:103], a[164:167], v[140:143], a[100:103]
    v_add_f32 v248, v248, v44
    v_add_f32 v248, v248, v45
    s_waitcnt lgkmcnt(4)
    v_mfma_f32_16x16x32_bf16 v[96:99], a[128:131], v[192:195], v[152:155]
    v_cvt_pk_bf16_f32 v114, v44, v45
    v_exp_f32 v40, v56
    v_mfma_f32_16x16x32_bf16 v[96:99], a[132:135], v[196:199], v[96:99]
    v_exp_f32 v41, v57
    s_add_u32 m0, s35, 8192
    v_mfma_f32_16x16x32_bf16 v[96:99], a[136:139], v[200:203], v[96:99]
    buffer_load_dwordx4 v24, s[20:23], s37 offen offset:0 nt lds
    v_add_f32 v248, v248, v46
    v_add_f32 v248, v248, v47
    v_mfma_f32_16x16x32_bf16 v[96:99], a[140:143], v[204:207], v[96:99]
    v_mfma_f32_16x16x32_bf16 a[8:11], a[168:171], v[128:131], a[8:11]
    ds_read_b64_tr_b16 a[180:181], v21 offset:8192
    v_cvt_pk_bf16_f32 v115, v46, v47
    v_exp_f32 v42, v58
    v_mfma_f32_16x16x32_bf16 a[40:43], a[168:171], v[132:135], a[40:43]
    ds_read_b64_tr_b16 a[182:183], v21 offset:12288
    v_exp_f32 v43, v59
    v_mfma_f32_16x16x32_bf16 a[72:75], a[168:171], v[136:139], a[72:75]
    v_mfma_f32_16x16x32_bf16 a[104:107], a[168:171], v[140:143], a[104:107]
    v_add_f32 v249, v40, v41
    v_cvt_pk_bf16_f32 v116, v40, v41
    v_exp_f32 v44, v60
    v_mfma_f32_16x16x32_bf16 v[104:107], a[128:131], v[208:211], v[156:159]
    v_mfma_f32_16x16x32_bf16 v[104:107], a[132:135], v[212:215], v[104:107]
    v_mfma_f32_16x16x32_bf16 v[104:107], a[136:139], v[216:219], v[104:107]
    buffer_load_dwordx4 v25, s[20:23], s37 offen offset:1024 nt lds
    v_exp_f32 v45, v61
    s_add_u32 m0, s36, 40960
    v_mfma_f32_16x16x32_bf16 v[104:107], a[140:143], v[220:223], v[104:107]
    v_add_f32 v249, v249, v42
    v_add_f32 v249, v249, v43
    s_add_u32 s37, s37, 2048
    v_mfma_f32_16x16x32_bf16 a[12:15], a[172:175], v[128:131], a[12:15]
    ds_read_b64_tr_b16 a[184:185], v22 offset:8192
    v_cvt_pk_bf16_f32 v117, v42, v43
    v_exp_f32 v46, v62
    v_mfma_f32_16x16x32_bf16 a[44:47], a[172:175], v[132:135], a[44:47]
    ds_read_b64_tr_b16 a[186:187], v22 offset:12288
    v_exp_f32 v47, v63
    v_mfma_f32_16x16x32_bf16 a[76:79], a[172:175], v[136:139], a[76:79]
    v_add_f32 v249, v249, v44
    v_add_f32 v249, v249, v45
    v_cvt_pk_bf16_f32 v118, v44, v45
    v_mfma_f32_16x16x32_bf16 a[108:111], a[172:175], v[140:143], a[108:111]
    v_exp_f32 v40, v64
    s_waitcnt lgkmcnt(2)
    v_mfma_f32_16x16x32_bf16 v[84:87], a[144:147], v[160:163], v[144:147]
    v_mfma_f32_16x16x32_bf16 v[84:87], a[148:151], v[164:167], v[84:87]
    v_mfma_f32_16x16x32_bf16 v[84:87], a[152:155], v[168:171], v[84:87]
    buffer_load_dwordx4 v26, s[24:27], s41 offen offset:0 nt lds
    v_exp_f32 v41, v65
    v_add_f32 v249, v249, v46
    v_mfma_f32_16x16x32_bf16 v[84:87], a[156:159], v[172:175], v[84:87]
    v_add_f32 v249, v249, v47
    v_cvt_pk_bf16_f32 v119, v46, v47
    v_exp_f32 v42, v66
    v_mfma_f32_16x16x32_bf16 a[16:19], a[176:179], v[128:131], a[16:19]
    ds_read_b64_tr_b16 a[188:189], v23 offset:8192
    v_exp_f32 v43, v67
    v_add_f32 v250, v40, v41
    v_mfma_f32_16x16x32_bf16 a[48:51], a[176:179], v[132:135], a[48:51]
    ds_read_b64_tr_b16 a[190:191], v23 offset:12288
    v_cvt_pk_bf16_f32 v120, v40, v41
    v_exp_f32 v44, v68
    v_mfma_f32_16x16x32_bf16 a[80:83], a[176:179], v[136:139], a[80:83]
    v_mfma_f32_16x16x32_bf16 a[112:115], a[176:179], v[140:143], a[112:115]
    v_mfma_f32_16x16x32_bf16 v[92:95], a[144:147], v[176:179], v[148:151]
    v_exp_f32 v45, v69
    v_add_f32 v250, v250, v42
    v_mfma_f32_16x16x32_bf16 v[92:95], a[148:151], v[180:183], v[92:95]
    v_mfma_f32_16x16x32_bf16 v[92:95], a[152:155], v[184:187], v[92:95]
    buffer_load_dwordx4 v27, s[24:27], s41 offen offset:1024 nt lds
    v_add_f32 v250, v250, v43
    v_cvt_pk_bf16_f32 v121, v42, v43
    s_add_u32 s41, s41, 2048
    v_mfma_f32_16x16x32_bf16 v[92:95], a[156:159], v[188:191], v[92:95]
    v_mfma_f32_16x16x32_bf16 a[20:23], a[180:183], v[128:131], a[20:23]
    v_exp_f32 v46, v70
    v_exp_f32 v47, v71
    v_mfma_f32_16x16x32_bf16 a[52:55], a[180:183], v[132:135], a[52:55]
    v_mfma_f32_16x16x32_bf16 a[84:87], a[180:183], v[136:139], a[84:87]
    v_mfma_f32_16x16x32_bf16 a[116:119], a[180:183], v[140:143], a[116:119]
    v_add_f32 v250, v250, v44
    v_add_f32 v250, v250, v45
    s_waitcnt lgkmcnt(0)
    v_mfma_f32_16x16x32_bf16 v[100:103], a[144:147], v[192:195], v[152:155]
    ds_read_b128 a[128:131], v8 offset:32768
    v_cvt_pk_bf16_f32 v122, v44, v45
    v_exp_f32 v40, v72
    v_mfma_f32_16x16x32_bf16 v[100:103], a[148:151], v[196:199], v[100:103]
    ds_read_b128 a[132:135], v9 offset:32768
    v_exp_f32 v41, v73
    v_mfma_f32_16x16x32_bf16 v[100:103], a[152:155], v[200:203], v[100:103]
    ds_read_b128 a[136:139], v10 offset:32768
    v_add_f32 v250, v250, v46
    v_add_f32 v250, v250, v47
    v_mfma_f32_16x16x32_bf16 v[100:103], a[156:159], v[204:207], v[100:103]
    ds_read_b128 a[140:143], v11 offset:32768
    v_cvt_pk_bf16_f32 v123, v46, v47
    v_exp_f32 v42, v74
    v_mfma_f32_16x16x32_bf16 a[24:27], a[184:187], v[128:131], a[24:27]
    ds_read_b64_tr_b16 a[160:161], v16 offset:16384
    v_exp_f32 v43, v75
    v_add_f32 v251, v40, v41
    v_mfma_f32_16x16x32_bf16 a[56:59], a[184:187], v[132:135], a[56:59]
    ds_read_b64_tr_b16 a[162:163], v16 offset:20480
    v_cvt_pk_bf16_f32 v124, v40, v41
    v_exp_f32 v44, v76
    v_mfma_f32_16x16x32_bf16 a[88:91], a[184:187], v[136:139], a[88:91]
    v_exp_f32 v45, v77
    v_add_f32 v251, v251, v42
    v_add_f32 v251, v251, v43
    v_mfma_f32_16x16x32_bf16 a[120:123], a[184:187], v[140:143], a[120:123]
    v_mfma_f32_16x16x32_bf16 v[108:111], a[144:147], v[208:211], v[156:159]
    ds_read_b64_tr_b16 a[164:165], v17 offset:16384
    v_cvt_pk_bf16_f32 v125, v42, v43
    v_exp_f32 v46, v78
    v_mfma_f32_16x16x32_bf16 v[108:111], a[148:151], v[212:215], v[108:111]
    ds_read_b64_tr_b16 a[166:167], v17 offset:20480
    v_exp_f32 v47, v79
    v_mfma_f32_16x16x32_bf16 v[108:111], a[152:155], v[216:219], v[108:111]
    v_mfma_f32_16x16x32_bf16 v[108:111], a[156:159], v[220:223], v[108:111]
    v_add_f32 v251, v251, v44
    v_add_f32 v251, v251, v45
    v_cvt_pk_bf16_f32 v126, v44, v45
    v_mfma_f32_16x16x32_bf16 a[28:31], a[188:191], v[128:131], a[28:31]
    ds_read_b64_tr_b16 a[168:169], v18 offset:16384
    v_add_f32 v251, v251, v46
    v_add_f32 v251, v251, v47
    v_cvt_pk_bf16_f32 v127, v46, v47
    v_mfma_f32_16x16x32_bf16 a[60:63], a[188:191], v[132:135], a[60:63]
    ds_read_b64_tr_b16 a[170:171], v18 offset:20480
    v_max3_f32 v35, v248, v249, v250
    v_max_f32 v35, v35, v251
    v_cmp_lt_f32 vcc, s40, v35
    v_mfma_f32_16x16x32_bf16 a[92:95], a[188:191], v[136:139], a[92:95]
    v_mfma_f32_16x16x32_bf16 a[124:127], a[188:191], v[140:143], a[124:127]
    s_cbranch_vccnz L_rare_h1q6
L_ret_h1q6:
    s_waitcnt lgkmcnt(2)
    s_mov_b32 s39, 4
L_loops1:
    v_mfma_f32_16x16x32_bf16 v[48:51], a[128:131], v[160:163], v[144:147]
    ds_read_b128 a[144:147], v8 offset:36864
    v_add_f32 v244, v244, v248
    v_add_f32 v245, v245, v249
    v_mfma_f32_16x16x32_bf16 v[48:51], a[132:135], v[164:167], v[48:51]
    v_mfma_f32_16x16x32_bf16 v[48:51], a[136:139], v[168:171], v[48:51]
    ds_read_b128 a[148:151], v9 offset:36864
    v_add_f32 v246, v246, v250
    v_add_f32 v247, v247, v251
    v_mfma_f32_16x16x32_bf16 v[48:51], a[140:143], v[172:175], v[48:51]
    v_exp_f32 v40, v80
    v_exp_f32 v41, v81
    v_mfma_f32_16x16x32_bf16 a[0:3], a[160:163], v[112:115], a[0:3]
    ds_read_b64_tr_b16 a[172:173], v19 offset:16384
    v_exp_f32 v42, v82
    v_mfma_f32_16x16x32_bf16 a[32:35], a[160:163], v[116:119], a[32:35]
    ds_read_b64_tr_b16 a[174:175], v19 offset:20480
    v_exp_f32 v43, v83
    v_mfma_f32_16x16x32_bf16 a[64:67], a[160:163], v[120:123], a[64:67]
    v_mfma_f32_16x16x32_bf16 a[96:99], a[160:163], v[124:127], a[96:99]
    v_mfma_f32_16x16x32_bf16 v[56:59], a[128:131], v[176:179], v[148:151]
    ds_read_b128 a[152:155], v10 offset:36864
    v_add_f32 v4, v40, v41
    v_cvt_pk_bf16_f32 v128, v40, v41
    v_mfma_f32_16x16x32_bf16 v[56:59], a[132:135], v[180:183], v[56:59]
    v_exp_f32 v44, v84
    v_exp_f32 v45, v85
    v_mfma_f32_16x16x32_bf16 v[56:59], a[136:139], v[184:187], v[56:59]
    ds_read_b128 a[156:159], v11 offset:36864
    v_add_f32 v4, v4, v42
    v_add_f32 v4, v4, v43
    v_mfma_f32_16x16x32_bf16 v[56:59], a[140:143], v[188:191], v[56:59]
    v_mfma_f32_16x16x32_bf16 a[4:7], a[164:167], v[112:115], a[4:7]
    ds_read_b64_tr_b16 a[176:177], v20 offset:16384
    v_cvt_pk_bf16_f32 v129, v42, v43
    v_exp_f32 v46, v86
    v_mfma_f32_16x16x32_bf16 a[36:39], a[164:167], v[116:119], a[36:39]
    ds_read_b64_tr_b16 a[178:179], v20 offset:20480
    v_exp_f32 v47, v87
    v_mfma_f32_16x16x32_bf16 a[68:71], a[164:167], v[120:123], a[68:71]
    v_mfma_f32_16x16x32_bf16 a[100:103], a[164:167], v[124:127], a[100:103]
    v_add_f32 v4, v4, v44
    v_add_f32 v4, v4, v45
    s_waitcnt lgkmcnt(4)
    v_mfma_f32_16x16x32_bf16 v[64:67], a[128:131], v[192:195], v[152:155]
    v_cvt_pk_bf16_f32 v130, v44, v45
    v_exp_f32 v40, v88
    v_mfma_f32_16x16x32_bf16 v[64:67], a[132:135], v[196:199], v[64:67]
    v_exp_f32 v41, v89
    s_add_u32 m0, s35, 16384
    v_mfma_f32_16x16x32_bf16 v[64:67], a[136:139], v[200:203], v[64:67]
    buffer_load_dwordx4 v24, s[20:23], s37 offen offset:0 nt lds
    v_add_f32 v4, v4, v46
    v_add_f32 v4, v4, v47
    v_mfma_f32_16x16x32_bf16 v[64:67], a[140:143], v[204:207], v[64:67]
    v_mfma_f32_16x16x32_bf16 a[8:11], a[168:171], v[112:115], a[8:11]
    ds_read_b64_tr_b16 a[180:181], v21 offset:16384
    v_cvt_pk_bf16_f32 v131, v46, v47
    v_exp_f32 v42, v90
    v_mfma_f32_16x16x32_bf16 a[40:43], a[168:171], v[116:119], a[40:43]
    ds_read_b64_tr_b16 a[182:183], v21 offset:20480
    v_exp_f32 v43, v91
    v_mfma_f32_16x16x32_bf16 a[72:75], a[168:171], v[120:123], a[72:75]
    v_mfma_f32_16x16x32_bf16 a[104:107], a[168:171], v[124:127], a[104:107]
    v_add_f32 v5, v40, v41
    v_cvt_pk_bf16_f32 v132, v40, v41
    v_exp_f32 v44, v92
    v_mfma_f32_16x16x32_bf16 v[72:75], a[128:131], v[208:211], v[156:159]
    v_mfma_f32_16x16x32_bf16 v[72:75], a[132:135], v[212:215], v[72:75]
    v_mfma_f32_16x16x32_bf16 v[72:75], a[136:139], v[216:219], v[72:75]
    buffer_load_dwordx4 v25, s[20:23], s37 offen offset:1024 nt lds
    v_exp_f32 v45, v93
    s_add_u32 m0, s36, 0
    v_mfma_f32_16x16x32_bf16 v[72:75], a[140:143], v[220:223], v[72:75]
    v_add_f32 v5, v5, v42
    v_add_f32 v5, v5, v43
    s_add_u32 s37, s37, 2048
    v_mfma_f32_16x16x32_bf16 a[12:15], a[172:175], v[112:115], a[12:15]
    ds_read_b64_tr_b16 a[184:185], v22 offset:16384
    v_cvt_pk_bf16_f32 v133, v42, v43
    v_exp_f32 v46, v94
    v_mfma_f32_16x16x32_bf16 a[44:47], a[172:175], v[116:119], a[44:47]
    ds_read_b64_tr_b16 a[186:187], v22 offset:20480
    v_exp_f32 v47, v95
    v_mfma_f32_16x16x32_bf16 a[76:79], a[172:175], v[120:123], a[76:79]
    v_add_f32 v5, v5, v44
    v_add_f32 v5, v5, v45
    v_cvt_pk_bf16_f32 v134, v44, v45
    v_mfma_f32_16x16x32_bf16 a[108:111], a[172:175], v[124:127], a[108:111]
    v_exp_f32 v40, v96
    s_waitcnt lgkmcnt(2)
    v_mfma_f32_16x16x32_bf16 v[52:55], a[144:147], v[160:163], v[144:147]
    v_mfma_f32_16x16x32_bf16 v[52:55], a[148:151], v[164:167], v[52:55]
    v_mfma_f32_16x16x32_bf16 v[52:55], a[152:155], v[168:171], v[52:55]
    buffer_load_dwordx4 v26, s[24:27], s41 offen offset:0 nt lds
    v_exp_f32 v41, v97
    v_add_f32 v5, v5, v46
    v_mfma_f32_16x16x32_bf16 v[52:55], a[156:159], v[172:175], v[52:55]
    v_add_f32 v5, v5, v47
    v_cvt_pk_bf16_f32 v135, v46, v47
    v_exp_f32 v42, v98
    v_mfma_f32_16x16x32_bf16 a[16:19], a[176:179], v[112:115], a[16:19]
    ds_read_b64_tr_b16 a[188:189], v23 offset:16384
    v_exp_f32 v43, v99
    v_add_f32 v6, v40, v41
    v_mfma_f32_16x16x32_bf16 a[48:51], a[176:179], v[116:119], a[48:51]
    ds_read_b64_tr_b16 a[190:191], v23 offset:20480
    v_cvt_pk_bf16_f32 v136, v40, v41
    v_exp_f32 v44, v100
    v_mfma_f32_16x16x32_bf16 a[80:83], a[176:179], v[120:123], a[80:83]
    v_mfma_f32_16x16x32_bf16 a[112:115], a[176:179], v[124:127], a[112:115]
    v_mfma_f32_16x16x32_bf16 v[60:63], a[144:147], v[176:179], v[148:151]
    v_exp_f32 v45, v101
    v_add_f32 v6, v6, v42
    v_mfma_f32_16x16x32_bf16 v[60:63], a[148:151], v[180:183], v[60:63]
    v_mfma_f32_16x16x32_bf16 v[60:63], a[152:155], v[184:187], v[60:63]
    buffer_load_dwordx4 v27, s[24:27], s41 offen offset:1024 nt lds
    v_add_f32 v6, v6, v43
    v_cvt_pk_bf16_f32 v137, v42, v43
    s_add_u32 s41, s41, 2048
    v_mfma_f32_16x16x32_bf16 v[60:63], a[156:159], v[188:191], v[60:63]
    v_mfma_f32_16x16x32_bf16 a[20:23], a[180:183], v[112:115], a[20:23]
    v_exp_f32 v46, v102
    v_exp_f32 v47, v103
    v_mfma_f32_16x16x32_bf16 a[52:55], a[180:183], v[116:119], a[52:55]
    v_mfma_f32_16x16x32_bf16 a[84:87], a[180:183], v[120:123], a[84:87]
    v_mfma_f32_16x16x32_bf16 a[116:119], a[180:183], v[124:127], a[116:119]
    v_add_f32 v6, v6, v44
    v_add_f32 v6, v6, v45
    s_waitcnt vmcnt(8) lgkmcnt(0)
    s_barrier
    v_mfma_f32_16x16x32_bf16 v[68:71], a[144:147], v[192:195], v[152:155]
    ds_read_b128 a[128:131], v8 offset:40960
    v_cvt_pk_bf16_f32 v138, v44, v45
    v_exp_f32 v40, v104
    v_mfma_f32_16x16x32_bf16 v[68:71], a[148:151], v[196:199], v[68:71]
    ds_read_b128 a[132:135], v9 offset:40960
    v_exp_f32 v41, v105
    v_mfma_f32_16x16x32_bf16 v[68:71], a[152:155], v[200:203], v[68:71]
    ds_read_b128 a[136:139], v10 offset:40960
    v_add_f32 v6, v6, v46
    v_add_f32 v6, v6, v47
    v_mfma_f32_16x16x32_bf16 v[68:71], a[156:159], v[204:207], v[68:71]
    ds_read_b128 a[140:143], v11 offset:40960
    v_cvt_pk_bf16_f32 v139, v46, v47
    v_exp_f32 v42, v106
    v_mfma_f32_16x16x32_bf16 a[24:27], a[184:187], v[112:115], a[24:27]
    ds_read_b64_tr_b16 a[160:161], v16 offset:24576
    v_exp_f32 v43, v107
    v_add_f32 v7, v40, v41
    v_mfma_f32_16x16x32_bf16 a[56:59], a[184:187], v[116:119], a[56:59]
    ds_read_b64_tr_b16 a[162:163], v16 offset:28672
    v_cvt_pk_bf16_f32 v140, v40, v41
    v_exp_f32 v44, v108
    v_mfma_f32_16x16x32_bf16 a[88:91], a[184:187], v[120:123], a[88:91]
    v_exp_f32 v45, v109
    v_add_f32 v7, v7, v42
    v_add_f32 v7, v7, v43
    v_mfma_f32_16x16x32_bf16 a[120:123], a[184:187], v[124:127], a[120:123]
    v_mfma_f32_16x16x32_bf16 v[76:79], a[144:147], v[208:211], v[156:159]
    ds_read_b64_tr_b16 a[164:165], v17 offset:24576
    v_cvt_pk_bf16_f32 v141, v42, v43
    v_exp_f32 v46, v110
    v_mfma_f32_16x16x32_bf16 v[76:79], a[148:151], v[212:215], v[76:79]
    ds_read_b64_tr_b16 a[166:167], v17 offset:28672
    v_exp_f32 v47, v111
    v_mfma_f32_16x16x32_bf16 v[76:79], a[152:155], v[216:219], v[76:79]
    v_mfma_f32_16x16x32_bf16 v[76:79], a[156:159], v[220:223], v[76:79]
    v_add_f32 v7, v7, v44
    v_add_f32 v7, v7, v45
    v_cvt_pk_bf16_f32 v142, v44, v45
    v_mfma_f32_16x16x32_bf16 a[28:31], a[188:191], v[112:115], a[28:31]
    ds_read_b64_tr_b16 a[168:169], v18 offset:24576
    v_add_f32 v7, v7, v46
    v_add_f32 v7, v7, v47
    v_cvt_pk_bf16_f32 v143, v46, v47
    v_mfma_f32_16x16x32_bf16 a[60:63], a[188:191], v[116:119], a[60:63]
    ds_read_b64_tr_b16 a[170:171], v18 offset:28672
    v_max3_f32 v35, v4, v5, v6
    v_max_f32 v35, v35, v7
    v_cmp_lt_f32 vcc, s40, v35
    v_mfma_f32_16x16x32_bf16 a[92:95], a[188:191], v[120:123], a[92:95]
    v_mfma_f32_16x16x32_bf16 a[124:127], a[188:191], v[124:127], a[124:127]
    s_cbranch_vccnz L_rare_h1v0
L_ret_h1v0:
    s_waitcnt lgkmcnt(2)
    v_mfma_f32_16x16x32_bf16 v[80:83], a[128:131], v[160:163], v[144:147]
    ds_read_b128 a[144:147], v8 offset:45056
    v_add_f32 v244, v244, v4
    v_add_f32 v245, v245, v5
    v_mfma_f32_16x16x32_bf16 v[80:83], a[132:135], v[164:167], v[80:83]
    v_mfma_f32_16x16x32_bf16 v[80:83], a[136:139], v[168:171], v[80:83]
    ds_read_b128 a[148:151], v9 offset:45056
    v_add_f32 v246, v246, v6
    v_add_f32 v247, v247, v7
    v_mfma_f32_16x16x32_bf16 v[80:83], a[140:143], v[172:175], v[80:83]
    v_exp_f32 v40, v48
    v_exp_f32 v41, v49
    v_mfma_f32_16x16x32_bf16 a[0:3], a[160:163], v[128:131], a[0:3]
    ds_read_b64_tr_b16 a[172:173], v19 offset:24576
    v_exp_f32 v42, v50
    v_mfma_f32_16x16x32_bf16 a[32:35], a[160:163], v[132:135], a[32:35]
    ds_read_b64_tr_b16 a[174:175], v19 offset:28672
    v_exp_f32 v43, v51
    v_mfma_f32_16x16x32_bf16 a[64:67], a[160:163], v[136:139], a[64:67]
    v_mfma_f32_16x16x32_bf16 a[96:99], a[160:163], v[140:143], a[96:99]
    v_mfma_f32_16x16x32_bf16 v[88:91], a[128:131], v[176:179], v[148:151]
    ds_read_b128 a[152:155], v10 offset:45056
    v_add_f32 v248, v40, v41
    v_cvt_pk_bf16_f32 v112, v40, v41
    v_mfma_f32_16x16x32_bf16 v[88:91], a[132:135], v[180:183], v[88:91]
    v_exp_f32 v44, v52
    v_exp_f32 v45, v53
    v_mfma_f32_16x16x32_bf16 v[88:91], a[136:139], v[184:187], v[88:91]
    ds_read_b128 a[156:159], v11 offset:45056
    v_add_f32 v248, v248, v42
    v_add_f32 v248, v248, v43
    v_mfma_f32_16x16x32_bf16 v[88:91], a[140:143], v[188:191], v[88:91]
    v_mfma_f32_16x16x32_bf16 a[4:7], a[164:167], v[128:131], a[4:7]
    ds_read_b64_tr_b16 a[176:177], v20 offset:24576
    v_cvt_pk_bf16_f32 v113, v42, v43
    v_exp_f32 v46, v54
    v_mfma_f32_16x16x32_bf16 a[36:39], a[164:167], v[132:135], a[36:39]
    ds_read_b64_tr_b16 a[178:179], v20 offset:28672
    v_exp_f32 v47, v55
    v_mfma_f32_16x16x32_bf16 a[68:71], a[164:167], v[136:139], a[68:71]
    v_mfma_f32_16x16x32_bf16 a[100:103], a[164:167], v[140:143], a[100:103]
    v_add_f32 v248, v248, v44
    v_add_f32 v248, v248, v45
    s_waitcnt lgkmcnt(4)
    v_mfma_f32_16x16x32_bf16 v[96:99], a[128:131], v[192:195], v[152:155]
    v_cvt_pk_bf16_f32 v114, v44, v45
    v_exp_f32 v40, v56
    v_mfma_f32_16x16x32_bf16 v[96:99], a[132:135], v[196:199], v[96:99]
    v_exp_f32 v41, v57
    s_add_u32 m0, s35, 24576
    v_mfma_f32_16x16x32_bf16 v[96:99], a[136:139], v[200:203], v[96:99]
    buffer_load_dwordx4 v24, s[20:23], s37 offen offset:0 nt lds
    v_add_f32 v248, v248, v46
    v_add_f32 v248, v248, v47
    v_mfma_f32_16x16x32_bf16 v[96:99], a[140:143], v[204:207], v[96:99]
    v_mfma_f32_16x16x32_bf16 a[8:11], a[168:171], v[128:131], a[8:11]
    ds_read_b64_tr_b16 a[180:181], v21 offset:24576
    v_cvt_pk_bf16_f32 v115, v46, v47
    v_exp_f32 v42, v58
    v_mfma_f32_16x16x32_bf16 a[40:43], a[168:171], v[132:135], a[40:43]
    ds_read_b64_tr_b16 a[182:183], v21 offset:28672
    v_exp_f32 v43, v59
    v_mfma_f32_16x16x32_bf16 a[72:75], a[168:171], v[136:139], a[72:75]
    v_mfma_f32_16x16x32_bf16 a[104:107], a[168:171], v[140:143], a[104:107]
    v_add_f32 v249, v40, v41
    v_cvt_pk_bf16_f32 v116, v40, v41
    v_exp_f32 v44, v60
    v_mfma_f32_16x16x32_bf16 v[104:107], a[128:131], v[208:211], v[156:159]
    v_mfma_f32_16x16x32_bf16 v[104:107], a[132:135], v[212:215], v[104:107]
    v_mfma_f32_16x16x32_bf16 v[104:107], a[136:139], v[216:219], v[104:107]
    buffer_load_dwordx4 v25, s[20:23], s37 offen offset:1024 nt lds
    v_exp_f32 v45, v61
    s_add_u32 m0, s36, 8192
    v_mfma_f32_16x16x32_bf16 v[104:107], a[140:143], v[220:223], v[104:107]
    v_add_f32 v249, v249, v42
    v_add_f32 v249, v249, v43
    s_add_u32 s37, s37, 2048
    v_mfma_f32_16x16x32_bf16 a[12:15], a[172:175], v[128:131], a[12:15]
    ds_read_b64_tr_b16 a[184:185], v22 offset:24576
    s_cmp_eq_u32 s37, 327680
    s_cmov_b32 s37, 268435456
    v_mfma_f32_16x16x32_bf16 a[44:47], a[172:175], v[132:135], a[44:47]
    ds_read_b64_tr_b16 a[186:187], v22 offset:28672
    v_cvt_pk_bf16_f32 v117, v42, v43
    v_exp_f32 v46, v62
    v_mfma_f32_16x16x32_bf16 a[76:79], a[172:175], v[136:139], a[76:79]
    v_exp_f32 v47, v63
    v_add_f32 v249, v249, v44
    v_add_f32 v249, v249, v45
    v_mfma_f32_16x16x32_bf16 a[108:111], a[172:175], v[140:143], a[108:111]
    v_cvt_pk_bf16_f32 v118, v44, v45
    v_exp_f32 v40, v64
    s_waitcnt lgkmcnt(2)
    v_mfma_f32_16x16x32_bf16 v[84:87], a[144:147], v[160:163], v[144:147]
    v_mfma_f32_16x16x32_bf16 v[84:87], a[148:151], v[164:167], v[84:87]
    v_mfma_f32_16x16x32_bf16 v[84:87], a[152:155], v[168:171], v[84:87]
    buffer_load_dwordx4 v26, s[24:27], s41 offen offset:0 nt lds
    v_exp_f32 v41, v65
    v_add_f32 v249, v249, v46
    v_mfma_f32_16x16x32_bf16 v[84:87], a[156:159], v[172:175], v[84:87]
    v_add_f32 v249, v249, v47
    v_cvt_pk_bf16_f32 v119, v46, v47
    v_exp_f32 v42, v66
    v_mfma_f32_16x16x32_bf16 a[16:19], a[176:179], v[128:131], a[16:19]
    ds_read_b64_tr_b16 a[188:189], v23 offset:24576
    v_exp_f32 v43, v67
    v_add_f32 v250, v40, v41
    v_mfma_f32_16x16x32_bf16 a[48:51], a[176:179], v[132:135], a[48:51]
    ds_read_b64_tr_b16 a[190:191], v23 offset:28672
    v_cvt_pk_bf16_f32 v120, v40, v41
    v_exp_f32 v44, v68
    v_mfma_f32_16x16x32_bf16 a[80:83], a[176:179], v[136:139], a[80:83]
    v_mfma_f32_16x16x32_bf16 a[112:115], a[176:179], v[140:143], a[112:115]
    v_mfma_f32_16x16x32_bf16 v[92:95], a[144:147], v[176:179], v[148:151]
    v_exp_f32 v45, v69
    v_add_f32 v250, v250, v42
    v_mfma_f32_16x16x32_bf16 v[92:95], a[148:151], v[180:183], v[92:95]
    v_mfma_f32_16x16x32_bf16 v[92:95], a[152:155], v[184:187], v[92:95]
    buffer_load_dwordx4 v27, s[24:27], s41 offen offset:1024 nt lds
    v_add_f32 v250, v250, v43
    v_cvt_pk_bf16_f32 v121, v42, v43
    s_add_u32 s41, s41, 2048
    v_mfma_f32_16x16x32_bf16 v[92:95], a[156:159], v[188:191], v[92:95]
    v_mfma_f32_16x16x32_bf16 a[20:23], a[180:183], v[128:131], a[20:23]
    v_exp_f32 v46, v70
    v_exp_f32 v47, v71
    v_mfma_f32_16x16x32_bf16 a[52:55], a[180:183], v[132:135], a[52:55]
    v_mfma_f32_16x16x32_bf16 a[84:87], a[180:183], v[136:139], a[84:87]
    v_mfma_f32_16x16x32_bf16 a[116:119], a[180:183], v[140:143], a[116:119]
    v_add_f32 v250, v250, v44
    v_add_f32 v250, v250, v45
    s_waitcnt lgkmcnt(0)
    v_mfma_f32_16x16x32_bf16 v[100:103], a[144:147], v[192:195], v[152:155]
    ds_read_b128 a[128:131], v8 offset:0
    v_cvt_pk_bf16_f32 v122, v44, v45
    v_exp_f32 v40, v72
    v_mfma_f32_16x16x32_bf16 v[100:103], a[148:151], v[196:199], v[100:103]
    ds_read_b128 a[132:135], v9 offset:0
    v_exp_f32 v41, v73
    v_mfma_f32_16x16x32_bf16 v[100:103], a[152:155], v[200:203], v[100:103]
    ds_read_b128 a[136:139], v10 offset:0
    v_add_f32 v250, v250, v46
    v_add_f32 v250, v250, v47
    v_mfma_f32_16x16x32_bf16 v[100:103], a[156:159], v[204:207], v[100:103]
    ds_read_b128 a[140:143], v11 offset:0
    v_cvt_pk_bf16_f32 v123, v46, v47
    v_exp_f32 v42, v74
    v_mfma_f32_16x16x32_bf16 a[24:27], a[184:187], v[128:131], a[24:27]
    ds_read_b64_tr_b16 a[160:161], v16 offset:32768
    v_exp_f32 v43, v75
    v_add_f32 v251, v40, v41
    v_mfma_f32_16x16x32_bf16 a[56:59], a[184:187], v[132:135], a[56:59]
    ds_read_b64_tr_b16 a[162:163], v16 offset:36864
    v_cvt_pk_bf16_f32 v124, v40, v41
    v_exp_f32 v44, v76
    v_mfma_f32_16x16x32_bf16 a[88:91], a[184:187], v[136:139], a[88:91]
    v_exp_f32 v45, v77
    v_add_f32 v251, v251, v42
    v_add_f32 v251, v251, v43
    v_mfma_f32_16x16x32_bf16 a[120:123], a[184:187], v[140:143], a[120:123]
    v_mfma_f32_16x16x32_bf16 v[108:111], a[144:147], v[208:211], v[156:159]
    ds_read_b64_tr_b16 a[164:165], v17 offset:32768
    v_cvt_pk_bf16_f32 v125, v42, v43
    v_exp_f32 v46, v78
    v_mfma_f32_16x16x32_bf16 v[108:111], a[148:151], v[212:215], v[108:111]
    ds_read_b64_tr_b16 a[166:167], v17 offset:36864
    v_exp_f32 v47, v79
    v_mfma_f32_16x16x32_bf16 v[108:111], a[152:155], v[216:219], v[108:111]
    v_mfma_f32_16x16x32_bf16 v[108:111], a[156:159], v[220:223], v[108:111]
    v_add_f32 v251, v251, v44
    v_add_f32 v251, v251, v45
    v_cvt_pk_bf16_f32 v126, v44, v45
    v_mfma_f32_16x16x32_bf16 a[28:31], a[188:191], v[128:131], a[28:31]
    ds_read_b64_tr_b16 a[168:169], v18 offset:32768
    v_add_f32 v251, v251, v46
    v_add_f32 v251, v251, v47
    v_cvt_pk_bf16_f32 v127, v46, v47
    v_mfma_f32_16x16x32_bf16 a[60:63], a[188:191], v[132:135], a[60:63]
    ds_read_b64_tr_b16 a[170:171], v18 offset:36864
    v_max3_f32 v35, v248, v249, v250
    v_max_f32 v35, v35, v251
    v_cmp_lt_f32 vcc, s40, v35
    v_mfma_f32_16x16x32_bf16 a[92:95], a[188:191], v[136:139], a[92:95]
    v_mfma_f32_16x16x32_bf16 a[124:127], a[188:191], v[140:143], a[124:127]
    s_cbranch_vccnz L_rare_h1v1
L_ret_h1v1:
    s_waitcnt lgkmcnt(2)
    v_mfma_f32_16x16x32_bf16 v[48:51], a[128:131], v[160:163], v[144:147]
    ds_read_b128 a[144:147], v8 offset:4096
    v_add_f32 v244, v244, v248
    v_add_f32 v245, v245, v249
    v_mfma_f32_16x16x32_bf16 v[48:51], a[132:135], v[164:167], v[48:51]
    v_mfma_f32_16x16x32_bf16 v[48:51], a[136:139], v[168:171], v[48:51]
    ds_read_b128 a[148:151], v9 offset:4096
    v_add_f32 v246, v246, v250
    v_add_f32 v247, v247, v251
    v_mfma_f32_16x16x32_bf16 v[48:51], a[140:143], v[172:175], v[48:51]
    v_exp_f32 v40, v80
    v_exp_f32 v41, v81
    v_mfma_f32_16x16x32_bf16 a[0:3], a[160:163], v[112:115], a[0:3]
    ds_read_b64_tr_b16 a[172:173], v19 offset:32768
    v_exp_f32 v42, v82
    v_mfma_f32_16x16x32_bf16 a[32:35], a[160:163], v[116:119], a[32:35]
    ds_read_b64_tr_b16 a[174:175], v19 offset:36864
    v_exp_f32 v43, v83
    v_mfma_f32_16x16x32_bf16 a[64:67], a[160:163], v[120:123], a[64:67]
    v_mfma_f32_16x16x32_bf16 a[96:99], a[160:163], v[124:127], a[96:99]
    v_mfma_f32_16x16x32_bf16 v[56:59], a[128:131], v[176:179], v[148:151]
    ds_read_b128 a[152:155], v10 offset:4096
    v_add_f32 v4, v40, v41
    v_cvt_pk_bf16_f32 v128, v40, v41
    v_mfma_f32_16x16x32_bf16 v[56:59], a[132:135], v[180:183], v[56:59]
    v_exp_f32 v44, v84
    v_exp_f32 v45, v85
    v_mfma_f32_16x16x32_bf16 v[56:59], a[136:139], v[184:187], v[56:59]
    ds_read_b128 a[156:159], v11 offset:4096
    v_add_f32 v4, v4, v42
    v_add_f32 v4, v4, v43
    v_mfma_f32_16x16x32_bf16 v[56:59], a[140:143], v[188:191], v[56:59]
    v_mfma_f32_16x16x32_bf16 a[4:7], a[164:167], v[112:115], a[4:7]
    ds_read_b64_tr_b16 a[176:177], v20 offset:32768
    v_cvt_pk_bf16_f32 v129, v42, v43
    v_exp_f32 v46, v86
    v_mfma_f32_16x16x32_bf16 a[36:39], a[164:167], v[116:119], a[36:39]
    ds_read_b64_tr_b16 a[178:179], v20 offset:36864
    v_exp_f32 v47, v87
    v_mfma_f32_16x16x32_bf16 a[68:71], a[164:167], v[120:123], a[68:71]
    v_mfma_f32_16x16x32_bf16 a[100:103], a[164:167], v[124:127], a[100:103]
    v_add_f32 v4, v4, v44
    v_add_f32 v4, v4, v45
    s_waitcnt lgkmcnt(4)
    v_mfma_f32_16x16x32_bf16 v[64:67], a[128:131], v[192:195], v[152:155]
    v_cvt_pk_bf16_f32 v130, v44, v45
    v_exp_f32 v40, v88
    v_mfma_f32_16x16x32_bf16 v[64:67], a[132:135], v[196:199], v[64:67]
    v_exp_f32 v41, v89
    s_add_u32 m0, s35, 32768
    v_mfma_f32_16x16x32_bf16 v[64:67], a[136:139], v[200:203], v[64:67]
    buffer_load_dwordx4 v24, s[20:23], s37 offen offset:0 nt lds
    v_add_f32 v4, v4, v46
    v_add_f32 v4, v4, v47
    v_mfma_f32_16x16x32_bf16 v[64:67], a[140:143], v[204:207], v[64:67]
    v_mfma_f32_16x16x32_bf16 a[8:11], a[168:171], v[112:115], a[8:11]
    ds_read_b64_tr_b16 a[180:181], v21 offset:32768
    v_cvt_pk_bf16_f32 v131, v46, v47
    v_exp_f32 v42, v90
    v_mfma_f32_16x16x32_bf16 a[40:43], a[168:171], v[116:119], a[40:43]
    ds_read_b64_tr_b16 a[182:183], v21 offset:36864
    v_exp_f32 v43, v91
    v_mfma_f32_16x16x32_bf16 a[72:75], a[168:171], v[120:123], a[72:75]
    v_mfma_f32_16x16x32_bf16 a[104:107], a[168:171], v[124:127], a[104:107]
    v_add_f32 v5, v40, v41
    v_cvt_pk_bf16_f32 v132, v40, v41
    v_exp_f32 v44, v92
    v_mfma_f32_16x16x32_bf16 v[72:75], a[128:131], v[208:211], v[156:159]
    v_mfma_f32_16x16x32_bf16 v[72:75], a[132:135], v[212:215], v[72:75]
    v_mfma_f32_16x16x32_bf16 v[72:75], a[136:139], v[216:219], v[72:75]
    buffer_load_dwordx4 v25, s[20:23], s37 offen offset:1024 nt lds
    v_exp_f32 v45, v93
    s_add_u32 m0, s36, 16384
    v_mfma_f32_16x16x32_bf16 v[72:75], a[140:143], v[220:223], v[72:75]
    v_add_f32 v5, v5, v42
    v_add_f32 v5, v5, v43
    s_add_u32 s37, s37, 2048
    v_mfma_f32_16x16x32_bf16 a[12:15], a[172:175], v[112:115], a[12:15]
    ds_read_b64_tr_b16 a[184:185], v22 offset:32768
    v_cvt_pk_bf16_f32 v133, v42, v43
    v_exp_f32 v46, v94
    v_mfma_f32_16x16x32_bf16 a[44:47], a[172:175], v[116:119], a[44:47]
    ds_read_b64_tr_b16 a[186:187], v22 offset:36864
    v_exp_f32 v47, v95
    v_mfma_f32_16x16x32_bf16 a[76:79], a[172:175], v[120:123], a[76:79]
    v_add_f32 v5, v5, v44
    v_add_f32 v5, v5, v45
    v_cvt_pk_bf16_f32 v134, v44, v45
    v_mfma_f32_16x16x32_bf16 a[108:111], a[172:175], v[124:127], a[108:111]
    v_exp_f32 v40, v96
    s_waitcnt lgkmcnt(2)
    v_mfma_f32_16x16x32_bf16 v[52:55], a[144:147], v[160:163], v[144:147]
    v_mfma_f32_16x16x32_bf16 v[52:55], a[148:151], v[164:167], v[52:55]
    v_mfma_f32_16x16x32_bf16 v[52:55], a[152:155], v[168:171], v[52:55]
    buffer_load_dwordx4 v26, s[24:27], s41 offen offset:0 nt lds
    v_exp_f32 v41, v97
    v_add_f32 v5, v5, v46
    v_mfma_f32_16x16x32_bf16 v[52:55], a[156:159], v[172:175], v[52:55]
    v_add_f32 v5, v5, v47
    v_cvt_pk_bf16_f32 v135, v46, v47
    v_exp_f32 v42, v98
    v_mfma_f32_16x16x32_bf16 a[16:19], a[176:179], v[112:115], a[16:19]
    ds_read_b64_tr_b16 a[188:189], v23 offset:32768
    v_exp_f32 v43, v99
    v_add_f32 v6, v40, v41
    v_mfma_f32_16x16x32_bf16 a[48:51], a[176:179], v[116:119], a[48:51]
    ds_read_b64_tr_b16 a[190:191], v23 offset:36864
    v_cvt_pk_bf16_f32 v136, v40, v41
    v_exp_f32 v44, v100
    v_mfma_f32_16x16x32_bf16 a[80:83], a[176:179], v[120:123], a[80:83]
    v_mfma_f32_16x16x32_bf16 a[112:115], a[176:179], v[124:127], a[112:115]
    v_mfma_f32_16x16x32_bf16 v[60:63], a[144:147], v[176:179], v[148:151]
    v_exp_f32 v45, v101
    v_add_f32 v6, v6, v42
    v_mfma_f32_16x16x32_bf16 v[60:63], a[148:151], v[180:183], v[60:63]
    v_mfma_f32_16x16x32_bf16 v[60:63], a[152:155], v[184:187], v[60:63]
    buffer_load_dwordx4 v27, s[24:27], s41 offen offset:1024 nt lds
    v_add_f32 v6, v6, v43
    v_cvt_pk_bf16_f32 v137, v42, v43
    s_add_u32 s41, s41, 2048
    v_mfma_f32_16x16x32_bf16 v[60:63], a[156:159], v[188:191], v[60:63]
    v_mfma_f32_16x16x32_bf16 a[20:23], a[180:183], v[112:115], a[20:23]
    v_exp_f32 v46, v102
    v_exp_f32 v47, v103
    v_mfma_f32_16x16x32_bf16 a[52:55], a[180:183], v[116:119], a[52:55]
    v_mfma_f32_16x16x32_bf16 a[84:87], a[180:183], v[120:123], a[84:87]
    v_mfma_f32_16x16x32_bf16 a[116:119], a[180:183], v[124:127], a[116:119]
    v_add_f32 v6, v6, v44
    v_add_f32 v6, v6, v45
    s_waitcnt vmcnt(8) lgkmcnt(0)
    s_barrier
    v_mfma_f32_16x16x32_bf16 v[68:71], a[144:147], v[192:195], v[152:155]
    ds_read_b128 a[128:131], v8 offset:8192
    v_cvt_pk_bf16_f32 v138, v44, v45
    v_exp_f32 v40, v104
    v_mfma_f32_16x16x32_bf16 v[68:71], a[148:151], v[196:199], v[68:71]
    ds_read_b128 a[132:135], v9 offset:8192
    v_exp_f32 v41, v105
    v_mfma_f32_16x16x32_bf16 v[68:71], a[152:155], v[200:203], v[68:71]
    ds_read_b128 a[136:139], v10 offset:8192
    v_add_f32 v6, v6, v46
    v_add_f32 v6, v6, v47
    v_mfma_f32_16x16x32_bf16 v[68:71], a[156:159], v[204:207], v[68:71]
    ds_read_b128 a[140:143], v11 offset:8192
    v_cvt_pk_bf16_f32 v139, v46, v47
    v_exp_f32 v42, v106
    v_mfma_f32_16x16x32_bf16 a[24:27], a[184:187], v[112:115], a[24:27]
    ds_read_b64_tr_b16 a[160:161], v16 offset:40960
    v_exp_f32 v43, v107
    v_add_f32 v7, v40, v41
    v_mfma_f32_16x16x32_bf16 a[56:59], a[184:187], v[116:119], a[56:59]
    ds_read_b64_tr_b16 a[162:163], v16 offset:45056
    v_cvt_pk_bf16_f32 v140, v40, v41
    v_exp_f32 v44, v108
    v_mfma_f32_16x16x32_bf16 a[88:91], a[184:187], v[120:123], a[88:91]
    v_exp_f32 v45, v109
    v_add_f32 v7, v7, v42
    v_add_f32 v7, v7, v43
    v_mfma_f32_16x16x32_bf16 a[120:123], a[184:187], v[124:127], a[120:123]
    v_mfma_f32_16x16x32_bf16 v[76:79], a[144:147], v[208:211], v[156:159]
    ds_read_b64_tr_b16 a[164:165], v17 offset:40960
    v_cvt_pk_bf16_f32 v141, v42, v43
    v_exp_f32 v46, v110
    v_mfma_f32_16x16x32_bf16 v[76:79], a[148:151], v[212:215], v[76:79]
    ds_read_b64_tr_b16 a[166:167], v17 offset:45056
    v_exp_f32 v47, v111
    v_mfma_f32_16x16x32_bf16 v[76:79], a[152:155], v[216:219], v[76:79]
    v_mfma_f32_16x16x32_bf16 v[76:79], a[156:159], v[220:223], v[76:79]
    v_add_f32 v7, v7, v44
    v_add_f32 v7, v7, v45
    v_cvt_pk_bf16_f32 v142, v44, v45
    v_mfma_f32_16x16x32_bf16 a[28:31], a[188:191], v[112:115], a[28:31]
    ds_read_b64_tr_b16 a[168:169], v18 offset:40960
    v_add_f32 v7, v7, v46
    v_add_f32 v7, v7, v47
    v_cvt_pk_bf16_f32 v143, v46, v47
    v_mfma_f32_16x16x32_bf16 a[60:63], a[188:191], v[116:119], a[60:63]
    ds_read_b64_tr_b16 a[170:171], v18 offset:45056
    v_max3_f32 v35, v4, v5, v6
    v_max_f32 v35, v35, v7
    v_cmp_lt_f32 vcc, s40, v35
    v_mfma_f32_16x16x32_bf16 a[92:95], a[188:191], v[120:123], a[92:95]
    v_mfma_f32_16x16x32_bf16 a[124:127], a[188:191], v[124:127], a[124:127]
    s_cbranch_vccnz L_rare_h1v2
L_ret_h1v2:
    s_waitcnt lgkmcnt(2)
    v_mfma_f32_16x16x32_bf16 v[80:83], a[128:131], v[160:163], v[144:147]
    ds_read_b128 a[144:147], v8 offset:12288
    v_add_f32 v244, v244, v4
    v_add_f32 v245, v245, v5
    v_mfma_f32_16x16x32_bf16 v[80:83], a[132:135], v[164:167], v[80:83]
    v_mfma_f32_16x16x32_bf16 v[80:83], a[136:139], v[168:171], v[80:83]
    ds_read_b128 a[148:151], v9 offset:12288
    v_add_f32 v246, v246, v6
    v_add_f32 v247, v247, v7
    v_mfma_f32_16x16x32_bf16 v[80:83], a[140:143], v[172:175], v[80:83]
    v_exp_f32 v40, v48
    v_exp_f32 v41, v49
    v_mfma_f32_16x16x32_bf16 a[0:3], a[160:163], v[128:131], a[0:3]
    ds_read_b64_tr_b16 a[172:173], v19 offset:40960
    v_exp_f32 v42, v50
    v_mfma_f32_16x16x32_bf16 a[32:35], a[160:163], v[132:135], a[32:35]
    ds_read_b64_tr_b16 a[174:175], v19 offset:45056
    v_exp_f32 v43, v51
    v_mfma_f32_16x16x32_bf16 a[64:67], a[160:163], v[136:139], a[64:67]
    v_mfma_f32_16x16x32_bf16 a[96:99], a[160:163], v[140:143], a[96:99]
    v_mfma_f32_16x16x32_bf16 v[88:91], a[128:131], v[176:179], v[148:151]
    ds_read_b128 a[152:155], v10 offset:12288
    v_add_f32 v248, v40, v41
    v_cvt_pk_bf16_f32 v112, v40, v41
    v_mfma_f32_16x16x32_bf16 v[88:91], a[132:135], v[180:183], v[88:91]
    v_exp_f32 v44, v52
    v_exp_f32 v45, v53
    v_mfma_f32_16x16x32_bf16 v[88:91], a[136:139], v[184:187], v[88:91]
    ds_read_b128 a[156:159], v11 offset:12288
    v_add_f32 v248, v248, v42
    v_add_f32 v248, v248, v43
    v_mfma_f32_16x16x32_bf16 v[88:91], a[140:143], v[188:191], v[88:91]
    v_mfma_f32_16x16x32_bf16 a[4:7], a[164:167], v[128:131], a[4:7]
    ds_read_b64_tr_b16 a[176:177], v20 offset:40960
    v_cvt_pk_bf16_f32 v113, v42, v43
    v_exp_f32 v46, v54
    v_mfma_f32_16x16x32_bf16 a[36:39], a[164:167], v[132:135], a[36:39]
    ds_read_b64_tr_b16 a[178:179], v20 offset:45056
    v_exp_f32 v47, v55
    v_mfma_f32_16x16x32_bf16 a[68:71], a[164:167], v[136:139], a[68:71]
    v_mfma_f32_16x16x32_bf16 a[100:103], a[164:167], v[140:143], a[100:103]
    v_add_f32 v248, v248, v44
    v_add_f32 v248, v248, v45
    s_waitcnt lgkmcnt(4)
    v_mfma_f32_16x16x32_bf16 v[96:99], a[128:131], v[192:195], v[152:155]
    v_mfma_f32_16x16x32_bf16 v[96:99], a[132:135], v[196:199], v[96:99]
    v_cvt_pk_bf16_f32 v114, v44, v45
    v_exp_f32 v40, v56
    s_add_u32 m0, s35, 40960
    v_mfma_f32_16x16x32_bf16 v[96:99], a[136:139], v[200:203], v[96:99]
    buffer_load_dwordx4 v24, s[20:23], s37 offen offset:0 nt lds
    v_exp_f32 v41, v57
    v_add_f32 v248, v248, v46
    v_mfma_f32_16x16x32_bf16 v[96:99], a[140:143], v[204:207], v[96:99]
    v_add_f32 v248, v248, v47
    v_cvt_pk_bf16_f32 v115, v46, v47
    v_exp_f32 v42, v58
    v_mfma_f32_16x16x32_bf16 a[8:11], a[168:171], v[128:131], a[8:11]
    ds_read_b64_tr_b16 a[180:181], v21 offset:40960
    v_exp_f32 v43, v59
    v_mfma_f32_16x16x32_bf16 a[40:43], a[168:171], v[132:135], a[40:43]
    ds_read_b64_tr_b16 a[182:183], v21 offset:45056
    v_add_f32 v249, v40, v41
    v_cvt_pk_bf16_f32 v116, v40, v41
    v_mfma_f32_16x16x32_bf16 a[72:75], a[168:171], v[136:139], a[72:75]
    v_mfma_f32_16x16x32_bf16 a[104:107], a[168:171], v[140:143], a[104:107]
    v_mfma_f32_16x16x32_bf16 v[104:107], a[128:131], v[208:211], v[156:159]
    v_exp_f32 v44, v60
    v_exp_f32 v45, v61
    v_mfma_f32_16x16x32_bf16 v[104:107], a[132:135], v[212:215], v[104:107]
    v_mfma_f32_16x16x32_bf16 v[104:107], a[136:139], v[216:219], v[104:107]
    buffer_load_dwordx4 v25, s[20:23], s37 offen offset:1024 nt lds
    v_add_f32 v249, v249, v42
    v_add_f32 v249, v249, v43
    s_add_u32 m0, s36, 24576
    v_mfma_f32_16x16x32_bf16 v[104:107], a[140:143], v[220:223], v[104:107]
    v_cvt_pk_bf16_f32 v117, v42, v43
    v_exp_f32 v46, v62
    s_add_u32 s37, s37, 2048
    v_mfma_f32_16x16x32_bf16 a[12:15], a[172:175], v[128:131], a[12:15]
    ds_read_b64_tr_b16 a[184:185], v22 offset:40960
    v_exp_f32 v47, v63
    v_mfma_f32_16x16x32_bf16 a[44:47], a[172:175], v[132:135], a[44:47]
    ds_read_b64_tr_b16 a[186:187], v22 offset:45056
    v_add_f32 v249, v249, v44
    v_add_f32 v249, v249, v45
    v_mfma_f32_16x16x32_bf16 a[76:79], a[172:175], v[136:139], a[76:79]
    v_mfma_f32_16x16x32_bf16 a[108:111], a[172:175], v[140:143], a[108:111]
    v_cvt_pk_bf16_f32 v118, v44, v45
    v_exp_f32 v40, v64
    s_waitcnt lgkmcnt(2)
    v_mfma_f32_16x16x32_bf16 v[84:87], a[144:147], v[160:163], v[144:147]
    v_exp_f32 v41, v65
    v_add_f32 v249, v249, v46
    v_add_f32 v249, v249, v47
    v_mfma_f32_16x16x32_bf16 v[84:87], a[148:151], v[164:167], v[84:87]
    v_mfma_f32_16x16x32_bf16 v[84:87], a[152:155], v[168:171], v[84:87]
    buffer_load_dwordx4 v26, s[24:27], s41 offen offset:0 nt lds
    v_cvt_pk_bf16_f32 v119, v46, v47
    v_exp_f32 v42, v66
    v_mfma_f32_16x16x32_bf16 v[84:87], a[156:159], v[172:175], v[84:87]
    v_mfma_f32_16x16x32_bf16 a[16:19], a[176:179], v[128:131], a[16:19]
    ds_read_b64_tr_b16 a[188:189], v23 offset:40960
    v_exp_f32 v43, v67
    v_mfma_f32_16x16x32_bf16 a[48:51], a[176:179], v[132:135], a[48:51]
    ds_read_b64_tr_b16 a[190:191], v23 offset:45056
    v_add_f32 v250, v40, v41
    v_cvt_pk_bf16_f32 v120, v40, v41
    v_mfma_f32_16x16x32_bf16 a[80:83], a[176:179], v[136:139], a[80:83]
    v_exp_f32 v44, v68
    v_exp_f32 v45, v69
    v_mfma_f32_16x16x32_bf16 a[112:115], a[176:179], v[140:143], a[112:115]
    v_mfma_f32_16x16x32_bf16 v[92:95], a[144:147], v[176:179], v[148:151]
    v_mfma_f32_16x16x32_bf16 v[92:95], a[148:151], v[180:183], v[92:95]
    v_add_f32 v250, v250, v42
    v_add_f32 v250, v250, v43
    v_cvt_pk_bf16_f32 v121, v42, v43
    v_mfma_f32_16x16x32_bf16 v[92:95], a[152:155], v[184:187], v[92:95]
    buffer_load_dwordx4 v27, s[24:27], s41 offen offset:1024 nt lds
    v_exp_f32 v46, v70
    s_add_u32 s41, s41, 2048
    v_mfma_f32_16x16x32_bf16 v[92:95], a[156:159], v[188:191], v[92:95]
    v_exp_f32 v47, v71
    s_cmp_eq_u32 s41, 327680
    s_cmov_b32 s41, 268435456
    v_mfma_f32_16x16x32_bf16 a[20:23], a[180:183], v[128:131], a[20:23]
    v_mfma_f32_16x16x32_bf16 a[52:55], a[180:183], v[132:135], a[52:55]
    v_mfma_f32_16x16x32_bf16 a[84:87], a[180:183], v[136:139], a[84:87]
    v_mfma_f32_16x16x32_bf16 a[116:119], a[180:183], v[140:143], a[116:119]
    v_add_f32 v250, v250, v44
    v_add_f32 v250, v250, v45
    s_waitcnt lgkmcnt(0)
    v_mfma_f32_16x16x32_bf16 v[100:103], a[144:147], v[192:195], v[152:155]
    ds_read_b128 a[128:131], v8 offset:16384
    v_cvt_pk_bf16_f32 v122, v44, v45
    v_exp_f32 v40, v72
    v_mfma_f32_16x16x32_bf16 v[100:103], a[148:151], v[196:199], v[100:103]
    ds_read_b128 a[132:135], v9 offset:16384
    v_exp_f32 v41, v73
    v_mfma_f32_16x16x32_bf16 v[100:103], a[152:155], v[200:203], v[100:103]
    ds_read_b128 a[136:139], v10 offset:16384
    v_add_f32 v250, v250, v46
    v_add_f32 v250, v250, v47
    v_mfma_f32_16x16x32_bf16 v[100:103], a[156:159], v[204:207], v[100:103]
    ds_read_b128 a[140:143], v11 offset:16384
    v_cvt_pk_bf16_f32 v123, v46, v47
    v_exp_f32 v42, v74
    v_mfma_f32_16x16x32_bf16 a[24:27], a[184:187], v[128:131], a[24:27]
    ds_read_b64_tr_b16 a[160:161], v16 offset:0
    v_exp_f32 v43, v75
    v_add_f32 v251, v40, v41
    v_mfma_f32_16x16x32_bf16 a[56:59], a[184:187], v[132:135], a[56:59]
    ds_read_b64_tr_b16 a[162:163], v16 offset:4096
    v_cvt_pk_bf16_f32 v124, v40, v41
    v_exp_f32 v44, v76
    v_mfma_f32_16x16x32_bf16 a[88:91], a[184:187], v[136:139], a[88:91]
    v_exp_f32 v45, v77
    v_add_f32 v251, v251, v42
    v_add_f32 v251, v251, v43
    v_mfma_f32_16x16x32_bf16 a[120:123], a[184:187], v[140:143], a[120:123]
    v_mfma_f32_16x16x32_bf16 v[108:111], a[144:147], v[208:211], v[156:159]
    ds_read_b64_tr_b16 a[164:165], v17 offset:0
    v_cvt_pk_bf16_f32 v125, v42, v43
    v_exp_f32 v46, v78
    v_mfma_f32_16x16x32_bf16 v[108:111], a[148:151], v[212:215], v[108:111]
    ds_read_b64_tr_b16 a[166:167], v17 offset:4096
    v_exp_f32 v47, v79
    v_mfma_f32_16x16x32_bf16 v[108:111], a[152:155], v[216:219], v[108:111]
    v_mfma_f32_16x16x32_bf16 v[108:111], a[156:159], v[220:223], v[108:111]
    v_add_f32 v251, v251, v44
    v_add_f32 v251, v251, v45
    v_cvt_pk_bf16_f32 v126, v44, v45
    v_mfma_f32_16x16x32_bf16 a[28:31], a[188:191], v[128:131], a[28:31]
    ds_read_b64_tr_b16 a[168:169], v18 offset:0
    v_add_f32 v251, v251, v46
    v_add_f32 v251, v251, v47
    v_cvt_pk_bf16_f32 v127, v46, v47
    v_mfma_f32_16x16x32_bf16 a[60:63], a[188:191], v[132:135], a[60:63]
    ds_read_b64_tr_b16 a[170:171], v18 offset:4096
    v_max3_f32 v35, v248, v249, v250
    v_max_f32 v35, v35, v251
    v_cmp_lt_f32 vcc, s40, v35
    v_mfma_f32_16x16x32_bf16 a[92:95], a[188:191], v[136:139], a[92:95]
    v_mfma_f32_16x16x32_bf16 a[124:127], a[188:191], v[140:143], a[124:127]
    s_cbranch_vccnz L_rare_h1v3
L_ret_h1v3:
    s_waitcnt lgkmcnt(2)
    v_mfma_f32_16x16x32_bf16 v[48:51], a[128:131], v[160:163], v[144:147]
    ds_read_b128 a[144:147], v8 offset:20480
    v_add_f32 v244, v244, v248
    v_add_f32 v245, v245, v249
    v_mfma_f32_16x16x32_bf16 v[48:51], a[132:135], v[164:167], v[48:51]
    v_mfma_f32_16x16x32_bf16 v[48:51], a[136:139], v[168:171], v[48:51]
    ds_read_b128 a[148:151], v9 offset:20480
    v_add_f32 v246, v246, v250
    v_add_f32 v247, v247, v251
    v_mfma_f32_16x16x32_bf16 v[48:51], a[140:143], v[172:175], v[48:51]
    v_exp_f32 v40, v80
    v_exp_f32 v41, v81
    v_mfma_f32_16x16x32_bf16 a[0:3], a[160:163], v[112:115], a[0:3]
    ds_read_b64_tr_b16 a[172:173], v19 offset:0
    v_exp_f32 v42, v82
    v_mfma_f32_16x16x32_bf16 a[32:35], a[160:163], v[116:119], a[32:35]
    ds_read_b64_tr_b16 a[174:175], v19 offset:4096
    v_exp_f32 v43, v83
    v_mfma_f32_16x16x32_bf16 a[64:67], a[160:163], v[120:123], a[64:67]
    v_mfma_f32_16x16x32_bf16 a[96:99], a[160:163], v[124:127], a[96:99]
    v_mfma_f32_16x16x32_bf16 v[56:59], a[128:131], v[176:179], v[148:151]
    ds_read_b128 a[152:155], v10 offset:20480
    v_add_f32 v4, v40, v41
    v_cvt_pk_bf16_f32 v128, v40, v41
    v_mfma_f32_16x16x32_bf16 v[56:59], a[132:135], v[180:183], v[56:59]
    v_exp_f32 v44, v84
    v_exp_f32 v45, v85
    v_mfma_f32_16x16x32_bf16 v[56:59], a[136:139], v[184:187], v[56:59]
    ds_read_b128 a[156:159], v11 offset:20480
    v_add_f32 v4, v4, v42
    v_add_f32 v4, v4, v43
    v_mfma_f32_16x16x32_bf16 v[56:59], a[140:143], v[188:191], v[56:59]
    v_mfma_f32_16x16x32_bf16 a[4:7], a[164:167], v[112:115], a[4:7]
    ds_read_b64_tr_b16 a[176:177], v20 offset:0
    v_cvt_pk_bf16_f32 v129, v42, v43
    v_exp_f32 v46, v86
    v_mfma_f32_16x16x32_bf16 a[36:39], a[164:167], v[116:119], a[36:39]
    ds_read_b64_tr_b16 a[178:179], v20 offset:4096
    v_exp_f32 v47, v87
    v_mfma_f32_16x16x32_bf16 a[68:71], a[164:167], v[120:123], a[68:71]
    v_mfma_f32_16x16x32_bf16 a[100:103], a[164:167], v[124:127], a[100:103]
    v_add_f32 v4, v4, v44
    v_add_f32 v4, v4, v45
    s_waitcnt lgkmcnt(4)
    v_mfma_f32_16x16x32_bf16 v[64:67], a[128:131], v[192:195], v[152:155]
    v_cvt_pk_bf16_f32 v130, v44, v45
    v_exp_f32 v40, v88
    v_mfma_f32_16x16x32_bf16 v[64:67], a[132:135], v[196:199], v[64:67]
    v_exp_f32 v41, v89
    s_add_u32 m0, s35, 0
    v_mfma_f32_16x16x32_bf16 v[64:67], a[136:139], v[200:203], v[64:67]
    buffer_load_dwordx4 v24, s[20:23], s37 offen offset:0 nt lds
    v_add_f32 v4, v4, v46
    v_add_f32 v4, v4, v47
    v_mfma_f32_16x16x32_bf16 v[64:67], a[140:143], v[204:207], v[64:67]
    v_mfma_f32_16x16x32_bf16 a[8:11], a[168:171], v[112:115], a[8:11]
    ds_read_b64_tr_b16 a[180:181], v21 offset:0
    v_cvt_pk_bf16_f32 v131, v46, v47
    v_exp_f32 v42, v90
    v_mfma_f32_16x16x32_bf16 a[40:43], a[168:171], v[116:119], a[40:43]
    ds_read_b64_tr_b16 a[182:183], v21 offset:4096
    v_exp_f32 v43, v91
    v_mfma_f32_16x16x32_bf16 a[72:75], a[168:171], v[120:123], a[72:75]
    v_mfma_f32_16x16x32_bf16 a[104:107], a[168:171], v[124:127], a[104:107]
    v_add_f32 v5, v40, v41
    v_cvt_pk_bf16_f32 v132, v40, v41
    v_exp_f32 v44, v92
    v_mfma_f32_16x16x32_bf16 v[72:75], a[128:131], v[208:211], v[156:159]
    v_mfma_f32_16x16x32_bf16 v[72:75], a[132:135], v[212:215], v[72:75]
    v_mfma_f32_16x16x32_bf16 v[72:75], a[136:139], v[216:219], v[72:75]
    buffer_load_dwordx4 v25, s[20:23], s37 offen offset:1024 nt lds
    v_exp_f32 v45, v93
    s_add_u32 m0, s36, 32768
    v_mfma_f32_16x16x32_bf16 v[72:75], a[140:143], v[220:223], v[72:75]
    v_add_f32 v5, v5, v42
    v_add_f32 v5, v5, v43
    s_add_u32 s37, s37, 2048
    v_mfma_f32_16x16x32_bf16 a[12:15], a[172:175], v[112:115], a[12:15]
    ds_read_b64_tr_b16 a[184:185], v22 offset:0
    v_cvt_pk_bf16_f32 v133, v42, v43
    v_exp_f32 v46, v94
    v_mfma_f32_16x16x32_bf16 a[44:47], a[172:175], v[116:119], a[44:47]
    ds_read_b64_tr_b16 a[186:187], v22 offset:4096
    v_exp_f32 v47, v95
    v_mfma_f32_16x16x32_bf16 a[76:79], a[172:175], v[120:123], a[76:79]
    v_add_f32 v5, v5, v44
    v_add_f32 v5, v5, v45
    v_cvt_pk_bf16_f32 v134, v44, v45
    v_mfma_f32_16x16x32_bf16 a[108:111], a[172:175], v[124:127], a[108:111]
    v_exp_f32 v40, v96
    s_waitcnt lgkmcnt(2)
    v_mfma_f32_16x16x32_bf16 v[52:55], a[144:147], v[160:163], v[144:147]
    v_mfma_f32_16x16x32_bf16 v[52:55], a[148:151], v[164:167], v[52:55]
    v_mfma_f32_16x16x32_bf16 v[52:55], a[152:155], v[168:171], v[52:55]
    buffer_load_dwordx4 v26, s[24:27], s41 offen offset:0 nt lds
    v_exp_f32 v41, v97
    v_add_f32 v5, v5, v46
    v_mfma_f32_16x16x32_bf16 v[52:55], a[156:159], v[172:175], v[52:55]
    v_add_f32 v5, v5, v47
    v_cvt_pk_bf16_f32 v135, v46, v47
    v_exp_f32 v42, v98
    v_mfma_f32_16x16x32_bf16 a[16:19], a[176:179], v[112:115], a[16:19]
    ds_read_b64_tr_b16 a[188:189], v23 offset:0
    v_exp_f32 v43, v99
    v_add_f32 v6, v40, v41
    v_mfma_f32_16x16x32_bf16 a[48:51], a[176:179], v[116:119], a[48:51]
    ds_read_b64_tr_b16 a[190:191], v23 offset:4096
    v_cvt_pk_bf16_f32 v136, v40, v41
    v_exp_f32 v44, v100
    v_mfma_f32_16x16x32_bf16 a[80:83], a[176:179], v[120:123], a[80:83]
    v_mfma_f32_16x16x32_bf16 a[112:115], a[176:179], v[124:127], a[112:115]
    v_mfma_f32_16x16x32_bf16 v[60:63], a[144:147], v[176:179], v[148:151]
    v_exp_f32 v45, v101
    v_add_f32 v6, v6, v42
    v_mfma_f32_16x16x32_bf16 v[60:63], a[148:151], v[180:183], v[60:63]
    v_mfma_f32_16x16x32_bf16 v[60:63], a[152:155], v[184:187], v[60:63]
    buffer_load_dwordx4 v27, s[24:27], s41 offen offset:1024 nt lds
    v_add_f32 v6, v6, v43
    v_cvt_pk_bf16_f32 v137, v42, v43
    s_add_u32 s41, s41, 2048
    v_mfma_f32_16x16x32_bf16 v[60:63], a[156:159], v[188:191], v[60:63]
    v_mfma_f32_16x16x32_bf16 a[20:23], a[180:183], v[112:115], a[20:23]
    v_exp_f32 v46, v102
    v_exp_f32 v47, v103
    v_mfma_f32_16x16x32_bf16 a[52:55], a[180:183], v[116:119], a[52:55]
    v_mfma_f32_16x16x32_bf16 a[84:87], a[180:183], v[120:123], a[84:87]
    v_mfma_f32_16x16x32_bf16 a[116:119], a[180:183], v[124:127], a[116:119]
    v_add_f32 v6, v6, v44
    v_add_f32 v6, v6, v45
    s_waitcnt vmcnt(8) lgkmcnt(0)
    s_barrier
    v_mfma_f32_16x16x32_bf16 v[68:71], a[144:147], v[192:195], v[152:155]
    ds_read_b128 a[128:131], v8 offset:24576
    v_cvt_pk_bf16_f32 v138, v44, v45
    v_exp_f32 v40, v104
    v_mfma_f32_16x16x32_bf16 v[68:71], a[148:151], v[196:199], v[68:71]
    ds_read_b128 a[132:135], v9 offset:24576
    v_exp_f32 v41, v105
    v_mfma_f32_16x16x32_bf16 v[68:71], a[152:155], v[200:203], v[68:71]
    ds_read_b128 a[136:139], v10 offset:24576
    v_add_f32 v6, v6, v46
    v_add_f32 v6, v6, v47
    v_mfma_f32_16x16x32_bf16 v[68:71], a[156:159], v[204:207], v[68:71]
    ds_read_b128 a[140:143], v11 offset:24576
    v_cvt_pk_bf16_f32 v139, v46, v47
    v_exp_f32 v42, v106
    v_mfma_f32_16x16x32_bf16 a[24:27], a[184:187], v[112:115], a[24:27]
    ds_read_b64_tr_b16 a[160:161], v16 offset:8192
    v_exp_f32 v43, v107
    v_add_f32 v7, v40, v41
    v_mfma_f32_16x16x32_bf16 a[56:59], a[184:187], v[116:119], a[56:59]
    ds_read_b64_tr_b16 a[162:163], v16 offset:12288
    v_cvt_pk_bf16_f32 v140, v40, v41
    v_exp_f32 v44, v108
    v_mfma_f32_16x16x32_bf16 a[88:91], a[184:187], v[120:123], a[88:91]
    v_exp_f32 v45, v109
    v_add_f32 v7, v7, v42
    v_add_f32 v7, v7, v43
    v_mfma_f32_16x16x32_bf16 a[120:123], a[184:187], v[124:127], a[120:123]
    v_mfma_f32_16x16x32_bf16 v[76:79], a[144:147], v[208:211], v[156:159]
    ds_read_b64_tr_b16 a[164:165], v17 offset:8192
    v_cvt_pk_bf16_f32 v141, v42, v43
    v_exp_f32 v46, v110
    v_mfma_f32_16x16x32_bf16 v[76:79], a[148:151], v[212:215], v[76:79]
    ds_read_b64_tr_b16 a[166:167], v17 offset:12288
    v_exp_f32 v47, v111
    v_mfma_f32_16x16x32_bf16 v[76:79], a[152:155], v[216:219], v[76:79]
    v_mfma_f32_16x16x32_bf16 v[76:79], a[156:159], v[220:223], v[76:79]
    v_add_f32 v7, v7, v44
    v_add_f32 v7, v7, v45
    v_cvt_pk_bf16_f32 v142, v44, v45
    v_mfma_f32_16x16x32_bf16 a[28:31], a[188:191], v[112:115], a[28:31]
    ds_read_b64_tr_b16 a[168:169], v18 offset:8192
    v_add_f32 v7, v7, v46
    v_add_f32 v7, v7, v47
    v_cvt_pk_bf16_f32 v143, v46, v47
    v_mfma_f32_16x16x32_bf16 a[60:63], a[188:191], v[116:119], a[60:63]
    ds_read_b64_tr_b16 a[170:171], v18 offset:12288
    v_max3_f32 v35, v4, v5, v6
    v_max_f32 v35, v35, v7
    v_cmp_lt_f32 vcc, s40, v35
    v_mfma_f32_16x16x32_bf16 a[92:95], a[188:191], v[120:123], a[92:95]
    v_mfma_f32_16x16x32_bf16 a[124:127], a[188:191], v[124:127], a[124:127]
    s_cbranch_vccnz L_rare_h1v4
L_ret_h1v4:
    s_waitcnt lgkmcnt(2)
    v_mfma_f32_16x16x32_bf16 v[80:83], a[128:131], v[160:163], v[144:147]
    ds_read_b128 a[144:147], v8 offset:28672
    v_add_f32 v244, v244, v4
    v_add_f32 v245, v245, v5
    v_mfma_f32_16x16x32_bf16 v[80:83], a[132:135], v[164:167], v[80:83]
    v_mfma_f32_16x16x32_bf16 v[80:83], a[136:139], v[168:171], v[80:83]
    ds_read_b128 a[148:151], v9 offset:28672
    v_add_f32 v246, v246, v6
    v_add_f32 v247, v247, v7
    v_mfma_f32_16x16x32_bf16 v[80:83], a[140:143], v[172:175], v[80:83]
    v_exp_f32 v40, v48
    v_exp_f32 v41, v49
    v_mfma_f32_16x16x32_bf16 a[0:3], a[160:163], v[128:131], a[0:3]
    ds_read_b64_tr_b16 a[172:173], v19 offset:8192
    v_exp_f32 v42, v50
    v_mfma_f32_16x16x32_bf16 a[32:35], a[160:163], v[132:135], a[32:35]
    ds_read_b64_tr_b16 a[174:175], v19 offset:12288
    v_exp_f32 v43, v51
    v_mfma_f32_16x16x32_bf16 a[64:67], a[160:163], v[136:139], a[64:67]
    v_mfma_f32_16x16x32_bf16 a[96:99], a[160:163], v[140:143], a[96:99]
    v_mfma_f32_16x16x32_bf16 v[88:91], a[128:131], v[176:179], v[148:151]
    ds_read_b128 a[152:155], v10 offset:28672
    v_add_f32 v248, v40, v41
    v_cvt_pk_bf16_f32 v112, v40, v41
    v_mfma_f32_16x16x32_bf16 v[88:91], a[132:135], v[180:183], v[88:91]
    v_exp_f32 v44, v52
    v_exp_f32 v45, v53
    v_mfma_f32_16x16x32_bf16 v[88:91], a[136:139], v[184:187], v[88:91]
    ds_read_b128 a[156:159], v11 offset:28672
    v_add_f32 v248, v248, v42
    v_add_f32 v248, v248, v43
    v_mfma_f32_16x16x32_bf16 v[88:91], a[140:143], v[188:191], v[88:91]
    v_mfma_f32_16x16x32_bf16 a[4:7], a[164:167], v[128:131], a[4:7]
    ds_read_b64_tr_b16 a[176:177], v20 offset:8192
    v_cvt_pk_bf16_f32 v113, v42, v43
    v_exp_f32 v46, v54
    v_mfma_f32_16x16x32_bf16 a[36:39], a[164:167], v[132:135], a[36:39]
    ds_read_b64_tr_b16 a[178:179], v20 offset:12288
    v_exp_f32 v47, v55
    v_mfma_f32_16x16x32_bf16 a[68:71], a[164:167], v[136:139], a[68:71]
    v_mfma_f32_16x16x32_bf16 a[100:103], a[164:167], v[140:143], a[100:103]
    v_add_f32 v248, v248, v44
    v_add_f32 v248, v248, v45
    s_waitcnt lgkmcnt(4)
    v_mfma_f32_16x16x32_bf16 v[96:99], a[128:131], v[192:195], v[152:155]
    v_mfma_f32_16x16x32_bf16 v[96:99], a[132:135], v[196:199], v[96:99]
    v_cvt_pk_bf16_f32 v114, v44, v45
    v_exp_f32 v40, v56
    s_add_u32 m0, s35, 8192
    v_mfma_f32_16x16x32_bf16 v[96:99], a[136:139], v[200:203], v[96:99]
    buffer_load_dwordx4 v24, s[20:23], s37 offen offset:0 nt lds
    v_exp_f32 v41, v57
    v_add_f32 v248, v248, v46
    v_mfma_f32_16x16x32_bf16 v[96:99], a[140:143], v[204:207], v[96:99]
    v_add_f32 v248, v248, v47
    v_cvt_pk_bf16_f32 v115, v46, v47
    v_exp_f32 v42, v58
    v_mfma_f32_16x16x32_bf16 a[8:11], a[168:171], v[128:131], a[8:11]
    ds_read_b64_tr_b16 a[180:181], v21 offset:8192
    v_exp_f32 v43, v59
    v_mfma_f32_16x16x32_bf16 a[40:43], a[168:171], v[132:135], a[40:43]
    ds_read_b64_tr_b16 a[182:183], v21 offset:12288
    v_add_f32 v249, v40, v41
    v_cvt_pk_bf16_f32 v116, v40, v41
    v_mfma_f32_16x16x32_bf16 a[72:75], a[168:171], v[136:139], a[72:75]
    v_mfma_f32_16x16x32_bf16 a[104:107], a[168:171], v[140:143], a[104:107]
    v_mfma_f32_16x16x32_bf16 v[104:107], a[128:131], v[208:211], v[156:159]
    v_exp_f32 v44, v60
    v_exp_f32 v45, v61
    v_mfma_f32_16x16x32_bf16 v[104:107], a[132:135], v[212:215], v[104:107]
    v_mfma_f32_16x16x32_bf16 v[104:107], a[136:139], v[216:219], v[104:107]
    buffer_load_dwordx4 v25, s[20:23], s37 offen offset:1024 nt lds
    v_add_f32 v249, v249, v42
    v_add_f32 v249, v249, v43
    s_add_u32 m0, s36, 40960
    v_mfma_f32_16x16x32_bf16 v[104:107], a[140:143], v[220:223], v[104:107]
    v_cvt_pk_bf16_f32 v117, v42, v43
    v_exp_f32 v46, v62
    s_add_u32 s37, s37, 2048
    v_mfma_f32_16x16x32_bf16 a[12:15], a[172:175], v[128:131], a[12:15]
    ds_read_b64_tr_b16 a[184:185], v22 offset:8192
    v_exp_f32 v47, v63
    v_mfma_f32_16x16x32_bf16 a[44:47], a[172:175], v[132:135], a[44:47]
    ds_read_b64_tr_b16 a[186:187], v22 offset:12288
    v_add_f32 v249, v249, v44
    v_add_f32 v249, v249, v45
    v_mfma_f32_16x16x32_bf16 a[76:79], a[172:175], v[136:139], a[76:79]
    v_mfma_f32_16x16x32_bf16 a[108:111], a[172:175], v[140:143], a[108:111]
    v_cvt_pk_bf16_f32 v118, v44, v45
    v_exp_f32 v40, v64
    s_waitcnt lgkmcnt(2)
    v_mfma_f32_16x16x32_bf16 v[84:87], a[144:147], v[160:163], v[144:147]
    v_exp_f32 v41, v65
    v_add_f32 v249, v249, v46
    v_add_f32 v249, v249, v47
    v_mfma_f32_16x16x32_bf16 v[84:87], a[148:151], v[164:167], v[84:87]
    v_mfma_f32_16x16x32_bf16 v[84:87], a[152:155], v[168:171], v[84:87]
    buffer_load_dwordx4 v26, s[24:27], s41 offen offset:0 nt lds
    v_cvt_pk_bf16_f32 v119, v46, v47
    v_exp_f32 v42, v66
    v_mfma_f32_16x16x32_bf16 v[84:87], a[156:159], v[172:175], v[84:87]
    v_mfma_f32_16x16x32_bf16 a[16:19], a[176:179], v[128:131], a[16:19]
    ds_read_b64_tr_b16 a[188:189], v23 offset:8192
    v_exp_f32 v43, v67
    v_mfma_f32_16x16x32_bf16 a[48:51], a[176:179], v[132:135], a[48:51]
    ds_read_b64_tr_b16 a[190:191], v23 offset:12288
    v_add_f32 v250, v40, v41
    v_cvt_pk_bf16_f32 v120, v40, v41
    v_mfma_f32_16x16x32_bf16 a[80:83], a[176:179], v[136:139], a[80:83]
    v_exp_f32 v44, v68
    v_exp_f32 v45, v69
    v_mfma_f32_16x16x32_bf16 a[112:115], a[176:179], v[140:143], a[112:115]
    v_mfma_f32_16x16x32_bf16 v[92:95], a[144:147], v[176:179], v[148:151]
    v_mfma_f32_16x16x32_bf16 v[92:95], a[148:151], v[180:183], v[92:95]
    v_add_f32 v250, v250, v42
    v_add_f32 v250, v250, v43
    v_cvt_pk_bf16_f32 v121, v42, v43
    v_mfma_f32_16x16x32_bf16 v[92:95], a[152:155], v[184:187], v[92:95]
    buffer_load_dwordx4 v27, s[24:27], s41 offen offset:1024 nt lds
    v_exp_f32 v46, v70
    s_add_u32 s41, s41, 2048
    v_mfma_f32_16x16x32_bf16 v[92:95], a[156:159], v[188:191], v[92:95]
    v_mfma_f32_16x16x32_bf16 a[20:23], a[180:183], v[128:131], a[20:23]
    v_mfma_f32_16x16x32_bf16 a[52:55], a[180:183], v[132:135], a[52:55]
    v_mfma_f32_16x16x32_bf16 a[84:87], a[180:183], v[136:139], a[84:87]
    v_exp_f32 v47, v71
    v_add_f32 v250, v250, v44
    v_add_f32 v250, v250, v45
    v_mfma_f32_16x16x32_bf16 a[116:119], a[180:183], v[140:143], a[116:119]
    v_cvt_pk_bf16_f32 v122, v44, v45
    v_exp_f32 v40, v72
    s_waitcnt lgkmcnt(0)
    v_mfma_f32_16x16x32_bf16 v[100:103], a[144:147], v[192:195], v[152:155]
    ds_read_b128 a[128:131], v8 offset:32768
    v_exp_f32 v41, v73
    v_mfma_f32_16x16x32_bf16 v[100:103], a[148:151], v[196:199], v[100:103]
    ds_read_b128 a[132:135], v9 offset:32768
    v_add_f32 v250, v250, v46
    v_add_f32 v250, v250, v47
    v_mfma_f32_16x16x32_bf16 v[100:103], a[152:155], v[200:203], v[100:103]
    ds_read_b128 a[136:139], v10 offset:32768
    v_cvt_pk_bf16_f32 v123, v46, v47
    v_exp_f32 v42, v74
    v_mfma_f32_16x16x32_bf16 v[100:103], a[156:159], v[204:207], v[100:103]
    ds_read_b128 a[140:143], v11 offset:32768
    v_exp_f32 v43, v75
    v_add_f32 v251, v40, v41
    v_mfma_f32_16x16x32_bf16 a[24:27], a[184:187], v[128:131], a[24:27]
    ds_read_b64_tr_b16 a[160:161], v16 offset:16384
    v_cvt_pk_bf16_f32 v124, v40, v41
    v_exp_f32 v44, v76
    v_mfma_f32_16x16x32_bf16 a[56:59], a[184:187], v[132:135], a[56:59]
    ds_read_b64_tr_b16 a[162:163], v16 offset:20480
    v_exp_f32 v45, v77
    v_mfma_f32_16x16x32_bf16 a[88:91], a[184:187], v[136:139], a[88:91]
    v_mfma_f32_16x16x32_bf16 a[120:123], a[184:187], v[140:143], a[120:123]
    v_mfma_f32_16x16x32_bf16 v[108:111], a[144:147], v[208:211], v[156:159]
    ds_read_b64_tr_b16 a[164:165], v17 offset:16384
    v_add_f32 v251, v251, v42
    v_add_f32 v251, v251, v43
    v_mfma_f32_16x16x32_bf16 v[108:111], a[148:151], v[212:215], v[108:111]
    ds_read_b64_tr_b16 a[166:167], v17 offset:20480
    v_cvt_pk_bf16_f32 v125, v42, v43
    v_exp_f32 v46, v78
    v_mfma_f32_16x16x32_bf16 v[108:111], a[152:155], v[216:219], v[108:111]
    v_exp_f32 v47, v79
    s_sub_u32 s39, s39, 1
    v_mfma_f32_16x16x32_bf16 v[108:111], a[156:159], v[220:223], v[108:111]
    v_add_f32 v251, v251, v44
    v_add_f32 v251, v251, v45
    v_cvt_pk_bf16_f32 v126, v44, v45
    v_add_f32 v251, v251, v46
    v_mfma_f32_16x16x32_bf16 a[28:31], a[188:191], v[128:131], a[28:31]
    ds_read_b64_tr_b16 a[168:169], v18 offset:16384
    v_add_f32 v251, v251, v47
    v_cvt_pk_bf16_f32 v127, v46, v47
    s_cmp_lg_u32 s39, 0
    v_mfma_f32_16x16x32_bf16 a[60:63], a[188:191], v[132:135], a[60:63]
    ds_read_b64_tr_b16 a[170:171], v18 offset:20480
    v_max3_f32 v35, v248, v249, v250
    v_max_f32 v35, v35, v251
    v_cmp_lt_f32 vcc, s40, v35
    v_mfma_f32_16x16x32_bf16 a[92:95], a[188:191], v[136:139], a[92:95]
    v_mfma_f32_16x16x32_bf16 a[124:127], a[188:191], v[140:143], a[124:127]
    s_cbranch_vccnz L_rare_h1v5
L_ret_h1v5:
    s_waitcnt lgkmcnt(2)
    s_cbranch_scc1 L_loops1
L_loopx1:
    v_mfma_f32_16x16x32_bf16 a[0:3], a[160:163], v[112:115], a[0:3]
    v_add_f32 v244, v244, v248
    v_add_f32 v245, v245, v249
    v_add_f32 v246, v246, v250
    v_add_f32 v247, v247, v251
    v_mfma_f32_16x16x32_bf16 a[32:35], a[160:163], v[116:119], a[32:35]
    v_exp_f32 v40, v80
    v_exp_f32 v41, v81
    v_mfma_f32_16x16x32_bf16 a[64:67], a[160:163], v[120:123], a[64:67]
    ds_read_b64_tr_b16 a[172:173], v19 offset:16384
    v_exp_f32 v42, v82
    v_exp_f32 v43, v83
    v_mfma_f32_16x16x32_bf16 a[96:99], a[160:163], v[124:127], a[96:99]
    ds_read_b64_tr_b16 a[174:175], v19 offset:20480
    v_add_f32 v4, v40, v41
    v_cvt_pk_bf16_f32 v128, v40, v41
    v_exp_f32 v44, v84
    v_mfma_f32_16x16x32_bf16 a[4:7], a[164:167], v[112:115], a[4:7]
    v_exp_f32 v45, v85
    v_add_f32 v4, v4, v42
    v_add_f32 v4, v4, v43
    v_mfma_f32_16x16x32_bf16 a[36:39], a[164:167], v[116:119], a[36:39]
    v_cvt_pk_bf16_f32 v129, v42, v43
    v_exp_f32 v46, v86
    v_exp_f32 v47, v87
    v_mfma_f32_16x16x32_bf16 a[68:71], a[164:167], v[120:123], a[68:71]
    ds_read_b64_tr_b16 a[176:177], v20 offset:16384
    v_add_f32 v4, v4, v44
    v_add_f32 v4, v4, v45
    v_cvt_pk_bf16_f32 v130, v44, v45
    v_mfma_f32_16x16x32_bf16 a[100:103], a[164:167], v[124:127], a[100:103]
    ds_read_b64_tr_b16 a[178:179], v20 offset:20480
    v_exp_f32 v40, v88
    s_waitcnt lgkmcnt(2)
    v_mfma_f32_16x16x32_bf16 a[8:11], a[168:171], v[112:115], a[8:11]
    v_exp_f32 v41, v89
    v_add_f32 v4, v4, v46
    v_add_f32 v4, v4, v47
    v_mfma_f32_16x16x32_bf16 a[40:43], a[168:171], v[116:119], a[40:43]
    v_cvt_pk_bf16_f32 v131, v46, v47
    v_exp_f32 v42, v90
    v_exp_f32 v43, v91
    v_mfma_f32_16x16x32_bf16 a[72:75], a[168:171], v[120:123], a[72:75]
    ds_read_b64_tr_b16 a[180:181], v21 offset:16384
    v_add_f32 v5, v40, v41
    v_cvt_pk_bf16_f32 v132, v40, v41
    v_exp_f32 v44, v92
    v_mfma_f32_16x16x32_bf16 a[104:107], a[168:171], v[124:127], a[104:107]
    ds_read_b64_tr_b16 a[182:183], v21 offset:20480
    v_exp_f32 v45, v93
    v_add_f32 v5, v5, v42
    v_mfma_f32_16x16x32_bf16 a[12:15], a[172:175], v[112:115], a[12:15]
    v_add_f32 v5, v5, v43
    v_cvt_pk_bf16_f32 v133, v42, v43
    v_exp_f32 v46, v94
    v_mfma_f32_16x16x32_bf16 a[44:47], a[172:175], v[116:119], a[44:47]
    v_exp_f32 v47, v95
    v_add_f32 v5, v5, v44
    v_add_f32 v5, v5, v45
    v_mfma_f32_16x16x32_bf16 a[76:79], a[172:175], v[120:123], a[76:79]
    ds_read_b64_tr_b16 a[184:185], v22 offset:16384
    v_cvt_pk_bf16_f32 v134, v44, v45
    v_exp_f32 v40, v96
    v_mfma_f32_16x16x32_bf16 a[108:111], a[172:175], v[124:127], a[108:111]
    ds_read_b64_tr_b16 a[186:187], v22 offset:20480
    v_exp_f32 v41, v97
    s_waitcnt lgkmcnt(2)
    v_mfma_f32_16x16x32_bf16 a[16:19], a[176:179], v[112:115], a[16:19]
    v_add_f32 v5, v5, v46
    v_add_f32 v5, v5, v47
    v_cvt_pk_bf16_f32 v135, v46, v47
    v_exp_f32 v42, v98
    v_mfma_f32_16x16x32_bf16 a[48:51], a[176:179], v[116:119], a[48:51]
    v_exp_f32 v43, v99
    v_add_f32 v6, v40, v41
    v_cvt_pk_bf16_f32 v136, v40, v41
    v_mfma_f32_16x16x32_bf16 a[80:83], a[176:179], v[120:123], a[80:83]
    ds_read_b64_tr_b16 a[188:189], v23 offset:16384
    v_exp_f32 v44, v100
    v_exp_f32 v45, v101
    v_mfma_f32_16x16x32_bf16 a[112:115], a[176:179], v[124:127], a[112:115]
    ds_read_b64_tr_b16 a[190:191], v23 offset:20480
    v_add_f32 v6, v6, v42
    v_add_f32 v6, v6, v43
    v_cvt_pk_bf16_f32 v137, v42, v43
    v_mfma_f32_16x16x32_bf16 a[20:23], a[180:183], v[112:115], a[20:23]
    v_exp_f32 v46, v102
    v_exp_f32 v47, v103
    v_mfma_f32_16x16x32_bf16 a[52:55], a[180:183], v[116:119], a[52:55]
    v_add_f32 v6, v6, v44
    v_add_f32 v6, v6, v45
    v_cvt_pk_bf16_f32 v138, v44, v45
    v_exp_f32 v40, v104
    v_mfma_f32_16x16x32_bf16 a[84:87], a[180:183], v[120:123], a[84:87]
    v_exp_f32 v41, v105
    v_add_f32 v6, v6, v46
    v_add_f32 v6, v6, v47
    v_mfma_f32_16x16x32_bf16 a[116:119], a[180:183], v[124:127], a[116:119]
    v_cvt_pk_bf16_f32 v139, v46, v47
    v_exp_f32 v42, v106
    s_waitcnt vmcnt(4) lgkmcnt(0)
    s_barrier
    v_mfma_f32_16x16x32_bf16 a[24:27], a[184:187], v[112:115], a[24:27]
    v_exp_f32 v43, v107
    v_add_f32 v7, v40, v41
    v_cvt_pk_bf16_f32 v140, v40, v41
    v_mfma_f32_16x16x32_bf16 a[56:59], a[184:187], v[116:119], a[56:59]
    v_exp_f32 v44, v108
    v_exp_f32 v45, v109
    v_mfma_f32_16x16x32_bf16 a[88:91], a[184:187], v[120:123], a[88:91]
    ds_read_b64_tr_b16 a[160:161], v16 offset:24576
    v_add_f32 v7, v7, v42
    v_add_f32 v7, v7, v43
    v_cvt_pk_bf16_f32 v141, v42, v43
    v_mfma_f32_16x16x32_bf16 a[120:123], a[184:187], v[124:127], a[120:123]
    ds_read_b64_tr_b16 a[162:163], v16 offset:28672
    v_exp_f32 v46, v110
    v_exp_f32 v47, v111
    v_mfma_f32_16x16x32_bf16 a[28:31], a[188:191], v[112:115], a[28:31]
    ds_read_b64_tr_b16 a[164:165], v17 offset:24576
    v_add_f32 v7, v7, v44
    v_add_f32 v7, v7, v45
    v_cvt_pk_bf16_f32 v142, v44, v45
    v_mfma_f32_16x16x32_bf16 a[60:63], a[188:191], v[116:119], a[60:63]
    ds_read_b64_tr_b16 a[166:167], v17 offset:28672
    v_add_f32 v7, v7, v46
    v_add_f32 v7, v7, v47
    v_cvt_pk_bf16_f32 v143, v46, v47
    v_mfma_f32_16x16x32_bf16 a[92:95], a[188:191], v[120:123], a[92:95]
    ds_read_b64_tr_b16 a[168:169], v18 offset:24576
    v_max3_f32 v35, v4, v5, v6
    v_max_f32 v35, v35, v7
    v_cmp_lt_f32 vcc, s40, v35
    v_mfma_f32_16x16x32_bf16 a[124:127], a[188:191], v[124:127], a[124:127]
    ds_read_b64_tr_b16 a[170:171], v18 offset:28672
    s_cbranch_vccnz L_rare_h1s31
L_ret_h1s31:
    s_waitcnt lgkmcnt(2)
    v_mfma_f32_16x16x32_bf16 a[0:3], a[160:163], v[128:131], a[0:3]
    ds_read_b64_tr_b16 a[172:173], v19 offset:24576
    ds_read_b64_tr_b16 a[174:175], v19 offset:28672
    v_add_f32 v176, v244, v4
    v_add_f32 v177, v245, v5
    v_add_f32 v178, v246, v6
    v_mfma_f32_16x16x32_bf16 a[32:35], a[160:163], v[132:135], a[32:35]
    ds_read_b64_tr_b16 a[176:177], v20 offset:24576
    ds_read_b64_tr_b16 a[178:179], v20 offset:28672
    v_add_f32 v179, v247, v7
    v_mov_b32 v180, v176
    v_mov_b32 v181, v177
    v_mfma_f32_16x16x32_bf16 a[4:7], a[164:167], v[128:131], a[4:7]
    ds_read_b64_tr_b16 a[180:181], v21 offset:24576
    ds_read_b64_tr_b16 a[182:183], v21 offset:28672
    v_mov_b32 v182, v178
    v_mov_b32 v183, v179
    v_permlane16_swap_b32 v180, v176
    v_mfma_f32_16x16x32_bf16 a[36:39], a[164:167], v[132:135], a[36:39]
    ds_read_b64_tr_b16 a[184:185], v22 offset:24576
    ds_read_b64_tr_b16 a[186:187], v22 offset:28672
    v_permlane16_swap_b32 v181, v177
    v_permlane16_swap_b32 v182, v178
    v_permlane16_swap_b32 v183, v179
    s_waitcnt lgkmcnt(6)
    v_mfma_f32_16x16x32_bf16 a[8:11], a[168:171], v[128:131], a[8:11]
    ds_read_b64_tr_b16 a[188:189], v23 offset:24576
    ds_read_b64_tr_b16 a[190:191], v23 offset:28672
    v_add_f32 v176, v176, v180
    v_add_f32 v177, v177, v181
    v_add_f32 v178, v178, v182
    v_mfma_f32_16x16x32_bf16 a[40:43], a[168:171], v[132:135], a[40:43]
    v_add_f32 v179, v179, v183
    v_mov_b32 v180, v176
    v_mov_b32 v181, v177
    v_mfma_f32_16x16x32_bf16 a[12:15], a[172:175], v[128:131], a[12:15]
    v_mov_b32 v182, v178
    v_mov_b32 v183, v179
    v_permlane32_swap_b32 v180, v176
    v_mfma_f32_16x16x32_bf16 a[44:47], a[172:175], v[132:135], a[44:47]
    v_permlane32_swap_b32 v181, v177
    v_permlane32_swap_b32 v182, v178
    v_permlane32_swap_b32 v183, v179
    s_waitcnt lgkmcnt(4)
    v_mfma_f32_16x16x32_bf16 a[16:19], a[176:179], v[128:131], a[16:19]
    v_add_f32 v176, v176, v180
    v_add_f32 v177, v177, v181
    v_add_f32 v178, v178, v182
    v_mfma_f32_16x16x32_bf16 a[48:51], a[176:179], v[132:135], a[48:51]
    v_add_f32 v179, v179, v183
    v_rcp_f32 v168, v176
    v_rcp_f32 v170, v177
    v_mfma_f32_16x16x32_bf16 a[20:23], a[180:183], v[128:131], a[20:23]
    v_rcp_f32 v172, v178
    v_rcp_f32 v174, v179
    v_and_b32 v36, 15, v0
    v_mfma_f32_16x16x32_bf16 a[52:55], a[180:183], v[132:135], a[52:55]
    v_lshlrev_b32 v160, 8, v36
    v_lshrrev_b32 v37, 5, v0
    v_and_b32 v36, 7, v0
    s_waitcnt lgkmcnt(0)
    v_mfma_f32_16x16x32_bf16 a[24:27], a[184:187], v[128:131], a[24:27]
    v_xor_b32 v36, v36, v37
    v_lshl_add_u32 v160, v36, 4, v160
    v_bfe_u32 v36, v0, 4, 1
    v_mfma_f32_16x16x32_bf16 a[56:59], a[184:187], v[132:135], a[56:59]
    v_lshl_add_u32 v160, v36, 3, v160
    v_add_u32 v160, s42, v160
    v_xor_b32 v161, 32, v160
    v_mfma_f32_16x16x32_bf16 a[28:31], a[188:191], v[128:131], a[28:31]
    v_xor_b32 v162, 64, v160
    v_xor_b32 v163, 96, v160
    v_xor_b32 v164, 128, v160
    v_mfma_f32_16x16x32_bf16 a[60:63], a[188:191], v[132:135], a[60:63]
    v_xor_b32 v165, 160, v160
    v_xor_b32 v166, 192, v160
    v_xor_b32 v167, 224, v160
    s_mov_b32 s52, 65536
    s_mov_b32 s53, 69632
    s_mov_b32 s54, 73728
    s_mov_b32 s55, 77824
    v_mfma_f32_16x16x32_bf16 a[64:67], a[160:163], v[136:139], a[64:67]
    v_accvgpr_read_b32 v184, a0
    v_accvgpr_read_b32 v185, a1
    v_accvgpr_read_b32 v186, a2
    v_accvgpr_read_b32 v187, a3
    v_pk_mul_f32 v[184:185], v[184:185], v[168:169] op_sel_hi:[1,0]
    v_pk_mul_f32 v[186:187], v[186:187], v[168:169] op_sel_hi:[1,0]
    v_cvt_pk_bf16_f32 v192, v184, v185
    v_cvt_pk_bf16_f32 v193, v186, v187
    v_mfma_f32_16x16x32_bf16 a[96:99], a[160:163], v[140:143], a[96:99]
    v_accvgpr_read_b32 v188, a4
    v_accvgpr_read_b32 v189, a5
    v_accvgpr_read_b32 v190, a6
    v_accvgpr_read_b32 v191, a7
    v_pk_mul_f32 v[188:189], v[188:189], v[168:169] op_sel_hi:[1,0]
    v_pk_mul_f32 v[190:191], v[190:191], v[168:169] op_sel_hi:[1,0]
    v_cvt_pk_bf16_f32 v194, v188, v189
    v_cvt_pk_bf16_f32 v195, v190, v191
    v_mfma_f32_16x16x32_bf16 a[68:71], a[164:167], v[136:139], a[68:71]
    v_accvgpr_read_b32 v184, a8
    v_accvgpr_read_b32 v185, a9
    v_accvgpr_read_b32 v186, a10
    v_accvgpr_read_b32 v187, a11
    v_pk_mul_f32 v[184:185], v[184:185], v[168:169] op_sel_hi:[1,0]
    v_pk_mul_f32 v[186:187], v[186:187], v[168:169] op_sel_hi:[1,0]
    v_cvt_pk_bf16_f32 v196, v184, v185
    v_cvt_pk_bf16_f32 v197, v186, v187
    v_mfma_f32_16x16x32_bf16 a[100:103], a[164:167], v[140:143], a[100:103]
    v_accvgpr_read_b32 v188, a12
    v_accvgpr_read_b32 v189, a13
    v_accvgpr_read_b32 v190, a14
    v_accvgpr_read_b32 v191, a15
    v_pk_mul_f32 v[188:189], v[188:189], v[168:169] op_sel_hi:[1,0]
    v_pk_mul_f32 v[190:191], v[190:191], v[168:169] op_sel_hi:[1,0]
    v_cvt_pk_bf16_f32 v198, v188, v189
    v_cvt_pk_bf16_f32 v199, v190, v191
    v_mfma_f32_16x16x32_bf16 a[72:75], a[168:171], v[136:139], a[72:75]
    ds_write_b64 v160, v[192:193] offset:0
    ds_write_b64 v161, v[194:195] offset:0
    ds_write_b64 v162, v[196:197] offset:0
    ds_write_b64 v163, v[198:199] offset:0
    v_mfma_f32_16x16x32_bf16 a[104:107], a[168:171], v[140:143], a[104:107]
    v_accvgpr_read_b32 v184, a16
    v_accvgpr_read_b32 v185, a17
    v_accvgpr_read_b32 v186, a18
    v_accvgpr_read_b32 v187, a19
    v_pk_mul_f32 v[184:185], v[184:185], v[168:169] op_sel_hi:[1,0]
    v_pk_mul_f32 v[186:187], v[186:187], v[168:169] op_sel_hi:[1,0]
    v_cvt_pk_bf16_f32 v200, v184, v185
    v_cvt_pk_bf16_f32 v201, v186, v187
    v_mfma_f32_16x16x32_bf16 a[76:79], a[172:175], v[136:139], a[76:79]
    v_accvgpr_read_b32 v188, a20
    v_accvgpr_read_b32 v189, a21
    v_accvgpr_read_b32 v190, a22
    v_accvgpr_read_b32 v191, a23
    v_pk_mul_f32 v[188:189], v[188:189], v[168:169] op_sel_hi:[1,0]
    v_pk_mul_f32 v[190:191], v[190:191], v[168:169] op_sel_hi:[1,0]
    v_cvt_pk_bf16_f32 v202, v188, v189
    v_cvt_pk_bf16_f32 v203, v190, v191
    v_mfma_f32_16x16x32_bf16 a[108:111], a[172:175], v[140:143], a[108:111]
    v_accvgpr_read_b32 v184, a24
    v_accvgpr_read_b32 v185, a25
    v_accvgpr_read_b32 v186, a26
    v_accvgpr_read_b32 v187, a27
    v_pk_mul_f32 v[184:185], v[184:185], v[168:169] op_sel_hi:[1,0]
    v_pk_mul_f32 v[186:187], v[186:187], v[168:169] op_sel_hi:[1,0]
    v_cvt_pk_bf16_f32 v204, v184, v185
    v_cvt_pk_bf16_f32 v205, v186, v187
    v_mfma_f32_16x16x32_bf16 a[80:83], a[176:179], v[136:139], a[80:83]
    v_accvgpr_read_b32 v188, a28
    v_accvgpr_read_b32 v189, a29
    v_accvgpr_read_b32 v190, a30
    v_accvgpr_read_b32 v191, a31
    v_pk_mul_f32 v[188:189], v[188:189], v[168:169] op_sel_hi:[1,0]
    v_pk_mul_f32 v[190:191], v[190:191], v[168:169] op_sel_hi:[1,0]
    v_cvt_pk_bf16_f32 v206, v188, v189
    v_cvt_pk_bf16_f32 v207, v190, v191
    v_mfma_f32_16x16x32_bf16 a[112:115], a[176:179], v[140:143], a[112:115]
    ds_write_b64 v164, v[200:201] offset:0
    ds_write_b64 v165, v[202:203] offset:0
    ds_write_b64 v166, v[204:205] offset:0
    ds_write_b64 v167, v[206:207] offset:0
    ds_read_b128 v[224:227], v32 offset:0
    ds_read_b128 v[228:231], v33 offset:1024
    ds_read_b128 v[232:235], v32 offset:2048
    ds_read_b128 v[236:239], v33 offset:3072
    v_mfma_f32_16x16x32_bf16 a[84:87], a[180:183], v[136:139], a[84:87]
    v_accvgpr_read_b32 v184, a32
    v_accvgpr_read_b32 v185, a33
    v_accvgpr_read_b32 v186, a34
    v_accvgpr_read_b32 v187, a35
    v_pk_mul_f32 v[184:185], v[184:185], v[170:171] op_sel_hi:[1,0]
    v_pk_mul_f32 v[186:187], v[186:187], v[170:171] op_sel_hi:[1,0]
    v_cvt_pk_bf16_f32 v192, v184, v185
    v_cvt_pk_bf16_f32 v193, v186, v187
    v_mfma_f32_16x16x32_bf16 a[116:119], a[180:183], v[140:143], a[116:119]
    v_accvgpr_read_b32 v188, a36
    v_accvgpr_read_b32 v189, a37
    v_accvgpr_read_b32 v190, a38
    v_accvgpr_read_b32 v191, a39
    v_pk_mul_f32 v[188:189], v[188:189], v[170:171] op_sel_hi:[1,0]
    v_pk_mul_f32 v[190:191], v[190:191], v[170:171] op_sel_hi:[1,0]
    v_cvt_pk_bf16_f32 v194, v188, v189
    v_cvt_pk_bf16_f32 v195, v190, v191
    v_mfma_f32_16x16x32_bf16 a[88:91], a[184:187], v[136:139], a[88:91]
    v_accvgpr_read_b32 v184, a40
    v_accvgpr_read_b32 v185, a41
    v_accvgpr_read_b32 v186, a42
    v_accvgpr_read_b32 v187, a43
    v_pk_mul_f32 v[184:185], v[184:185], v[170:171] op_sel_hi:[1,0]
    v_pk_mul_f32 v[186:187], v[186:187], v[170:171] op_sel_hi:[1,0]
    v_cvt_pk_bf16_f32 v196, v184, v185
    v_cvt_pk_bf16_f32 v197, v186, v187
    v_mfma_f32_16x16x32_bf16 a[120:123], a[184:187], v[140:143], a[120:123]
    v_accvgpr_read_b32 v188, a44
    v_accvgpr_read_b32 v189, a45
    v_accvgpr_read_b32 v190, a46
    v_accvgpr_read_b32 v191, a47
    v_pk_mul_f32 v[188:189], v[188:189], v[170:171] op_sel_hi:[1,0]
    v_pk_mul_f32 v[190:191], v[190:191], v[170:171] op_sel_hi:[1,0]
    v_cvt_pk_bf16_f32 v198, v188, v189
    v_cvt_pk_bf16_f32 v199, v190, v191
    v_mfma_f32_16x16x32_bf16 a[92:95], a[188:191], v[136:139], a[92:95]
    ds_write_b64 v160, v[192:193] offset:4096
    ds_write_b64 v161, v[194:195] offset:4096
    ds_write_b64 v162, v[196:197] offset:4096
    ds_write_b64 v163, v[198:199] offset:4096
    s_waitcnt lgkmcnt(7)
    buffer_store_dwordx4 v[224:227], v34, s[28:31], s52 offen offset:0 sc0 sc1
    s_waitcnt lgkmcnt(6)
    buffer_store_dwordx4 v[228:231], v34, s[28:31], s52 offen offset:1024 sc0 sc1
    v_mfma_f32_16x16x32_bf16 a[124:127], a[188:191], v[140:143], a[124:127]
    v_accvgpr_read_b32 v184, a48
    v_accvgpr_read_b32 v185, a49
    v_accvgpr_read_b32 v186, a50
    v_accvgpr_read_b32 v187, a51
    v_pk_mul_f32 v[184:185], v[184:185], v[170:171] op_sel_hi:[1,0]
    v_pk_mul_f32 v[186:187], v[186:187], v[170:171] op_sel_hi:[1,0]
    v_cvt_pk_bf16_f32 v200, v184, v185
    v_cvt_pk_bf16_f32 v201, v186, v187
    v_accvgpr_read_b32 v188, a52
    v_accvgpr_read_b32 v189, a53
    v_accvgpr_read_b32 v190, a54
    v_accvgpr_read_b32 v191, a55
    v_pk_mul_f32 v[188:189], v[188:189], v[170:171] op_sel_hi:[1,0]
    v_pk_mul_f32 v[190:191], v[190:191], v[170:171] op_sel_hi:[1,0]
    v_cvt_pk_bf16_f32 v202, v188, v189
    v_cvt_pk_bf16_f32 v203, v190, v191
    v_accvgpr_read_b32 v184, a56
    v_accvgpr_read_b32 v185, a57
    v_accvgpr_read_b32 v186, a58
    v_accvgpr_read_b32 v187, a59
    v_pk_mul_f32 v[184:185], v[184:185], v[170:171] op_sel_hi:[1,0]
    v_pk_mul_f32 v[186:187], v[186:187], v[170:171] op_sel_hi:[1,0]
    v_cvt_pk_bf16_f32 v204, v184, v185
    v_cvt_pk_bf16_f32 v205, v186, v187
    v_accvgpr_read_b32 v188, a60
    v_accvgpr_read_b32 v189, a61
    v_accvgpr_read_b32 v190, a62
    v_accvgpr_read_b32 v191, a63
    v_pk_mul_f32 v[188:189], v[188:189], v[170:171] op_sel_hi:[1,0]
    v_pk_mul_f32 v[190:191], v[190:191], v[170:171] op_sel_hi:[1,0]
    v_cvt_pk_bf16_f32 v206, v188, v189
    v_cvt_pk_bf16_f32 v207, v190, v191
    ds_write_b64 v164, v[200:201] offset:4096
    ds_write_b64 v165, v[202:203] offset:4096
    ds_write_b64 v166, v[204:205] offset:4096
    ds_write_b64 v167, v[206:207] offset:4096
    s_waitcnt lgkmcnt(9)
    buffer_store_dwordx4 v[232:235], v34, s[28:31], s52 offen offset:2048 sc0 sc1
    s_waitcnt lgkmcnt(8)
    buffer_store_dwordx4 v[236:239], v34, s[28:31], s52 offen offset:3072 sc0 sc1
    ds_read_b128 v[112:115], v32 offset:4096
    ds_read_b128 v[116:119], v33 offset:5120
    ds_read_b128 v[120:123], v32 offset:6144
    ds_read_b128 v[124:127], v33 offset:7168
    v_accvgpr_read_b32 v184, a64
    v_accvgpr_read_b32 v185, a65
    v_accvgpr_read_b32 v186, a66
    v_accvgpr_read_b32 v187, a67
    v_pk_mul_f32 v[184:185], v[184:185], v[172:173] op_sel_hi:[1,0]
    v_pk_mul_f32 v[186:187], v[186:187], v[172:173] op_sel_hi:[1,0]
    v_cvt_pk_bf16_f32 v192, v184, v185
    v_cvt_pk_bf16_f32 v193, v186, v187
    v_accvgpr_read_b32 v188, a68
    v_accvgpr_read_b32 v189, a69
    v_accvgpr_read_b32 v190, a70
    v_accvgpr_read_b32 v191, a71
    v_pk_mul_f32 v[188:189], v[188:189], v[172:173] op_sel_hi:[1,0]
    v_pk_mul_f32 v[190:191], v[190:191], v[172:173] op_sel_hi:[1,0]
    v_cvt_pk_bf16_f32 v194, v188, v189
    v_cvt_pk_bf16_f32 v195, v190, v191
    v_accvgpr_read_b32 v184, a72
    v_accvgpr_read_b32 v185, a73
    v_accvgpr_read_b32 v186, a74
    v_accvgpr_read_b32 v187, a75
    v_pk_mul_f32 v[184:185], v[184:185], v[172:173] op_sel_hi:[1,0]
    v_pk_mul_f32 v[186:187], v[186:187], v[172:173] op_sel_hi:[1,0]
    v_cvt_pk_bf16_f32 v196, v184, v185
    v_cvt_pk_bf16_f32 v197, v186, v187
    v_accvgpr_read_b32 v188, a76
    v_accvgpr_read_b32 v189, a77
    v_accvgpr_read_b32 v190, a78
    v_accvgpr_read_b32 v191, a79
    v_pk_mul_f32 v[188:189], v[188:189], v[172:173] op_sel_hi:[1,0]
    v_pk_mul_f32 v[190:191], v[190:191], v[172:173] op_sel_hi:[1,0]
    v_cvt_pk_bf16_f32 v198, v188, v189
    v_cvt_pk_bf16_f32 v199, v190, v191
    ds_write_b64 v160, v[192:193] offset:8192
    ds_write_b64 v161, v[194:195] offset:8192
    ds_write_b64 v162, v[196:197] offset:8192
    ds_write_b64 v163, v[198:199] offset:8192
    s_waitcnt lgkmcnt(7)
    buffer_store_dwordx4 v[112:115], v34, s[28:31], s53 offen offset:0 sc0 sc1
    s_waitcnt lgkmcnt(6)
    buffer_store_dwordx4 v[116:119], v34, s[28:31], s53 offen offset:1024 sc0 sc1
    v_accvgpr_read_b32 v184, a80
    v_accvgpr_read_b32 v185, a81
    v_accvgpr_read_b32 v186, a82
    v_accvgpr_read_b32 v187, a83
    v_pk_mul_f32 v[184:185], v[184:185], v[172:173] op_sel_hi:[1,0]
    v_pk_mul_f32 v[186:187], v[186:187], v[172:173] op_sel_hi:[1,0]
    v_cvt_pk_bf16_f32 v200, v184, v185
    v_cvt_pk_bf16_f32 v201, v186, v187
    v_accvgpr_read_b32 v188, a84
    v_accvgpr_read_b32 v189, a85
    v_accvgpr_read_b32 v190, a86
    v_accvgpr_read_b32 v191, a87
    v_pk_mul_f32 v[188:189], v[188:189], v[172:173] op_sel_hi:[1,0]
    v_pk_mul_f32 v[190:191], v[190:191], v[172:173] op_sel_hi:[1,0]
    v_cvt_pk_bf16_f32 v202, v188, v189
    v_cvt_pk_bf16_f32 v203, v190, v191
    v_accvgpr_read_b32 v184, a88
    v_accvgpr_read_b32 v185, a89
    v_accvgpr_read_b32 v186, a90
    v_accvgpr_read_b32 v187, a91
    v_pk_mul_f32 v[184:185], v[184:185], v[172:173] op_sel_hi:[1,0]
    v_pk_mul_f32 v[186:187], v[186:187], v[172:173] op_sel_hi:[1,0]
    v_cvt_pk_bf16_f32 v204, v184, v185
    v_cvt_pk_bf16_f32 v205, v186, v187
    v_accvgpr_read_b32 v188, a92
    v_accvgpr_read_b32 v189, a93
    v_accvgpr_read_b32 v190, a94
    v_accvgpr_read_b32 v191, a95
    v_pk_mul_f32 v[188:189], v[188:189], v[172:173] op_sel_hi:[1,0]
    v_pk_mul_f32 v[190:191], v[190:191], v[172:173] op_sel_hi:[1,0]
    v_cvt_pk_bf16_f32 v206, v188, v189
    v_cvt_pk_bf16_f32 v207, v190, v191
    ds_write_b64 v164, v[200:201] offset:8192
    ds_write_b64 v165, v[202:203] offset:8192
    ds_write_b64 v166, v[204:205] offset:8192
    ds_write_b64 v167, v[206:207] offset:8192
    s_waitcnt lgkmcnt(9)
    buffer_store_dwordx4 v[120:123], v34, s[28:31], s53 offen offset:2048 sc0 sc1
    s_waitcnt lgkmcnt(8)
    buffer_store_dwordx4 v[124:127], v34, s[28:31], s53 offen offset:3072 sc0 sc1
    ds_read_b128 v[224:227], v32 offset:8192
    ds_read_b128 v[228:231], v33 offset:9216
    ds_read_b128 v[232:235], v32 offset:10240
    ds_read_b128 v[236:239], v33 offset:11264
    v_accvgpr_read_b32 v184, a96
    v_accvgpr_read_b32 v185, a97
    v_accvgpr_read_b32 v186, a98
    v_accvgpr_read_b32 v187, a99
    v_pk_mul_f32 v[184:185], v[184:185], v[174:175] op_sel_hi:[1,0]
    v_pk_mul_f32 v[186:187], v[186:187], v[174:175] op_sel_hi:[1,0]
    v_cvt_pk_bf16_f32 v192, v184, v185
    v_cvt_pk_bf16_f32 v193, v186, v187
    v_accvgpr_read_b32 v188, a100
    v_accvgpr_read_b32 v189, a101
    v_accvgpr_read_b32 v190, a102
    v_accvgpr_read_b32 v191, a103
    v_pk_mul_f32 v[188:189], v[188:189], v[174:175] op_sel_hi:[1,0]
    v_pk_mul_f32 v[190:191], v[190:191], v[174:175] op_sel_hi:[1,0]
    v_cvt_pk_bf16_f32 v194, v188, v189
    v_cvt_pk_bf16_f32 v195, v190, v191
    v_accvgpr_read_b32 v184, a104
    v_accvgpr_read_b32 v185, a105
    v_accvgpr_read_b32 v186, a106
    v_accvgpr_read_b32 v187, a107
    v_pk_mul_f32 v[184:185], v[184:185], v[174:175] op_sel_hi:[1,0]
    v_pk_mul_f32 v[186:187], v[186:187], v[174:175] op_sel_hi:[1,0]
    v_cvt_pk_bf16_f32 v196, v184, v185
    v_cvt_pk_bf16_f32 v197, v186, v187
    v_accvgpr_read_b32 v188, a108
    v_accvgpr_read_b32 v189, a109
    v_accvgpr_read_b32 v190, a110
    v_accvgpr_read_b32 v191, a111
    v_pk_mul_f32 v[188:189], v[188:189], v[174:175] op_sel_hi:[1,0]
    v_pk_mul_f32 v[190:191], v[190:191], v[174:175] op_sel_hi:[1,0]
    v_cvt_pk_bf16_f32 v198, v188, v189
    v_cvt_pk_bf16_f32 v199, v190, v191
    ds_write_b64 v160, v[192:193] offset:12288
    ds_write_b64 v161, v[194:195] offset:12288
    ds_write_b64 v162, v[196:197] offset:12288
    ds_write_b64 v163, v[198:199] offset:12288
    s_waitcnt lgkmcnt(7)
    buffer_store_dwordx4 v[224:227], v34, s[28:31], s54 offen offset:0 sc0 sc1
    s_waitcnt lgkmcnt(6)
    buffer_store_dwordx4 v[228:231], v34, s[28:31], s54 offen offset:1024 sc0 sc1
    v_accvgpr_read_b32 v184, a112
    v_accvgpr_read_b32 v185, a113
    v_accvgpr_read_b32 v186, a114
    v_accvgpr_read_b32 v187, a115
    v_pk_mul_f32 v[184:185], v[184:185], v[174:175] op_sel_hi:[1,0]
    v_pk_mul_f32 v[186:187], v[186:187], v[174:175] op_sel_hi:[1,0]
    v_cvt_pk_bf16_f32 v200, v184, v185
    v_cvt_pk_bf16_f32 v201, v186, v187
    v_accvgpr_read_b32 v188, a116
    v_accvgpr_read_b32 v189, a117
    v_accvgpr_read_b32 v190, a118
    v_accvgpr_read_b32 v191, a119
    v_pk_mul_f32 v[188:189], v[188:189], v[174:175] op_sel_hi:[1,0]
    v_pk_mul_f32 v[190:191], v[190:191], v[174:175] op_sel_hi:[1,0]
    v_cvt_pk_bf16_f32 v202, v188, v189
    v_cvt_pk_bf16_f32 v203, v190, v191
    v_accvgpr_read_b32 v184, a120
    v_accvgpr_read_b32 v185, a121
    v_accvgpr_read_b32 v186, a122
    v_accvgpr_read_b32 v187, a123
    v_pk_mul_f32 v[184:185], v[184:185], v[174:175] op_sel_hi:[1,0]
    v_pk_mul_f32 v[186:187], v[186:187], v[174:175] op_sel_hi:[1,0]
    v_cvt_pk_bf16_f32 v204, v184, v185
    v_cvt_pk_bf16_f32 v205, v186, v187
    v_accvgpr_read_b32 v188, a124
    v_accvgpr_read_b32 v189, a125
    v_accvgpr_read_b32 v190, a126
    v_accvgpr_read_b32 v191, a127
    v_pk_mul_f32 v[188:189], v[188:189], v[174:175] op_sel_hi:[1,0]
    v_pk_mul_f32 v[190:191], v[190:191], v[174:175] op_sel_hi:[1,0]
    v_cvt_pk_bf16_f32 v206, v188, v189
    v_cvt_pk_bf16_f32 v207, v190, v191
    ds_write_b64 v164, v[200:201] offset:12288
    ds_write_b64 v165, v[202:203] offset:12288
    ds_write_b64 v166, v[204:205] offset:12288
    ds_write_b64 v167, v[206:207] offset:12288
    s_waitcnt lgkmcnt(9)
    buffer_store_dwordx4 v[232:235], v34, s[28:31], s54 offen offset:2048 sc0 sc1
    s_waitcnt lgkmcnt(8)
    buffer_store_dwordx4 v[236:239], v34, s[28:31], s54 offen offset:3072 sc0 sc1
    ds_read_b128 v[112:115], v32 offset:12288
    ds_read_b128 v[116:119], v33 offset:13312
    ds_read_b128 v[120:123], v32 offset:14336
    ds_read_b128 v[124:127], v33 offset:15360
    s_waitcnt lgkmcnt(3)
    buffer_store_dwordx4 v[112:115], v34, s[28:31], s55 offen offset:0 sc0 sc1
    s_waitcnt lgkmcnt(2)
    buffer_store_dwordx4 v[116:119], v34, s[28:31], s55 offen offset:1024 sc0 sc1
    s_waitcnt lgkmcnt(1)
    buffer_store_dwordx4 v[120:123], v34, s[28:31], s55 offen offset:2048 sc0 sc1
    s_waitcnt lgkmcnt(0)
    buffer_store_dwordx4 v[124:127], v34, s[28:31], s55 offen offset:3072 sc0 sc1
L_end:
    s_endpgm
L_rare_h0s0:
    s_call_b64 s[32:33], L_fix_0
    s_branch L_ret_h0s0
L_rare_h0p1:
    s_call_b64 s[32:33], L_fix_1
    s_branch L_ret_h0p1
L_rare_h0p2:
    s_call_b64 s[32:33], L_fix_0
    s_branch L_ret_h0p2
L_rare_h0p3:
    s_call_b64 s[32:33], L_fix_1
    s_branch L_ret_h0p3
L_rare_h0p4:
    s_call_b64 s[32:33], L_fix_0
    s_branch L_ret_h0p4
L_rare_h0p5:
    s_call_b64 s[32:33], L_fix_1
    s_branch L_ret_h0p5
L_rare_h0p6:
    s_call_b64 s[32:33], L_fix_0
    s_branch L_ret_h0p6
L_rare_h0q1:
    s_call_b64 s[32:33], L_fix_1
    s_branch L_ret_h0q1
L_rare_h0q2:
    s_call_b64 s[32:33], L_fix_0
    s_branch L_ret_h0q2
L_rare_h0q3:
    s_call_b64 s[32:33], L_fix_1
    s_branch L_ret_h0q3
L_rare_h0q4:
    s_call_b64 s[32:33], L_fix_0
    s_branch L_ret_h0q4
L_rare_h0q5:
    s_call_b64 s[32:33], L_fix_1
    s_branch L_ret_h0q5
L_rare_h0q6:
    s_call_b64 s[32:33], L_fix_0
    s_branch L_ret_h0q6
L_rare_h0u0:
    s_call_b64 s[32:33], L_fix_1
    s_branch L_ret_h0u0
L_rare_h0u1:
    s_call_b64 s[32:33], L_fix_0
    s_branch L_ret_h0u1
L_rare_h0u2:
    s_call_b64 s[32:33], L_fix_1
    s_branch L_ret_h0u2
L_rare_h0u3:
    s_call_b64 s[32:33], L_fix_0
    s_branch L_ret_h0u3
L_rare_h0u4:
    s_call_b64 s[32:33], L_fix_1
    s_branch L_ret_h0u4
L_rare_h0u5:
    s_call_b64 s[32:33], L_fix_0
    s_branch L_ret_h0u5
L_rare_h0v0:
    s_call_b64 s[32:33], L_fix_1
    s_branch L_ret_h0v0
L_rare_h0v1:
    s_call_b64 s[32:33], L_fix_0
    s_branch L_ret_h0v1
L_rare_h0v2:
    s_call_b64 s[32:33], L_fix_1
    s_branch L_ret_h0v2
L_rare_h0v3:
    s_call_b64 s[32:33], L_fix_0
    s_branch L_ret_h0v3
L_rare_h0v4:
    s_call_b64 s[32:33], L_fix_1
    s_branch L_ret_h0v4
L_rare_h0v5:
    s_call_b64 s[32:33], L_fix_0
    s_branch L_ret_h0v5
L_rare_h0s31:
    s_call_b64 s[32:33], L_fix_1
    s_branch L_ret_h0s31
L_rare_h1s0:
    s_call_b64 s[32:33], L_fix_0
    s_branch L_ret_h1s0
L_rare_h1p1:
    s_call_b64 s[32:33], L_fix_1
    s_branch L_ret_h1p1
L_rare_h1p2:
    s_call_b64 s[32:33], L_fix_0
    s_branch L_ret_h1p2
L_rare_h1p3:
    s_call_b64 s[32:33], L_fix_1
    s_branch L_ret_h1p3
L_rare_h1p4:
    s_call_b64 s[32:33], L_fix_0
    s_branch L_ret_h1p4
L_rare_h1p5:
    s_call_b64 s[32:33], L_fix_1
    s_branch L_ret_h1p5
L_rare_h1p6:
    s_call_b64 s[32:33], L_fix_0
    s_branch L_ret_h1p6
L_rare_h1q1:
    s_call_b64 s[32:33], L_fix_1
    s_branch L_ret_h1q1
L_rare_h1q2:
    s_call_b64 s[32:33], L_fix_0
    s_branch L_ret_h1q2
L_rare_h1q3:
    s_call_b64 s[32:33], L_fix_1
    s_branch L_ret_h1q3
L_rare_h1q4:
    s_call_b64 s[32:33], L_fix_0
    s_branch L_ret_h1q4
L_rare_h1q5:
    s_call_b64 s[32:33], L_fix_1
    s_branch L_ret_h1q5
L_rare_h1q6:
    s_call_b64 s[32:33], L_fix_0
    s_branch L_ret_h1q6
L_rare_h1u0:
    s_call_b64 s[32:33], L_fix_1
    s_branch L_ret_h1u0
L_rare_h1u1:
    s_call_b64 s[32:33], L_fix_0
    s_branch L_ret_h1u1
L_rare_h1u2:
    s_call_b64 s[32:33], L_fix_1
    s_branch L_ret_h1u2
L_rare_h1u3:
    s_call_b64 s[32:33], L_fix_0
    s_branch L_ret_h1u3
L_rare_h1u4:
    s_call_b64 s[32:33], L_fix_1
    s_branch L_ret_h1u4
L_rare_h1u5:
    s_call_b64 s[32:33], L_fix_0
    s_branch L_ret_h1u5
L_rare_h1v0:
    s_call_b64 s[32:33], L_fix_1
    s_branch L_ret_h1v0
L_rare_h1v1:
    s_call_b64 s[32:33], L_fix_0
    s_branch L_ret_h1v1
L_rare_h1v2:
    s_call_b64 s[32:33], L_fix_1
    s_branch L_ret_h1v2
L_rare_h1v3:
    s_call_b64 s[32:33], L_fix_0
    s_branch L_ret_h1v3
L_rare_h1v4:
    s_call_b64 s[32:33], L_fix_1
    s_branch L_ret_h1v4
L_rare_h1v5:
    s_call_b64 s[32:33], L_fix_0
    s_branch L_ret_h1v5
L_rare_h1s31:
    s_call_b64 s[32:33], L_fix_1
    s_branch L_ret_h1s31
L_fix_0:
    s_nop 15
    v_max3_f32 v40, v48, v49, v50
    v_max3_f32 v40, v40, v51, v52
    v_max3_f32 v40, v40, v53, v54
    v_max_f32 v40, v40, v55
    v_max3_f32 v41, v56, v57, v58
    v_max3_f32 v41, v41, v59, v60
    v_max3_f32 v41, v41, v61, v62
    v_max_f32 v41, v41, v63
    v_max3_f32 v42, v64, v65, v66
    v_max3_f32 v42, v42, v67, v68
    v_max3_f32 v42, v42, v69, v70
    v_max_f32 v42, v42, v71
    v_max3_f32 v43, v72, v73, v74
    v_max3_f32 v43, v43, v75, v76
    v_max3_f32 v43, v43, v77, v78
    v_max_f32 v43, v43, v79
    v_mov_b32 v44, v40
    v_mov_b32 v45, v41
    v_mov_b32 v46, v42
    v_mov_b32 v47, v43
    v_permlane16_swap_b32 v44, v40
    v_permlane16_swap_b32 v45, v41
    v_permlane16_swap_b32 v46, v42
    v_permlane16_swap_b32 v47, v43
    v_max_f32 v40, v40, v44
    v_max_f32 v41, v41, v45
    v_max_f32 v42, v42, v46
    v_max_f32 v43, v43, v47
    v_mov_b32 v44, v40
    v_mov_b32 v45, v41
    v_mov_b32 v46, v42
    v_mov_b32 v47, v43
    v_permlane32_swap_b32 v44, v40
    v_permlane32_swap_b32 v45, v41
    v_permlane32_swap_b32 v46, v42
    v_permlane32_swap_b32 v47, v43
    v_max_f32 v40, v40, v44
    v_max_f32 v41, v41, v45
    v_max_f32 v42, v42, v46
    v_max_f32 v43, v43, v47
    v_max_f32 v40, 0, v40
    v_add_f32 v240, v240, v40
    v_sub_f32 v45, 0, v40
    v_exp_f32 v45, v45
    v_sub_f32 v144, 0, v240
    v_sub_f32 v145, 0, v240
    v_sub_f32 v146, 0, v240
    v_sub_f32 v147, 0, v240
    v_sub_f32 v48, v48, v40
    v_sub_f32 v80, v80, v40
    v_sub_f32 v49, v49, v40
    v_sub_f32 v81, v81, v40
    v_sub_f32 v50, v50, v40
    v_sub_f32 v82, v82, v40
    v_sub_f32 v51, v51, v40
    v_sub_f32 v83, v83, v40
    v_sub_f32 v52, v52, v40
    v_sub_f32 v84, v84, v40
    v_sub_f32 v53, v53, v40
    v_sub_f32 v85, v85, v40
    v_sub_f32 v54, v54, v40
    v_sub_f32 v86, v86, v40
    v_sub_f32 v55, v55, v40
    v_sub_f32 v87, v87, v40
    v_mul_f32 v244, v244, v45
    v_mov_b32 v248, 0
    v_accvgpr_read_b32 v44, a0
    v_mul_f32 v44, v44, v45
    v_accvgpr_write_b32 a0, v44
    v_accvgpr_read_b32 v44, a1
    v_mul_f32 v44, v44, v45
    v_accvgpr_write_b32 a1, v44
    v_accvgpr_read_b32 v44, a2
    v_mul_f32 v44, v44, v45
    v_accvgpr_write_b32 a2, v44
    v_accvgpr_read_b32 v44, a3
    v_mul_f32 v44, v44, v45
    v_accvgpr_write_b32 a3, v44
    v_accvgpr_read_b32 v44, a4
    v_mul_f32 v44, v44, v45
    v_accvgpr_write_b32 a4, v44
    v_accvgpr_read_b32 v44, a5
    v_mul_f32 v44, v44, v45
    v_accvgpr_write_b32 a5, v44
    v_accvgpr_read_b32 v44, a6
    v_mul_f32 v44, v44, v45
    v_accvgpr_write_b32 a6, v44
    v_accvgpr_read_b32 v44, a7
    v_mul_f32 v44, v44, v45
    v_accvgpr_write_b32 a7, v44
    v_accvgpr_read_b32 v44, a8
    v_mul_f32 v44, v44, v45
    v_accvgpr_write_b32 a8, v44
    v_accvgpr_read_b32 v44, a9
    v_mul_f32 v44, v44, v45
    v_accvgpr_write_b32 a9, v44
    v_accvgpr_read_b32 v44, a10
    v_mul_f32 v44, v44, v45
    v_accvgpr_write_b32 a10, v44
    v_accvgpr_read_b32 v44, a11
    v_mul_f32 v44, v44, v45
    v_accvgpr_write_b32 a11, v44
    v_accvgpr_read_b32 v44, a12
    v_mul_f32 v44, v44, v45
    v_accvgpr_write_b32 a12, v44
    v_accvgpr_read_b32 v44, a13
    v_mul_f32 v44, v44, v45
    v_accvgpr_write_b32 a13, v44
    v_accvgpr_read_b32 v44, a14
    v_mul_f32 v44, v44, v45
    v_accvgpr_write_b32 a14, v44
    v_accvgpr_read_b32 v44, a15
    v_mul_f32 v44, v44, v45
    v_accvgpr_write_b32 a15, v44
    v_accvgpr_read_b32 v44, a16
    v_mul_f32 v44, v44, v45
    v_accvgpr_write_b32 a16, v44
    v_accvgpr_read_b32 v44, a17
    v_mul_f32 v44, v44, v45
    v_accvgpr_write_b32 a17, v44
    v_accvgpr_read_b32 v44, a18
    v_mul_f32 v44, v44, v45
    v_accvgpr_write_b32 a18, v44
    v_accvgpr_read_b32 v44, a19
    v_mul_f32 v44, v44, v45
    v_accvgpr_write_b32 a19, v44
    v_accvgpr_read_b32 v44, a20
    v_mul_f32 v44, v44, v45
    v_accvgpr_write_b32 a20, v44
    v_accvgpr_read_b32 v44, a21
    v_mul_f32 v44, v44, v45
    v_accvgpr_write_b32 a21, v44
    v_accvgpr_read_b32 v44, a22
    v_mul_f32 v44, v44, v45
    v_accvgpr_write_b32 a22, v44
    v_accvgpr_read_b32 v44, a23
    v_mul_f32 v44, v44, v45
    v_accvgpr_write_b32 a23, v44
    v_accvgpr_read_b32 v44, a24
    v_mul_f32 v44, v44, v45
    v_accvgpr_write_b32 a24, v44
    v_accvgpr_read_b32 v44, a25
    v_mul_f32 v44, v44, v45
    v_accvgpr_write_b32 a25, v44
    v_accvgpr_read_b32 v44, a26
    v_mul_f32 v44, v44, v45
    v_accvgpr_write_b32 a26, v44
    v_accvgpr_read_b32 v44, a27
    v_mul_f32 v44, v44, v45
    v_accvgpr_write_b32 a27, v44
    v_accvgpr_read_b32 v44, a28
    v_mul_f32 v44, v44, v45
    v_accvgpr_write_b32 a28, v44
    v_accvgpr_read_b32 v44, a29
    v_mul_f32 v44, v44, v45
    v_accvgpr_write_b32 a29, v44
    v_accvgpr_read_b32 v44, a30
    v_mul_f32 v44, v44, v45
    v_accvgpr_write_b32 a30, v44
    v_accvgpr_read_b32 v44, a31
    v_mul_f32 v44, v44, v45
    v_accvgpr_write_b32 a31, v44
    v_exp_f32 v46, v48
    v_exp_f32 v47, v49
    s_nop 0
    v_add_f32 v248, v248, v46
    v_add_f32 v248, v248, v47
    v_cvt_pk_bf16_f32 v112, v46, v47
    v_exp_f32 v46, v50
    v_exp_f32 v47, v51
    s_nop 0
    v_add_f32 v248, v248, v46
    v_add_f32 v248, v248, v47
    v_cvt_pk_bf16_f32 v113, v46, v47
    v_exp_f32 v46, v52
    v_exp_f32 v47, v53
    s_nop 0
    v_add_f32 v248, v248, v46
    v_add_f32 v248, v248, v47
    v_cvt_pk_bf16_f32 v114, v46, v47
    v_exp_f32 v46, v54
    v_exp_f32 v47, v55
    s_nop 0
    v_add_f32 v248, v248, v46
    v_add_f32 v248, v248, v47
    v_cvt_pk_bf16_f32 v115, v46, v47
    v_max_f32 v41, 0, v41
    v_add_f32 v241, v241, v41
    v_sub_f32 v45, 0, v41
    v_exp_f32 v45, v45
    v_sub_f32 v148, 0, v241
    v_sub_f32 v149, 0, v241
    v_sub_f32 v150, 0, v241
    v_sub_f32 v151, 0, v241
    v_sub_f32 v56, v56, v41
    v_sub_f32 v88, v88, v41
    v_sub_f32 v57, v57, v41
    v_sub_f32 v89, v89, v41
    v_sub_f32 v58, v58, v41
    v_sub_f32 v90, v90, v41
    v_sub_f32 v59, v59, v41
    v_sub_f32 v91, v91, v41
    v_sub_f32 v60, v60, v41
    v_sub_f32 v92, v92, v41
    v_sub_f32 v61, v61, v41
    v_sub_f32 v93, v93, v41
    v_sub_f32 v62, v62, v41
    v_sub_f32 v94, v94, v41
    v_sub_f32 v63, v63, v41
    v_sub_f32 v95, v95, v41
    v_mul_f32 v245, v245, v45
    v_mov_b32 v249, 0
    v_accvgpr_read_b32 v44, a32
    v_mul_f32 v44, v44, v45
    v_accvgpr_write_b32 a32, v44
    v_accvgpr_read_b32 v44, a33
    v_mul_f32 v44, v44, v45
    v_accvgpr_write_b32 a33, v44
    v_accvgpr_read_b32 v44, a34
    v_mul_f32 v44, v44, v45
    v_accvgpr_write_b32 a34, v44
    v_accvgpr_read_b32 v44, a35
    v_mul_f32 v44, v44, v45
    v_accvgpr_write_b32 a35, v44
    v_accvgpr_read_b32 v44, a36
    v_mul_f32 v44, v44, v45
    v_accvgpr_write_b32 a36, v44
    v_accvgpr_read_b32 v44, a37
    v_mul_f32 v44, v44, v45
    v_accvgpr_write_b32 a37, v44
    v_accvgpr_read_b32 v44, a38
    v_mul_f32 v44, v44, v45
    v_accvgpr_write_b32 a38, v44
    v_accvgpr_read_b32 v44, a39
    v_mul_f32 v44, v44, v45
    v_accvgpr_write_b32 a39, v44
    v_accvgpr_read_b32 v44, a40
    v_mul_f32 v44, v44, v45
    v_accvgpr_write_b32 a40, v44
    v_accvgpr_read_b32 v44, a41
    v_mul_f32 v44, v44, v45
    v_accvgpr_write_b32 a41, v44
    v_accvgpr_read_b32 v44, a42
    v_mul_f32 v44, v44, v45
    v_accvgpr_write_b32 a42, v44
    v_accvgpr_read_b32 v44, a43
    v_mul_f32 v44, v44, v45
    v_accvgpr_write_b32 a43, v44
    v_accvgpr_read_b32 v44, a44
    v_mul_f32 v44, v44, v45
    v_accvgpr_write_b32 a44, v44
    v_accvgpr_read_b32 v44, a45
    v_mul_f32 v44, v44, v45
    v_accvgpr_write_b32 a45, v44
    v_accvgpr_read_b32 v44, a46
    v_mul_f32 v44, v44, v45
    v_accvgpr_write_b32 a46, v44
    v_accvgpr_read_b32 v44, a47
    v_mul_f32 v44, v44, v45
    v_accvgpr_write_b32 a47, v44
    v_accvgpr_read_b32 v44, a48
    v_mul_f32 v44, v44, v45
    v_accvgpr_write_b32 a48, v44
    v_accvgpr_read_b32 v44, a49
    v_mul_f32 v44, v44, v45
    v_accvgpr_write_b32 a49, v44
    v_accvgpr_read_b32 v44, a50
    v_mul_f32 v44, v44, v45
    v_accvgpr_write_b32 a50, v44
    v_accvgpr_read_b32 v44, a51
    v_mul_f32 v44, v44, v45
    v_accvgpr_write_b32 a51, v44
    v_accvgpr_read_b32 v44, a52
    v_mul_f32 v44, v44, v45
    v_accvgpr_write_b32 a52, v44
    v_accvgpr_read_b32 v44, a53
    v_mul_f32 v44, v44, v45
    v_accvgpr_write_b32 a53, v44
    v_accvgpr_read_b32 v44, a54
    v_mul_f32 v44, v44, v45
    v_accvgpr_write_b32 a54, v44
    v_accvgpr_read_b32 v44, a55
    v_mul_f32 v44, v44, v45
    v_accvgpr_write_b32 a55, v44
    v_accvgpr_read_b32 v44, a56
    v_mul_f32 v44, v44, v45
    v_accvgpr_write_b32 a56, v44
    v_accvgpr_read_b32 v44, a57
    v_mul_f32 v44, v44, v45
    v_accvgpr_write_b32 a57, v44
    v_accvgpr_read_b32 v44, a58
    v_mul_f32 v44, v44, v45
    v_accvgpr_write_b32 a58, v44
    v_accvgpr_read_b32 v44, a59
    v_mul_f32 v44, v44, v45
    v_accvgpr_write_b32 a59, v44
    v_accvgpr_read_b32 v44, a60
    v_mul_f32 v44, v44, v45
    v_accvgpr_write_b32 a60, v44
    v_accvgpr_read_b32 v44, a61
    v_mul_f32 v44, v44, v45
    v_accvgpr_write_b32 a61, v44
    v_accvgpr_read_b32 v44, a62
    v_mul_f32 v44, v44, v45
    v_accvgpr_write_b32 a62, v44
    v_accvgpr_read_b32 v44, a63
    v_mul_f32 v44, v44, v45
    v_accvgpr_write_b32 a63, v44
    v_exp_f32 v46, v56
    v_exp_f32 v47, v57
    s_nop 0
    v_add_f32 v249, v249, v46
    v_add_f32 v249, v249, v47
    v_cvt_pk_bf16_f32 v116, v46, v47
    v_exp_f32 v46, v58
    v_exp_f32 v47, v59
    s_nop 0
    v_add_f32 v249, v249, v46
    v_add_f32 v249, v249, v47
    v_cvt_pk_bf16_f32 v117, v46, v47
    v_exp_f32 v46, v60
    v_exp_f32 v47, v61
    s_nop 0
    v_add_f32 v249, v249, v46
    v_add_f32 v249, v249, v47
    v_cvt_pk_bf16_f32 v118, v46, v47
    v_exp_f32 v46, v62
    v_exp_f32 v47, v63
    s_nop 0
    v_add_f32 v249, v249, v46
    v_add_f32 v249, v249, v47
    v_cvt_pk_bf16_f32 v119, v46, v47
    v_max_f32 v42, 0, v42
    v_add_f32 v242, v242, v42
    v_sub_f32 v45, 0, v42
    v_exp_f32 v45, v45
    v_sub_f32 v152, 0, v242
    v_sub_f32 v153, 0, v242
    v_sub_f32 v154, 0, v242
    v_sub_f32 v155, 0, v242
    v_sub_f32 v64, v64, v42
    v_sub_f32 v96, v96, v42
    v_sub_f32 v65, v65, v42
    v_sub_f32 v97, v97, v42
    v_sub_f32 v66, v66, v42
    v_sub_f32 v98, v98, v42
    v_sub_f32 v67, v67, v42
    v_sub_f32 v99, v99, v42
    v_sub_f32 v68, v68, v42
    v_sub_f32 v100, v100, v42
    v_sub_f32 v69, v69, v42
    v_sub_f32 v101, v101, v42
    v_sub_f32 v70, v70, v42
    v_sub_f32 v102, v102, v42
    v_sub_f32 v71, v71, v42
    v_sub_f32 v103, v103, v42
    v_mul_f32 v246, v246, v45
    v_mov_b32 v250, 0
    v_accvgpr_read_b32 v44, a64
    v_mul_f32 v44, v44, v45
    v_accvgpr_write_b32 a64, v44
    v_accvgpr_read_b32 v44, a65
    v_mul_f32 v44, v44, v45
    v_accvgpr_write_b32 a65, v44
    v_accvgpr_read_b32 v44, a66
    v_mul_f32 v44, v44, v45
    v_accvgpr_write_b32 a66, v44
    v_accvgpr_read_b32 v44, a67
    v_mul_f32 v44, v44, v45
    v_accvgpr_write_b32 a67, v44
    v_accvgpr_read_b32 v44, a68
    v_mul_f32 v44, v44, v45
    v_accvgpr_write_b32 a68, v44
    v_accvgpr_read_b32 v44, a69
    v_mul_f32 v44, v44, v45
    v_accvgpr_write_b32 a69, v44
    v_accvgpr_read_b32 v44, a70
    v_mul_f32 v44, v44, v45
    v_accvgpr_write_b32 a70, v44
    v_accvgpr_read_b32 v44, a71
    v_mul_f32 v44, v44, v45
    v_accvgpr_write_b32 a71, v44
    v_accvgpr_read_b32 v44, a72
    v_mul_f32 v44, v44, v45
    v_accvgpr_write_b32 a72, v44
    v_accvgpr_read_b32 v44, a73
    v_mul_f32 v44, v44, v45
    v_accvgpr_write_b32 a73, v44
    v_accvgpr_read_b32 v44, a74
    v_mul_f32 v44, v44, v45
    v_accvgpr_write_b32 a74, v44
    v_accvgpr_read_b32 v44, a75
    v_mul_f32 v44, v44, v45
    v_accvgpr_write_b32 a75, v44
    v_accvgpr_read_b32 v44, a76
    v_mul_f32 v44, v44, v45
    v_accvgpr_write_b32 a76, v44
    v_accvgpr_read_b32 v44, a77
    v_mul_f32 v44, v44, v45
    v_accvgpr_write_b32 a77, v44
    v_accvgpr_read_b32 v44, a78
    v_mul_f32 v44, v44, v45
    v_accvgpr_write_b32 a78, v44
    v_accvgpr_read_b32 v44, a79
    v_mul_f32 v44, v44, v45
    v_accvgpr_write_b32 a79, v44
    v_accvgpr_read_b32 v44, a80
    v_mul_f32 v44, v44, v45
    v_accvgpr_write_b32 a80, v44
    v_accvgpr_read_b32 v44, a81
    v_mul_f32 v44, v44, v45
    v_accvgpr_write_b32 a81, v44
    v_accvgpr_read_b32 v44, a82
    v_mul_f32 v44, v44, v45
    v_accvgpr_write_b32 a82, v44
    v_accvgpr_read_b32 v44, a83
    v_mul_f32 v44, v44, v45
    v_accvgpr_write_b32 a83, v44
    v_accvgpr_read_b32 v44, a84
    v_mul_f32 v44, v44, v45
    v_accvgpr_write_b32 a84, v44
    v_accvgpr_read_b32 v44, a85
    v_mul_f32 v44, v44, v45
    v_accvgpr_write_b32 a85, v44
    v_accvgpr_read_b32 v44, a86
    v_mul_f32 v44, v44, v45
    v_accvgpr_write_b32 a86, v44
    v_accvgpr_read_b32 v44, a87
    v_mul_f32 v44, v44, v45
    v_accvgpr_write_b32 a87, v44
    v_accvgpr_read_b32 v44, a88
    v_mul_f32 v44, v44, v45
    v_accvgpr_write_b32 a88, v44
    v_accvgpr_read_b32 v44, a89
    v_mul_f32 v44, v44, v45
    v_accvgpr_write_b32 a89, v44
    v_accvgpr_read_b32 v44, a90
    v_mul_f32 v44, v44, v45
    v_accvgpr_write_b32 a90, v44
    v_accvgpr_read_b32 v44, a91
    v_mul_f32 v44, v44, v45
    v_accvgpr_write_b32 a91, v44
    v_accvgpr_read_b32 v44, a92
    v_mul_f32 v44, v44, v45
    v_accvgpr_write_b32 a92, v44
    v_accvgpr_read_b32 v44, a93
    v_mul_f32 v44, v44, v45
    v_accvgpr_write_b32 a93, v44
    v_accvgpr_read_b32 v44, a94
    v_mul_f32 v44, v44, v45
    v_accvgpr_write_b32 a94, v44
    v_accvgpr_read_b32 v44, a95
    v_mul_f32 v44, v44, v45
    v_accvgpr_write_b32 a95, v44
    v_exp_f32 v46, v64
    v_exp_f32 v47, v65
    s_nop 0
    v_add_f32 v250, v250, v46
    v_add_f32 v250, v250, v47
    v_cvt_pk_bf16_f32 v120, v46, v47
    v_exp_f32 v46, v66
    v_exp_f32 v47, v67
    s_nop 0
    v_add_f32 v250, v250, v46
    v_add_f32 v250, v250, v47
    v_cvt_pk_bf16_f32 v121, v46, v47
    v_exp_f32 v46, v68
    v_exp_f32 v47, v69
    s_nop 0
    v_add_f32 v250, v250, v46
    v_add_f32 v250, v250, v47
    v_cvt_pk_bf16_f32 v122, v46, v47
    v_exp_f32 v46, v70
    v_exp_f32 v47, v71
    s_nop 0
    v_add_f32 v250, v250, v46
    v_add_f32 v250, v250, v47
    v_cvt_pk_bf16_f32 v123, v46, v47
    v_max_f32 v43, 0, v43
    v_add_f32 v243, v243, v43
    v_sub_f32 v45, 0, v43
    v_exp_f32 v45, v45
    v_sub_f32 v156, 0, v243
    v_sub_f32 v157, 0, v243
    v_sub_f32 v158, 0, v243
    v_sub_f32 v159, 0, v243
    v_sub_f32 v72, v72, v43
    v_sub_f32 v104, v104, v43
    v_sub_f32 v73, v73, v43
    v_sub_f32 v105, v105, v43
    v_sub_f32 v74, v74, v43
    v_sub_f32 v106, v106, v43
    v_sub_f32 v75, v75, v43
    v_sub_f32 v107, v107, v43
    v_sub_f32 v76, v76, v43
    v_sub_f32 v108, v108, v43
    v_sub_f32 v77, v77, v43
    v_sub_f32 v109, v109, v43
    v_sub_f32 v78, v78, v43
    v_sub_f32 v110, v110, v43
    v_sub_f32 v79, v79, v43
    v_sub_f32 v111, v111, v43
    v_mul_f32 v247, v247, v45
    v_mov_b32 v251, 0
    v_accvgpr_read_b32 v44, a96
    v_mul_f32 v44, v44, v45
    v_accvgpr_write_b32 a96, v44
    v_accvgpr_read_b32 v44, a97
    v_mul_f32 v44, v44, v45
    v_accvgpr_write_b32 a97, v44
    v_accvgpr_read_b32 v44, a98
    v_mul_f32 v44, v44, v45
    v_accvgpr_write_b32 a98, v44
    v_accvgpr_read_b32 v44, a99
    v_mul_f32 v44, v44, v45
    v_accvgpr_write_b32 a99, v44
    v_accvgpr_read_b32 v44, a100
    v_mul_f32 v44, v44, v45
    v_accvgpr_write_b32 a100, v44
    v_accvgpr_read_b32 v44, a101
    v_mul_f32 v44, v44, v45
    v_accvgpr_write_b32 a101, v44
    v_accvgpr_read_b32 v44, a102
    v_mul_f32 v44, v44, v45
    v_accvgpr_write_b32 a102, v44
    v_accvgpr_read_b32 v44, a103
    v_mul_f32 v44, v44, v45
    v_accvgpr_write_b32 a103, v44
    v_accvgpr_read_b32 v44, a104
    v_mul_f32 v44, v44, v45
    v_accvgpr_write_b32 a104, v44
    v_accvgpr_read_b32 v44, a105
    v_mul_f32 v44, v44, v45
    v_accvgpr_write_b32 a105, v44
    v_accvgpr_read_b32 v44, a106
    v_mul_f32 v44, v44, v45
    v_accvgpr_write_b32 a106, v44
    v_accvgpr_read_b32 v44, a107
    v_mul_f32 v44, v44, v45
    v_accvgpr_write_b32 a107, v44
    v_accvgpr_read_b32 v44, a108
    v_mul_f32 v44, v44, v45
    v_accvgpr_write_b32 a108, v44
    v_accvgpr_read_b32 v44, a109
    v_mul_f32 v44, v44, v45
    v_accvgpr_write_b32 a109, v44
    v_accvgpr_read_b32 v44, a110
    v_mul_f32 v44, v44, v45
    v_accvgpr_write_b32 a110, v44
    v_accvgpr_read_b32 v44, a111
    v_mul_f32 v44, v44, v45
    v_accvgpr_write_b32 a111, v44
    v_accvgpr_read_b32 v44, a112
    v_mul_f32 v44, v44, v45
    v_accvgpr_write_b32 a112, v44
    v_accvgpr_read_b32 v44, a113
    v_mul_f32 v44, v44, v45
    v_accvgpr_write_b32 a113, v44
    v_accvgpr_read_b32 v44, a114
    v_mul_f32 v44, v44, v45
    v_accvgpr_write_b32 a114, v44
    v_accvgpr_read_b32 v44, a115
    v_mul_f32 v44, v44, v45
    v_accvgpr_write_b32 a115, v44
    v_accvgpr_read_b32 v44, a116
    v_mul_f32 v44, v44, v45
    v_accvgpr_write_b32 a116, v44
    v_accvgpr_read_b32 v44, a117
    v_mul_f32 v44, v44, v45
    v_accvgpr_write_b32 a117, v44
    v_accvgpr_read_b32 v44, a118
    v_mul_f32 v44, v44, v45
    v_accvgpr_write_b32 a118, v44
    v_accvgpr_read_b32 v44, a119
    v_mul_f32 v44, v44, v45
    v_accvgpr_write_b32 a119, v44
    v_accvgpr_read_b32 v44, a120
    v_mul_f32 v44, v44, v45
    v_accvgpr_write_b32 a120, v44
    v_accvgpr_read_b32 v44, a121
    v_mul_f32 v44, v44, v45
    v_accvgpr_write_b32 a121, v44
    v_accvgpr_read_b32 v44, a122
    v_mul_f32 v44, v44, v45
    v_accvgpr_write_b32 a122, v44
    v_accvgpr_read_b32 v44, a123
    v_mul_f32 v44, v44, v45
    v_accvgpr_write_b32 a123, v44
    v_accvgpr_read_b32 v44, a124
    v_mul_f32 v44, v44, v45
    v_accvgpr_write_b32 a124, v44
    v_accvgpr_read_b32 v44, a125
    v_mul_f32 v44, v44, v45
    v_accvgpr_write_b32 a125, v44
    v_accvgpr_read_b32 v44, a126
    v_mul_f32 v44, v44, v45
    v_accvgpr_write_b32 a126, v44
    v_accvgpr_read_b32 v44, a127
    v_mul_f32 v44, v44, v45
    v_accvgpr_write_b32 a127, v44
    v_exp_f32 v46, v72
    v_exp_f32 v47, v73
    s_nop 0
    v_add_f32 v251, v251, v46
    v_add_f32 v251, v251, v47
    v_cvt_pk_bf16_f32 v124, v46, v47
    v_exp_f32 v46, v74
    v_exp_f32 v47, v75
    s_nop 0
    v_add_f32 v251, v251, v46
    v_add_f32 v251, v251, v47
    v_cvt_pk_bf16_f32 v125, v46, v47
    v_exp_f32 v46, v76
    v_exp_f32 v47, v77
    s_nop 0
    v_add_f32 v251, v251, v46
    v_add_f32 v251, v251, v47
    v_cvt_pk_bf16_f32 v126, v46, v47
    v_exp_f32 v46, v78
    v_exp_f32 v47, v79
    s_nop 0
    v_add_f32 v251, v251, v46
    v_add_f32 v251, v251, v47
    v_cvt_pk_bf16_f32 v127, v46, v47
    s_nop 2
    s_setpc_b64 s[32:33]
L_fix_1:
    s_nop 15
    v_max3_f32 v40, v80, v81, v82
    v_max3_f32 v40, v40, v83, v84
    v_max3_f32 v40, v40, v85, v86
    v_max_f32 v40, v40, v87
    v_max3_f32 v41, v88, v89, v90
    v_max3_f32 v41, v41, v91, v92
    v_max3_f32 v41, v41, v93, v94
    v_max_f32 v41, v41, v95
    v_max3_f32 v42, v96, v97, v98
    v_max3_f32 v42, v42, v99, v100
    v_max3_f32 v42, v42, v101, v102
    v_max_f32 v42, v42, v103
    v_max3_f32 v43, v104, v105, v106
    v_max3_f32 v43, v43, v107, v108
    v_max3_f32 v43, v43, v109, v110
    v_max_f32 v43, v43, v111
    v_mov_b32 v44, v40
    v_mov_b32 v45, v41
    v_mov_b32 v46, v42
    v_mov_b32 v47, v43
    v_permlane16_swap_b32 v44, v40
    v_permlane16_swap_b32 v45, v41
    v_permlane16_swap_b32 v46, v42
    v_permlane16_swap_b32 v47, v43
    v_max_f32 v40, v40, v44
    v_max_f32 v41, v41, v45
    v_max_f32 v42, v42, v46
    v_max_f32 v43, v43, v47
    v_mov_b32 v44, v40
    v_mov_b32 v45, v41
    v_mov_b32 v46, v42
    v_mov_b32 v47, v43
    v_permlane32_swap_b32 v44, v40
    v_permlane32_swap_b32 v45, v41
    v_permlane32_swap_b32 v46, v42
    v_permlane32_swap_b32 v47, v43
    v_max_f32 v40, v40, v44
    v_max_f32 v41, v41, v45
    v_max_f32 v42, v42, v46
    v_max_f32 v43, v43, v47
    v_max_f32 v40, 0, v40
    v_add_f32 v240, v240, v40
    v_sub_f32 v45, 0, v40
    v_exp_f32 v45, v45
    v_sub_f32 v144, 0, v240
    v_sub_f32 v145, 0, v240
    v_sub_f32 v146, 0, v240
    v_sub_f32 v147, 0, v240
    v_sub_f32 v80, v80, v40
    v_sub_f32 v48, v48, v40
    v_sub_f32 v81, v81, v40
    v_sub_f32 v49, v49, v40
    v_sub_f32 v82, v82, v40
    v_sub_f32 v50, v50, v40
    v_sub_f32 v83, v83, v40
    v_sub_f32 v51, v51, v40
    v_sub_f32 v84, v84, v40
    v_sub_f32 v52, v52, v40
    v_sub_f32 v85, v85, v40
    v_sub_f32 v53, v53, v40
    v_sub_f32 v86, v86, v40
    v_sub_f32 v54, v54, v40
    v_sub_f32 v87, v87, v40
    v_sub_f32 v55, v55, v40
    v_mul_f32 v244, v244, v45
    v_mov_b32 v4, 0
    v_accvgpr_read_b32 v44, a0
    v_mul_f32 v44, v44, v45
    v_accvgpr_write_b32 a0, v44
    v_accvgpr_read_b32 v44, a1
    v_mul_f32 v44, v44, v45
    v_accvgpr_write_b32 a1, v44
    v_accvgpr_read_b32 v44, a2
    v_mul_f32 v44, v44, v45
    v_accvgpr_write_b32 a2, v44
    v_accvgpr_read_b32 v44, a3
    v_mul_f32 v44, v44, v45
    v_accvgpr_write_b32 a3, v44
    v_accvgpr_read_b32 v44, a4
    v_mul_f32 v44, v44, v45
    v_accvgpr_write_b32 a4, v44
    v_accvgpr_read_b32 v44, a5
    v_mul_f32 v44, v44, v45
    v_accvgpr_write_b32 a5, v44
    v_accvgpr_read_b32 v44, a6
    v_mul_f32 v44, v44, v45
    v_accvgpr_write_b32 a6, v44
    v_accvgpr_read_b32 v44, a7
    v_mul_f32 v44, v44, v45
    v_accvgpr_write_b32 a7, v44
    v_accvgpr_read_b32 v44, a8
    v_mul_f32 v44, v44, v45
    v_accvgpr_write_b32 a8, v44
    v_accvgpr_read_b32 v44, a9
    v_mul_f32 v44, v44, v45
    v_accvgpr_write_b32 a9, v44
    v_accvgpr_read_b32 v44, a10
    v_mul_f32 v44, v44, v45
    v_accvgpr_write_b32 a10, v44
    v_accvgpr_read_b32 v44, a11
    v_mul_f32 v44, v44, v45
    v_accvgpr_write_b32 a11, v44
    v_accvgpr_read_b32 v44, a12
    v_mul_f32 v44, v44, v45
    v_accvgpr_write_b32 a12, v44
    v_accvgpr_read_b32 v44, a13
    v_mul_f32 v44, v44, v45
    v_accvgpr_write_b32 a13, v44
    v_accvgpr_read_b32 v44, a14
    v_mul_f32 v44, v44, v45
    v_accvgpr_write_b32 a14, v44
    v_accvgpr_read_b32 v44, a15
    v_mul_f32 v44, v44, v45
    v_accvgpr_write_b32 a15, v44
    v_accvgpr_read_b32 v44, a16
    v_mul_f32 v44, v44, v45
    v_accvgpr_write_b32 a16, v44
    v_accvgpr_read_b32 v44, a17
    v_mul_f32 v44, v44, v45
    v_accvgpr_write_b32 a17, v44
    v_accvgpr_read_b32 v44, a18
    v_mul_f32 v44, v44, v45
    v_accvgpr_write_b32 a18, v44
    v_accvgpr_read_b32 v44, a19
    v_mul_f32 v44, v44, v45
    v_accvgpr_write_b32 a19, v44
    v_accvgpr_read_b32 v44, a20
    v_mul_f32 v44, v44, v45
    v_accvgpr_write_b32 a20, v44
    v_accvgpr_read_b32 v44, a21
    v_mul_f32 v44, v44, v45
    v_accvgpr_write_b32 a21, v44
    v_accvgpr_read_b32 v44, a22
    v_mul_f32 v44, v44, v45
    v_accvgpr_write_b32 a22, v44
    v_accvgpr_read_b32 v44, a23
    v_mul_f32 v44, v44, v45
    v_accvgpr_write_b32 a23, v44
    v_accvgpr_read_b32 v44, a24
    v_mul_f32 v44, v44, v45
    v_accvgpr_write_b32 a24, v44
    v_accvgpr_read_b32 v44, a25
    v_mul_f32 v44, v44, v45
    v_accvgpr_write_b32 a25, v44
    v_accvgpr_read_b32 v44, a26
    v_mul_f32 v44, v44, v45
    v_accvgpr_write_b32 a26, v44
    v_accvgpr_read_b32 v44, a27
    v_mul_f32 v44, v44, v45
    v_accvgpr_write_b32 a27, v44
    v_accvgpr_read_b32 v44, a28
    v_mul_f32 v44, v44, v45
    v_accvgpr_write_b32 a28, v44
    v_accvgpr_read_b32 v44, a29
    v_mul_f32 v44, v44, v45
    v_accvgpr_write_b32 a29, v44
    v_accvgpr_read_b32 v44, a30
    v_mul_f32 v44, v44, v45
    v_accvgpr_write_b32 a30, v44
    v_accvgpr_read_b32 v44, a31
    v_mul_f32 v44, v44, v45
    v_accvgpr_write_b32 a31, v44
    v_exp_f32 v46, v80
    v_exp_f32 v47, v81
    s_nop 0
    v_add_f32 v4, v4, v46
    v_add_f32 v4, v4, v47
    v_cvt_pk_bf16_f32 v128, v46, v47
    v_exp_f32 v46, v82
    v_exp_f32 v47, v83
    s_nop 0
    v_add_f32 v4, v4, v46
    v_add_f32 v4, v4, v47
    v_cvt_pk_bf16_f32 v129, v46, v47
    v_exp_f32 v46, v84
    v_exp_f32 v47, v85
    s_nop 0
    v_add_f32 v4, v4, v46
    v_add_f32 v4, v4, v47
    v_cvt_pk_bf16_f32 v130, v46, v47
    v_exp_f32 v46, v86
    v_exp_f32 v47, v87
    s_nop 0
    v_add_f32 v4, v4, v46
    v_add_f32 v4, v4, v47
    v_cvt_pk_bf16_f32 v131, v46, v47
    v_max_f32 v41, 0, v41
    v_add_f32 v241, v241, v41
    v_sub_f32 v45, 0, v41
    v_exp_f32 v45, v45
    v_sub_f32 v148, 0, v241
    v_sub_f32 v149, 0, v241
    v_sub_f32 v150, 0, v241
    v_sub_f32 v151, 0, v241
    v_sub_f32 v88, v88, v41
    v_sub_f32 v56, v56, v41
    v_sub_f32 v89, v89, v41
    v_sub_f32 v57, v57, v41
    v_sub_f32 v90, v90, v41
    v_sub_f32 v58, v58, v41
    v_sub_f32 v91, v91, v41
    v_sub_f32 v59, v59, v41
    v_sub_f32 v92, v92, v41
    v_sub_f32 v60, v60, v41
    v_sub_f32 v93, v93, v41
    v_sub_f32 v61, v61, v41
    v_sub_f32 v94, v94, v41
    v_sub_f32 v62, v62, v41
    v_sub_f32 v95, v95, v41
    v_sub_f32 v63, v63, v41
    v_mul_f32 v245, v245, v45
    v_mov_b32 v5, 0
    v_accvgpr_read_b32 v44, a32
    v_mul_f32 v44, v44, v45
    v_accvgpr_write_b32 a32, v44
    v_accvgpr_read_b32 v44, a33
    v_mul_f32 v44, v44, v45
    v_accvgpr_write_b32 a33, v44
    v_accvgpr_read_b32 v44, a34
    v_mul_f32 v44, v44, v45
    v_accvgpr_write_b32 a34, v44
    v_accvgpr_read_b32 v44, a35
    v_mul_f32 v44, v44, v45
    v_accvgpr_write_b32 a35, v44
    v_accvgpr_read_b32 v44, a36
    v_mul_f32 v44, v44, v45
    v_accvgpr_write_b32 a36, v44
    v_accvgpr_read_b32 v44, a37
    v_mul_f32 v44, v44, v45
    v_accvgpr_write_b32 a37, v44
    v_accvgpr_read_b32 v44, a38
    v_mul_f32 v44, v44, v45
    v_accvgpr_write_b32 a38, v44
    v_accvgpr_read_b32 v44, a39
    v_mul_f32 v44, v44, v45
    v_accvgpr_write_b32 a39, v44
    v_accvgpr_read_b32 v44, a40
    v_mul_f32 v44, v44, v45
    v_accvgpr_write_b32 a40, v44
    v_accvgpr_read_b32 v44, a41
    v_mul_f32 v44, v44, v45
    v_accvgpr_write_b32 a41, v44
    v_accvgpr_read_b32 v44, a42
    v_mul_f32 v44, v44, v45
    v_accvgpr_write_b32 a42, v44
    v_accvgpr_read_b32 v44, a43
    v_mul_f32 v44, v44, v45
    v_accvgpr_write_b32 a43, v44
    v_accvgpr_read_b32 v44, a44
    v_mul_f32 v44, v44, v45
    v_accvgpr_write_b32 a44, v44
    v_accvgpr_read_b32 v44, a45
    v_mul_f32 v44, v44, v45
    v_accvgpr_write_b32 a45, v44
    v_accvgpr_read_b32 v44, a46
    v_mul_f32 v44, v44, v45
    v_accvgpr_write_b32 a46, v44
    v_accvgpr_read_b32 v44, a47
    v_mul_f32 v44, v44, v45
    v_accvgpr_write_b32 a47, v44
    v_accvgpr_read_b32 v44, a48
    v_mul_f32 v44, v44, v45
    v_accvgpr_write_b32 a48, v44
    v_accvgpr_read_b32 v44, a49
    v_mul_f32 v44, v44, v45
    v_accvgpr_write_b32 a49, v44
    v_accvgpr_read_b32 v44, a50
    v_mul_f32 v44, v44, v45
    v_accvgpr_write_b32 a50, v44
    v_accvgpr_read_b32 v44, a51
    v_mul_f32 v44, v44, v45
    v_accvgpr_write_b32 a51, v44
    v_accvgpr_read_b32 v44, a52
    v_mul_f32 v44, v44, v45
    v_accvgpr_write_b32 a52, v44
    v_accvgpr_read_b32 v44, a53
    v_mul_f32 v44, v44, v45
    v_accvgpr_write_b32 a53, v44
    v_accvgpr_read_b32 v44, a54
    v_mul_f32 v44, v44, v45
    v_accvgpr_write_b32 a54, v44
    v_accvgpr_read_b32 v44, a55
    v_mul_f32 v44, v44, v45
    v_accvgpr_write_b32 a55, v44
    v_accvgpr_read_b32 v44, a56
    v_mul_f32 v44, v44, v45
    v_accvgpr_write_b32 a56, v44
    v_accvgpr_read_b32 v44, a57
    v_mul_f32 v44, v44, v45
    v_accvgpr_write_b32 a57, v44
    v_accvgpr_read_b32 v44, a58
    v_mul_f32 v44, v44, v45
    v_accvgpr_write_b32 a58, v44
    v_accvgpr_read_b32 v44, a59
    v_mul_f32 v44, v44, v45
    v_accvgpr_write_b32 a59, v44
    v_accvgpr_read_b32 v44, a60
    v_mul_f32 v44, v44, v45
    v_accvgpr_write_b32 a60, v44
    v_accvgpr_read_b32 v44, a61
    v_mul_f32 v44, v44, v45
    v_accvgpr_write_b32 a61, v44
    v_accvgpr_read_b32 v44, a62
    v_mul_f32 v44, v44, v45
    v_accvgpr_write_b32 a62, v44
    v_accvgpr_read_b32 v44, a63
    v_mul_f32 v44, v44, v45
    v_accvgpr_write_b32 a63, v44
    v_exp_f32 v46, v88
    v_exp_f32 v47, v89
    s_nop 0
    v_add_f32 v5, v5, v46
    v_add_f32 v5, v5, v47
    v_cvt_pk_bf16_f32 v132, v46, v47
    v_exp_f32 v46, v90
    v_exp_f32 v47, v91
    s_nop 0
    v_add_f32 v5, v5, v46
    v_add_f32 v5, v5, v47
    v_cvt_pk_bf16_f32 v133, v46, v47
    v_exp_f32 v46, v92
    v_exp_f32 v47, v93
    s_nop 0
    v_add_f32 v5, v5, v46
    v_add_f32 v5, v5, v47
    v_cvt_pk_bf16_f32 v134, v46, v47
    v_exp_f32 v46, v94
    v_exp_f32 v47, v95
    s_nop 0
    v_add_f32 v5, v5, v46
    v_add_f32 v5, v5, v47
    v_cvt_pk_bf16_f32 v135, v46, v47
    v_max_f32 v42, 0, v42
    v_add_f32 v242, v242, v42
    v_sub_f32 v45, 0, v42
    v_exp_f32 v45, v45
    v_sub_f32 v152, 0, v242
    v_sub_f32 v153, 0, v242
    v_sub_f32 v154, 0, v242
    v_sub_f32 v155, 0, v242
    v_sub_f32 v96, v96, v42
    v_sub_f32 v64, v64, v42
    v_sub_f32 v97, v97, v42
    v_sub_f32 v65, v65, v42
    v_sub_f32 v98, v98, v42
    v_sub_f32 v66, v66, v42
    v_sub_f32 v99, v99, v42
    v_sub_f32 v67, v67, v42
    v_sub_f32 v100, v100, v42
    v_sub_f32 v68, v68, v42
    v_sub_f32 v101, v101, v42
    v_sub_f32 v69, v69, v42
    v_sub_f32 v102, v102, v42
    v_sub_f32 v70, v70, v42
    v_sub_f32 v103, v103, v42
    v_sub_f32 v71, v71, v42
    v_mul_f32 v246, v246, v45
    v_mov_b32 v6, 0
    v_accvgpr_read_b32 v44, a64
    v_mul_f32 v44, v44, v45
    v_accvgpr_write_b32 a64, v44
    v_accvgpr_read_b32 v44, a65
    v_mul_f32 v44, v44, v45
    v_accvgpr_write_b32 a65, v44
    v_accvgpr_read_b32 v44, a66
    v_mul_f32 v44, v44, v45
    v_accvgpr_write_b32 a66, v44
    v_accvgpr_read_b32 v44, a67
    v_mul_f32 v44, v44, v45
    v_accvgpr_write_b32 a67, v44
    v_accvgpr_read_b32 v44, a68
    v_mul_f32 v44, v44, v45
    v_accvgpr_write_b32 a68, v44
    v_accvgpr_read_b32 v44, a69
    v_mul_f32 v44, v44, v45
    v_accvgpr_write_b32 a69, v44
    v_accvgpr_read_b32 v44, a70
    v_mul_f32 v44, v44, v45
    v_accvgpr_write_b32 a70, v44
    v_accvgpr_read_b32 v44, a71
    v_mul_f32 v44, v44, v45
    v_accvgpr_write_b32 a71, v44
    v_accvgpr_read_b32 v44, a72
    v_mul_f32 v44, v44, v45
    v_accvgpr_write_b32 a72, v44
    v_accvgpr_read_b32 v44, a73
    v_mul_f32 v44, v44, v45
    v_accvgpr_write_b32 a73, v44
    v_accvgpr_read_b32 v44, a74
    v_mul_f32 v44, v44, v45
    v_accvgpr_write_b32 a74, v44
    v_accvgpr_read_b32 v44, a75
    v_mul_f32 v44, v44, v45
    v_accvgpr_write_b32 a75, v44
    v_accvgpr_read_b32 v44, a76
    v_mul_f32 v44, v44, v45
    v_accvgpr_write_b32 a76, v44
    v_accvgpr_read_b32 v44, a77
    v_mul_f32 v44, v44, v45
    v_accvgpr_write_b32 a77, v44
    v_accvgpr_read_b32 v44, a78
    v_mul_f32 v44, v44, v45
    v_accvgpr_write_b32 a78, v44
    v_accvgpr_read_b32 v44, a79
    v_mul_f32 v44, v44, v45
    v_accvgpr_write_b32 a79, v44
    v_accvgpr_read_b32 v44, a80
    v_mul_f32 v44, v44, v45
    v_accvgpr_write_b32 a80, v44
    v_accvgpr_read_b32 v44, a81
    v_mul_f32 v44, v44, v45
    v_accvgpr_write_b32 a81, v44
    v_accvgpr_read_b32 v44, a82
    v_mul_f32 v44, v44, v45
    v_accvgpr_write_b32 a82, v44
    v_accvgpr_read_b32 v44, a83
    v_mul_f32 v44, v44, v45
    v_accvgpr_write_b32 a83, v44
    v_accvgpr_read_b32 v44, a84
    v_mul_f32 v44, v44, v45
    v_accvgpr_write_b32 a84, v44
    v_accvgpr_read_b32 v44, a85
    v_mul_f32 v44, v44, v45
    v_accvgpr_write_b32 a85, v44
    v_accvgpr_read_b32 v44, a86
    v_mul_f32 v44, v44, v45
    v_accvgpr_write_b32 a86, v44
    v_accvgpr_read_b32 v44, a87
    v_mul_f32 v44, v44, v45
    v_accvgpr_write_b32 a87, v44
    v_accvgpr_read_b32 v44, a88
    v_mul_f32 v44, v44, v45
    v_accvgpr_write_b32 a88, v44
    v_accvgpr_read_b32 v44, a89
    v_mul_f32 v44, v44, v45
    v_accvgpr_write_b32 a89, v44
    v_accvgpr_read_b32 v44, a90
    v_mul_f32 v44, v44, v45
    v_accvgpr_write_b32 a90, v44
    v_accvgpr_read_b32 v44, a91
    v_mul_f32 v44, v44, v45
    v_accvgpr_write_b32 a91, v44
    v_accvgpr_read_b32 v44, a92
    v_mul_f32 v44, v44, v45
    v_accvgpr_write_b32 a92, v44
    v_accvgpr_read_b32 v44, a93
    v_mul_f32 v44, v44, v45
    v_accvgpr_write_b32 a93, v44
    v_accvgpr_read_b32 v44, a94
    v_mul_f32 v44, v44, v45
    v_accvgpr_write_b32 a94, v44
    v_accvgpr_read_b32 v44, a95
    v_mul_f32 v44, v44, v45
    v_accvgpr_write_b32 a95, v44
    v_exp_f32 v46, v96
    v_exp_f32 v47, v97
    s_nop 0
    v_add_f32 v6, v6, v46
    v_add_f32 v6, v6, v47
    v_cvt_pk_bf16_f32 v136, v46, v47
    v_exp_f32 v46, v98
    v_exp_f32 v47, v99
    s_nop 0
    v_add_f32 v6, v6, v46
    v_add_f32 v6, v6, v47
    v_cvt_pk_bf16_f32 v137, v46, v47
    v_exp_f32 v46, v100
    v_exp_f32 v47, v101
    s_nop 0
    v_add_f32 v6, v6, v46
    v_add_f32 v6, v6, v47
    v_cvt_pk_bf16_f32 v138, v46, v47
    v_exp_f32 v46, v102
    v_exp_f32 v47, v103
    s_nop 0
    v_add_f32 v6, v6, v46
    v_add_f32 v6, v6, v47
    v_cvt_pk_bf16_f32 v139, v46, v47
    v_max_f32 v43, 0, v43
    v_add_f32 v243, v243, v43
    v_sub_f32 v45, 0, v43
    v_exp_f32 v45, v45
    v_sub_f32 v156, 0, v243
    v_sub_f32 v157, 0, v243
    v_sub_f32 v158, 0, v243
    v_sub_f32 v159, 0, v243
    v_sub_f32 v104, v104, v43
    v_sub_f32 v72, v72, v43
    v_sub_f32 v105, v105, v43
    v_sub_f32 v73, v73, v43
    v_sub_f32 v106, v106, v43
    v_sub_f32 v74, v74, v43
    v_sub_f32 v107, v107, v43
    v_sub_f32 v75, v75, v43
    v_sub_f32 v108, v108, v43
    v_sub_f32 v76, v76, v43
    v_sub_f32 v109, v109, v43
    v_sub_f32 v77, v77, v43
    v_sub_f32 v110, v110, v43
    v_sub_f32 v78, v78, v43
    v_sub_f32 v111, v111, v43
    v_sub_f32 v79, v79, v43
    v_mul_f32 v247, v247, v45
    v_mov_b32 v7, 0
    v_accvgpr_read_b32 v44, a96
    v_mul_f32 v44, v44, v45
    v_accvgpr_write_b32 a96, v44
    v_accvgpr_read_b32 v44, a97
    v_mul_f32 v44, v44, v45
    v_accvgpr_write_b32 a97, v44
    v_accvgpr_read_b32 v44, a98
    v_mul_f32 v44, v44, v45
    v_accvgpr_write_b32 a98, v44
    v_accvgpr_read_b32 v44, a99
    v_mul_f32 v44, v44, v45
    v_accvgpr_write_b32 a99, v44
    v_accvgpr_read_b32 v44, a100
    v_mul_f32 v44, v44, v45
    v_accvgpr_write_b32 a100, v44
    v_accvgpr_read_b32 v44, a101
    v_mul_f32 v44, v44, v45
    v_accvgpr_write_b32 a101, v44
    v_accvgpr_read_b32 v44, a102
    v_mul_f32 v44, v44, v45
    v_accvgpr_write_b32 a102, v44
    v_accvgpr_read_b32 v44, a103
    v_mul_f32 v44, v44, v45
    v_accvgpr_write_b32 a103, v44
    v_accvgpr_read_b32 v44, a104
    v_mul_f32 v44, v44, v45
    v_accvgpr_write_b32 a104, v44
    v_accvgpr_read_b32 v44, a105
    v_mul_f32 v44, v44, v45
    v_accvgpr_write_b32 a105, v44
    v_accvgpr_read_b32 v44, a106
    v_mul_f32 v44, v44, v45
    v_accvgpr_write_b32 a106, v44
    v_accvgpr_read_b32 v44, a107
    v_mul_f32 v44, v44, v45
    v_accvgpr_write_b32 a107, v44
    v_accvgpr_read_b32 v44, a108
    v_mul_f32 v44, v44, v45
    v_accvgpr_write_b32 a108, v44
    v_accvgpr_read_b32 v44, a109
    v_mul_f32 v44, v44, v45
    v_accvgpr_write_b32 a109, v44
    v_accvgpr_read_b32 v44, a110
    v_mul_f32 v44, v44, v45
    v_accvgpr_write_b32 a110, v44
    v_accvgpr_read_b32 v44, a111
    v_mul_f32 v44, v44, v45
    v_accvgpr_write_b32 a111, v44
    v_accvgpr_read_b32 v44, a112
    v_mul_f32 v44, v44, v45
    v_accvgpr_write_b32 a112, v44
    v_accvgpr_read_b32 v44, a113
    v_mul_f32 v44, v44, v45
    v_accvgpr_write_b32 a113, v44
    v_accvgpr_read_b32 v44, a114
    v_mul_f32 v44, v44, v45
    v_accvgpr_write_b32 a114, v44
    v_accvgpr_read_b32 v44, a115
    v_mul_f32 v44, v44, v45
    v_accvgpr_write_b32 a115, v44
    v_accvgpr_read_b32 v44, a116
    v_mul_f32 v44, v44, v45
    v_accvgpr_write_b32 a116, v44
    v_accvgpr_read_b32 v44, a117
    v_mul_f32 v44, v44, v45
    v_accvgpr_write_b32 a117, v44
    v_accvgpr_read_b32 v44, a118
    v_mul_f32 v44, v44, v45
    v_accvgpr_write_b32 a118, v44
    v_accvgpr_read_b32 v44, a119
    v_mul_f32 v44, v44, v45
    v_accvgpr_write_b32 a119, v44
    v_accvgpr_read_b32 v44, a120
    v_mul_f32 v44, v44, v45
    v_accvgpr_write_b32 a120, v44
    v_accvgpr_read_b32 v44, a121
    v_mul_f32 v44, v44, v45
    v_accvgpr_write_b32 a121, v44
    v_accvgpr_read_b32 v44, a122
    v_mul_f32 v44, v44, v45
    v_accvgpr_write_b32 a122, v44
    v_accvgpr_read_b32 v44, a123
    v_mul_f32 v44, v44, v45
    v_accvgpr_write_b32 a123, v44
    v_accvgpr_read_b32 v44, a124
    v_mul_f32 v44, v44, v45
    v_accvgpr_write_b32 a124, v44
    v_accvgpr_read_b32 v44, a125
    v_mul_f32 v44, v44, v45
    v_accvgpr_write_b32 a125, v44
    v_accvgpr_read_b32 v44, a126
    v_mul_f32 v44, v44, v45
    v_accvgpr_write_b32 a126, v44
    v_accvgpr_read_b32 v44, a127
    v_mul_f32 v44, v44, v45
    v_accvgpr_write_b32 a127, v44
    v_exp_f32 v46, v104
    v_exp_f32 v47, v105
    s_nop 0
    v_add_f32 v7, v7, v46
    v_add_f32 v7, v7, v47
    v_cvt_pk_bf16_f32 v140, v46, v47
    v_exp_f32 v46, v106
    v_exp_f32 v47, v107
    s_nop 0
    v_add_f32 v7, v7, v46
    v_add_f32 v7, v7, v47
    v_cvt_pk_bf16_f32 v141, v46, v47
    v_exp_f32 v46, v108
    v_exp_f32 v47, v109
    s_nop 0
    v_add_f32 v7, v7, v46
    v_add_f32 v7, v7, v47
    v_cvt_pk_bf16_f32 v142, v46, v47
    v_exp_f32 v46, v110
    v_exp_f32 v47, v111
    s_nop 0
    v_add_f32 v7, v7, v46
    v_add_f32 v7, v7, v47
    v_cvt_pk_bf16_f32 v143, v46, v47
    s_nop 2
    s_setpc_b64 s[32:33]
.section .rodata,"a"
.p2align 6
.amdhsa_kernel standalone__gqa_softmax__near_ridge_kernel
  .amdhsa_next_free_vgpr 512
  .amdhsa_next_free_sgpr 102
  .amdhsa_accum_offset 256
  .amdhsa_group_segment_fixed_size 0
  .amdhsa_kernarg_size 48
  .amdhsa_user_sgpr_count 2
  .amdhsa_user_sgpr_kernarg_segment_ptr 1
  .amdhsa_system_sgpr_workgroup_id_x 1
.end_amdhsa_kernel
```
